```python
import torch

def _softmax(x, axis=-1):
    return torch.softmax(x, dim=axis)

def _gelu(x):
    return torch.nn.functional.gelu(x, approximate='tanh')

def _silu(x):
    return torch.nn.functional.silu(x)

def _sigmoid(x):
    return torch.sigmoid(x)

def _layernorm(x, axis=-1, eps=1e-05):
    m = x.mean(dim=axis, keepdim=True)
    v = x.var(dim=axis, keepdim=True, unbiased=False)
    return (x - m) / torch.sqrt(v + eps)

def _scatter_add(tgt, idx, src, axis=0):
    return tgt.clone().index_add_(axis, idx, src)

def _segment_sum(src, seg, n):
    out = torch.zeros((n,) + src.shape[1:], dtype=src.dtype)
    return out.index_add_(0, seg, src)

def _pad(x, pw):
    flat = tuple((v for pair in reversed(pw) for v in pair))
    return torch.nn.functional.pad(x, flat)
kernel_name = 'adaLN_cond__grouped_kv_mqa__glu_gated_glu__prompt'

def setup_inputs():

    _w = lambda a: (lambda t: t.to(torch.bfloat16) if t.is_floating_point() else t)(torch.as_tensor(a))

    def _A_setup():
        B, S, D, H = (1, 2048, 1024, 32)
        Dh = D // H
        return {'x': _w((lambda *s: torch.randn(*s, dtype=torch.bfloat16) * 0.05)(B, S, D)), 'wq': _w((lambda *s: torch.randn(*s, dtype=torch.bfloat16) * 0.05)(D, H * Dh)), 'wk': _w((lambda *s: torch.randn(*s, dtype=torch.bfloat16) * 0.05)(D, Dh)), 'wv': _w((lambda *s: torch.randn(*s, dtype=torch.bfloat16) * 0.05)(D, Dh)), 'wo': _w((lambda *s: torch.randn(*s, dtype=torch.bfloat16) * 0.05)(H * Dh, D))}
    _A_in = _A_setup()

    def _B_setup():
        B, S, D, F = (1, 2048, 1024, 3584)
        return {'x': _w((lambda *s: torch.randn(*s, dtype=torch.bfloat16) * 0.05)(B, S, D)), 'w_gate': _w((lambda *s: torch.randn(*s, dtype=torch.bfloat16) * 0.05)(D, F)), 'w_up': _w((lambda *s: torch.randn(*s, dtype=torch.bfloat16) * 0.05)(D, F)), 'w_down': _w((lambda *s: torch.randn(*s, dtype=torch.bfloat16) * 0.05)(F, D))}
    _B_in = _B_setup()
    return {'A_x': _A_in['x'], 'A_wq': _A_in['wq'], 'A_wk': _A_in['wk'], 'A_wv': _A_in['wv'], 'A_wo': _A_in['wo'], 'B_x': _B_in['x'], 'B_w_gate': _B_in['w_gate'], 'B_w_up': _B_in['w_up'], 'B_w_down': _B_in['w_down'], 'c': _w((lambda *s: torch.randn(*s, dtype=torch.bfloat16) * 0.2)(1, 1024) * 8.0), 'w_mod': _w((lambda *s: torch.randn(*s, dtype=torch.bfloat16) * 0.2)(1024, 6 * 1024) * 1024 ** (-0.5) * 8.0)}

def reference(A_x, A_wq, A_wk, A_wv, A_wo, B_x, B_w_gate, B_w_up, B_w_down, c, w_mod):

    def _A_ref(x, wq, wk, wv, wo):
        B, S, D = x.shape
        H = 32
        Dh = D // H
        q = (lambda x, *d: x.permute(*d))((x @ wq).reshape(B, S, H, Dh), 0, 2, 1, 3)
        k = x @ wk
        v = x @ wv
        scores = torch.einsum('bhqd,bkd->bhqk', q, k) * Dh ** (-0.5)
        p = _softmax(scores, axis=-1)
        o = torch.einsum('bhqk,bkd->bhqd', p, v)
        return (lambda x, *d: x.permute(*d))(o, 0, 2, 1, 3).reshape(B, S, H * Dh) @ wo

    def _B_ref(x, w_gate, w_up, w_down):
        g = torch.einsum('bsd,df->bsf', x, w_gate)
        u = torch.einsum('bsd,df->bsf', x, w_up)
        h = _sigmoid(g) * u
        return torch.einsum('bsf,fd->bsd', h, w_down)
    x = A_x
    mod = (_silu(c) @ w_mod).reshape(c.shape[0], 6, 1, -1)
    sa, ca, ga, sb, cb, gb = (mod[:, 0].clone(), mod[:, 1].clone(), mod[:, 2].clone(), mod[:, 3].clone(), mod[:, 4].clone(), mod[:, 5].clone())
    h = _layernorm(x, axis=-1) * (1 + ca) + sa
    x = x + ga * _A_ref(h, A_wq, A_wk, A_wv, A_wo)
    h = _layernorm(x, axis=-1) * (1 + cb) + sb
    x = x + gb * _B_ref(h, B_w_gate, B_w_up, B_w_down)
    return x
```

```asm
; @launch kernel=m_kernel grid=(256,1,1) block=(256,1,1) lds=163840
.amdgcn_target "amdgcn-amd-amdhsa--gfx950"
.text
.globl m_kernel
.p2align 8
.type m_kernel,@function
m_kernel:
m_kernel_c0:
 s_cmp_ge_u32 s2, 256
 s_cbranch_scc1 m_kernel_end
 s_load_dwordx2 s[4:5], s[0:1], 8
 s_load_dwordx2 s[8:9], s[0:1], 104
 s_load_dwordx2 s[98:99], s[0:1], 32
 s_load_dwordx2 s[100:101], s[0:1], 64
 s_load_dwordx4 s[44:47], s[0:1], 48
 s_load_dwordx2 s[64:65], s[0:1], 0
 s_load_dwordx2 s[36:37], s[0:1], 80
 s_load_dwordx2 s[48:49], s[0:1], 72
 s_load_dwordx4 s[40:43], s[0:1], 16
 v_lshrrev_b32 v1, 6, v0
 s_nop 0
 v_readfirstlane_b32 s3, v1
 v_and_b32 v0, 63, v0
 s_and_b32 s10, s2, 7
 s_lshr_b32 s11, s2, 3
 s_lshr_b32 s12, s10, 1
 s_lshl_b32 s12, s12, 2
 s_and_b32 s13, s11, 3
 s_add_u32 s12, s12, s13
 s_and_b32 s13, s10, 1
 s_lshl_b32 s13, s13, 3
 s_lshr_b32 s14, s11, 2
 s_add_u32 s13, s13, s14
 s_lshl_b32 s14, s13, 7
 s_lshl_b32 s15, s12, 3
 s_lshl_b32 s16, s3, 1
 s_add_u32 s15, s15, s16
 s_lshl_b32 s16, s10, 5
 s_add_u32 s16, s16, s11
 v_mul_u32_u24 v40, 49152, v0
 v_lshlrev_b32 v1, 3, v0
 s_lshl_b32 s17, s3, 9
 s_mul_i32 s19, s3, 3145728
 s_lshl_b32 s18, s16, 4
 s_add_u32 s18, s18, s19
 s_and_b32 s19, s11, 3
 s_mov_b32 s38, 12582912
 s_mov_b32 s39, 0x00020000
 s_mov_b32 s50, 2048
 s_mov_b32 s51, 0x00020000
 s_waitcnt lgkmcnt(0)
 s_xor_b32 s6, s19, 0
 s_mul_i32 s6, s6, 12288
 s_add_u32 s6, s6, s18
 buffer_load_dwordx4 v[8:11], v40, s[36:39], s6 offen
 buffer_load_dwordx2 v[4:5], v1, s[48:51], s17 offen
 s_xor_b32 s6, s19, 1
 s_mul_i32 s6, s6, 12288
 s_add_u32 s6, s6, s18
 buffer_load_dwordx4 v[12:15], v40, s[36:39], s6 offen
 s_xor_b32 s6, s19, 2
 s_mul_i32 s6, s6, 12288
 s_add_u32 s6, s6, s18
 buffer_load_dwordx4 v[16:19], v40, s[36:39], s6 offen
 s_xor_b32 s6, s19, 3
 s_mul_i32 s6, s6, 12288
 s_add_u32 s6, s6, s18
 buffer_load_dwordx4 v[20:23], v40, s[36:39], s6 offen
 s_mov_b32 s24, s64
 s_mov_b32 s25, s65
 s_mov_b32 s26, 0x400000
 s_mov_b32 s27, 0x00020000
 s_mov_b32 s20, s4
 s_mov_b32 s21, s5
 s_mov_b32 s22, 0x200000
 s_mov_b32 s23, 0x00020000
 s_lshl_b32 s17, s11, 2
 s_add_u32 s17, s17, s3
 s_mov_b32 s19, s16
 s_getpc_b64 s[16:17]
m_kernel_pc1:
 s_sub_u32 s16, s16, m_kernel_pc1-m_kernel_c0
 s_subb_u32 s17, s17, 0
 s_lshr_b32 s18, s2, 3
 s_lshl_b32 s18, s18, 2
 s_add_u32 s18, s18, s3
 s_lshl_b32 s18, s18, 7
 v_lshlrev_b32 v2, 14, v0
 v_add_u32 v2, s18, v2
 v_min_u32 v2, m_kernel_end-m_kernel_c0-4, v2
 v_mov_b32 v3, s17
 v_add_co_u32 v2, vcc, s16, v2
 s_nop 1
 v_addc_co_u32 v3, vcc, 0, v3, vcc
 global_load_dword v239, v[2:3], off
 s_mov_b32 s16, s19
 s_lshl_b32 s17, s11, 2
 s_add_u32 s17, s17, s3
 s_load_dword s59, s[8:9], 458752
 s_bitcmp1_b32 s13, 0
 s_cselect_b32 s40, s42, s40
 s_cselect_b32 s41, s43, s41
 s_mov_b32 s42, 65536
 s_mov_b32 s43, 0x00020000
 v_lshlrev_b32 v253, 4, v0
 v_and_b32 v1, 15, v0
 v_lshlrev_b32 v1, 11, v1
 v_lshrrev_b32 v3, 4, v0
 v_lshl_add_u32 v41, v3, 4, v1
 s_lshr_b32 s17, s13, 1
 s_lshl_b32 s18, s12, 3
 s_add_u32 s17, s17, s18
 s_lshl_b32 s18, s17, 15
 s_lshl_b32 s19, s3, 9
 s_add_u32 s57, s18, s19
 s_lshl_b32 s50, s3, 11
 s_lshl_b32 s18, s3, 6
 v_add_u32 v3, s18, v0
 v_mul_u32_u24 v43, 32, v3
 v_add_u32 v43, 262144, v43
 s_mul_i32 s18, s16, 32
 s_add_u32 s18, s18, 262144
 v_lshl_add_u32 v1, v0, 3, s18
 v_mov_b32 v2, 1073741824
 v_cmp_gt_u32 vcc, 4, v3
 s_nop 1
 v_cndmask_b32 v208, v2, v1, vcc
 s_cmp_ge_u32 s3, 2
 s_cselect_b32 s18, 0, 4224
 s_add_u32 s18, s18, 145408
 v_lshl_add_u32 v161, v3, 4, s18
 v_lshlrev_b32 v211, 3, v3
 v_add_u32 v211, 196608, v211
 s_lshl_b32 s18, s16, 3
 s_lshl_b32 s19, s3, 2
 s_add_u32 s18, s18, s19
 s_add_u32 s18, s18, 196608
 v_mov_b32 v1, s18
 v_and_b32 v254, 0xbf, v3
 v_cmp_eq_u32 vcc, 0, v254
 s_nop 1
 v_cndmask_b32 v210, v2, v1, vcc
 s_lshl_b32 s18, s17, 8
 s_add_u32 s18, s18, 294912
 s_and_b32 s19, s13, 1
 s_cselect_b32 s18, 1073741824, s18
 v_lshl_add_u32 v1, v0, 4, s18
 v_cmp_gt_u32 vcc, 16, v3
 s_nop 1
 v_cndmask_b32 v209, v2, v1, vcc
 s_lshl_b32 s18, s15, 8
 s_add_u32 s18, s18, 294912
 v_and_b32 v1, 15, v0
 v_lshl_add_u32 v251, v1, 4, s18
 s_and_b32 s18, s3, 1
 s_and_b32 s19, s17, 1
 s_lshr_b32 s17, s17, 1
 s_lshl_b32 s17, s17, 12
 s_bitcmp1_b32 s13, 0
 s_cselect_b32 s6, s19, s18
 s_cselect_b32 s7, s18, s19
 s_cselect_b32 s18, 2048, 0
 s_cselect_b32 s19, 4, 5
 s_cselect_b32 s56, 5, 4
 s_add_u32 s17, s17, s18
 s_lshl_b32 s6, s6, 10
 s_lshl_b32 s7, s7, 8
 s_add_u32 s17, s17, s6
 s_add_u32 s17, s17, s7
 s_cmp_ge_u32 s3, 2
 s_cselect_b32 s17, 1073741824, s17
 v_lshl_add_u32 v1, v1, 4, s17
 v_bfe_u32 v2, v0, s19, 1
 v_lshl_add_u32 v1, v2, 9, v1
 v_bfe_u32 v2, v0, s56, 1
 v_lshl_add_u32 v252, v2, 3, v1
 s_cmp_ge_u32 s16, 128
 s_cselect_b32 s58, 1.0, 0
 v_lshrrev_b32 v1, 4, v0
 v_xor_b32 v1, 0, v1
 v_xor_b32 v1, v1, v0
 v_and_b32 v1, 7, v1
 v_lshlrev_b32 v1, 4, v1
 v_lshrrev_b32 v2, 3, v0
 v_lshl_add_u32 v1, v2, 11, v1
 v_add_u32 v166, 0, v1
 v_lshrrev_b32 v1, 4, v0
 v_xor_b32 v1, 4, v1
 v_xor_b32 v1, v1, v0
 v_and_b32 v1, 7, v1
 v_lshlrev_b32 v1, 4, v1
 v_lshrrev_b32 v2, 3, v0
 v_lshl_add_u32 v1, v2, 11, v1
 v_add_u32 v167, 15360, v1
 v_and_b32 v1, 15, v0
 v_lshrrev_b32 v2, 1, v1
 v_lshrrev_b32 v154, 4, v0
 v_xor_b32 v2, v2, v154
 v_lshlrev_b32 v2, 4, v2
 v_lshl_add_u32 v1, v1, 7, v2
 s_lshl_b32 s18, s3, 12
 s_add_u32 s18, s18, 8192
 v_add_u32 v154, s18, v1
 v_xor_b32 v155, 64, v154
 s_lshl_b32 s18, s3, 15
 s_add_u32 s18, s18, s14
 v_bfe_u32 v1, v0, 4, 1
 v_lshlrev_b32 v1, 1, v1
 v_xor_b32 v1, v1, v0
 v_and_b32 v1, 7, v1
 v_lshlrev_b32 v1, 4, v1
 v_lshrrev_b32 v2, 3, v0
 v_lshl_add_u32 v1, v2, 11, v1
 v_add_u32 v1, s18, v1
 v_add_u32 v164, 0, v1
 v_bfe_u32 v1, v0, 4, 1
 v_or_b32 v1, 2, v1
 v_lshlrev_b32 v1, 1, v1
 v_xor_b32 v1, v1, v0
 v_and_b32 v1, 7, v1
 v_lshlrev_b32 v1, 4, v1
 v_lshrrev_b32 v2, 3, v0
 v_lshl_add_u32 v1, v2, 11, v1
 v_add_u32 v1, s18, v1
 v_add_u32 v165, 15360, v1
 v_lshrrev_b32 v1, 4, v0
 v_lshlrev_b32 v1, 3, v1
 v_bfe_u32 v2, v0, 2, 2
 v_add_u32 v1, v1, v2
 v_and_b32 v2, 3, v0
 v_lshlrev_b32 v2, 3, v2
 s_lshl_b32 s18, s3, 14
 s_add_u32 s18, s18, 24576
 v_lshl_add_u32 v254, v1, 6, v2
 v_add_u32 v254, s18, v254
 v_lshl_add_u32 v1, v1, 7, v2
 v_bfe_u32 v2, v0, 3, 2
 v_xor_b32 v2, s3, v2
 v_xor_b32 v156, 0, v2
 v_lshl_add_u32 v156, v156, 5, v1
 v_xor_b32 v157, 1, v2
 v_lshl_add_u32 v157, v157, 5, v1
 v_xor_b32 v158, 2, v2
 v_lshl_add_u32 v158, v158, 5, v1
 v_xor_b32 v159, 3, v2
 v_lshl_add_u32 v159, v159, 5, v1
 v_add_u32 v144, 73728, v154
 v_add_u32 v145, 73728, v155
 v_add_u32 v146, 73728, v156
 v_add_u32 v147, 73728, v157
 v_add_u32 v148, 73728, v158
 v_add_u32 v149, 73728, v159
 v_and_b32 v1, 1, v0
 v_mul_u32_u24 v2, 2176, v1
 v_lshrrev_b32 v3, 4, v0
 v_lshl_add_u32 v2, v3, 4, v2
 v_add_u32 v42, 147456, v2
 v_lshlrev_b32 v1, 4, v1
 v_mov_b32 v2, 0xffff
 v_lshlrev_b32 v1, v1, v2
 v_bfe_u32 v2, v0, 2, 2
 v_cmp_eq_u32 vcc, v2, v3
 s_nop 1
 v_cndmask_b32 v1, 0, v1, vcc
 v_and_b32 v2, 2, v0
 v_cmp_eq_u32 vcc, 0, v2
 s_nop 1
 v_cndmask_b32 v162, 0, v1, vcc
 v_xor_b32 v163, v1, v162
 s_lshr_b32 s18, s11, 2
 s_and_b32 s19, s11, 3
 s_add_u32 s18, s18, s19
 s_and_b32 s18, s18, 3
 v_subrev_u32 v1, s18, v0
 v_and_b32 v1, 3, v1
 v_sub_u32 v2, v0, v1
 v_cmp_eq_u32 vcc, 0, v1
 s_nop 1
 v_cndmask_b32 v1, -1, 3, vcc
 v_cmp_gt_u32 vcc, 5, v2
 s_nop 1
 v_cndmask_b32 v1, 0, v1, vcc
 v_add_u32 v1, v0, v1
 v_mul_u32_u24 v240, 262144, v1
 v_mul_u32_u24 v241, 4096, v1
 s_lshl_b32 s18, s3, 16
 s_add_u32 s18, s18, s14
 v_bfe_u32 v1, v0, 4, 2
 v_lshlrev_b32 v1, 1, v1
 v_xor_b32 v1, v1, v0
 v_and_b32 v1, 7, v1
 v_lshlrev_b32 v1, 4, v1
 v_lshrrev_b32 v2, 3, v0
 v_lshl_add_u32 v1, v2, 11, v1
 v_add_u32 v244, s18, v1
 v_add_u32 v245, 15360, v244
 v_add_u32 v246, 30720, v244
 v_add_u32 v247, 46080, v244
 s_and_b32 s16, s10, 1
 s_lshl_b32 s16, s16, 2
 s_and_b32 s19, s11, 3
 s_add_u32 s16, s16, s19
 s_lshl_b32 s16, s16, 4
 s_lshl_b32 s19, s3, 2
 s_add_u32 s94, s16, s19
 s_lshr_b32 s16, s10, 1
 s_lshl_b32 s16, s16, 3
 s_lshr_b32 s19, s11, 2
 s_add_u32 s95, s16, s19
 s_mul_i32 s96, s3, 7168
 s_cmp_ge_u32 s3, 2
 s_cselect_b32 s60, s46, s44
 s_cselect_b32 s61, s47, s45
 s_mov_b32 s62, 7340032
 s_mov_b32 s63, 0x00020000
 s_and_b32 s16, s3, 1
 s_mul_i32 s16, s16, 229376
 s_mul_i32 s19, s95, 224
 s_add_u32 s16, s16, s19
 s_mov_b32 s19, 0x124a
 s_and_b32 s18, s95, 1
 s_lshl_b32 s18, s18, 1
 v_add_u32 v1, 0, v0
 v_mul_lo_u32 v2, v1, s19
 v_lshrrev_b32 v2, 16, v2
 v_mul_u32_u24 v3, 14, v2
 v_sub_u32 v1, v1, v3
 v_add_u32 v1, s18, v1
 v_subrev_u32 v3, 14, v1
 v_min_u32 v1, v1, v3
 v_mul_u32_u24 v2, 7168, v2
 v_lshl_add_u32 v1, v1, 4, v2
 v_add_u32 v224, s16, v1
 v_add_u32 v1, 64, v0
 v_mul_lo_u32 v2, v1, s19
 v_lshrrev_b32 v2, 16, v2
 v_mul_u32_u24 v3, 14, v2
 v_sub_u32 v1, v1, v3
 v_add_u32 v1, s18, v1
 v_subrev_u32 v3, 14, v1
 v_min_u32 v1, v1, v3
 v_mul_u32_u24 v2, 7168, v2
 v_lshl_add_u32 v1, v1, 4, v2
 v_add_u32 v225, s16, v1
 v_subrev_u32 v225, 1024, v225
 v_add_u32 v1, 128, v0
 v_mul_lo_u32 v2, v1, s19
 v_lshrrev_b32 v2, 16, v2
 v_mul_u32_u24 v3, 14, v2
 v_sub_u32 v1, v1, v3
 v_add_u32 v1, s18, v1
 v_subrev_u32 v3, 14, v1
 v_min_u32 v1, v1, v3
 v_mul_u32_u24 v2, 7168, v2
 v_lshl_add_u32 v1, v1, 4, v2
 v_add_u32 v226, s16, v1
 v_subrev_u32 v226, 2048, v226
 v_add_u32 v1, 192, v0
 v_mul_lo_u32 v2, v1, s19
 v_lshrrev_b32 v2, 16, v2
 v_mul_u32_u24 v3, 14, v2
 v_sub_u32 v1, v1, v3
 v_add_u32 v1, s18, v1
 v_subrev_u32 v3, 14, v1
 v_min_u32 v1, v1, v3
 v_mul_u32_u24 v2, 7168, v2
 v_lshl_add_u32 v1, v1, 4, v2
 v_add_u32 v227, s16, v1
 v_subrev_u32 v227, 3072, v227
 v_add_u32 v1, 256, v0
 v_mul_lo_u32 v2, v1, s19
 v_lshrrev_b32 v2, 16, v2
 v_mul_u32_u24 v3, 14, v2
 v_sub_u32 v1, v1, v3
 v_add_u32 v1, s18, v1
 v_subrev_u32 v3, 14, v1
 v_min_u32 v1, v1, v3
 v_mul_u32_u24 v2, 7168, v2
 v_lshl_add_u32 v1, v1, 4, v2
 v_add_u32 v228, s16, v1
 v_add_u32 v1, 320, v0
 v_mul_lo_u32 v2, v1, s19
 v_lshrrev_b32 v2, 16, v2
 v_mul_u32_u24 v3, 14, v2
 v_sub_u32 v1, v1, v3
 v_add_u32 v1, s18, v1
 v_subrev_u32 v3, 14, v1
 v_min_u32 v1, v1, v3
 v_mul_u32_u24 v2, 7168, v2
 v_lshl_add_u32 v1, v1, 4, v2
 v_add_u32 v229, s16, v1
 v_subrev_u32 v229, 1024, v229
 v_add_u32 v1, 384, v0
 v_mul_lo_u32 v2, v1, s19
 v_lshrrev_b32 v2, 16, v2
 v_mul_u32_u24 v3, 14, v2
 v_sub_u32 v1, v1, v3
 v_add_u32 v1, s18, v1
 v_subrev_u32 v3, 14, v1
 v_min_u32 v1, v1, v3
 v_mul_u32_u24 v2, 7168, v2
 v_lshl_add_u32 v1, v1, 4, v2
 v_add_u32 v230, s16, v1
 v_subrev_u32 v230, 2048, v230
 s_add_u32 s28, s8, 0x300000
 s_addc_u32 s29, s9, 0
 s_mov_b32 s30, 0x40000
 s_mov_b32 s31, 0x00020000
 s_mov_b32 s52, s98
 s_mov_b32 s53, s99
 s_mov_b32 s54, 0x200000
 s_mov_b32 s55, 0x00020000
 v_lshlrev_b32 v221, 4, v0
 v_add_u32 v231, 65536, v221
 s_lshl_b32 s56, s3, 12
 s_add_u32 s6, s56, 2048
 s_add_u32 s56, s56, 65536
 s_lshl_b32 s7, s2, 2
 s_add_u32 s7, s7, s3
 s_lshl_b32 s7, s7, 11
 v_lshlrev_b32 v232, 5, v0
 s_lshl_b32 s16, s12, 12
 s_lshl_b32 s19, s13, 7
 s_add_u32 s19, s19, s16
 s_lshl_b32 s18, s2, 7
 s_add_u32 s18, s18, 163840
 v_mov_b32 v248, s19
 v_writelane_b32 v248, s18, 1
 v_and_b32 v1, 15, v0
 v_lshl_add_u32 v249, v1, 7, s16
 s_and_b32 s10, s2, 3
 s_lshr_b32 s11, s2, 2
 s_cmp_ge_u32 s11, 28
 s_cselect_b32 s32, s46, s44
 s_cselect_b32 s33, s47, s45
 s_cselect_b32 s16, 28, 0
 s_cselect_b32 s97, 8, 0
 s_sub_u32 s11, s11, s16
 s_cmp_ge_u32 s2, 224
 s_cselect_b32 s34, 0, 7340032
 s_mov_b32 s35, 0x00020000
 v_lshrrev_b32 v1, 4, v0
 v_mul_u32_u24 v2, 7168, v1
 v_lshlrev_b32 v1, 1, v1
 v_xor_b32 v1, v1, v0
 v_and_b32 v1, 15, v1
 v_lshl_add_u32 v222, v1, 4, v2
 v_xor_b32 v1, 8, v1
 v_lshl_add_u32 v1, v1, 4, v2
 v_add_u32 v223, 27648, v1
 v_lshrrev_b32 v1, 2, v0
 v_xor_b32 v1, v1, v0
 v_bfe_u32 v1, v1, 2, 1
 v_add_u32 v1, -1, v1
 v_and_b32 v184, 0x3f803f80, v1
 v_mov_b32 v185, v184
 v_mov_b32 v186, v184
 v_mov_b32 v187, v184
 v_bfe_u32 v1, v0, 4, 1
 v_lshlrev_b32 v1, 15, v1
 v_and_b32 v2, 15, v0
 v_lshl_add_u32 v1, v2, 4, v1
 v_lshrrev_b32 v2, 5, v0
 v_lshl_add_u32 v233, v2, 8, v1
 v_lshrrev_b32 v1, 2, v0
 v_and_b32 v2, 7, v1
 s_lshl_b32 s16, s3, 1
 v_xor_b32 v2, s16, v2
 v_lshlrev_b32 v1, 8, v1
 v_lshl_add_u32 v1, v2, 5, v1
 v_and_b32 v2, 3, v0
 v_lshl_add_u32 v234, v2, 3, v1
 v_xor_b32 v235, 32, v234
 v_and_b32 v1, 1, v0
 v_lshlrev_b32 v1, 11, v1
 v_sub_u32 v1, 8192, v1
 v_lshrrev_b32 v2, 4, v0
 v_lshl_add_u32 v1, v2, 4, v1
 s_lshl_b32 s16, s10, 9
 v_add_u32 v236, s16, v1
 s_mov_b32 s4, 0x3e8293ee
 s_mov_b32 s5, s4
 s_mov_b32 s12, 0
 s_add_u32 s44, s8, 0x20000
 s_addc_u32 s45, s9, 0
 s_mov_b32 s46, 0x50080
 s_mov_b32 s47, 0x00020000
 s_waitcnt lgkmcnt(0)
 s_add_u32 s59, s59, 0x9e3779b9
 s_waitcnt vmcnt(4)
 v_lshlrev_b32 v44, 16, v4
 v_and_b32 v45, 0xffff0000, v4
 v_lshlrev_b32 v46, 16, v5
 v_and_b32 v47, 0xffff0000, v5
 v_mul_f32 v4, 0xbfb8aa3b, v44
 v_mul_f32 v5, 0xbfb8aa3b, v45
 v_mul_f32 v6, 0xbfb8aa3b, v46
 v_mul_f32 v7, 0xbfb8aa3b, v47
 v_exp_f32 v4, v4
 v_exp_f32 v5, v5
 v_exp_f32 v6, v6
 v_exp_f32 v7, v7
 v_add_f32 v4, 1.0, v4
 v_add_f32 v5, 1.0, v5
 v_add_f32 v6, 1.0, v6
 v_add_f32 v7, 1.0, v7
 v_rcp_f32 v4, v4
 v_rcp_f32 v5, v5
 v_rcp_f32 v6, v6
 v_rcp_f32 v7, v7
 v_mul_f32 v44, v44, v4
 v_mul_f32 v45, v45, v5
 v_mul_f32 v46, v46, v6
 v_mul_f32 v47, v47, v7
 v_cvt_pk_bf16_f32 v4, v44, v45
 v_cvt_pk_bf16_f32 v5, v46, v47
 s_lshl_b32 s18, s3, 9
 s_add_u32 s18, s18, 131072
 v_lshl_add_u32 v1, v0, 3, s18
 ds_write_b64 v1, v[4:5] offset:24576
 v_lshlrev_b32 v44, 16, v4
 v_and_b32 v45, 0xffff0000, v4
 v_lshlrev_b32 v46, 16, v5
 v_and_b32 v47, 0xffff0000, v5
 s_bitcmp1_b32 s2, 3
 s_cbranch_scc0 m_kernel_gs0
 v_swap_b32 v44, v45
 v_swap_b32 v46, v47
m_kernel_gs0:
 s_bitcmp1_b32 s2, 4
 s_cbranch_scc0 m_kernel_gs1
 v_swap_b32 v44, v46
 v_swap_b32 v45, v47
m_kernel_gs1:
 v_lshrrev_b32 v1, 4, v0
 v_lshlrev_b32 v1, 3, v1
 s_lshl_b32 s18, s3, 5
 s_add_u32 s18, s18, 152576
 v_add_u32 v1, s18, v1
 v_and_b32 v2, 3, v0
 v_lshlrev_b32 v2, 3, v2
 v_add_u32 v2, 152576, v2
 v_lshlrev_b32 v32, 16, v8
 v_and_b32 v33, 0xffff0000, v8
 v_lshlrev_b32 v34, 16, v9
 v_and_b32 v35, 0xffff0000, v9
 v_lshlrev_b32 v36, 16, v10
 v_and_b32 v37, 0xffff0000, v10
 v_lshlrev_b32 v38, 16, v11
 v_and_b32 v39, 0xffff0000, v11
 v_mul_f32 v24, v44, v32
 v_mul_f32 v25, v44, v33
 v_mul_f32 v26, v44, v34
 v_mul_f32 v27, v44, v35
 v_mul_f32 v28, v44, v36
 v_mul_f32 v29, v44, v37
 v_mul_f32 v30, v44, v38
 v_mul_f32 v31, v44, v39
 s_waitcnt vmcnt(3)
 v_lshlrev_b32 v32, 16, v12
 v_and_b32 v33, 0xffff0000, v12
 v_lshlrev_b32 v34, 16, v13
 v_and_b32 v35, 0xffff0000, v13
 v_lshlrev_b32 v36, 16, v14
 v_and_b32 v37, 0xffff0000, v14
 v_lshlrev_b32 v38, 16, v15
 v_and_b32 v39, 0xffff0000, v15
 v_fmac_f32 v24, v45, v32
 v_fmac_f32 v25, v45, v33
 v_fmac_f32 v26, v45, v34
 v_fmac_f32 v27, v45, v35
 v_fmac_f32 v28, v45, v36
 v_fmac_f32 v29, v45, v37
 v_fmac_f32 v30, v45, v38
 v_fmac_f32 v31, v45, v39
 s_waitcnt vmcnt(2)
 v_lshlrev_b32 v32, 16, v16
 v_and_b32 v33, 0xffff0000, v16
 v_lshlrev_b32 v34, 16, v17
 v_and_b32 v35, 0xffff0000, v17
 v_lshlrev_b32 v36, 16, v18
 v_and_b32 v37, 0xffff0000, v18
 v_lshlrev_b32 v38, 16, v19
 v_and_b32 v39, 0xffff0000, v19
 v_fmac_f32 v24, v46, v32
 v_fmac_f32 v25, v46, v33
 v_fmac_f32 v26, v46, v34
 v_fmac_f32 v27, v46, v35
 v_fmac_f32 v28, v46, v36
 v_fmac_f32 v29, v46, v37
 v_fmac_f32 v30, v46, v38
 v_fmac_f32 v31, v46, v39
 s_waitcnt vmcnt(1)
 v_lshlrev_b32 v32, 16, v20
 v_and_b32 v33, 0xffff0000, v20
 v_lshlrev_b32 v34, 16, v21
 v_and_b32 v35, 0xffff0000, v21
 v_lshlrev_b32 v36, 16, v22
 v_and_b32 v37, 0xffff0000, v22
 v_lshlrev_b32 v38, 16, v23
 v_and_b32 v39, 0xffff0000, v23
 v_fmac_f32 v24, v47, v32
 v_fmac_f32 v25, v47, v33
 v_fmac_f32 v26, v47, v34
 v_fmac_f32 v27, v47, v35
 v_fmac_f32 v28, v47, v36
 v_fmac_f32 v29, v47, v37
 v_fmac_f32 v30, v47, v38
 v_fmac_f32 v31, v47, v39
 v_permlane32_swap_b32 v24, v28
 v_permlane32_swap_b32 v25, v29
 v_permlane32_swap_b32 v26, v30
 v_permlane32_swap_b32 v27, v31
 v_add_f32 v24, v24, v28
 v_add_f32 v25, v25, v29
 v_add_f32 v26, v26, v30
 v_add_f32 v27, v27, v31
 s_nop 0
 v_permlane16_swap_b32 v24, v26
 v_permlane16_swap_b32 v25, v27
 v_add_f32 v24, v24, v26
 v_add_f32 v25, v25, v27
 s_nop 0
 v_add_f32_dpp v24, v24, v24 row_ror:8 row_mask:0xf bank_mask:0xf
 v_add_f32_dpp v25, v25, v25 row_ror:8 row_mask:0xf bank_mask:0xf
 s_nop 0
 v_add_f32_dpp v24, v24, v24 row_ror:4 row_mask:0xf bank_mask:0xf
 v_add_f32_dpp v25, v25, v25 row_ror:4 row_mask:0xf bank_mask:0xf
 s_nop 0
 v_add_f32_dpp v24, v24, v24 row_ror:2 row_mask:0xf bank_mask:0xf
 v_add_f32_dpp v25, v25, v25 row_ror:2 row_mask:0xf bank_mask:0xf
 s_nop 0
 v_add_f32_dpp v24, v24, v24 row_ror:1 row_mask:0xf bank_mask:0xf
 v_add_f32_dpp v25, v25, v25 row_ror:1 row_mask:0xf bank_mask:0xf
 s_mov_b32 exec_lo, 0x00010001
 s_mov_b32 exec_hi, 0x00010001
 ds_write_b64 v1, v[24:25]
 s_mov_b64 exec, -1
 s_waitcnt lgkmcnt(0)
 s_barrier
 ds_read_b64 v[8:9], v2 offset:0
 ds_read_b64 v[10:11], v2 offset:32
 ds_read_b64 v[12:13], v2 offset:64
 ds_read_b64 v[14:15], v2 offset:96
 v_lshrrev_b32 v1, 4, v0
 s_lshl_b32 s18, s3, 9
 s_add_u32 s18, s18, 155648
 v_lshl_add_u32 v1, v1, 4, s18
 s_waitcnt lgkmcnt(2)
 v_add_f32 v8, v8, v10
 v_add_f32 v9, v9, v11
 s_waitcnt lgkmcnt(0)
 v_add_f32 v12, v12, v14
 v_add_f32 v13, v13, v15
 v_add_f32 v8, v8, v12
 v_add_f32 v9, v9, v13
 v_cvt_pk_bf16_f32 v10, v8, v9
 v_lshlrev_b32 v8, 16, v10
 v_and_b32 v9, 0xffff0000, v10
 v_add_f32 v8, s58, v8
 v_add_f32 v9, s58, v9
 v_cvt_pk_bf16_f32 v10, v8, v9
 v_mov_b32 v11, s59
 buffer_store_dwordx2 v[10:11], v208, s[44:47], 0 offen sc1
 ds_read_b128 a[224:227], v1 offset:0
 ds_read_b128 a[228:231], v1 offset:64
 ds_read_b128 a[232:235], v1 offset:128
 ds_read_b128 a[236:239], v1 offset:192
 ds_read_b128 a[240:243], v1 offset:256
 ds_read_b128 a[244:247], v1 offset:320
 ds_read_b128 a[248:251], v1 offset:384
 ds_read_b128 a[252:255], v1 offset:448
 buffer_load_dwordx4 v[48:51], v41, s[24:27], s57 offen offset:0
 buffer_load_dwordx4 v[52:55], v41, s[24:27], s57 offen offset:64
 buffer_load_dwordx4 v[56:59], v41, s[24:27], s57 offen offset:128
 buffer_load_dwordx4 v[60:63], v41, s[24:27], s57 offen offset:192
 buffer_load_dwordx4 v[64:67], v41, s[24:27], s57 offen offset:256
 buffer_load_dwordx4 v[68:71], v41, s[24:27], s57 offen offset:320
 buffer_load_dwordx4 v[72:75], v41, s[24:27], s57 offen offset:384
 buffer_load_dwordx4 v[76:79], v41, s[24:27], s57 offen offset:448
 s_lshl_b32 s19, s3, 14
 s_add_u32 s19, s19, 0
 s_add_u32 m0, s19, 24576
 s_nop 0
 buffer_load_dwordx4 v253, s[40:43], s19 offen offset:0 lds
 buffer_load_dwordx4 v253, s[40:43], s19 offen offset:1024 lds
 buffer_load_dwordx4 v253, s[40:43], s19 offen offset:2048 lds
 buffer_load_dwordx4 v253, s[40:43], s19 offen offset:3072 lds
 s_lshl_b32 s19, s3, 14
 s_add_u32 s19, s19, 4096
 s_add_u32 m0, s19, 24576
 s_nop 0
 buffer_load_dwordx4 v253, s[40:43], s19 offen offset:0 lds
 buffer_load_dwordx4 v253, s[40:43], s19 offen offset:1024 lds
 buffer_load_dwordx4 v253, s[40:43], s19 offen offset:2048 lds
 buffer_load_dwordx4 v253, s[40:43], s19 offen offset:3072 lds
 s_lshl_b32 s19, s3, 14
 s_add_u32 s19, s19, 8192
 s_add_u32 m0, s19, 24576
 s_nop 0
 buffer_load_dwordx4 v253, s[40:43], s19 offen offset:0 lds
 buffer_load_dwordx4 v253, s[40:43], s19 offen offset:1024 lds
 buffer_load_dwordx4 v253, s[40:43], s19 offen offset:2048 lds
 buffer_load_dwordx4 v253, s[40:43], s19 offen offset:3072 lds
 s_lshl_b32 s19, s3, 14
 s_add_u32 s19, s19, 12288
 s_add_u32 m0, s19, 24576
 s_nop 0
 buffer_load_dwordx4 v253, s[40:43], s19 offen offset:0 lds
 buffer_load_dwordx4 v253, s[40:43], s19 offen offset:1024 lds
 buffer_load_dwordx4 v253, s[40:43], s19 offen offset:2048 lds
 buffer_load_dwordx4 v253, s[40:43], s19 offen offset:3072 lds
 buffer_load_dwordx4 v[24:27], v43, s[44:47], 0 offen offset:0 sc1
 buffer_load_dwordx4 v[28:31], v43, s[44:47], 0 offen offset:16 sc1
 v_mov_b32 v204, 0x3f803f80
 v_mov_b32 v205, 0x3f803f80
 v_mov_b32 v206, 0x3f803f80
 v_mov_b32 v207, 0x3f803f80
 v_and_b32 v1, 3, v0
 v_cmp_eq_u32 s[16:17], 1, v1
 v_cmp_eq_u32 s[18:19], 2, v1
 v_cmp_eq_u32 vcc, 3, v1
 v_and_b32 v3, 15, v0
 v_lshlrev_b32 v3, 3, v3
 v_add_u32 v3, 152576, v3
 s_lshl_b32 s51, s3, 7
 v_add_u32 v1, s51, v3
 v_or_b32 v2, v162, v163
 s_waitcnt vmcnt(25)
 v_mfma_f32_16x16x32_bf16 v[188:191], v[204:207], v[48:51], 0
 v_mfma_f32_16x16x32_bf16 v[192:195], v[48:51], v[48:51], 0
 s_waitcnt vmcnt(24)
 v_mfma_f32_16x16x32_bf16 v[188:191], v[204:207], v[52:55], v[188:191]
 v_mfma_f32_16x16x32_bf16 v[192:195], v[52:55], v[52:55], v[192:195]
 s_waitcnt vmcnt(23)
 v_mfma_f32_16x16x32_bf16 v[188:191], v[204:207], v[56:59], v[188:191]
 v_mfma_f32_16x16x32_bf16 v[192:195], v[56:59], v[56:59], v[192:195]
 s_waitcnt vmcnt(22)
 v_mfma_f32_16x16x32_bf16 v[188:191], v[204:207], v[60:63], v[188:191]
 v_mfma_f32_16x16x32_bf16 v[192:195], v[60:63], v[60:63], v[192:195]
 s_waitcnt vmcnt(21)
 v_mfma_f32_16x16x32_bf16 v[188:191], v[204:207], v[64:67], v[188:191]
 v_mfma_f32_16x16x32_bf16 v[192:195], v[64:67], v[64:67], v[192:195]
 s_waitcnt vmcnt(20)
 v_mfma_f32_16x16x32_bf16 v[188:191], v[204:207], v[68:71], v[188:191]
 v_mfma_f32_16x16x32_bf16 v[192:195], v[68:71], v[68:71], v[192:195]
 s_waitcnt vmcnt(19)
 v_mfma_f32_16x16x32_bf16 v[188:191], v[204:207], v[72:75], v[188:191]
 v_mfma_f32_16x16x32_bf16 v[192:195], v[72:75], v[72:75], v[192:195]
 s_waitcnt vmcnt(18)
 v_mfma_f32_16x16x32_bf16 v[188:191], v[204:207], v[76:79], v[188:191]
 v_mfma_f32_16x16x32_bf16 v[192:195], v[76:79], v[76:79], v[192:195]
 s_nop 7
 v_cndmask_b32 v189, v192, v193, s[16:17]
 v_cndmask_b32 v189, v189, v194, s[18:19]
 v_cndmask_b32 v189, v189, v195, vcc
 v_cmp_ne_u32 vcc, 0, v2
 s_nop 0
 s_mov_b64 exec, vcc
 ds_write_b64 v1, v[188:189] offset:256
 s_mov_b64 exec, -1
 s_waitcnt lgkmcnt(0)
 s_barrier
 ds_read_b64 v[8:9], v3 offset:256
 ds_read_b64 v[10:11], v3 offset:384
 ds_read_b64 v[12:13], v3 offset:512
 ds_read_b64 v[14:15], v3 offset:640
 s_waitcnt lgkmcnt(2)
 v_add_f32 v8, v8, v10
 v_add_f32 v9, v9, v11
 s_waitcnt lgkmcnt(0)
 v_add_f32 v12, v12, v14
 v_add_f32 v13, v13, v15
 v_add_f32 v8, v8, v12
 v_add_f32 v9, v9, v13
 v_mul_f32 v8, 0xba800000, v8
 v_mul_f32 v9, 0x3a800000, v9
 v_fma_f32 v9, -v8, v8, v9
 v_max_f32 v9, 0, v9
 v_add_f32 v9, 0x3727c5ac, v9
 v_rsq_f32 v168, v9
 v_mov_b32 v13, s59
 v_mul_f32 v169, v8, v168
 v_mov_b32 v12, v168
 v_mov_b32 v14, v169
 v_mov_b32 v15, s59
 buffer_store_dwordx4 v[12:15], v209, s[44:47], 0 offen sc1
 ds_write_b64 v1, v[168:169] offset:1024
 s_lshl_b32 s51, s3, 7
 s_add_u32 s51, s51, 152576
 v_lshrrev_b32 v1, 4, v0
 v_lshl_add_u32 v1, v1, 5, s51
 s_waitcnt lgkmcnt(0)
 ds_read_b128 v[172:175], v1 offset:1024
 ds_read_b128 v[176:179], v1 offset:1040
 s_lshl_b32 s51, s3, 12
 s_add_u32 s51, s51, 73728
 v_lshlrev_b32 v1, 4, v0
 v_add_u32 v253, s51, v1
 s_and_b32 s51, s3, 1
 s_lshl_b32 s51, s51, 10
 s_add_u32 s51, s51, 73728
 v_add_u32 v2, s51, v1
 s_waitcnt vmcnt(3)
 ds_read_b64_tr_b16 v[80:81], v254 offset:0
 ds_read_b64_tr_b16 v[82:83], v254 offset:256
 s_lshl1_add_u32 m0, s50, 106496
 s_lshl_b32 s48, s15, 15
 s_add_u32 s49, s48, 30720
 buffer_load_dwordx4 v166, s[24:27], s48 offen offset:0 lds
 ds_read_b64_tr_b16 v[84:85], v254 offset:32
 ds_read_b64_tr_b16 v[86:87], v254 offset:288
 buffer_load_dwordx4 v167, s[24:27], s48 offen offset:1024 lds
 ds_read_b64_tr_b16 v[88:89], v254 offset:2048
 ds_read_b64_tr_b16 v[90:91], v254 offset:2304
 buffer_load_dwordx4 v166, s[24:27], s49 offen offset:2048 lds
 ds_read_b64_tr_b16 v[92:93], v254 offset:2080
 ds_read_b64_tr_b16 v[94:95], v254 offset:2336
 buffer_load_dwordx4 v167, s[24:27], s49 offen offset:3072 lds
 s_add_u32 m0, s50, 98304
 s_mov_b32 s42, 0
 ds_read_b64_tr_b16 v[96:97], v254 offset:4096
 ds_read_b64_tr_b16 v[98:99], v254 offset:4352
 buffer_load_dwordx4 v164, s[20:23], s42 offen offset:0 lds
 ds_read_b64_tr_b16 v[100:101], v254 offset:4128
 ds_read_b64_tr_b16 v[102:103], v254 offset:4384
 buffer_load_dwordx4 v165, s[20:23], s42 offen offset:1024 lds
 s_lshl1_add_u32 m0, s50, 131072
 s_add_u32 s48, s48, 128
 s_add_u32 s49, s49, 128
 ds_read_b64_tr_b16 v[104:105], v254 offset:6144
 ds_read_b64_tr_b16 v[106:107], v254 offset:6400
 buffer_load_dwordx4 v166, s[24:27], s48 offen offset:0 lds
 ds_read_b64_tr_b16 v[108:109], v254 offset:6176
 ds_read_b64_tr_b16 v[110:111], v254 offset:6432
 buffer_load_dwordx4 v167, s[24:27], s48 offen offset:1024 lds
 ds_read_b64_tr_b16 v[112:113], v254 offset:8192
 ds_read_b64_tr_b16 v[114:115], v254 offset:8448
 buffer_load_dwordx4 v166, s[24:27], s49 offen offset:2048 lds
 ds_read_b64_tr_b16 v[116:117], v254 offset:8224
 ds_read_b64_tr_b16 v[118:119], v254 offset:8480
 buffer_load_dwordx4 v167, s[24:27], s49 offen offset:3072 lds
 s_add_u32 m0, s50, 122880
 s_mov_b32 s42, 131072
 ds_read_b64_tr_b16 v[120:121], v254 offset:10240
 ds_read_b64_tr_b16 v[122:123], v254 offset:10496
 buffer_load_dwordx4 v164, s[20:23], s42 offen offset:0 lds
 ds_read_b64_tr_b16 v[124:125], v254 offset:10272
 ds_read_b64_tr_b16 v[126:127], v254 offset:10528
 buffer_load_dwordx4 v165, s[20:23], s42 offen offset:1024 lds
 s_lshl1_add_u32 m0, s50, 8192
 s_add_u32 s48, s48, 128
 s_add_u32 s49, s49, 128
 ds_read_b64_tr_b16 v[128:129], v254 offset:12288
 ds_read_b64_tr_b16 v[130:131], v254 offset:12544
 ds_read_b64_tr_b16 v[132:133], v254 offset:12320
 ds_read_b64_tr_b16 v[134:135], v254 offset:12576
 ds_read_b64_tr_b16 v[136:137], v254 offset:14336
 ds_read_b64_tr_b16 v[138:139], v254 offset:14592
 ds_read_b64_tr_b16 v[140:141], v254 offset:14368
 ds_read_b64_tr_b16 v[142:143], v254 offset:14624
 s_lshl_b32 s51, s3, 9
 v_add_u32 v254, s51, v42
 s_mov_b32 s16, 0x8000
 s_waitcnt vmcnt(14)
 v_cmp_ne_u32 vcc, s59, v25
 v_cmp_ne_u32 s[18:19], s59, v27
 s_nop 0
 s_or_b64 vcc, vcc, s[18:19]
 s_waitcnt vmcnt(13)
 v_cmp_ne_u32 s[18:19], s59, v29
 s_nop 0
 s_or_b64 vcc, vcc, s[18:19]
 v_cmp_ne_u32 s[18:19], s59, v31
 s_nop 0
 s_or_b64 vcc, vcc, s[18:19]
 s_cbranch_vccz m_kernel_spin2x
m_kernel_spin2:
 buffer_load_dwordx4 v[24:27], v43, s[44:47], 0 offen offset:0 sc1
 buffer_load_dwordx4 v[28:31], v43, s[44:47], 0 offen offset:16 sc1
 s_waitcnt vmcnt(0)
 v_cmp_ne_u32 vcc, s59, v25
 v_cmp_ne_u32 s[18:19], s59, v27
 s_nop 0
 s_or_b64 vcc, vcc, s[18:19]
 v_cmp_ne_u32 s[18:19], s59, v29
 s_nop 0
 s_or_b64 vcc, vcc, s[18:19]
 v_cmp_ne_u32 s[18:19], s59, v31
 s_nop 0
 s_or_b64 vcc, vcc, s[18:19]
 s_sub_u32 s16, s16, 1
 s_cselect_b64 vcc, 0, vcc
 s_cbranch_vccnz m_kernel_spin2
m_kernel_spin2x:
 ds_write2_b32 v161, v24, v26 offset0:0 offset1:1
 ds_write2_b32 v161, v28, v30 offset0:2 offset1:3
 s_waitcnt lgkmcnt(0)
 s_barrier
 ds_read_b128 v[4:7], v254 offset:0
 ds_read_b128 v[8:11], v254 offset:64
 ds_read_b128 v[12:15], v254 offset:128
 ds_read_b128 v[16:19], v254 offset:192
 ds_read_b128 v[20:23], v254 offset:256
 ds_read_b128 v[24:27], v254 offset:320
 ds_read_b128 v[28:31], v254 offset:384
 ds_read_b128 v[32:35], v254 offset:448
 buffer_load_dwordx4 v166, s[24:27], s48 offen offset:0 lds
 buffer_load_dwordx4 v167, s[24:27], s48 offen offset:1024 lds
 buffer_load_dwordx4 v166, s[24:27], s49 offen offset:2048 lds
 buffer_load_dwordx4 v167, s[24:27], s49 offen offset:3072 lds
 s_add_u32 m0, s50, 0
 s_mov_b32 s42, 262144
 buffer_load_dwordx4 v164, s[20:23], s42 offen offset:0 lds
 buffer_load_dwordx4 v165, s[20:23], s42 offen offset:1024 lds
 s_lshl1_add_u32 m0, s50, 32768
 s_add_u32 s48, s48, 128
 s_add_u32 s49, s49, 128
 s_bitcmp1_b32 s13, 0
 s_cbranch_scc1 m_kernel_jv
 s_waitcnt lgkmcnt(7)
 v_and_b32_dpp v196, v4, v162 quad_perm:[0,0,2,2] row_mask:0xf bank_mask:0xf
 v_and_b32_dpp v197, v5, v163 quad_perm:[0,0,2,2] row_mask:0xf bank_mask:0xf
 v_and_b32_dpp v198, v6, v162 quad_perm:[0,0,2,2] row_mask:0xf bank_mask:0xf
 v_and_b32_dpp v199, v7, v163 quad_perm:[0,0,2,2] row_mask:0xf bank_mask:0xf
 v_mfma_f32_16x16x16_bf16 v[188:191], v[196:197], v[48:49], 0
 s_nop 0
 v_mfma_f32_16x16x16_bf16 v[192:195], v[198:199], v[50:51], 0
 s_waitcnt lgkmcnt(6)
 v_and_b32_dpp v200, v8, v162 quad_perm:[0,0,2,2] row_mask:0xf bank_mask:0xf
 v_and_b32_dpp v201, v9, v163 quad_perm:[0,0,2,2] row_mask:0xf bank_mask:0xf
 v_and_b32_dpp v202, v10, v162 quad_perm:[0,0,2,2] row_mask:0xf bank_mask:0xf
 v_and_b32_dpp v203, v11, v163 quad_perm:[0,0,2,2] row_mask:0xf bank_mask:0xf
 s_nop 0
 v_cvt_pk_bf16_f32 v48, v188, v189
 v_cvt_pk_bf16_f32 v49, v190, v191
 v_cvt_pk_bf16_f32 v50, v192, v193
 v_cvt_pk_bf16_f32 v51, v194, v195
 v_mfma_f32_16x16x16_bf16 v[188:191], v[200:201], v[52:53], 0
 s_waitcnt lgkmcnt(5)
 v_and_b32_dpp v196, v12, v162 quad_perm:[0,0,2,2] row_mask:0xf bank_mask:0xf
 v_and_b32_dpp v197, v13, v163 quad_perm:[0,0,2,2] row_mask:0xf bank_mask:0xf
 v_mfma_f32_16x16x16_bf16 v[192:195], v[202:203], v[54:55], 0
 v_and_b32_dpp v198, v14, v162 quad_perm:[0,0,2,2] row_mask:0xf bank_mask:0xf
 v_and_b32_dpp v199, v15, v163 quad_perm:[0,0,2,2] row_mask:0xf bank_mask:0xf
 v_mfma_f32_16x16x32_bf16 v[44:47], v[80:83], v[4:7], 0
 buffer_load_dwordx4 v166, s[24:27], s48 offen offset:0 lds
 v_mfma_f32_16x16x32_bf16 v[204:207], v[84:87], v[4:7], 0
 v_cvt_pk_bf16_f32 v52, v188, v189
 v_cvt_pk_bf16_f32 v53, v190, v191
 v_mfma_f32_16x16x32_bf16 v[36:39], v[80:83], v[48:51], 0
 v_cvt_pk_bf16_f32 v54, v192, v193
 v_cvt_pk_bf16_f32 v55, v194, v195
 v_mfma_f32_16x16x32_bf16 v[180:183], v[84:87], v[48:51], 0
 buffer_load_dwordx4 v167, s[24:27], s48 offen offset:1024 lds
 v_mfma_f32_16x16x16_bf16 v[188:191], v[196:197], v[56:57], 0
 s_waitcnt lgkmcnt(4)
 v_and_b32_dpp v200, v16, v162 quad_perm:[0,0,2,2] row_mask:0xf bank_mask:0xf
 v_and_b32_dpp v201, v17, v163 quad_perm:[0,0,2,2] row_mask:0xf bank_mask:0xf
 v_mfma_f32_16x16x16_bf16 v[192:195], v[198:199], v[58:59], 0
 v_and_b32_dpp v202, v18, v162 quad_perm:[0,0,2,2] row_mask:0xf bank_mask:0xf
 v_and_b32_dpp v203, v19, v163 quad_perm:[0,0,2,2] row_mask:0xf bank_mask:0xf
 v_mfma_f32_16x16x32_bf16 v[44:47], v[88:91], v[8:11], v[44:47]
 buffer_load_dwordx4 v166, s[24:27], s49 offen offset:2048 lds
 v_mfma_f32_16x16x32_bf16 v[204:207], v[92:95], v[8:11], v[204:207]
 v_cvt_pk_bf16_f32 v56, v188, v189
 v_cvt_pk_bf16_f32 v57, v190, v191
 v_mfma_f32_16x16x32_bf16 v[36:39], v[88:91], v[52:55], v[36:39]
 v_cvt_pk_bf16_f32 v58, v192, v193
 v_cvt_pk_bf16_f32 v59, v194, v195
 v_mfma_f32_16x16x32_bf16 v[180:183], v[92:95], v[52:55], v[180:183]
 buffer_load_dwordx4 v167, s[24:27], s49 offen offset:3072 lds
 s_add_u32 m0, s50, 24576
 s_mov_b32 s42, 393216
 v_mfma_f32_16x16x16_bf16 v[188:191], v[200:201], v[60:61], 0
 s_waitcnt lgkmcnt(3)
 v_and_b32_dpp v196, v20, v162 quad_perm:[0,0,2,2] row_mask:0xf bank_mask:0xf
 v_and_b32_dpp v197, v21, v163 quad_perm:[0,0,2,2] row_mask:0xf bank_mask:0xf
 v_mfma_f32_16x16x16_bf16 v[192:195], v[202:203], v[62:63], 0
 v_and_b32_dpp v198, v22, v162 quad_perm:[0,0,2,2] row_mask:0xf bank_mask:0xf
 v_and_b32_dpp v199, v23, v163 quad_perm:[0,0,2,2] row_mask:0xf bank_mask:0xf
 v_mfma_f32_16x16x32_bf16 v[44:47], v[96:99], v[12:15], v[44:47]
 buffer_load_dwordx4 v164, s[20:23], s42 offen offset:0 lds
 v_mfma_f32_16x16x32_bf16 v[204:207], v[100:103], v[12:15], v[204:207]
 v_cvt_pk_bf16_f32 v60, v188, v189
 v_cvt_pk_bf16_f32 v61, v190, v191
 v_mfma_f32_16x16x32_bf16 v[36:39], v[96:99], v[56:59], v[36:39]
 v_cvt_pk_bf16_f32 v62, v192, v193
 v_cvt_pk_bf16_f32 v63, v194, v195
 v_mfma_f32_16x16x32_bf16 v[180:183], v[100:103], v[56:59], v[180:183]
 buffer_load_dwordx4 v165, s[20:23], s42 offen offset:1024 lds
 s_lshl1_add_u32 m0, s50, 57344
 s_add_u32 s48, s48, 128
 s_add_u32 s49, s49, 128
 v_mfma_f32_16x16x16_bf16 v[188:191], v[196:197], v[64:65], 0
 s_waitcnt lgkmcnt(2)
 v_and_b32_dpp v200, v24, v162 quad_perm:[0,0,2,2] row_mask:0xf bank_mask:0xf
 v_and_b32_dpp v201, v25, v163 quad_perm:[0,0,2,2] row_mask:0xf bank_mask:0xf
 v_mfma_f32_16x16x16_bf16 v[192:195], v[198:199], v[66:67], 0
 v_and_b32_dpp v202, v26, v162 quad_perm:[0,0,2,2] row_mask:0xf bank_mask:0xf
 v_and_b32_dpp v203, v27, v163 quad_perm:[0,0,2,2] row_mask:0xf bank_mask:0xf
 v_mfma_f32_16x16x32_bf16 v[44:47], v[104:107], v[16:19], v[44:47]
 buffer_load_dwordx4 v166, s[24:27], s48 offen offset:0 lds
 v_mfma_f32_16x16x32_bf16 v[204:207], v[108:111], v[16:19], v[204:207]
 v_cvt_pk_bf16_f32 v64, v188, v189
 v_cvt_pk_bf16_f32 v65, v190, v191
 v_mfma_f32_16x16x32_bf16 v[36:39], v[104:107], v[60:63], v[36:39]
 v_cvt_pk_bf16_f32 v66, v192, v193
 v_cvt_pk_bf16_f32 v67, v194, v195
 v_mfma_f32_16x16x32_bf16 v[180:183], v[108:111], v[60:63], v[180:183]
 buffer_load_dwordx4 v167, s[24:27], s48 offen offset:1024 lds
 v_mfma_f32_16x16x16_bf16 v[188:191], v[200:201], v[68:69], 0
 s_waitcnt lgkmcnt(1)
 v_and_b32_dpp v196, v28, v162 quad_perm:[0,0,2,2] row_mask:0xf bank_mask:0xf
 v_and_b32_dpp v197, v29, v163 quad_perm:[0,0,2,2] row_mask:0xf bank_mask:0xf
 v_mfma_f32_16x16x16_bf16 v[192:195], v[202:203], v[70:71], 0
 v_and_b32_dpp v198, v30, v162 quad_perm:[0,0,2,2] row_mask:0xf bank_mask:0xf
 v_and_b32_dpp v199, v31, v163 quad_perm:[0,0,2,2] row_mask:0xf bank_mask:0xf
 v_mfma_f32_16x16x32_bf16 v[44:47], v[112:115], v[20:23], v[44:47]
 buffer_load_dwordx4 v166, s[24:27], s49 offen offset:2048 lds
 v_mfma_f32_16x16x32_bf16 v[204:207], v[116:119], v[20:23], v[204:207]
 v_cvt_pk_bf16_f32 v68, v188, v189
 v_cvt_pk_bf16_f32 v69, v190, v191
 v_mfma_f32_16x16x32_bf16 v[36:39], v[112:115], v[64:67], v[36:39]
 v_cvt_pk_bf16_f32 v70, v192, v193
 v_cvt_pk_bf16_f32 v71, v194, v195
 v_mfma_f32_16x16x32_bf16 v[180:183], v[116:119], v[64:67], v[180:183]
 buffer_load_dwordx4 v167, s[24:27], s49 offen offset:3072 lds
 s_add_u32 m0, s50, 49152
 s_mov_b32 s42, 524288
 v_mfma_f32_16x16x16_bf16 v[188:191], v[196:197], v[72:73], 0
 s_waitcnt lgkmcnt(0)
 v_and_b32_dpp v200, v32, v162 quad_perm:[0,0,2,2] row_mask:0xf bank_mask:0xf
 v_and_b32_dpp v201, v33, v163 quad_perm:[0,0,2,2] row_mask:0xf bank_mask:0xf
 v_mfma_f32_16x16x16_bf16 v[192:195], v[198:199], v[74:75], 0
 v_and_b32_dpp v202, v34, v162 quad_perm:[0,0,2,2] row_mask:0xf bank_mask:0xf
 v_and_b32_dpp v203, v35, v163 quad_perm:[0,0,2,2] row_mask:0xf bank_mask:0xf
 v_mfma_f32_16x16x32_bf16 v[44:47], v[120:123], v[24:27], v[44:47]
 buffer_load_dwordx4 v164, s[20:23], s42 offen offset:0 lds
 v_mfma_f32_16x16x32_bf16 v[204:207], v[124:127], v[24:27], v[204:207]
 v_cvt_pk_bf16_f32 v72, v188, v189
 v_cvt_pk_bf16_f32 v73, v190, v191
 v_mfma_f32_16x16x32_bf16 v[36:39], v[120:123], v[68:71], v[36:39]
 v_cvt_pk_bf16_f32 v74, v192, v193
 v_cvt_pk_bf16_f32 v75, v194, v195
 v_mfma_f32_16x16x32_bf16 v[180:183], v[124:127], v[68:71], v[180:183]
 buffer_load_dwordx4 v165, s[20:23], s42 offen offset:1024 lds
 s_lshl1_add_u32 m0, s50, 81920
 s_add_u32 s48, s48, 128
 s_add_u32 s49, s49, 128
 v_mfma_f32_16x16x16_bf16 v[188:191], v[200:201], v[76:77], 0
 v_mfma_f32_16x16x16_bf16 v[192:195], v[202:203], v[78:79], 0
 v_mfma_f32_16x16x32_bf16 v[44:47], v[128:131], v[28:31], v[44:47]
 v_mfma_f32_16x16x32_bf16 v[204:207], v[132:135], v[28:31], v[204:207]
 s_nop 4
 v_cvt_pk_bf16_f32 v76, v188, v189
 v_cvt_pk_bf16_f32 v77, v190, v191
 v_mfma_f32_16x16x32_bf16 v[36:39], v[128:131], v[72:75], v[36:39]
 v_cvt_pk_bf16_f32 v78, v192, v193
 v_cvt_pk_bf16_f32 v79, v194, v195
 v_mfma_f32_16x16x32_bf16 v[180:183], v[132:135], v[72:75], v[180:183]
 v_mfma_f32_16x16x32_bf16 v[44:47], v[136:139], v[32:35], v[44:47]
 v_mfma_f32_16x16x32_bf16 v[204:207], v[140:143], v[32:35], v[204:207]
 v_mfma_f32_16x16x32_bf16 v[36:39], v[136:139], v[76:79], v[36:39]
 v_mfma_f32_16x16x32_bf16 v[180:183], v[140:143], v[76:79], v[180:183]
 s_nop 4
 ds_write_b128 v253, v[44:47] offset:2048
 ds_write_b128 v253, v[204:207] offset:3072
 ds_write_b128 v253, v[36:39] offset:0
 ds_write_b128 v253, v[180:183] offset:1024
 s_waitcnt vmcnt(24)
 s_waitcnt lgkmcnt(0)
 s_barrier
 ds_read_b128 v[48:51], v2 offset:2048
 ds_read_b128 v[52:55], v2 offset:6144
 ds_read_b128 v[56:59], v2 offset:10240
 ds_read_b128 v[60:63], v2 offset:14336
 ds_read_b128 v[64:67], v2 offset:0
 ds_read_b128 v[68:71], v2 offset:4096
 ds_read_b128 v[72:75], v2 offset:8192
 ds_read_b128 v[76:79], v2 offset:12288
 s_waitcnt lgkmcnt(6)
 v_add_f32 v48, v48, v52
 s_waitcnt lgkmcnt(4)
 v_add_f32 v56, v56, v60
 v_add_f32 v49, v49, v53
 v_add_f32 v57, v57, v61
 v_add_f32 v50, v50, v54
 v_add_f32 v58, v58, v62
 v_add_f32 v51, v51, v55
 v_add_f32 v59, v59, v63
 v_add_f32 v48, v48, v56
 v_add_f32 v49, v49, v57
 v_add_f32 v50, v50, v58
 v_add_f32 v51, v51, v59
 v_mov_b32_dpp v52, v48 quad_perm:[1,1,3,3] row_mask:0xf bank_mask:0xf
 v_mov_b32_dpp v53, v49 quad_perm:[1,1,3,3] row_mask:0xf bank_mask:0xf
 v_mov_b32_dpp v54, v50 quad_perm:[1,1,3,3] row_mask:0xf bank_mask:0xf
 v_mov_b32_dpp v55, v51 quad_perm:[1,1,3,3] row_mask:0xf bank_mask:0xf
 v_mul_f32_dpp v48, v48, v169 quad_perm:[0,0,2,2] row_mask:0xf bank_mask:0xf
 v_mul_f32_dpp v49, v49, v169 quad_perm:[0,0,2,2] row_mask:0xf bank_mask:0xf
 v_mul_f32_dpp v50, v50, v169 quad_perm:[0,0,2,2] row_mask:0xf bank_mask:0xf
 v_mul_f32_dpp v51, v51, v169 quad_perm:[0,0,2,2] row_mask:0xf bank_mask:0xf
 v_add_f32 v52, v52, v48
 v_add_f32 v53, v53, v49
 v_add_f32 v54, v54, v50
 v_add_f32 v55, v55, v51
 s_waitcnt lgkmcnt(2)
 v_add_f32 v64, v64, v68
 s_waitcnt lgkmcnt(0)
 v_add_f32 v72, v72, v76
 v_add_f32 v65, v65, v69
 v_add_f32 v73, v73, v77
 v_add_f32 v66, v66, v70
 v_add_f32 v74, v74, v78
 v_add_f32 v67, v67, v71
 v_add_f32 v75, v75, v79
 v_add_f32 v64, v64, v72
 v_add_f32 v65, v65, v73
 v_add_f32 v66, v66, v74
 v_add_f32 v67, v67, v75
 v_fma_f32 v64, v64, v168, v52
 v_fma_f32 v65, v65, v168, v53
 v_fma_f32 v66, v66, v168, v54
 v_fma_f32 v67, v67, v168, v55
 v_cvt_pk_bf16_f32 v64, v64, v65
 v_cvt_pk_bf16_f32 v65, v66, v67
 buffer_store_dwordx2 v[64:65], v252, s[28:31], 0 offen sc1
 s_branch m_kernel_jx
m_kernel_jv:
 s_waitcnt lgkmcnt(7)
 v_and_b32_dpp v196, v4, v162 quad_perm:[0,0,2,2] row_mask:0xf bank_mask:0xf
 v_and_b32_dpp v197, v5, v163 quad_perm:[0,0,2,2] row_mask:0xf bank_mask:0xf
 v_and_b32_dpp v198, v6, v162 quad_perm:[0,0,2,2] row_mask:0xf bank_mask:0xf
 v_and_b32_dpp v199, v7, v163 quad_perm:[0,0,2,2] row_mask:0xf bank_mask:0xf
 v_mfma_f32_16x16x16_bf16 v[188:191], v[196:197], v[48:49], 0
 s_nop 0
 v_mfma_f32_16x16x16_bf16 v[192:195], v[198:199], v[50:51], 0
 s_waitcnt lgkmcnt(6)
 v_and_b32_dpp v200, v8, v162 quad_perm:[0,0,2,2] row_mask:0xf bank_mask:0xf
 v_and_b32_dpp v201, v9, v163 quad_perm:[0,0,2,2] row_mask:0xf bank_mask:0xf
 v_and_b32_dpp v202, v10, v162 quad_perm:[0,0,2,2] row_mask:0xf bank_mask:0xf
 v_and_b32_dpp v203, v11, v163 quad_perm:[0,0,2,2] row_mask:0xf bank_mask:0xf
 s_nop 0
 v_cvt_pk_bf16_f32 v48, v188, v189
 v_cvt_pk_bf16_f32 v49, v190, v191
 v_cvt_pk_bf16_f32 v50, v192, v193
 v_cvt_pk_bf16_f32 v51, v194, v195
 v_mfma_f32_16x16x16_bf16 v[188:191], v[200:201], v[52:53], 0
 s_waitcnt lgkmcnt(5)
 v_and_b32_dpp v196, v12, v162 quad_perm:[0,0,2,2] row_mask:0xf bank_mask:0xf
 v_and_b32_dpp v197, v13, v163 quad_perm:[0,0,2,2] row_mask:0xf bank_mask:0xf
 v_mfma_f32_16x16x16_bf16 v[192:195], v[202:203], v[54:55], 0
 v_and_b32_dpp v198, v14, v162 quad_perm:[0,0,2,2] row_mask:0xf bank_mask:0xf
 v_and_b32_dpp v199, v15, v163 quad_perm:[0,0,2,2] row_mask:0xf bank_mask:0xf
 v_mfma_f32_16x16x32_bf16 v[44:47], v[4:7], v[80:83], 0
 buffer_load_dwordx4 v166, s[24:27], s48 offen offset:0 lds
 v_mfma_f32_16x16x32_bf16 v[204:207], v[4:7], v[84:87], 0
 v_cvt_pk_bf16_f32 v52, v188, v189
 v_cvt_pk_bf16_f32 v53, v190, v191
 v_mfma_f32_16x16x32_bf16 v[36:39], v[48:51], v[80:83], 0
 v_cvt_pk_bf16_f32 v54, v192, v193
 v_cvt_pk_bf16_f32 v55, v194, v195
 v_mfma_f32_16x16x32_bf16 v[180:183], v[48:51], v[84:87], 0
 buffer_load_dwordx4 v167, s[24:27], s48 offen offset:1024 lds
 v_mfma_f32_16x16x16_bf16 v[188:191], v[196:197], v[56:57], 0
 s_waitcnt lgkmcnt(4)
 v_and_b32_dpp v200, v16, v162 quad_perm:[0,0,2,2] row_mask:0xf bank_mask:0xf
 v_and_b32_dpp v201, v17, v163 quad_perm:[0,0,2,2] row_mask:0xf bank_mask:0xf
 v_mfma_f32_16x16x16_bf16 v[192:195], v[198:199], v[58:59], 0
 v_and_b32_dpp v202, v18, v162 quad_perm:[0,0,2,2] row_mask:0xf bank_mask:0xf
 v_and_b32_dpp v203, v19, v163 quad_perm:[0,0,2,2] row_mask:0xf bank_mask:0xf
 v_mfma_f32_16x16x32_bf16 v[44:47], v[8:11], v[88:91], v[44:47]
 buffer_load_dwordx4 v166, s[24:27], s49 offen offset:2048 lds
 v_mfma_f32_16x16x32_bf16 v[204:207], v[8:11], v[92:95], v[204:207]
 v_cvt_pk_bf16_f32 v56, v188, v189
 v_cvt_pk_bf16_f32 v57, v190, v191
 v_mfma_f32_16x16x32_bf16 v[36:39], v[52:55], v[88:91], v[36:39]
 v_cvt_pk_bf16_f32 v58, v192, v193
 v_cvt_pk_bf16_f32 v59, v194, v195
 v_mfma_f32_16x16x32_bf16 v[180:183], v[52:55], v[92:95], v[180:183]
 buffer_load_dwordx4 v167, s[24:27], s49 offen offset:3072 lds
 s_add_u32 m0, s50, 24576
 s_mov_b32 s42, 393216
 v_mfma_f32_16x16x16_bf16 v[188:191], v[200:201], v[60:61], 0
 s_waitcnt lgkmcnt(3)
 v_and_b32_dpp v196, v20, v162 quad_perm:[0,0,2,2] row_mask:0xf bank_mask:0xf
 v_and_b32_dpp v197, v21, v163 quad_perm:[0,0,2,2] row_mask:0xf bank_mask:0xf
 v_mfma_f32_16x16x16_bf16 v[192:195], v[202:203], v[62:63], 0
 v_and_b32_dpp v198, v22, v162 quad_perm:[0,0,2,2] row_mask:0xf bank_mask:0xf
 v_and_b32_dpp v199, v23, v163 quad_perm:[0,0,2,2] row_mask:0xf bank_mask:0xf
 v_mfma_f32_16x16x32_bf16 v[44:47], v[12:15], v[96:99], v[44:47]
 buffer_load_dwordx4 v164, s[20:23], s42 offen offset:0 lds
 v_mfma_f32_16x16x32_bf16 v[204:207], v[12:15], v[100:103], v[204:207]
 v_cvt_pk_bf16_f32 v60, v188, v189
 v_cvt_pk_bf16_f32 v61, v190, v191
 v_mfma_f32_16x16x32_bf16 v[36:39], v[56:59], v[96:99], v[36:39]
 v_cvt_pk_bf16_f32 v62, v192, v193
 v_cvt_pk_bf16_f32 v63, v194, v195
 v_mfma_f32_16x16x32_bf16 v[180:183], v[56:59], v[100:103], v[180:183]
 buffer_load_dwordx4 v165, s[20:23], s42 offen offset:1024 lds
 s_lshl1_add_u32 m0, s50, 57344
 s_add_u32 s48, s48, 128
 s_add_u32 s49, s49, 128
 v_mfma_f32_16x16x16_bf16 v[188:191], v[196:197], v[64:65], 0
 s_waitcnt lgkmcnt(2)
 v_and_b32_dpp v200, v24, v162 quad_perm:[0,0,2,2] row_mask:0xf bank_mask:0xf
 v_and_b32_dpp v201, v25, v163 quad_perm:[0,0,2,2] row_mask:0xf bank_mask:0xf
 v_mfma_f32_16x16x16_bf16 v[192:195], v[198:199], v[66:67], 0
 v_and_b32_dpp v202, v26, v162 quad_perm:[0,0,2,2] row_mask:0xf bank_mask:0xf
 v_and_b32_dpp v203, v27, v163 quad_perm:[0,0,2,2] row_mask:0xf bank_mask:0xf
 v_mfma_f32_16x16x32_bf16 v[44:47], v[16:19], v[104:107], v[44:47]
 buffer_load_dwordx4 v166, s[24:27], s48 offen offset:0 lds
 v_mfma_f32_16x16x32_bf16 v[204:207], v[16:19], v[108:111], v[204:207]
 v_cvt_pk_bf16_f32 v64, v188, v189
 v_cvt_pk_bf16_f32 v65, v190, v191
 v_mfma_f32_16x16x32_bf16 v[36:39], v[60:63], v[104:107], v[36:39]
 v_cvt_pk_bf16_f32 v66, v192, v193
 v_cvt_pk_bf16_f32 v67, v194, v195
 v_mfma_f32_16x16x32_bf16 v[180:183], v[60:63], v[108:111], v[180:183]
 buffer_load_dwordx4 v167, s[24:27], s48 offen offset:1024 lds
 v_mfma_f32_16x16x16_bf16 v[188:191], v[200:201], v[68:69], 0
 s_waitcnt lgkmcnt(1)
 v_and_b32_dpp v196, v28, v162 quad_perm:[0,0,2,2] row_mask:0xf bank_mask:0xf
 v_and_b32_dpp v197, v29, v163 quad_perm:[0,0,2,2] row_mask:0xf bank_mask:0xf
 v_mfma_f32_16x16x16_bf16 v[192:195], v[202:203], v[70:71], 0
 v_and_b32_dpp v198, v30, v162 quad_perm:[0,0,2,2] row_mask:0xf bank_mask:0xf
 v_and_b32_dpp v199, v31, v163 quad_perm:[0,0,2,2] row_mask:0xf bank_mask:0xf
 v_mfma_f32_16x16x32_bf16 v[44:47], v[20:23], v[112:115], v[44:47]
 buffer_load_dwordx4 v166, s[24:27], s49 offen offset:2048 lds
 v_mfma_f32_16x16x32_bf16 v[204:207], v[20:23], v[116:119], v[204:207]
 v_cvt_pk_bf16_f32 v68, v188, v189
 v_cvt_pk_bf16_f32 v69, v190, v191
 v_mfma_f32_16x16x32_bf16 v[36:39], v[64:67], v[112:115], v[36:39]
 v_cvt_pk_bf16_f32 v70, v192, v193
 v_cvt_pk_bf16_f32 v71, v194, v195
 v_mfma_f32_16x16x32_bf16 v[180:183], v[64:67], v[116:119], v[180:183]
 buffer_load_dwordx4 v167, s[24:27], s49 offen offset:3072 lds
 s_add_u32 m0, s50, 49152
 s_mov_b32 s42, 524288
 v_mfma_f32_16x16x16_bf16 v[188:191], v[196:197], v[72:73], 0
 s_waitcnt lgkmcnt(0)
 v_and_b32_dpp v200, v32, v162 quad_perm:[0,0,2,2] row_mask:0xf bank_mask:0xf
 v_and_b32_dpp v201, v33, v163 quad_perm:[0,0,2,2] row_mask:0xf bank_mask:0xf
 v_mfma_f32_16x16x16_bf16 v[192:195], v[198:199], v[74:75], 0
 v_and_b32_dpp v202, v34, v162 quad_perm:[0,0,2,2] row_mask:0xf bank_mask:0xf
 v_and_b32_dpp v203, v35, v163 quad_perm:[0,0,2,2] row_mask:0xf bank_mask:0xf
 v_mfma_f32_16x16x32_bf16 v[44:47], v[24:27], v[120:123], v[44:47]
 buffer_load_dwordx4 v164, s[20:23], s42 offen offset:0 lds
 v_mfma_f32_16x16x32_bf16 v[204:207], v[24:27], v[124:127], v[204:207]
 v_cvt_pk_bf16_f32 v72, v188, v189
 v_cvt_pk_bf16_f32 v73, v190, v191
 v_mfma_f32_16x16x32_bf16 v[36:39], v[68:71], v[120:123], v[36:39]
 v_cvt_pk_bf16_f32 v74, v192, v193
 v_cvt_pk_bf16_f32 v75, v194, v195
 v_mfma_f32_16x16x32_bf16 v[180:183], v[68:71], v[124:127], v[180:183]
 buffer_load_dwordx4 v165, s[20:23], s42 offen offset:1024 lds
 s_lshl1_add_u32 m0, s50, 81920
 s_add_u32 s48, s48, 128
 s_add_u32 s49, s49, 128
 v_mfma_f32_16x16x16_bf16 v[188:191], v[200:201], v[76:77], 0
 v_mfma_f32_16x16x16_bf16 v[192:195], v[202:203], v[78:79], 0
 v_mfma_f32_16x16x32_bf16 v[44:47], v[28:31], v[128:131], v[44:47]
 v_mfma_f32_16x16x32_bf16 v[204:207], v[28:31], v[132:135], v[204:207]
 s_nop 4
 v_cvt_pk_bf16_f32 v76, v188, v189
 v_cvt_pk_bf16_f32 v77, v190, v191
 v_mfma_f32_16x16x32_bf16 v[36:39], v[72:75], v[128:131], v[36:39]
 v_cvt_pk_bf16_f32 v78, v192, v193
 v_cvt_pk_bf16_f32 v79, v194, v195
 v_mfma_f32_16x16x32_bf16 v[180:183], v[72:75], v[132:135], v[180:183]
 v_mfma_f32_16x16x32_bf16 v[44:47], v[32:35], v[136:139], v[44:47]
 v_mfma_f32_16x16x32_bf16 v[204:207], v[32:35], v[140:143], v[204:207]
 v_mfma_f32_16x16x32_bf16 v[36:39], v[76:79], v[136:139], v[36:39]
 v_mfma_f32_16x16x32_bf16 v[180:183], v[76:79], v[140:143], v[180:183]
 s_nop 4
 ds_write_b128 v253, v[44:47] offset:2048
 ds_write_b128 v253, v[204:207] offset:3072
 ds_write_b128 v253, v[36:39] offset:0
 ds_write_b128 v253, v[180:183] offset:1024
 s_waitcnt vmcnt(24)
 s_waitcnt lgkmcnt(0)
 s_barrier
 ds_read_b128 v[48:51], v2 offset:2048
 ds_read_b128 v[52:55], v2 offset:6144
 ds_read_b128 v[56:59], v2 offset:10240
 ds_read_b128 v[60:63], v2 offset:14336
 ds_read_b128 v[64:67], v2 offset:0
 ds_read_b128 v[68:71], v2 offset:4096
 ds_read_b128 v[72:75], v2 offset:8192
 ds_read_b128 v[76:79], v2 offset:12288
 s_waitcnt lgkmcnt(6)
 v_add_f32 v48, v48, v52
 s_waitcnt lgkmcnt(4)
 v_add_f32 v56, v56, v60
 v_add_f32 v49, v49, v53
 v_add_f32 v57, v57, v61
 v_add_f32 v48, v48, v56
 v_add_f32 v49, v49, v57
 v_fma_f32 v52, v173, v48, v49
 v_fma_f32 v53, v175, v48, v49
 v_fma_f32 v54, v177, v48, v49
 v_fma_f32 v55, v179, v48, v49
 s_waitcnt lgkmcnt(2)
 v_add_f32 v64, v64, v68
 s_waitcnt lgkmcnt(0)
 v_add_f32 v72, v72, v76
 v_add_f32 v65, v65, v69
 v_add_f32 v73, v73, v77
 v_add_f32 v66, v66, v70
 v_add_f32 v74, v74, v78
 v_add_f32 v67, v67, v71
 v_add_f32 v75, v75, v79
 v_add_f32 v64, v64, v72
 v_add_f32 v65, v65, v73
 v_add_f32 v66, v66, v74
 v_add_f32 v67, v67, v75
 v_fma_f32 v64, v64, v172, v52
 v_fma_f32 v65, v65, v174, v53
 v_fma_f32 v66, v66, v176, v54
 v_fma_f32 v67, v67, v178, v55
 v_cvt_pk_bf16_f32 v64, v64, v65
 v_cvt_pk_bf16_f32 v65, v66, v67
 buffer_store_dwordx2 v[64:65], v252, s[28:31], 0 offen sc1
m_kernel_jx:
 ds_read_b128 v[88:91], v42 offset:0
 ds_read_b128 a[0:3], v144 offset:24576
 ds_read_b128 a[4:7], v144 offset:26624
 ds_read_b128 v[92:95], v42 offset:64
 ds_read_b128 a[8:11], v145 offset:24576
 ds_read_b128 a[12:15], v145 offset:26624
 ds_read_b128 v[96:99], v42 offset:128
 ds_read_b128 v[100:103], v42 offset:192
 ds_read_b64_tr_b16 v[48:49], v146 offset:24576
 ds_read_b64_tr_b16 v[50:51], v146 offset:25088
 ds_read_b64_tr_b16 v[52:53], v147 offset:24576
 ds_read_b64_tr_b16 v[54:55], v147 offset:25088
 ds_read_b64_tr_b16 v[56:57], v148 offset:24576
 ds_read_b64_tr_b16 v[58:59], v148 offset:25088
 ds_read_b64_tr_b16 v[60:61], v149 offset:24576
 ds_read_b64_tr_b16 v[62:63], v149 offset:25088
 s_waitcnt lgkmcnt(15)
 v_and_b32_dpp v104, v88, v162 quad_perm:[0,0,2,2] row_mask:0xf bank_mask:0xf
 v_and_b32_dpp v105, v89, v163 quad_perm:[0,0,2,2] row_mask:0xf bank_mask:0xf
 v_and_b32_dpp v106, v90, v162 quad_perm:[0,0,2,2] row_mask:0xf bank_mask:0xf
 v_and_b32_dpp v107, v91, v163 quad_perm:[0,0,2,2] row_mask:0xf bank_mask:0xf
 s_waitcnt lgkmcnt(12)
 v_and_b32_dpp v108, v92, v162 quad_perm:[0,0,2,2] row_mask:0xf bank_mask:0xf
 v_and_b32_dpp v109, v93, v163 quad_perm:[0,0,2,2] row_mask:0xf bank_mask:0xf
 v_and_b32_dpp v110, v94, v162 quad_perm:[0,0,2,2] row_mask:0xf bank_mask:0xf
 v_and_b32_dpp v111, v95, v163 quad_perm:[0,0,2,2] row_mask:0xf bank_mask:0xf
 v_mfma_f32_16x16x16_bf16 v[112:115], v[104:105], a[0:1], 0
 v_mfma_f32_16x16x16_bf16 v[116:119], v[104:105], a[4:5], 0
 v_mfma_f32_16x16x16_bf16 v[120:123], v[106:107], a[2:3], 0
 v_mfma_f32_16x16x16_bf16 v[124:127], v[106:107], a[6:7], 0
 s_waitcnt vmcnt(21)
 ds_read_b128 a[0:3], v144 offset:49152
 ds_read_b128 a[4:7], v144 offset:51200
 s_nop 1
 v_cvt_pk_bf16_f32 v128, v112, v113
 v_cvt_pk_bf16_f32 v129, v114, v115
 v_cvt_pk_bf16_f32 v132, v116, v117
 v_cvt_pk_bf16_f32 v133, v118, v119
 v_cvt_pk_bf16_f32 v130, v120, v121
 v_cvt_pk_bf16_f32 v131, v122, v123
 s_waitcnt lgkmcnt(13)
 v_mfma_f32_16x16x16_bf16 v[112:115], v[108:109], a[8:9], 0
 v_cvt_pk_bf16_f32 v134, v124, v125
 v_cvt_pk_bf16_f32 v135, v126, v127
 s_waitcnt lgkmcnt(12)
 v_mfma_f32_16x16x16_bf16 v[116:119], v[108:109], a[12:13], 0
 s_waitcnt lgkmcnt(11)
 v_and_b32_dpp v104, v96, v162 quad_perm:[0,0,2,2] row_mask:0xf bank_mask:0xf
 v_and_b32_dpp v105, v97, v163 quad_perm:[0,0,2,2] row_mask:0xf bank_mask:0xf
 v_mfma_f32_16x16x16_bf16 v[120:123], v[110:111], a[10:11], 0
 v_and_b32_dpp v106, v98, v162 quad_perm:[0,0,2,2] row_mask:0xf bank_mask:0xf
 v_and_b32_dpp v107, v99, v163 quad_perm:[0,0,2,2] row_mask:0xf bank_mask:0xf
 v_mfma_f32_16x16x16_bf16 v[124:127], v[110:111], a[14:15], 0
 v_cvt_pk_bf16_f32 v136, v112, v113
 v_cvt_pk_bf16_f32 v137, v114, v115
 s_waitcnt lgkmcnt(8)
 v_mfma_f32_16x16x32_bf16 v[36:39], v[48:51], v[88:91], 0
 v_cvt_pk_bf16_f32 v140, v116, v117
 v_cvt_pk_bf16_f32 v141, v118, v119
 v_mfma_f32_16x16x32_bf16 v[4:7], v[48:51], v[128:131], 0
 v_cvt_pk_bf16_f32 v138, v120, v121
 v_cvt_pk_bf16_f32 v139, v122, v123
 v_mfma_f32_16x16x32_bf16 v[8:11], v[48:51], v[132:135], 0
 ds_read_b64_tr_b16 v[64:65], v146 offset:28672
 ds_read_b64_tr_b16 v[66:67], v146 offset:29184
 s_waitcnt lgkmcnt(8)
 v_mfma_f32_16x16x32_bf16 v[16:19], v[52:55], v[132:135], 0
 ds_read_b64_tr_b16 v[68:69], v147 offset:28672
 ds_read_b64_tr_b16 v[70:71], v147 offset:29184
 v_mfma_f32_16x16x32_bf16 v[12:15], v[52:55], v[128:131], 0
 ds_read_b64_tr_b16 v[72:73], v148 offset:28672
 ds_read_b64_tr_b16 v[74:75], v148 offset:29184
 s_waitcnt lgkmcnt(10)
 v_mfma_f32_16x16x32_bf16 v[20:23], v[56:59], v[128:131], 0
 ds_read_b64_tr_b16 v[76:77], v149 offset:28672
 ds_read_b64_tr_b16 v[78:79], v149 offset:29184
 v_mfma_f32_16x16x32_bf16 v[24:27], v[56:59], v[132:135], 0
 ds_read_b128 a[8:11], v145 offset:49152
 ds_read_b128 a[12:15], v145 offset:51200
 s_waitcnt lgkmcnt(12)
 v_mfma_f32_16x16x32_bf16 v[32:35], v[60:63], v[132:135], 0
 ds_read_b128 v[88:91], v42 offset:256
 v_mfma_f32_16x16x32_bf16 v[28:31], v[60:63], v[128:131], 0
 s_waitcnt lgkmcnt(12)
 v_mfma_f32_16x16x16_bf16 v[112:115], v[104:105], a[0:1], 0
 v_cvt_pk_bf16_f32 v142, v124, v125
 v_cvt_pk_bf16_f32 v143, v126, v127
 s_waitcnt lgkmcnt(11)
 v_mfma_f32_16x16x16_bf16 v[116:119], v[104:105], a[4:5], 0
 v_and_b32_dpp v108, v100, v162 quad_perm:[0,0,2,2] row_mask:0xf bank_mask:0xf
 v_and_b32_dpp v109, v101, v163 quad_perm:[0,0,2,2] row_mask:0xf bank_mask:0xf
 v_mfma_f32_16x16x16_bf16 v[120:123], v[106:107], a[2:3], 0
 v_and_b32_dpp v110, v102, v162 quad_perm:[0,0,2,2] row_mask:0xf bank_mask:0xf
 v_and_b32_dpp v111, v103, v163 quad_perm:[0,0,2,2] row_mask:0xf bank_mask:0xf
 v_mfma_f32_16x16x16_bf16 v[124:127], v[106:107], a[6:7], 0
 v_cvt_pk_bf16_f32 v128, v112, v113
 v_cvt_pk_bf16_f32 v129, v114, v115
 s_waitcnt lgkmcnt(0)
 v_mfma_f32_16x16x32_bf16 v[36:39], v[64:67], v[92:95], v[36:39]
 v_cvt_pk_bf16_f32 v132, v116, v117
 v_cvt_pk_bf16_f32 v133, v118, v119
 v_mfma_f32_16x16x32_bf16 v[4:7], v[64:67], v[136:139], v[4:7]
 v_cvt_pk_bf16_f32 v130, v120, v121
 v_cvt_pk_bf16_f32 v131, v122, v123
 s_waitcnt vmcnt(15)
 s_barrier
 v_mfma_f32_16x16x32_bf16 v[8:11], v[64:67], v[140:143], v[8:11]
 ds_read_b64_tr_b16 v[48:49], v146 offset:49152
 ds_read_b64_tr_b16 v[50:51], v146 offset:49664
 buffer_load_dwordx4 v166, s[24:27], s48 offen offset:0 lds
 v_mfma_f32_16x16x32_bf16 v[16:19], v[68:71], v[140:143], v[16:19]
 ds_read_b64_tr_b16 v[52:53], v147 offset:49152
 ds_read_b64_tr_b16 v[54:55], v147 offset:49664
 v_mfma_f32_16x16x32_bf16 v[12:15], v[68:71], v[136:139], v[12:15]
 ds_read_b64_tr_b16 v[56:57], v148 offset:49152
 ds_read_b64_tr_b16 v[58:59], v148 offset:49664
 buffer_load_dwordx4 v167, s[24:27], s48 offen offset:1024 lds
 v_mfma_f32_16x16x32_bf16 v[20:23], v[72:75], v[136:139], v[20:23]
 ds_read_b64_tr_b16 v[60:61], v149 offset:49152
 ds_read_b64_tr_b16 v[62:63], v149 offset:49664
 v_mfma_f32_16x16x32_bf16 v[24:27], v[72:75], v[140:143], v[24:27]
 ds_read_b128 a[0:3], v154 offset:0
 ds_read_b128 a[4:7], v154 offset:2048
 buffer_load_dwordx4 v166, s[24:27], s49 offen offset:2048 lds
 v_mfma_f32_16x16x32_bf16 v[32:35], v[76:79], v[140:143], v[32:35]
 ds_read_b128 v[92:95], v42 offset:320
 v_mfma_f32_16x16x32_bf16 v[28:31], v[76:79], v[136:139], v[28:31]
 v_mfma_f32_16x16x16_bf16 v[112:115], v[108:109], a[8:9], 0
 v_cvt_pk_bf16_f32 v134, v124, v125
 v_cvt_pk_bf16_f32 v135, v126, v127
 v_mfma_f32_16x16x16_bf16 v[116:119], v[108:109], a[12:13], 0
 v_and_b32_dpp v104, v88, v162 quad_perm:[0,0,2,2] row_mask:0xf bank_mask:0xf
 v_and_b32_dpp v105, v89, v163 quad_perm:[0,0,2,2] row_mask:0xf bank_mask:0xf
 v_mfma_f32_16x16x16_bf16 v[120:123], v[110:111], a[10:11], 0
 v_and_b32_dpp v106, v90, v162 quad_perm:[0,0,2,2] row_mask:0xf bank_mask:0xf
 v_and_b32_dpp v107, v91, v163 quad_perm:[0,0,2,2] row_mask:0xf bank_mask:0xf
 v_mfma_f32_16x16x16_bf16 v[124:127], v[110:111], a[14:15], 0
 v_cvt_pk_bf16_f32 v136, v112, v113
 v_cvt_pk_bf16_f32 v137, v114, v115
 buffer_load_dwordx4 v167, s[24:27], s49 offen offset:3072 lds
 s_add_u32 m0, s50, 73728
 s_mov_b32 s42, 655360
 s_waitcnt lgkmcnt(0)
 v_mfma_f32_16x16x32_bf16 v[36:39], v[48:51], v[96:99], v[36:39]
 v_cvt_pk_bf16_f32 v140, v116, v117
 v_cvt_pk_bf16_f32 v141, v118, v119
 v_mfma_f32_16x16x32_bf16 v[4:7], v[48:51], v[128:131], v[4:7]
 v_cvt_pk_bf16_f32 v138, v120, v121
 v_cvt_pk_bf16_f32 v139, v122, v123
 v_mfma_f32_16x16x32_bf16 v[8:11], v[48:51], v[132:135], v[8:11]
 ds_read_b64_tr_b16 v[64:65], v146 offset:53248
 ds_read_b64_tr_b16 v[66:67], v146 offset:53760
 v_mfma_f32_16x16x32_bf16 v[16:19], v[52:55], v[132:135], v[16:19]
 ds_read_b64_tr_b16 v[68:69], v147 offset:53248
 ds_read_b64_tr_b16 v[70:71], v147 offset:53760
 buffer_load_dwordx4 v164, s[20:23], s42 offen offset:0 lds
 v_mfma_f32_16x16x32_bf16 v[12:15], v[52:55], v[128:131], v[12:15]
 ds_read_b64_tr_b16 v[72:73], v148 offset:53248
 ds_read_b64_tr_b16 v[74:75], v148 offset:53760
 v_mfma_f32_16x16x32_bf16 v[20:23], v[56:59], v[128:131], v[20:23]
 ds_read_b64_tr_b16 v[76:77], v149 offset:53248
 ds_read_b64_tr_b16 v[78:79], v149 offset:53760
 v_mfma_f32_16x16x32_bf16 v[24:27], v[56:59], v[132:135], v[24:27]
 ds_read_b128 a[8:11], v155 offset:0
 ds_read_b128 a[12:15], v155 offset:2048
 v_mfma_f32_16x16x32_bf16 v[32:35], v[60:63], v[132:135], v[32:35]
 ds_read_b128 v[96:99], v42 offset:384
 buffer_load_dwordx4 v165, s[20:23], s42 offen offset:1024 lds
 s_lshl1_add_u32 m0, s50, 106496
 s_add_u32 s48, s48, 128
 s_add_u32 s49, s49, 128
 v_mfma_f32_16x16x32_bf16 v[28:31], v[60:63], v[128:131], v[28:31]
 v_mfma_f32_16x16x16_bf16 v[112:115], v[104:105], a[0:1], 0
 v_cvt_pk_bf16_f32 v142, v124, v125
 v_cvt_pk_bf16_f32 v143, v126, v127
 v_mfma_f32_16x16x16_bf16 v[116:119], v[104:105], a[4:5], 0
 v_and_b32_dpp v108, v92, v162 quad_perm:[0,0,2,2] row_mask:0xf bank_mask:0xf
 v_and_b32_dpp v109, v93, v163 quad_perm:[0,0,2,2] row_mask:0xf bank_mask:0xf
 v_mfma_f32_16x16x16_bf16 v[120:123], v[106:107], a[2:3], 0
 v_and_b32_dpp v110, v94, v162 quad_perm:[0,0,2,2] row_mask:0xf bank_mask:0xf
 v_and_b32_dpp v111, v95, v163 quad_perm:[0,0,2,2] row_mask:0xf bank_mask:0xf
 v_mfma_f32_16x16x16_bf16 v[124:127], v[106:107], a[6:7], 0
 v_cvt_pk_bf16_f32 v128, v112, v113
 v_cvt_pk_bf16_f32 v129, v114, v115
 buffer_load_dwordx4 v166, s[24:27], s48 offen offset:0 lds
 s_waitcnt lgkmcnt(0)
 v_mfma_f32_16x16x32_bf16 v[36:39], v[64:67], v[100:103], v[36:39]
 v_cvt_pk_bf16_f32 v132, v116, v117
 v_cvt_pk_bf16_f32 v133, v118, v119
 v_mfma_f32_16x16x32_bf16 v[4:7], v[64:67], v[136:139], v[4:7]
 v_cvt_pk_bf16_f32 v130, v120, v121
 v_cvt_pk_bf16_f32 v131, v122, v123
 s_waitcnt vmcnt(16)
 s_barrier
 s_waitcnt vmcnt(7)
 v_mov_b32 v1, s59
 buffer_store_dword v1, v210, s[44:47], 0 offen sc1
 v_mfma_f32_16x16x32_bf16 v[8:11], v[64:67], v[140:143], v[8:11]
 ds_read_b64_tr_b16 v[48:49], v156 offset:0
 ds_read_b64_tr_b16 v[50:51], v156 offset:512
 v_mfma_f32_16x16x32_bf16 v[16:19], v[68:71], v[140:143], v[16:19]
 ds_read_b64_tr_b16 v[52:53], v157 offset:0
 ds_read_b64_tr_b16 v[54:55], v157 offset:512
 buffer_load_dwordx4 v167, s[24:27], s48 offen offset:1024 lds
 v_mfma_f32_16x16x32_bf16 v[12:15], v[68:71], v[136:139], v[12:15]
 ds_read_b64_tr_b16 v[56:57], v158 offset:0
 ds_read_b64_tr_b16 v[58:59], v158 offset:512
 v_mfma_f32_16x16x32_bf16 v[20:23], v[72:75], v[136:139], v[20:23]
 ds_read_b64_tr_b16 v[60:61], v159 offset:0
 ds_read_b64_tr_b16 v[62:63], v159 offset:512
 v_mfma_f32_16x16x32_bf16 v[24:27], v[72:75], v[140:143], v[24:27]
 ds_read_b128 a[0:3], v154 offset:24576
 ds_read_b128 a[4:7], v154 offset:26624
 v_mfma_f32_16x16x32_bf16 v[32:35], v[76:79], v[140:143], v[32:35]
 ds_read_b128 v[100:103], v42 offset:448
 buffer_load_dwordx4 v166, s[24:27], s49 offen offset:2048 lds
 v_mfma_f32_16x16x32_bf16 v[28:31], v[76:79], v[136:139], v[28:31]
 v_mfma_f32_16x16x16_bf16 v[112:115], v[108:109], a[8:9], 0
 v_cvt_pk_bf16_f32 v134, v124, v125
 v_cvt_pk_bf16_f32 v135, v126, v127
 v_mfma_f32_16x16x16_bf16 v[116:119], v[108:109], a[12:13], 0
 v_and_b32_dpp v104, v96, v162 quad_perm:[0,0,2,2] row_mask:0xf bank_mask:0xf
 v_and_b32_dpp v105, v97, v163 quad_perm:[0,0,2,2] row_mask:0xf bank_mask:0xf
 v_mfma_f32_16x16x16_bf16 v[120:123], v[110:111], a[10:11], 0
 v_and_b32_dpp v106, v98, v162 quad_perm:[0,0,2,2] row_mask:0xf bank_mask:0xf
 v_and_b32_dpp v107, v99, v163 quad_perm:[0,0,2,2] row_mask:0xf bank_mask:0xf
 v_mfma_f32_16x16x16_bf16 v[124:127], v[110:111], a[14:15], 0
 v_cvt_pk_bf16_f32 v136, v112, v113
 v_cvt_pk_bf16_f32 v137, v114, v115
 buffer_load_dwordx4 v167, s[24:27], s49 offen offset:3072 lds
 s_add_u32 m0, s50, 98304
 s_mov_b32 s42, 786432
 s_waitcnt lgkmcnt(0)
 v_mfma_f32_16x16x32_bf16 v[36:39], v[48:51], v[88:91], v[36:39]
 v_cvt_pk_bf16_f32 v140, v116, v117
 v_cvt_pk_bf16_f32 v141, v118, v119
 v_mfma_f32_16x16x32_bf16 v[4:7], v[48:51], v[128:131], v[4:7]
 v_cvt_pk_bf16_f32 v138, v120, v121
 v_cvt_pk_bf16_f32 v139, v122, v123
 v_mfma_f32_16x16x32_bf16 v[8:11], v[48:51], v[132:135], v[8:11]
 ds_read_b64_tr_b16 v[64:65], v156 offset:4096
 ds_read_b64_tr_b16 v[66:67], v156 offset:4608
 v_mfma_f32_16x16x32_bf16 v[16:19], v[52:55], v[132:135], v[16:19]
 ds_read_b64_tr_b16 v[68:69], v157 offset:4096
 ds_read_b64_tr_b16 v[70:71], v157 offset:4608
 buffer_load_dwordx4 v164, s[20:23], s42 offen offset:0 lds
 v_mfma_f32_16x16x32_bf16 v[12:15], v[52:55], v[128:131], v[12:15]
 ds_read_b64_tr_b16 v[72:73], v158 offset:4096
 ds_read_b64_tr_b16 v[74:75], v158 offset:4608
 v_mfma_f32_16x16x32_bf16 v[20:23], v[56:59], v[128:131], v[20:23]
 ds_read_b64_tr_b16 v[76:77], v159 offset:4096
 ds_read_b64_tr_b16 v[78:79], v159 offset:4608
 v_mfma_f32_16x16x32_bf16 v[24:27], v[56:59], v[132:135], v[24:27]
 ds_read_b128 a[8:11], v155 offset:24576
 ds_read_b128 a[12:15], v155 offset:26624
 v_mfma_f32_16x16x32_bf16 v[32:35], v[60:63], v[132:135], v[32:35]
 ds_read_b128 v[88:91], v42 offset:512
 buffer_load_dwordx4 v165, s[20:23], s42 offen offset:1024 lds
 s_lshl1_add_u32 m0, s50, 131072
 s_add_u32 s48, s48, 128
 s_add_u32 s49, s49, 128
 v_mfma_f32_16x16x32_bf16 v[28:31], v[60:63], v[128:131], v[28:31]
 v_mfma_f32_16x16x16_bf16 v[112:115], v[104:105], a[0:1], 0
 v_cvt_pk_bf16_f32 v142, v124, v125
 v_cvt_pk_bf16_f32 v143, v126, v127
 v_mfma_f32_16x16x16_bf16 v[116:119], v[104:105], a[4:5], 0
 v_and_b32_dpp v108, v100, v162 quad_perm:[0,0,2,2] row_mask:0xf bank_mask:0xf
 v_and_b32_dpp v109, v101, v163 quad_perm:[0,0,2,2] row_mask:0xf bank_mask:0xf
 v_mfma_f32_16x16x16_bf16 v[120:123], v[106:107], a[2:3], 0
 v_and_b32_dpp v110, v102, v162 quad_perm:[0,0,2,2] row_mask:0xf bank_mask:0xf
 v_and_b32_dpp v111, v103, v163 quad_perm:[0,0,2,2] row_mask:0xf bank_mask:0xf
 v_mfma_f32_16x16x16_bf16 v[124:127], v[106:107], a[6:7], 0
 v_cvt_pk_bf16_f32 v128, v112, v113
 v_cvt_pk_bf16_f32 v129, v114, v115
 buffer_load_dwordx4 v166, s[24:27], s48 offen offset:0 lds
 s_waitcnt lgkmcnt(0)
 v_mfma_f32_16x16x32_bf16 v[36:39], v[64:67], v[92:95], v[36:39]
 v_cvt_pk_bf16_f32 v132, v116, v117
 v_cvt_pk_bf16_f32 v133, v118, v119
 v_mfma_f32_16x16x32_bf16 v[4:7], v[64:67], v[136:139], v[4:7]
 v_cvt_pk_bf16_f32 v130, v120, v121
 v_cvt_pk_bf16_f32 v131, v122, v123
 s_barrier
 v_mfma_f32_16x16x32_bf16 v[8:11], v[64:67], v[140:143], v[8:11]
 ds_read_b64_tr_b16 v[48:49], v156 offset:24576
 ds_read_b64_tr_b16 v[50:51], v156 offset:25088
 v_mfma_f32_16x16x32_bf16 v[16:19], v[68:71], v[140:143], v[16:19]
 ds_read_b64_tr_b16 v[52:53], v157 offset:24576
 ds_read_b64_tr_b16 v[54:55], v157 offset:25088
 buffer_load_dwordx4 v167, s[24:27], s48 offen offset:1024 lds
 v_mfma_f32_16x16x32_bf16 v[12:15], v[68:71], v[136:139], v[12:15]
 ds_read_b64_tr_b16 v[56:57], v158 offset:24576
 ds_read_b64_tr_b16 v[58:59], v158 offset:25088
 v_mfma_f32_16x16x32_bf16 v[20:23], v[72:75], v[136:139], v[20:23]
 ds_read_b64_tr_b16 v[60:61], v159 offset:24576
 ds_read_b64_tr_b16 v[62:63], v159 offset:25088
 v_mfma_f32_16x16x32_bf16 v[24:27], v[72:75], v[140:143], v[24:27]
 ds_read_b128 a[0:3], v154 offset:49152
 ds_read_b128 a[4:7], v154 offset:51200
 v_mfma_f32_16x16x32_bf16 v[32:35], v[76:79], v[140:143], v[32:35]
 ds_read_b128 v[92:95], v42 offset:576
 buffer_load_dwordx4 v166, s[24:27], s49 offen offset:2048 lds
 v_mfma_f32_16x16x32_bf16 v[28:31], v[76:79], v[136:139], v[28:31]
 v_mfma_f32_16x16x16_bf16 v[112:115], v[108:109], a[8:9], 0
 v_cvt_pk_bf16_f32 v134, v124, v125
 v_cvt_pk_bf16_f32 v135, v126, v127
 v_mfma_f32_16x16x16_bf16 v[116:119], v[108:109], a[12:13], 0
 v_and_b32_dpp v104, v88, v162 quad_perm:[0,0,2,2] row_mask:0xf bank_mask:0xf
 v_and_b32_dpp v105, v89, v163 quad_perm:[0,0,2,2] row_mask:0xf bank_mask:0xf
 v_mfma_f32_16x16x16_bf16 v[120:123], v[110:111], a[10:11], 0
 v_and_b32_dpp v106, v90, v162 quad_perm:[0,0,2,2] row_mask:0xf bank_mask:0xf
 v_and_b32_dpp v107, v91, v163 quad_perm:[0,0,2,2] row_mask:0xf bank_mask:0xf
 v_mfma_f32_16x16x16_bf16 v[124:127], v[110:111], a[14:15], 0
 v_cvt_pk_bf16_f32 v136, v112, v113
 v_cvt_pk_bf16_f32 v137, v114, v115
 buffer_load_dwordx4 v167, s[24:27], s49 offen offset:3072 lds
 s_add_u32 m0, s50, 122880
 s_mov_b32 s42, 917504
 s_waitcnt lgkmcnt(0)
 v_mfma_f32_16x16x32_bf16 v[36:39], v[48:51], v[96:99], v[36:39]
 v_cvt_pk_bf16_f32 v140, v116, v117
 v_cvt_pk_bf16_f32 v141, v118, v119
 v_mfma_f32_16x16x32_bf16 v[4:7], v[48:51], v[128:131], v[4:7]
 v_cvt_pk_bf16_f32 v138, v120, v121
 v_cvt_pk_bf16_f32 v139, v122, v123
 v_mfma_f32_16x16x32_bf16 v[8:11], v[48:51], v[132:135], v[8:11]
 ds_read_b64_tr_b16 v[64:65], v156 offset:28672
 ds_read_b64_tr_b16 v[66:67], v156 offset:29184
 v_mfma_f32_16x16x32_bf16 v[16:19], v[52:55], v[132:135], v[16:19]
 ds_read_b64_tr_b16 v[68:69], v157 offset:28672
 ds_read_b64_tr_b16 v[70:71], v157 offset:29184
 buffer_load_dwordx4 v164, s[20:23], s42 offen offset:0 lds
 v_mfma_f32_16x16x32_bf16 v[12:15], v[52:55], v[128:131], v[12:15]
 ds_read_b64_tr_b16 v[72:73], v158 offset:28672
 ds_read_b64_tr_b16 v[74:75], v158 offset:29184
 v_mfma_f32_16x16x32_bf16 v[20:23], v[56:59], v[128:131], v[20:23]
 ds_read_b64_tr_b16 v[76:77], v159 offset:28672
 ds_read_b64_tr_b16 v[78:79], v159 offset:29184
 v_mfma_f32_16x16x32_bf16 v[24:27], v[56:59], v[132:135], v[24:27]
 ds_read_b128 a[8:11], v155 offset:49152
 ds_read_b128 a[12:15], v155 offset:51200
 v_mfma_f32_16x16x32_bf16 v[32:35], v[60:63], v[132:135], v[32:35]
 ds_read_b128 v[96:99], v42 offset:640
 buffer_load_dwordx4 v165, s[20:23], s42 offen offset:1024 lds
 s_lshl1_add_u32 m0, s50, 8192
 s_add_u32 s48, s48, 128
 s_add_u32 s49, s49, 128
 v_mfma_f32_16x16x32_bf16 v[28:31], v[60:63], v[128:131], v[28:31]
 v_mfma_f32_16x16x16_bf16 v[112:115], v[104:105], a[0:1], 0
 v_cvt_pk_bf16_f32 v142, v124, v125
 v_cvt_pk_bf16_f32 v143, v126, v127
 v_mfma_f32_16x16x16_bf16 v[116:119], v[104:105], a[4:5], 0
 v_and_b32_dpp v108, v92, v162 quad_perm:[0,0,2,2] row_mask:0xf bank_mask:0xf
 v_and_b32_dpp v109, v93, v163 quad_perm:[0,0,2,2] row_mask:0xf bank_mask:0xf
 v_mfma_f32_16x16x16_bf16 v[120:123], v[106:107], a[2:3], 0
 v_and_b32_dpp v110, v94, v162 quad_perm:[0,0,2,2] row_mask:0xf bank_mask:0xf
 v_and_b32_dpp v111, v95, v163 quad_perm:[0,0,2,2] row_mask:0xf bank_mask:0xf
 v_mfma_f32_16x16x16_bf16 v[124:127], v[106:107], a[6:7], 0
 v_cvt_pk_bf16_f32 v128, v112, v113
 v_cvt_pk_bf16_f32 v129, v114, v115
 buffer_load_dwordx4 v166, s[24:27], s48 offen offset:0 lds
 s_waitcnt lgkmcnt(0)
 v_mfma_f32_16x16x32_bf16 v[36:39], v[64:67], v[100:103], v[36:39]
 v_cvt_pk_bf16_f32 v132, v116, v117
 v_cvt_pk_bf16_f32 v133, v118, v119
 v_mfma_f32_16x16x32_bf16 v[4:7], v[64:67], v[136:139], v[4:7]
 v_cvt_pk_bf16_f32 v130, v120, v121
 v_cvt_pk_bf16_f32 v131, v122, v123
 s_waitcnt vmcnt(16)
 s_barrier
 v_mfma_f32_16x16x32_bf16 v[8:11], v[64:67], v[140:143], v[8:11]
 ds_read_b64_tr_b16 v[48:49], v156 offset:49152
 ds_read_b64_tr_b16 v[50:51], v156 offset:49664
 v_mfma_f32_16x16x32_bf16 v[16:19], v[68:71], v[140:143], v[16:19]
 ds_read_b64_tr_b16 v[52:53], v157 offset:49152
 ds_read_b64_tr_b16 v[54:55], v157 offset:49664
 buffer_load_dwordx4 v167, s[24:27], s48 offen offset:1024 lds
 v_mfma_f32_16x16x32_bf16 v[12:15], v[68:71], v[136:139], v[12:15]
 ds_read_b64_tr_b16 v[56:57], v158 offset:49152
 ds_read_b64_tr_b16 v[58:59], v158 offset:49664
 v_mfma_f32_16x16x32_bf16 v[20:23], v[72:75], v[136:139], v[20:23]
 ds_read_b64_tr_b16 v[60:61], v159 offset:49152
 ds_read_b64_tr_b16 v[62:63], v159 offset:49664
 v_mfma_f32_16x16x32_bf16 v[24:27], v[72:75], v[140:143], v[24:27]
 ds_read_b128 a[0:3], v144 offset:0
 ds_read_b128 a[4:7], v144 offset:2048
 v_mfma_f32_16x16x32_bf16 v[32:35], v[76:79], v[140:143], v[32:35]
 ds_read_b128 v[100:103], v42 offset:704
 buffer_load_dwordx4 v166, s[24:27], s49 offen offset:2048 lds
 v_mfma_f32_16x16x32_bf16 v[28:31], v[76:79], v[136:139], v[28:31]
 v_mfma_f32_16x16x16_bf16 v[112:115], v[108:109], a[8:9], 0
 v_cvt_pk_bf16_f32 v134, v124, v125
 v_cvt_pk_bf16_f32 v135, v126, v127
 v_mfma_f32_16x16x16_bf16 v[116:119], v[108:109], a[12:13], 0
 v_and_b32_dpp v104, v96, v162 quad_perm:[0,0,2,2] row_mask:0xf bank_mask:0xf
 v_and_b32_dpp v105, v97, v163 quad_perm:[0,0,2,2] row_mask:0xf bank_mask:0xf
 v_mfma_f32_16x16x16_bf16 v[120:123], v[110:111], a[10:11], 0
 v_and_b32_dpp v106, v98, v162 quad_perm:[0,0,2,2] row_mask:0xf bank_mask:0xf
 v_and_b32_dpp v107, v99, v163 quad_perm:[0,0,2,2] row_mask:0xf bank_mask:0xf
 v_mfma_f32_16x16x16_bf16 v[124:127], v[110:111], a[14:15], 0
 v_cvt_pk_bf16_f32 v136, v112, v113
 v_cvt_pk_bf16_f32 v137, v114, v115
 buffer_load_dwordx4 v167, s[24:27], s49 offen offset:3072 lds
 s_add_u32 m0, s50, 0
 s_mov_b32 s42, 1048576
 s_waitcnt lgkmcnt(0)
 v_mfma_f32_16x16x32_bf16 v[36:39], v[48:51], v[88:91], v[36:39]
 v_cvt_pk_bf16_f32 v140, v116, v117
 v_cvt_pk_bf16_f32 v141, v118, v119
 v_mfma_f32_16x16x32_bf16 v[4:7], v[48:51], v[128:131], v[4:7]
 v_cvt_pk_bf16_f32 v138, v120, v121
 v_cvt_pk_bf16_f32 v139, v122, v123
 v_mfma_f32_16x16x32_bf16 v[8:11], v[48:51], v[132:135], v[8:11]
 ds_read_b64_tr_b16 v[64:65], v156 offset:53248
 ds_read_b64_tr_b16 v[66:67], v156 offset:53760
 v_mfma_f32_16x16x32_bf16 v[16:19], v[52:55], v[132:135], v[16:19]
 ds_read_b64_tr_b16 v[68:69], v157 offset:53248
 ds_read_b64_tr_b16 v[70:71], v157 offset:53760
 buffer_load_dwordx4 v164, s[20:23], s42 offen offset:0 lds
 v_mfma_f32_16x16x32_bf16 v[12:15], v[52:55], v[128:131], v[12:15]
 ds_read_b64_tr_b16 v[72:73], v158 offset:53248
 ds_read_b64_tr_b16 v[74:75], v158 offset:53760
 v_mfma_f32_16x16x32_bf16 v[20:23], v[56:59], v[128:131], v[20:23]
 ds_read_b64_tr_b16 v[76:77], v159 offset:53248
 ds_read_b64_tr_b16 v[78:79], v159 offset:53760
 v_mfma_f32_16x16x32_bf16 v[24:27], v[56:59], v[132:135], v[24:27]
 ds_read_b128 a[8:11], v145 offset:0
 ds_read_b128 a[12:15], v145 offset:2048
 v_mfma_f32_16x16x32_bf16 v[32:35], v[60:63], v[132:135], v[32:35]
 ds_read_b128 v[88:91], v42 offset:768
 buffer_load_dwordx4 v165, s[20:23], s42 offen offset:1024 lds
 s_lshl1_add_u32 m0, s50, 32768
 s_add_u32 s48, s48, 128
 s_add_u32 s49, s49, 128
 v_mfma_f32_16x16x32_bf16 v[28:31], v[60:63], v[128:131], v[28:31]
 v_mfma_f32_16x16x16_bf16 v[112:115], v[104:105], a[0:1], 0
 v_cvt_pk_bf16_f32 v142, v124, v125
 v_cvt_pk_bf16_f32 v143, v126, v127
 v_mfma_f32_16x16x16_bf16 v[116:119], v[104:105], a[4:5], 0
 v_and_b32_dpp v108, v100, v162 quad_perm:[0,0,2,2] row_mask:0xf bank_mask:0xf
 v_and_b32_dpp v109, v101, v163 quad_perm:[0,0,2,2] row_mask:0xf bank_mask:0xf
 v_mfma_f32_16x16x16_bf16 v[120:123], v[106:107], a[2:3], 0
 v_and_b32_dpp v110, v102, v162 quad_perm:[0,0,2,2] row_mask:0xf bank_mask:0xf
 v_and_b32_dpp v111, v103, v163 quad_perm:[0,0,2,2] row_mask:0xf bank_mask:0xf
 v_mfma_f32_16x16x16_bf16 v[124:127], v[106:107], a[6:7], 0
 v_cvt_pk_bf16_f32 v128, v112, v113
 v_cvt_pk_bf16_f32 v129, v114, v115
 buffer_load_dwordx4 v166, s[24:27], s48 offen offset:0 lds
 s_waitcnt lgkmcnt(0)
 v_mfma_f32_16x16x32_bf16 v[36:39], v[64:67], v[92:95], v[36:39]
 v_cvt_pk_bf16_f32 v132, v116, v117
 v_cvt_pk_bf16_f32 v133, v118, v119
 v_mfma_f32_16x16x32_bf16 v[4:7], v[64:67], v[136:139], v[4:7]
 v_cvt_pk_bf16_f32 v130, v120, v121
 v_cvt_pk_bf16_f32 v131, v122, v123
 s_waitcnt vmcnt(15)
 s_barrier
 v_mfma_f32_16x16x32_bf16 v[8:11], v[64:67], v[140:143], v[8:11]
 ds_read_b64_tr_b16 v[48:49], v146 offset:0
 ds_read_b64_tr_b16 v[50:51], v146 offset:512
 v_mfma_f32_16x16x32_bf16 v[16:19], v[68:71], v[140:143], v[16:19]
 ds_read_b64_tr_b16 v[52:53], v147 offset:0
 ds_read_b64_tr_b16 v[54:55], v147 offset:512
 buffer_load_dwordx4 v167, s[24:27], s48 offen offset:1024 lds
 v_mfma_f32_16x16x32_bf16 v[12:15], v[68:71], v[136:139], v[12:15]
 ds_read_b64_tr_b16 v[56:57], v148 offset:0
 ds_read_b64_tr_b16 v[58:59], v148 offset:512
 v_mfma_f32_16x16x32_bf16 v[20:23], v[72:75], v[136:139], v[20:23]
 ds_read_b64_tr_b16 v[60:61], v149 offset:0
 ds_read_b64_tr_b16 v[62:63], v149 offset:512
 v_mfma_f32_16x16x32_bf16 v[24:27], v[72:75], v[140:143], v[24:27]
 ds_read_b128 a[0:3], v144 offset:24576
 ds_read_b128 a[4:7], v144 offset:26624
 v_mfma_f32_16x16x32_bf16 v[32:35], v[76:79], v[140:143], v[32:35]
 ds_read_b128 v[92:95], v42 offset:832
 buffer_load_dwordx4 v166, s[24:27], s49 offen offset:2048 lds
 v_mfma_f32_16x16x32_bf16 v[28:31], v[76:79], v[136:139], v[28:31]
 v_mfma_f32_16x16x16_bf16 v[112:115], v[108:109], a[8:9], 0
 v_cvt_pk_bf16_f32 v134, v124, v125
 v_cvt_pk_bf16_f32 v135, v126, v127
 v_mfma_f32_16x16x16_bf16 v[116:119], v[108:109], a[12:13], 0
 v_and_b32_dpp v104, v88, v162 quad_perm:[0,0,2,2] row_mask:0xf bank_mask:0xf
 v_and_b32_dpp v105, v89, v163 quad_perm:[0,0,2,2] row_mask:0xf bank_mask:0xf
 v_mfma_f32_16x16x16_bf16 v[120:123], v[110:111], a[10:11], 0
 v_and_b32_dpp v106, v90, v162 quad_perm:[0,0,2,2] row_mask:0xf bank_mask:0xf
 v_and_b32_dpp v107, v91, v163 quad_perm:[0,0,2,2] row_mask:0xf bank_mask:0xf
 v_mfma_f32_16x16x16_bf16 v[124:127], v[110:111], a[14:15], 0
 v_cvt_pk_bf16_f32 v136, v112, v113
 v_cvt_pk_bf16_f32 v137, v114, v115
 buffer_load_dwordx4 v167, s[24:27], s49 offen offset:3072 lds
 s_add_u32 m0, s50, 24576
 s_mov_b32 s42, 1179648
 s_waitcnt lgkmcnt(0)
 v_mfma_f32_16x16x32_bf16 v[36:39], v[48:51], v[96:99], v[36:39]
 v_cvt_pk_bf16_f32 v140, v116, v117
 v_cvt_pk_bf16_f32 v141, v118, v119
 v_mfma_f32_16x16x32_bf16 v[4:7], v[48:51], v[128:131], v[4:7]
 v_cvt_pk_bf16_f32 v138, v120, v121
 v_cvt_pk_bf16_f32 v139, v122, v123
 s_or_b32 s18, s2, s3
 s_cselect_b32 s18, 1073741824, 0
 v_mfma_f32_16x16x32_bf16 v[8:11], v[48:51], v[132:135], v[8:11]
 ds_read_b64_tr_b16 v[64:65], v146 offset:4096
 ds_read_b64_tr_b16 v[66:67], v146 offset:4608
 s_add_u32 s18, s18, 327680
 v_mfma_f32_16x16x32_bf16 v[16:19], v[52:55], v[132:135], v[16:19]
 ds_read_b64_tr_b16 v[68:69], v147 offset:4096
 ds_read_b64_tr_b16 v[70:71], v147 offset:4608
 buffer_load_dwordx4 v164, s[20:23], s42 offen offset:0 lds
 v_mov_b32 v253, s18
 v_mfma_f32_16x16x32_bf16 v[12:15], v[52:55], v[128:131], v[12:15]
 ds_read_b64_tr_b16 v[72:73], v148 offset:4096
 ds_read_b64_tr_b16 v[74:75], v148 offset:4608
 v_cmp_eq_u32 vcc, 0, v0
 v_mfma_f32_16x16x32_bf16 v[20:23], v[56:59], v[128:131], v[20:23]
 ds_read_b64_tr_b16 v[76:77], v149 offset:4096
 ds_read_b64_tr_b16 v[78:79], v149 offset:4608
 v_mov_b32 v254, 1073741824
 v_mfma_f32_16x16x32_bf16 v[24:27], v[56:59], v[132:135], v[24:27]
 ds_read_b128 a[8:11], v145 offset:24576
 ds_read_b128 a[12:15], v145 offset:26624
 v_cndmask_b32 v253, v254, v253, vcc
 v_mfma_f32_16x16x32_bf16 v[32:35], v[60:63], v[132:135], v[32:35]
 ds_read_b128 v[96:99], v42 offset:896
 buffer_load_dwordx4 v165, s[20:23], s42 offen offset:1024 lds
 s_lshl1_add_u32 m0, s50, 57344
 s_add_u32 s48, s48, 128
 s_add_u32 s49, s49, 128
 v_mov_b32 v254, s59
 v_mfma_f32_16x16x32_bf16 v[28:31], v[60:63], v[128:131], v[28:31]
 v_mfma_f32_16x16x16_bf16 v[112:115], v[104:105], a[0:1], 0
 v_cvt_pk_bf16_f32 v142, v124, v125
 v_cvt_pk_bf16_f32 v143, v126, v127
 v_mfma_f32_16x16x16_bf16 v[116:119], v[104:105], a[4:5], 0
 v_and_b32_dpp v108, v92, v162 quad_perm:[0,0,2,2] row_mask:0xf bank_mask:0xf
 v_and_b32_dpp v109, v93, v163 quad_perm:[0,0,2,2] row_mask:0xf bank_mask:0xf
 v_mfma_f32_16x16x16_bf16 v[120:123], v[106:107], a[2:3], 0
 v_and_b32_dpp v110, v94, v162 quad_perm:[0,0,2,2] row_mask:0xf bank_mask:0xf
 v_and_b32_dpp v111, v95, v163 quad_perm:[0,0,2,2] row_mask:0xf bank_mask:0xf
 v_mfma_f32_16x16x16_bf16 v[124:127], v[106:107], a[6:7], 0
 v_cvt_pk_bf16_f32 v128, v112, v113
 v_cvt_pk_bf16_f32 v129, v114, v115
 buffer_load_dwordx4 v166, s[24:27], s48 offen offset:0 lds
 s_waitcnt lgkmcnt(0)
 v_mfma_f32_16x16x32_bf16 v[36:39], v[64:67], v[100:103], v[36:39]
 v_cvt_pk_bf16_f32 v132, v116, v117
 v_cvt_pk_bf16_f32 v133, v118, v119
 v_mfma_f32_16x16x32_bf16 v[4:7], v[64:67], v[136:139], v[4:7]
 v_cvt_pk_bf16_f32 v130, v120, v121
 v_cvt_pk_bf16_f32 v131, v122, v123
 s_waitcnt vmcnt(15)
 s_barrier
 v_and_b32 v1, 1, v0
 v_mfma_f32_16x16x32_bf16 v[8:11], v[64:67], v[140:143], v[8:11]
 ds_read_b64_tr_b16 v[48:49], v146 offset:24576
 ds_read_b64_tr_b16 v[50:51], v146 offset:25088
 v_cmp_eq_u32 vcc, 1, v1
 v_mfma_f32_16x16x32_bf16 v[16:19], v[68:71], v[140:143], v[16:19]
 ds_read_b64_tr_b16 v[52:53], v147 offset:24576
 ds_read_b64_tr_b16 v[54:55], v147 offset:25088
 buffer_load_dwordx4 v167, s[24:27], s48 offen offset:1024 lds
 v_mov_b32 v1, s4
 v_mfma_f32_16x16x32_bf16 v[12:15], v[68:71], v[136:139], v[12:15]
 ds_read_b64_tr_b16 v[56:57], v148 offset:24576
 ds_read_b64_tr_b16 v[58:59], v148 offset:25088
 v_cndmask_b32 v44, 1.0, v1, vcc
 v_mfma_f32_16x16x32_bf16 v[20:23], v[72:75], v[136:139], v[20:23]
 ds_read_b64_tr_b16 v[60:61], v149 offset:24576
 ds_read_b64_tr_b16 v[62:63], v149 offset:25088
 v_and_b32 v1, 1, v0
 v_mfma_f32_16x16x32_bf16 v[24:27], v[72:75], v[140:143], v[24:27]
 ds_read_b128 a[0:3], v144 offset:49152
 ds_read_b128 a[4:7], v144 offset:51200
 v_lshlrev_b32 v1, 6, v1
 v_mfma_f32_16x16x32_bf16 v[32:35], v[76:79], v[140:143], v[32:35]
 ds_read_b128 v[100:103], v42 offset:960
 buffer_load_dwordx4 v166, s[24:27], s49 offen offset:2048 lds
 v_lshrrev_b32 v2, 4, v0
 v_mfma_f32_16x16x32_bf16 v[28:31], v[76:79], v[136:139], v[28:31]
 v_lshlrev_b32 v2, 4, v2
 v_mfma_f32_16x16x16_bf16 v[112:115], v[108:109], a[8:9], 0
 v_cvt_pk_bf16_f32 v134, v124, v125
 v_cvt_pk_bf16_f32 v135, v126, v127
 v_mfma_f32_16x16x16_bf16 v[116:119], v[108:109], a[12:13], 0
 v_and_b32_dpp v104, v96, v162 quad_perm:[0,0,2,2] row_mask:0xf bank_mask:0xf
 v_and_b32_dpp v105, v97, v163 quad_perm:[0,0,2,2] row_mask:0xf bank_mask:0xf
 v_mfma_f32_16x16x16_bf16 v[120:123], v[110:111], a[10:11], 0
 v_and_b32_dpp v106, v98, v162 quad_perm:[0,0,2,2] row_mask:0xf bank_mask:0xf
 v_and_b32_dpp v107, v99, v163 quad_perm:[0,0,2,2] row_mask:0xf bank_mask:0xf
 v_mfma_f32_16x16x16_bf16 v[124:127], v[110:111], a[14:15], 0
 v_cvt_pk_bf16_f32 v136, v112, v113
 v_cvt_pk_bf16_f32 v137, v114, v115
 buffer_load_dwordx4 v167, s[24:27], s49 offen offset:3072 lds
 s_add_u32 m0, s50, 49152
 s_mov_b32 s42, 1310720
 s_waitcnt lgkmcnt(0)
 v_mfma_f32_16x16x32_bf16 v[36:39], v[48:51], v[88:91], v[36:39]
 v_cvt_pk_bf16_f32 v140, v116, v117
 v_cvt_pk_bf16_f32 v141, v118, v119
 v_mfma_f32_16x16x32_bf16 v[4:7], v[48:51], v[128:131], v[4:7]
 v_cvt_pk_bf16_f32 v138, v120, v121
 v_cvt_pk_bf16_f32 v139, v122, v123
 s_lshl_b32 s18, s3, 7
 v_mfma_f32_16x16x32_bf16 v[8:11], v[48:51], v[132:135], v[8:11]
 ds_read_b64_tr_b16 v[64:65], v146 offset:28672
 ds_read_b64_tr_b16 v[66:67], v146 offset:29184
 v_add3_u32 v1, v1, v2, s18
 v_mfma_f32_16x16x32_bf16 v[16:19], v[52:55], v[132:135], v[16:19]
 ds_read_b64_tr_b16 v[68:69], v147 offset:28672
 ds_read_b64_tr_b16 v[70:71], v147 offset:29184
 buffer_load_dwordx4 v164, s[20:23], s42 offen offset:0 lds
 v_add_u32 v45, 152064, v1
 v_mfma_f32_16x16x32_bf16 v[12:15], v[52:55], v[128:131], v[12:15]
 ds_read_b64_tr_b16 v[72:73], v148 offset:28672
 ds_read_b64_tr_b16 v[74:75], v148 offset:29184
 v_add_u32 v2, 152064, v2
 v_mfma_f32_16x16x32_bf16 v[20:23], v[56:59], v[128:131], v[20:23]
 ds_read_b64_tr_b16 v[76:77], v149 offset:28672
 ds_read_b64_tr_b16 v[78:79], v149 offset:29184
 v_add_u32 v180, s18, v2
 v_mfma_f32_16x16x32_bf16 v[24:27], v[56:59], v[132:135], v[24:27]
 ds_read_b128 a[8:11], v145 offset:49152
 ds_read_b128 a[12:15], v145 offset:51200
 v_xor_b32 v181, 128, v180
 v_mfma_f32_16x16x32_bf16 v[32:35], v[60:63], v[132:135], v[32:35]
 ds_read_b128 v[88:91], v42 offset:1024
 buffer_load_dwordx4 v165, s[20:23], s42 offen offset:1024 lds
 s_lshl1_add_u32 m0, s50, 81920
 s_add_u32 s48, s48, 128
 s_add_u32 s49, s49, 128
 v_xor_b32 v182, 256, v180
 v_mfma_f32_16x16x32_bf16 v[28:31], v[60:63], v[128:131], v[28:31]
 v_xor_b32 v183, 384, v180
 v_mfma_f32_16x16x16_bf16 v[112:115], v[104:105], a[0:1], 0
 v_cvt_pk_bf16_f32 v142, v124, v125
 v_cvt_pk_bf16_f32 v143, v126, v127
 v_mfma_f32_16x16x16_bf16 v[116:119], v[104:105], a[4:5], 0
 v_and_b32_dpp v108, v100, v162 quad_perm:[0,0,2,2] row_mask:0xf bank_mask:0xf
 v_and_b32_dpp v109, v101, v163 quad_perm:[0,0,2,2] row_mask:0xf bank_mask:0xf
 v_mfma_f32_16x16x16_bf16 v[120:123], v[106:107], a[2:3], 0
 v_and_b32_dpp v110, v102, v162 quad_perm:[0,0,2,2] row_mask:0xf bank_mask:0xf
 v_and_b32_dpp v111, v103, v163 quad_perm:[0,0,2,2] row_mask:0xf bank_mask:0xf
 v_mfma_f32_16x16x16_bf16 v[124:127], v[106:107], a[6:7], 0
 v_cvt_pk_bf16_f32 v128, v112, v113
 v_cvt_pk_bf16_f32 v129, v114, v115
 buffer_load_dwordx4 v166, s[24:27], s48 offen offset:0 lds
 s_waitcnt lgkmcnt(0)
 v_mfma_f32_16x16x32_bf16 v[36:39], v[64:67], v[92:95], v[36:39]
 v_cvt_pk_bf16_f32 v132, v116, v117
 v_cvt_pk_bf16_f32 v133, v118, v119
 v_mfma_f32_16x16x32_bf16 v[4:7], v[64:67], v[136:139], v[4:7]
 v_cvt_pk_bf16_f32 v130, v120, v121
 v_cvt_pk_bf16_f32 v131, v122, v123
 s_waitcnt vmcnt(15)
 s_barrier
 v_lshrrev_b32 v1, 1, v0
 v_mfma_f32_16x16x32_bf16 v[8:11], v[64:67], v[140:143], v[8:11]
 ds_read_b64_tr_b16 v[48:49], v146 offset:49152
 ds_read_b64_tr_b16 v[50:51], v146 offset:49664
 v_mul_u32_u24 v1, 12288, v1
 v_mfma_f32_16x16x32_bf16 v[16:19], v[68:71], v[140:143], v[16:19]
 ds_read_b64_tr_b16 v[52:53], v147 offset:49152
 ds_read_b64_tr_b16 v[54:55], v147 offset:49664
 buffer_load_dwordx4 v167, s[24:27], s48 offen offset:1024 lds
 v_and_b32 v2, 1, v0
 v_mfma_f32_16x16x32_bf16 v[12:15], v[68:71], v[136:139], v[12:15]
 ds_read_b64_tr_b16 v[56:57], v148 offset:49152
 ds_read_b64_tr_b16 v[58:59], v148 offset:49664
 v_lshl_add_u32 v40, v2, 4, v1
 v_mfma_f32_16x16x32_bf16 v[20:23], v[72:75], v[136:139], v[20:23]
 ds_read_b64_tr_b16 v[60:61], v149 offset:49152
 ds_read_b64_tr_b16 v[62:63], v149 offset:49664
 v_mfma_f32_16x16x32_bf16 v[24:27], v[72:75], v[140:143], v[24:27]
 ds_read_b128 a[0:3], v154 offset:0
 ds_read_b128 a[4:7], v154 offset:2048
 v_mfma_f32_16x16x32_bf16 v[32:35], v[76:79], v[140:143], v[32:35]
 ds_read_b128 v[92:95], v42 offset:1088
 buffer_load_dwordx4 v166, s[24:27], s49 offen offset:2048 lds
 v_mfma_f32_16x16x32_bf16 v[28:31], v[76:79], v[136:139], v[28:31]
 v_mfma_f32_16x16x16_bf16 v[112:115], v[108:109], a[8:9], 0
 v_cvt_pk_bf16_f32 v134, v124, v125
 v_cvt_pk_bf16_f32 v135, v126, v127
 v_mfma_f32_16x16x16_bf16 v[116:119], v[108:109], a[12:13], 0
 v_and_b32_dpp v104, v88, v162 quad_perm:[0,0,2,2] row_mask:0xf bank_mask:0xf
 v_and_b32_dpp v105, v89, v163 quad_perm:[0,0,2,2] row_mask:0xf bank_mask:0xf
 v_mfma_f32_16x16x16_bf16 v[120:123], v[110:111], a[10:11], 0
 v_and_b32_dpp v106, v90, v162 quad_perm:[0,0,2,2] row_mask:0xf bank_mask:0xf
 v_and_b32_dpp v107, v91, v163 quad_perm:[0,0,2,2] row_mask:0xf bank_mask:0xf
 v_mfma_f32_16x16x16_bf16 v[124:127], v[110:111], a[14:15], 0
 v_cvt_pk_bf16_f32 v136, v112, v113
 v_cvt_pk_bf16_f32 v137, v114, v115
 buffer_load_dwordx4 v167, s[24:27], s49 offen offset:3072 lds
 s_add_u32 m0, s50, 73728
 s_mov_b32 s42, 1441792
 s_waitcnt lgkmcnt(0)
 v_mfma_f32_16x16x32_bf16 v[36:39], v[48:51], v[96:99], v[36:39]
 v_cvt_pk_bf16_f32 v140, v116, v117
 v_cvt_pk_bf16_f32 v141, v118, v119
 v_mfma_f32_16x16x32_bf16 v[4:7], v[48:51], v[128:131], v[4:7]
 v_cvt_pk_bf16_f32 v138, v120, v121
 v_cvt_pk_bf16_f32 v139, v122, v123
 v_mfma_f32_16x16x32_bf16 v[8:11], v[48:51], v[132:135], v[8:11]
 ds_read_b64_tr_b16 v[64:65], v146 offset:53248
 ds_read_b64_tr_b16 v[66:67], v146 offset:53760
 v_mfma_f32_16x16x32_bf16 v[16:19], v[52:55], v[132:135], v[16:19]
 ds_read_b64_tr_b16 v[68:69], v147 offset:53248
 ds_read_b64_tr_b16 v[70:71], v147 offset:53760
 buffer_load_dwordx4 v164, s[20:23], s42 offen offset:0 lds
 v_mfma_f32_16x16x32_bf16 v[12:15], v[52:55], v[128:131], v[12:15]
 ds_read_b64_tr_b16 v[72:73], v148 offset:53248
 ds_read_b64_tr_b16 v[74:75], v148 offset:53760
 v_mfma_f32_16x16x32_bf16 v[20:23], v[56:59], v[128:131], v[20:23]
 ds_read_b64_tr_b16 v[76:77], v149 offset:53248
 ds_read_b64_tr_b16 v[78:79], v149 offset:53760
 v_mfma_f32_16x16x32_bf16 v[24:27], v[56:59], v[132:135], v[24:27]
 ds_read_b128 a[8:11], v155 offset:0
 ds_read_b128 a[12:15], v155 offset:2048
 v_mfma_f32_16x16x32_bf16 v[32:35], v[60:63], v[132:135], v[32:35]
 ds_read_b128 v[96:99], v42 offset:1152
 buffer_load_dwordx4 v165, s[20:23], s42 offen offset:1024 lds
 s_lshl1_add_u32 m0, s50, 106496
 s_add_u32 s48, s48, 128
 s_add_u32 s49, s49, 128
 v_mfma_f32_16x16x32_bf16 v[28:31], v[60:63], v[128:131], v[28:31]
 v_mfma_f32_16x16x16_bf16 v[112:115], v[104:105], a[0:1], 0
 v_cvt_pk_bf16_f32 v142, v124, v125
 v_cvt_pk_bf16_f32 v143, v126, v127
 v_mfma_f32_16x16x16_bf16 v[116:119], v[104:105], a[4:5], 0
 v_and_b32_dpp v108, v92, v162 quad_perm:[0,0,2,2] row_mask:0xf bank_mask:0xf
 v_and_b32_dpp v109, v93, v163 quad_perm:[0,0,2,2] row_mask:0xf bank_mask:0xf
 v_mfma_f32_16x16x16_bf16 v[120:123], v[106:107], a[2:3], 0
 v_and_b32_dpp v110, v94, v162 quad_perm:[0,0,2,2] row_mask:0xf bank_mask:0xf
 v_and_b32_dpp v111, v95, v163 quad_perm:[0,0,2,2] row_mask:0xf bank_mask:0xf
 v_mfma_f32_16x16x16_bf16 v[124:127], v[106:107], a[6:7], 0
 v_cvt_pk_bf16_f32 v128, v112, v113
 v_cvt_pk_bf16_f32 v129, v114, v115
 buffer_load_dwordx4 v166, s[24:27], s48 offen offset:0 lds
 s_waitcnt lgkmcnt(0)
 v_mfma_f32_16x16x32_bf16 v[36:39], v[64:67], v[100:103], v[36:39]
 v_cvt_pk_bf16_f32 v132, v116, v117
 v_cvt_pk_bf16_f32 v133, v118, v119
 v_mfma_f32_16x16x32_bf16 v[4:7], v[64:67], v[136:139], v[4:7]
 v_cvt_pk_bf16_f32 v130, v120, v121
 v_cvt_pk_bf16_f32 v131, v122, v123
 s_waitcnt vmcnt(15)
 s_barrier
 v_mfma_f32_16x16x32_bf16 v[8:11], v[64:67], v[140:143], v[8:11]
 ds_read_b64_tr_b16 v[48:49], v156 offset:0
 ds_read_b64_tr_b16 v[50:51], v156 offset:512
 v_mfma_f32_16x16x32_bf16 v[16:19], v[68:71], v[140:143], v[16:19]
 ds_read_b64_tr_b16 v[52:53], v157 offset:0
 ds_read_b64_tr_b16 v[54:55], v157 offset:512
 buffer_load_dwordx4 v167, s[24:27], s48 offen offset:1024 lds
 v_mfma_f32_16x16x32_bf16 v[12:15], v[68:71], v[136:139], v[12:15]
 ds_read_b64_tr_b16 v[56:57], v158 offset:0
 ds_read_b64_tr_b16 v[58:59], v158 offset:512
 v_mfma_f32_16x16x32_bf16 v[20:23], v[72:75], v[136:139], v[20:23]
 ds_read_b64_tr_b16 v[60:61], v159 offset:0
 ds_read_b64_tr_b16 v[62:63], v159 offset:512
 v_mfma_f32_16x16x32_bf16 v[24:27], v[72:75], v[140:143], v[24:27]
 ds_read_b128 a[0:3], v154 offset:24576
 ds_read_b128 a[4:7], v154 offset:26624
 v_mfma_f32_16x16x32_bf16 v[32:35], v[76:79], v[140:143], v[32:35]
 ds_read_b128 v[100:103], v42 offset:1216
 buffer_load_dwordx4 v166, s[24:27], s49 offen offset:2048 lds
 v_mfma_f32_16x16x32_bf16 v[28:31], v[76:79], v[136:139], v[28:31]
 v_mfma_f32_16x16x16_bf16 v[112:115], v[108:109], a[8:9], 0
 v_cvt_pk_bf16_f32 v134, v124, v125
 v_cvt_pk_bf16_f32 v135, v126, v127
 v_mfma_f32_16x16x16_bf16 v[116:119], v[108:109], a[12:13], 0
 v_and_b32_dpp v104, v96, v162 quad_perm:[0,0,2,2] row_mask:0xf bank_mask:0xf
 v_and_b32_dpp v105, v97, v163 quad_perm:[0,0,2,2] row_mask:0xf bank_mask:0xf
 v_mfma_f32_16x16x16_bf16 v[120:123], v[110:111], a[10:11], 0
 v_and_b32_dpp v106, v98, v162 quad_perm:[0,0,2,2] row_mask:0xf bank_mask:0xf
 v_and_b32_dpp v107, v99, v163 quad_perm:[0,0,2,2] row_mask:0xf bank_mask:0xf
 v_mfma_f32_16x16x16_bf16 v[124:127], v[110:111], a[14:15], 0
 v_cvt_pk_bf16_f32 v136, v112, v113
 v_cvt_pk_bf16_f32 v137, v114, v115
 buffer_load_dwordx4 v167, s[24:27], s49 offen offset:3072 lds
 s_add_u32 m0, s50, 98304
 s_mov_b32 s42, 1572864
 s_waitcnt lgkmcnt(0)
 v_mfma_f32_16x16x32_bf16 v[36:39], v[48:51], v[88:91], v[36:39]
 v_cvt_pk_bf16_f32 v140, v116, v117
 v_cvt_pk_bf16_f32 v141, v118, v119
 v_mfma_f32_16x16x32_bf16 v[4:7], v[48:51], v[128:131], v[4:7]
 v_cvt_pk_bf16_f32 v138, v120, v121
 v_cvt_pk_bf16_f32 v139, v122, v123
 v_mfma_f32_16x16x32_bf16 v[8:11], v[48:51], v[132:135], v[8:11]
 ds_read_b64_tr_b16 v[64:65], v156 offset:4096
 ds_read_b64_tr_b16 v[66:67], v156 offset:4608
 v_mfma_f32_16x16x32_bf16 v[16:19], v[52:55], v[132:135], v[16:19]
 ds_read_b64_tr_b16 v[68:69], v157 offset:4096
 ds_read_b64_tr_b16 v[70:71], v157 offset:4608
 buffer_load_dwordx4 v164, s[20:23], s42 offen offset:0 lds
 v_mfma_f32_16x16x32_bf16 v[12:15], v[52:55], v[128:131], v[12:15]
 ds_read_b64_tr_b16 v[72:73], v158 offset:4096
 ds_read_b64_tr_b16 v[74:75], v158 offset:4608
 v_mfma_f32_16x16x32_bf16 v[20:23], v[56:59], v[128:131], v[20:23]
 ds_read_b64_tr_b16 v[76:77], v159 offset:4096
 ds_read_b64_tr_b16 v[78:79], v159 offset:4608
 v_mfma_f32_16x16x32_bf16 v[24:27], v[56:59], v[132:135], v[24:27]
 ds_read_b128 a[8:11], v155 offset:24576
 ds_read_b128 a[12:15], v155 offset:26624
 v_mfma_f32_16x16x32_bf16 v[32:35], v[60:63], v[132:135], v[32:35]
 ds_read_b128 v[88:91], v42 offset:1280
 buffer_load_dwordx4 v165, s[20:23], s42 offen offset:1024 lds
 s_lshl1_add_u32 m0, s50, 131072
 s_add_u32 s48, s48, 128
 s_add_u32 s49, s49, 128
 v_mfma_f32_16x16x32_bf16 v[28:31], v[60:63], v[128:131], v[28:31]
 v_mfma_f32_16x16x16_bf16 v[112:115], v[104:105], a[0:1], 0
 v_cvt_pk_bf16_f32 v142, v124, v125
 v_cvt_pk_bf16_f32 v143, v126, v127
 v_mfma_f32_16x16x16_bf16 v[116:119], v[104:105], a[4:5], 0
 v_and_b32_dpp v108, v100, v162 quad_perm:[0,0,2,2] row_mask:0xf bank_mask:0xf
 v_and_b32_dpp v109, v101, v163 quad_perm:[0,0,2,2] row_mask:0xf bank_mask:0xf
 v_mfma_f32_16x16x16_bf16 v[120:123], v[106:107], a[2:3], 0
 v_and_b32_dpp v110, v102, v162 quad_perm:[0,0,2,2] row_mask:0xf bank_mask:0xf
 v_and_b32_dpp v111, v103, v163 quad_perm:[0,0,2,2] row_mask:0xf bank_mask:0xf
 v_mfma_f32_16x16x16_bf16 v[124:127], v[106:107], a[6:7], 0
 v_cvt_pk_bf16_f32 v128, v112, v113
 v_cvt_pk_bf16_f32 v129, v114, v115
 buffer_load_dwordx4 v166, s[24:27], s48 offen offset:0 lds
 s_waitcnt lgkmcnt(0)
 v_mfma_f32_16x16x32_bf16 v[36:39], v[64:67], v[92:95], v[36:39]
 v_cvt_pk_bf16_f32 v132, v116, v117
 v_cvt_pk_bf16_f32 v133, v118, v119
 v_mfma_f32_16x16x32_bf16 v[4:7], v[64:67], v[136:139], v[4:7]
 v_cvt_pk_bf16_f32 v130, v120, v121
 v_cvt_pk_bf16_f32 v131, v122, v123
 s_waitcnt vmcnt(15)
 s_barrier
 v_mfma_f32_16x16x32_bf16 v[8:11], v[64:67], v[140:143], v[8:11]
 ds_read_b64_tr_b16 v[48:49], v156 offset:24576
 ds_read_b64_tr_b16 v[50:51], v156 offset:25088
 v_mfma_f32_16x16x32_bf16 v[16:19], v[68:71], v[140:143], v[16:19]
 ds_read_b64_tr_b16 v[52:53], v157 offset:24576
 ds_read_b64_tr_b16 v[54:55], v157 offset:25088
 buffer_load_dwordx4 v167, s[24:27], s48 offen offset:1024 lds
 v_mfma_f32_16x16x32_bf16 v[12:15], v[68:71], v[136:139], v[12:15]
 ds_read_b64_tr_b16 v[56:57], v158 offset:24576
 ds_read_b64_tr_b16 v[58:59], v158 offset:25088
 v_mfma_f32_16x16x32_bf16 v[20:23], v[72:75], v[136:139], v[20:23]
 ds_read_b64_tr_b16 v[60:61], v159 offset:24576
 ds_read_b64_tr_b16 v[62:63], v159 offset:25088
 v_mfma_f32_16x16x32_bf16 v[24:27], v[72:75], v[140:143], v[24:27]
 ds_read_b128 a[0:3], v154 offset:49152
 ds_read_b128 a[4:7], v154 offset:51200
 v_mfma_f32_16x16x32_bf16 v[32:35], v[76:79], v[140:143], v[32:35]
 ds_read_b128 v[92:95], v42 offset:1344
 buffer_load_dwordx4 v166, s[24:27], s49 offen offset:2048 lds
 v_mfma_f32_16x16x32_bf16 v[28:31], v[76:79], v[136:139], v[28:31]
 v_mfma_f32_16x16x16_bf16 v[112:115], v[108:109], a[8:9], 0
 v_cvt_pk_bf16_f32 v134, v124, v125
 v_cvt_pk_bf16_f32 v135, v126, v127
 v_mfma_f32_16x16x16_bf16 v[116:119], v[108:109], a[12:13], 0
 v_and_b32_dpp v104, v88, v162 quad_perm:[0,0,2,2] row_mask:0xf bank_mask:0xf
 v_and_b32_dpp v105, v89, v163 quad_perm:[0,0,2,2] row_mask:0xf bank_mask:0xf
 v_mfma_f32_16x16x16_bf16 v[120:123], v[110:111], a[10:11], 0
 v_and_b32_dpp v106, v90, v162 quad_perm:[0,0,2,2] row_mask:0xf bank_mask:0xf
 v_and_b32_dpp v107, v91, v163 quad_perm:[0,0,2,2] row_mask:0xf bank_mask:0xf
 v_mfma_f32_16x16x16_bf16 v[124:127], v[110:111], a[14:15], 0
 v_cvt_pk_bf16_f32 v136, v112, v113
 v_cvt_pk_bf16_f32 v137, v114, v115
 buffer_load_dwordx4 v167, s[24:27], s49 offen offset:3072 lds
 s_add_u32 m0, s50, 122880
 s_mov_b32 s42, 1703936
 s_waitcnt lgkmcnt(0)
 v_mfma_f32_16x16x32_bf16 v[36:39], v[48:51], v[96:99], v[36:39]
 v_cvt_pk_bf16_f32 v140, v116, v117
 v_cvt_pk_bf16_f32 v141, v118, v119
 v_mfma_f32_16x16x32_bf16 v[4:7], v[48:51], v[128:131], v[4:7]
 v_cvt_pk_bf16_f32 v138, v120, v121
 v_cvt_pk_bf16_f32 v139, v122, v123
 buffer_load_dwordx2 v[196:197], v211, s[44:47], 0 offen sc1
 buffer_load_dwordx4 v[188:191], v251, s[44:47], 0 offen offset:0 sc1
 buffer_load_dwordx4 v[192:195], v251, s[44:47], 0 offen offset:256 sc1
 v_mfma_f32_16x16x32_bf16 v[8:11], v[48:51], v[132:135], v[8:11]
 ds_read_b64_tr_b16 v[64:65], v156 offset:28672
 ds_read_b64_tr_b16 v[66:67], v156 offset:29184
 v_mfma_f32_16x16x32_bf16 v[16:19], v[52:55], v[132:135], v[16:19]
 ds_read_b64_tr_b16 v[68:69], v157 offset:28672
 ds_read_b64_tr_b16 v[70:71], v157 offset:29184
 buffer_load_dwordx4 v164, s[20:23], s42 offen offset:0 lds
 v_mfma_f32_16x16x32_bf16 v[12:15], v[52:55], v[128:131], v[12:15]
 ds_read_b64_tr_b16 v[72:73], v158 offset:28672
 ds_read_b64_tr_b16 v[74:75], v158 offset:29184
 v_mfma_f32_16x16x32_bf16 v[20:23], v[56:59], v[128:131], v[20:23]
 ds_read_b64_tr_b16 v[76:77], v159 offset:28672
 ds_read_b64_tr_b16 v[78:79], v159 offset:29184
 v_mfma_f32_16x16x32_bf16 v[24:27], v[56:59], v[132:135], v[24:27]
 ds_read_b128 a[8:11], v155 offset:49152
 ds_read_b128 a[12:15], v155 offset:51200
 v_mfma_f32_16x16x32_bf16 v[32:35], v[60:63], v[132:135], v[32:35]
 ds_read_b128 v[96:99], v42 offset:1408
 buffer_load_dwordx4 v165, s[20:23], s42 offen offset:1024 lds
 s_lshl1_add_u32 m0, s50, 8192
 s_add_u32 s48, s48, 128
 s_add_u32 s49, s49, 128
 v_mfma_f32_16x16x32_bf16 v[28:31], v[60:63], v[128:131], v[28:31]
 v_mfma_f32_16x16x16_bf16 v[112:115], v[104:105], a[0:1], 0
 v_cvt_pk_bf16_f32 v142, v124, v125
 v_cvt_pk_bf16_f32 v143, v126, v127
 v_mfma_f32_16x16x16_bf16 v[116:119], v[104:105], a[4:5], 0
 v_and_b32_dpp v108, v92, v162 quad_perm:[0,0,2,2] row_mask:0xf bank_mask:0xf
 v_and_b32_dpp v109, v93, v163 quad_perm:[0,0,2,2] row_mask:0xf bank_mask:0xf
 v_mfma_f32_16x16x16_bf16 v[120:123], v[106:107], a[2:3], 0
 v_and_b32_dpp v110, v94, v162 quad_perm:[0,0,2,2] row_mask:0xf bank_mask:0xf
 v_and_b32_dpp v111, v95, v163 quad_perm:[0,0,2,2] row_mask:0xf bank_mask:0xf
 v_mfma_f32_16x16x16_bf16 v[124:127], v[106:107], a[6:7], 0
 v_cvt_pk_bf16_f32 v128, v112, v113
 v_cvt_pk_bf16_f32 v129, v114, v115
 buffer_load_dwordx4 v166, s[24:27], s48 offen offset:0 lds
 s_waitcnt lgkmcnt(0)
 v_mfma_f32_16x16x32_bf16 v[36:39], v[64:67], v[100:103], v[36:39]
 v_cvt_pk_bf16_f32 v132, v116, v117
 v_cvt_pk_bf16_f32 v133, v118, v119
 v_mfma_f32_16x16x32_bf16 v[4:7], v[64:67], v[136:139], v[4:7]
 v_cvt_pk_bf16_f32 v130, v120, v121
 v_cvt_pk_bf16_f32 v131, v122, v123
 s_waitcnt vmcnt(18)
 s_barrier
 v_mfma_f32_16x16x32_bf16 v[8:11], v[64:67], v[140:143], v[8:11]
 ds_read_b64_tr_b16 v[48:49], v156 offset:49152
 ds_read_b64_tr_b16 v[50:51], v156 offset:49664
 v_mfma_f32_16x16x32_bf16 v[16:19], v[68:71], v[140:143], v[16:19]
 ds_read_b64_tr_b16 v[52:53], v157 offset:49152
 ds_read_b64_tr_b16 v[54:55], v157 offset:49664
 buffer_load_dwordx4 v167, s[24:27], s48 offen offset:1024 lds
 v_mfma_f32_16x16x32_bf16 v[12:15], v[68:71], v[136:139], v[12:15]
 ds_read_b64_tr_b16 v[56:57], v158 offset:49152
 ds_read_b64_tr_b16 v[58:59], v158 offset:49664
 v_mfma_f32_16x16x32_bf16 v[20:23], v[72:75], v[136:139], v[20:23]
 ds_read_b64_tr_b16 v[60:61], v159 offset:49152
 ds_read_b64_tr_b16 v[62:63], v159 offset:49664
 v_mfma_f32_16x16x32_bf16 v[24:27], v[72:75], v[140:143], v[24:27]
 ds_read_b128 a[0:3], v144 offset:0
 ds_read_b128 a[4:7], v144 offset:2048
 v_mfma_f32_16x16x32_bf16 v[32:35], v[76:79], v[140:143], v[32:35]
 ds_read_b128 v[100:103], v42 offset:1472
 buffer_load_dwordx4 v166, s[24:27], s49 offen offset:2048 lds
 v_mfma_f32_16x16x32_bf16 v[28:31], v[76:79], v[136:139], v[28:31]
 v_mfma_f32_16x16x16_bf16 v[112:115], v[108:109], a[8:9], 0
 v_cvt_pk_bf16_f32 v134, v124, v125
 v_cvt_pk_bf16_f32 v135, v126, v127
 v_mfma_f32_16x16x16_bf16 v[116:119], v[108:109], a[12:13], 0
 v_and_b32_dpp v104, v96, v162 quad_perm:[0,0,2,2] row_mask:0xf bank_mask:0xf
 v_and_b32_dpp v105, v97, v163 quad_perm:[0,0,2,2] row_mask:0xf bank_mask:0xf
 v_mfma_f32_16x16x16_bf16 v[120:123], v[110:111], a[10:11], 0
 v_and_b32_dpp v106, v98, v162 quad_perm:[0,0,2,2] row_mask:0xf bank_mask:0xf
 v_and_b32_dpp v107, v99, v163 quad_perm:[0,0,2,2] row_mask:0xf bank_mask:0xf
 v_mfma_f32_16x16x16_bf16 v[124:127], v[110:111], a[14:15], 0
 v_cvt_pk_bf16_f32 v136, v112, v113
 v_cvt_pk_bf16_f32 v137, v114, v115
 buffer_load_dwordx4 v167, s[24:27], s49 offen offset:3072 lds
 s_add_u32 m0, s50, 0
 s_mov_b32 s42, 1835008
 s_waitcnt lgkmcnt(0)
 v_mfma_f32_16x16x32_bf16 v[36:39], v[48:51], v[88:91], v[36:39]
 v_cvt_pk_bf16_f32 v140, v116, v117
 v_cvt_pk_bf16_f32 v141, v118, v119
 v_mfma_f32_16x16x32_bf16 v[4:7], v[48:51], v[128:131], v[4:7]
 v_cvt_pk_bf16_f32 v138, v120, v121
 v_cvt_pk_bf16_f32 v139, v122, v123
 v_mfma_f32_16x16x32_bf16 v[8:11], v[48:51], v[132:135], v[8:11]
 ds_read_b64_tr_b16 v[64:65], v156 offset:53248
 ds_read_b64_tr_b16 v[66:67], v156 offset:53760
 v_mfma_f32_16x16x32_bf16 v[16:19], v[52:55], v[132:135], v[16:19]
 ds_read_b64_tr_b16 v[68:69], v157 offset:53248
 ds_read_b64_tr_b16 v[70:71], v157 offset:53760
 buffer_load_dwordx4 v164, s[20:23], s42 offen offset:0 lds
 v_mfma_f32_16x16x32_bf16 v[12:15], v[52:55], v[128:131], v[12:15]
 ds_read_b64_tr_b16 v[72:73], v158 offset:53248
 ds_read_b64_tr_b16 v[74:75], v158 offset:53760
 v_mfma_f32_16x16x32_bf16 v[20:23], v[56:59], v[128:131], v[20:23]
 ds_read_b64_tr_b16 v[76:77], v159 offset:53248
 ds_read_b64_tr_b16 v[78:79], v159 offset:53760
 v_mfma_f32_16x16x32_bf16 v[24:27], v[56:59], v[132:135], v[24:27]
 ds_read_b128 a[8:11], v145 offset:0
 ds_read_b128 a[12:15], v145 offset:2048
 v_mfma_f32_16x16x32_bf16 v[32:35], v[60:63], v[132:135], v[32:35]
 ds_read_b128 v[88:91], v42 offset:1536
 buffer_load_dwordx4 v165, s[20:23], s42 offen offset:1024 lds
 s_lshl1_add_u32 m0, s50, 32768
 s_add_u32 s48, s48, 128
 s_add_u32 s49, s49, 128
 v_mfma_f32_16x16x32_bf16 v[28:31], v[60:63], v[128:131], v[28:31]
 v_mfma_f32_16x16x16_bf16 v[112:115], v[104:105], a[0:1], 0
 v_cvt_pk_bf16_f32 v142, v124, v125
 v_cvt_pk_bf16_f32 v143, v126, v127
 v_mfma_f32_16x16x16_bf16 v[116:119], v[104:105], a[4:5], 0
 v_and_b32_dpp v108, v100, v162 quad_perm:[0,0,2,2] row_mask:0xf bank_mask:0xf
 v_and_b32_dpp v109, v101, v163 quad_perm:[0,0,2,2] row_mask:0xf bank_mask:0xf
 v_mfma_f32_16x16x16_bf16 v[120:123], v[106:107], a[2:3], 0
 v_and_b32_dpp v110, v102, v162 quad_perm:[0,0,2,2] row_mask:0xf bank_mask:0xf
 v_and_b32_dpp v111, v103, v163 quad_perm:[0,0,2,2] row_mask:0xf bank_mask:0xf
 v_mfma_f32_16x16x16_bf16 v[124:127], v[106:107], a[6:7], 0
 v_cvt_pk_bf16_f32 v128, v112, v113
 v_cvt_pk_bf16_f32 v129, v114, v115
 buffer_load_dwordx4 v166, s[24:27], s48 offen offset:0 lds
 s_waitcnt lgkmcnt(0)
 v_mfma_f32_16x16x32_bf16 v[36:39], v[64:67], v[92:95], v[36:39]
 v_cvt_pk_bf16_f32 v132, v116, v117
 v_cvt_pk_bf16_f32 v133, v118, v119
 v_mfma_f32_16x16x32_bf16 v[4:7], v[64:67], v[136:139], v[4:7]
 v_cvt_pk_bf16_f32 v130, v120, v121
 v_cvt_pk_bf16_f32 v131, v122, v123
 s_waitcnt vmcnt(18)
 s_barrier
 v_mfma_f32_16x16x32_bf16 v[8:11], v[64:67], v[140:143], v[8:11]
 ds_read_b64_tr_b16 v[48:49], v146 offset:0
 ds_read_b64_tr_b16 v[50:51], v146 offset:512
 v_mfma_f32_16x16x32_bf16 v[16:19], v[68:71], v[140:143], v[16:19]
 ds_read_b64_tr_b16 v[52:53], v147 offset:0
 ds_read_b64_tr_b16 v[54:55], v147 offset:512
 buffer_load_dwordx4 v167, s[24:27], s48 offen offset:1024 lds
 v_mfma_f32_16x16x32_bf16 v[12:15], v[68:71], v[136:139], v[12:15]
 ds_read_b64_tr_b16 v[56:57], v148 offset:0
 ds_read_b64_tr_b16 v[58:59], v148 offset:512
 v_mfma_f32_16x16x32_bf16 v[20:23], v[72:75], v[136:139], v[20:23]
 ds_read_b64_tr_b16 v[60:61], v149 offset:0
 ds_read_b64_tr_b16 v[62:63], v149 offset:512
 v_mfma_f32_16x16x32_bf16 v[24:27], v[72:75], v[140:143], v[24:27]
 ds_read_b128 a[0:3], v144 offset:24576
 ds_read_b128 a[4:7], v144 offset:26624
 v_mfma_f32_16x16x32_bf16 v[32:35], v[76:79], v[140:143], v[32:35]
 ds_read_b128 v[92:95], v42 offset:1600
 buffer_load_dwordx4 v166, s[24:27], s49 offen offset:2048 lds
 v_mfma_f32_16x16x32_bf16 v[28:31], v[76:79], v[136:139], v[28:31]
 v_mfma_f32_16x16x16_bf16 v[112:115], v[108:109], a[8:9], 0
 v_cvt_pk_bf16_f32 v134, v124, v125
 v_cvt_pk_bf16_f32 v135, v126, v127
 v_mfma_f32_16x16x16_bf16 v[116:119], v[108:109], a[12:13], 0
 v_and_b32_dpp v104, v88, v162 quad_perm:[0,0,2,2] row_mask:0xf bank_mask:0xf
 v_and_b32_dpp v105, v89, v163 quad_perm:[0,0,2,2] row_mask:0xf bank_mask:0xf
 v_mfma_f32_16x16x16_bf16 v[120:123], v[110:111], a[10:11], 0
 v_and_b32_dpp v106, v90, v162 quad_perm:[0,0,2,2] row_mask:0xf bank_mask:0xf
 v_and_b32_dpp v107, v91, v163 quad_perm:[0,0,2,2] row_mask:0xf bank_mask:0xf
 v_mfma_f32_16x16x16_bf16 v[124:127], v[110:111], a[14:15], 0
 v_cvt_pk_bf16_f32 v136, v112, v113
 v_cvt_pk_bf16_f32 v137, v114, v115
 buffer_load_dwordx4 v167, s[24:27], s49 offen offset:3072 lds
 s_add_u32 m0, s50, 24576
 s_mov_b32 s42, 1966080
 s_waitcnt lgkmcnt(0)
 v_mfma_f32_16x16x32_bf16 v[36:39], v[48:51], v[96:99], v[36:39]
 v_cvt_pk_bf16_f32 v140, v116, v117
 v_cvt_pk_bf16_f32 v141, v118, v119
 v_mfma_f32_16x16x32_bf16 v[4:7], v[48:51], v[128:131], v[4:7]
 v_cvt_pk_bf16_f32 v138, v120, v121
 v_cvt_pk_bf16_f32 v139, v122, v123
 v_mfma_f32_16x16x32_bf16 v[8:11], v[48:51], v[132:135], v[8:11]
 ds_read_b64_tr_b16 v[64:65], v146 offset:4096
 ds_read_b64_tr_b16 v[66:67], v146 offset:4608
 v_mfma_f32_16x16x32_bf16 v[16:19], v[52:55], v[132:135], v[16:19]
 ds_read_b64_tr_b16 v[68:69], v147 offset:4096
 ds_read_b64_tr_b16 v[70:71], v147 offset:4608
 buffer_load_dwordx4 v164, s[20:23], s42 offen offset:0 lds
 v_mfma_f32_16x16x32_bf16 v[12:15], v[52:55], v[128:131], v[12:15]
 ds_read_b64_tr_b16 v[72:73], v148 offset:4096
 ds_read_b64_tr_b16 v[74:75], v148 offset:4608
 v_mfma_f32_16x16x32_bf16 v[20:23], v[56:59], v[128:131], v[20:23]
 ds_read_b64_tr_b16 v[76:77], v149 offset:4096
 ds_read_b64_tr_b16 v[78:79], v149 offset:4608
 v_mfma_f32_16x16x32_bf16 v[24:27], v[56:59], v[132:135], v[24:27]
 ds_read_b128 a[8:11], v145 offset:24576
 ds_read_b128 a[12:15], v145 offset:26624
 v_mfma_f32_16x16x32_bf16 v[32:35], v[60:63], v[132:135], v[32:35]
 ds_read_b128 v[96:99], v42 offset:1664
 buffer_load_dwordx4 v165, s[20:23], s42 offen offset:1024 lds
 v_mfma_f32_16x16x32_bf16 v[28:31], v[60:63], v[128:131], v[28:31]
 s_mov_b32 s16, 0x8000
 s_waitcnt vmcnt(16)
 v_cmp_ne_u32 vcc, s59, v196
 v_cmp_ne_u32 s[18:19], s59, v197
 s_nop 0
 s_or_b64 vcc, vcc, s[18:19]
 s_waitcnt vmcnt(15)
 v_cmp_ne_u32 s[18:19], s59, v189
 s_nop 0
 s_or_b64 vcc, vcc, s[18:19]
 v_cmp_ne_u32 s[18:19], s59, v191
 s_nop 0
 s_or_b64 vcc, vcc, s[18:19]
 s_waitcnt vmcnt(14)
 v_cmp_ne_u32 s[18:19], s59, v193
 s_nop 0
 s_or_b64 vcc, vcc, s[18:19]
 v_cmp_ne_u32 s[18:19], s59, v195
 s_nop 0
 s_or_b64 vcc, vcc, s[18:19]
 s_cbranch_vccz m_kernel_spin3x
m_kernel_spin3:
 buffer_load_dwordx2 v[196:197], v211, s[44:47], 0 offen sc1
 buffer_load_dwordx4 v[188:191], v251, s[44:47], 0 offen offset:0 sc1
 buffer_load_dwordx4 v[192:195], v251, s[44:47], 0 offen offset:256 sc1
 s_waitcnt vmcnt(0)
 v_cmp_ne_u32 vcc, s59, v196
 v_cmp_ne_u32 s[18:19], s59, v197
 s_nop 0
 s_or_b64 vcc, vcc, s[18:19]
 v_cmp_ne_u32 s[18:19], s59, v189
 s_nop 0
 s_or_b64 vcc, vcc, s[18:19]
 v_cmp_ne_u32 s[18:19], s59, v191
 s_nop 0
 s_or_b64 vcc, vcc, s[18:19]
 v_cmp_ne_u32 s[18:19], s59, v193
 s_nop 0
 s_or_b64 vcc, vcc, s[18:19]
 v_cmp_ne_u32 s[18:19], s59, v195
 s_nop 0
 s_or_b64 vcc, vcc, s[18:19]
 s_sub_u32 s16, s16, 1
 s_cselect_b64 vcc, 0, vcc
 s_cbranch_vccnz m_kernel_spin3
m_kernel_spin3x:
 v_mfma_f32_16x16x16_bf16 v[112:115], v[104:105], a[0:1], 0
 v_cvt_pk_bf16_f32 v142, v124, v125
 v_cvt_pk_bf16_f32 v143, v126, v127
 v_mfma_f32_16x16x16_bf16 v[116:119], v[104:105], a[4:5], 0
 v_and_b32_dpp v108, v92, v162 quad_perm:[0,0,2,2] row_mask:0xf bank_mask:0xf
 v_and_b32_dpp v109, v93, v163 quad_perm:[0,0,2,2] row_mask:0xf bank_mask:0xf
 v_mfma_f32_16x16x16_bf16 v[120:123], v[106:107], a[2:3], 0
 v_and_b32_dpp v110, v94, v162 quad_perm:[0,0,2,2] row_mask:0xf bank_mask:0xf
 v_and_b32_dpp v111, v95, v163 quad_perm:[0,0,2,2] row_mask:0xf bank_mask:0xf
 v_mfma_f32_16x16x16_bf16 v[124:127], v[106:107], a[6:7], 0
 v_cvt_pk_bf16_f32 v128, v112, v113
 v_cvt_pk_bf16_f32 v129, v114, v115
 s_waitcnt lgkmcnt(0)
 v_mfma_f32_16x16x32_bf16 v[36:39], v[64:67], v[100:103], v[36:39]
 v_cvt_pk_bf16_f32 v132, v116, v117
 v_cvt_pk_bf16_f32 v133, v118, v119
 v_mfma_f32_16x16x32_bf16 v[4:7], v[64:67], v[136:139], v[4:7]
 v_cvt_pk_bf16_f32 v130, v120, v121
 v_cvt_pk_bf16_f32 v131, v122, v123
 s_barrier
 v_mfma_f32_16x16x32_bf16 v[8:11], v[64:67], v[140:143], v[8:11]
 ds_read_b64_tr_b16 v[48:49], v146 offset:24576
 ds_read_b64_tr_b16 v[50:51], v146 offset:25088
 buffer_load_dwordx4 v[212:215], v221, s[28:31], 0 offen offset:0 sc1
 v_mfma_f32_16x16x32_bf16 v[16:19], v[68:71], v[140:143], v[16:19]
 ds_read_b64_tr_b16 v[52:53], v147 offset:24576
 ds_read_b64_tr_b16 v[54:55], v147 offset:25088
 v_mfma_f32_16x16x32_bf16 v[12:15], v[68:71], v[136:139], v[12:15]
 ds_read_b64_tr_b16 v[56:57], v148 offset:24576
 ds_read_b64_tr_b16 v[58:59], v148 offset:25088
 buffer_load_dwordx4 v[216:219], v221, s[28:31], 0 offen offset:1024 sc1
 v_mfma_f32_16x16x32_bf16 v[20:23], v[72:75], v[136:139], v[20:23]
 ds_read_b64_tr_b16 v[60:61], v149 offset:24576
 ds_read_b64_tr_b16 v[62:63], v149 offset:25088
 v_mfma_f32_16x16x32_bf16 v[24:27], v[72:75], v[140:143], v[24:27]
 ds_read_b128 a[0:3], v144 offset:49152
 ds_read_b128 a[4:7], v144 offset:51200
 buffer_store_dword v254, v253, s[44:47], 0 offen
 v_mfma_f32_16x16x32_bf16 v[32:35], v[76:79], v[140:143], v[32:35]
 ds_read_b128 v[100:103], v42 offset:1728
 v_mfma_f32_16x16x32_bf16 v[28:31], v[76:79], v[136:139], v[28:31]
 s_add_u32 m0, s56, 0
 s_mov_b32 s42, s6
 buffer_load_dwordx4 v221, s[28:31], s42 offen offset:0 sc1 lds
 v_mfma_f32_16x16x16_bf16 v[112:115], v[108:109], a[8:9], 0
 v_cvt_pk_bf16_f32 v134, v124, v125
 v_cvt_pk_bf16_f32 v135, v126, v127
 v_mfma_f32_16x16x16_bf16 v[116:119], v[108:109], a[12:13], 0
 v_and_b32_dpp v104, v96, v162 quad_perm:[0,0,2,2] row_mask:0xf bank_mask:0xf
 v_and_b32_dpp v105, v97, v163 quad_perm:[0,0,2,2] row_mask:0xf bank_mask:0xf
 v_mfma_f32_16x16x16_bf16 v[120:123], v[110:111], a[10:11], 0
 v_and_b32_dpp v106, v98, v162 quad_perm:[0,0,2,2] row_mask:0xf bank_mask:0xf
 v_and_b32_dpp v107, v99, v163 quad_perm:[0,0,2,2] row_mask:0xf bank_mask:0xf
 v_mfma_f32_16x16x16_bf16 v[124:127], v[110:111], a[14:15], 0
 v_cvt_pk_bf16_f32 v136, v112, v113
 v_cvt_pk_bf16_f32 v137, v114, v115
 buffer_load_dwordx4 v221, s[28:31], s42 offen offset:1024 sc1 lds
 s_waitcnt lgkmcnt(0)
 v_mfma_f32_16x16x32_bf16 v[36:39], v[48:51], v[88:91], v[36:39]
 v_cvt_pk_bf16_f32 v140, v116, v117
 v_cvt_pk_bf16_f32 v141, v118, v119
 v_mfma_f32_16x16x32_bf16 v[4:7], v[48:51], v[128:131], v[4:7]
 v_cvt_pk_bf16_f32 v138, v120, v121
 v_cvt_pk_bf16_f32 v139, v122, v123
 v_mfma_f32_16x16x32_bf16 v[8:11], v[48:51], v[132:135], v[8:11]
 ds_read_b64_tr_b16 v[64:65], v146 offset:28672
 ds_read_b64_tr_b16 v[66:67], v146 offset:29184
 v_mfma_f32_16x16x32_bf16 v[16:19], v[52:55], v[132:135], v[16:19]
 ds_read_b64_tr_b16 v[68:69], v147 offset:28672
 ds_read_b64_tr_b16 v[70:71], v147 offset:29184
 buffer_load_dwordx4 v221, s[28:31], s42 offen offset:2048 sc1 lds
 v_mfma_f32_16x16x32_bf16 v[12:15], v[52:55], v[128:131], v[12:15]
 ds_read_b64_tr_b16 v[72:73], v148 offset:28672
 ds_read_b64_tr_b16 v[74:75], v148 offset:29184
 v_mfma_f32_16x16x32_bf16 v[20:23], v[56:59], v[128:131], v[20:23]
 ds_read_b64_tr_b16 v[76:77], v149 offset:28672
 ds_read_b64_tr_b16 v[78:79], v149 offset:29184
 v_mfma_f32_16x16x32_bf16 v[24:27], v[56:59], v[132:135], v[24:27]
 ds_read_b128 a[8:11], v145 offset:49152
 ds_read_b128 a[12:15], v145 offset:51200
 v_mfma_f32_16x16x32_bf16 v[32:35], v[60:63], v[132:135], v[32:35]
 ds_read_b128 v[88:91], v42 offset:1792
 buffer_load_dwordx4 v221, s[28:31], s42 offen offset:3072 sc1 lds
 v_mfma_f32_16x16x32_bf16 v[28:31], v[60:63], v[128:131], v[28:31]
 v_mfma_f32_16x16x16_bf16 v[112:115], v[104:105], a[0:1], 0
 v_cvt_pk_bf16_f32 v142, v124, v125
 v_cvt_pk_bf16_f32 v143, v126, v127
 v_mfma_f32_16x16x16_bf16 v[116:119], v[104:105], a[4:5], 0
 v_and_b32_dpp v108, v100, v162 quad_perm:[0,0,2,2] row_mask:0xf bank_mask:0xf
 v_and_b32_dpp v109, v101, v163 quad_perm:[0,0,2,2] row_mask:0xf bank_mask:0xf
 v_mfma_f32_16x16x16_bf16 v[120:123], v[106:107], a[2:3], 0
 v_and_b32_dpp v110, v102, v162 quad_perm:[0,0,2,2] row_mask:0xf bank_mask:0xf
 v_and_b32_dpp v111, v103, v163 quad_perm:[0,0,2,2] row_mask:0xf bank_mask:0xf
 v_mfma_f32_16x16x16_bf16 v[124:127], v[106:107], a[6:7], 0
 v_cvt_pk_bf16_f32 v128, v112, v113
 v_cvt_pk_bf16_f32 v129, v114, v115
 s_waitcnt lgkmcnt(0)
 v_mfma_f32_16x16x32_bf16 v[36:39], v[64:67], v[92:95], v[36:39]
 v_cvt_pk_bf16_f32 v132, v116, v117
 v_cvt_pk_bf16_f32 v133, v118, v119
 v_mfma_f32_16x16x32_bf16 v[4:7], v[64:67], v[136:139], v[4:7]
 v_cvt_pk_bf16_f32 v130, v120, v121
 v_cvt_pk_bf16_f32 v131, v122, v123
 s_waitcnt vmcnt(15)
 s_barrier
 v_mfma_f32_16x16x32_bf16 v[8:11], v[64:67], v[140:143], v[8:11]
 ds_read_b64_tr_b16 v[48:49], v146 offset:49152
 ds_read_b64_tr_b16 v[50:51], v146 offset:49664
 s_add_u32 m0, s56, 16384
 s_add_u32 s42, s42, 16384
 buffer_load_dwordx4 v221, s[28:31], s42 offen offset:0 sc1 lds
 v_mfma_f32_16x16x32_bf16 v[16:19], v[68:71], v[140:143], v[16:19]
 ds_read_b64_tr_b16 v[52:53], v147 offset:49152
 ds_read_b64_tr_b16 v[54:55], v147 offset:49664
 v_mfma_f32_16x16x32_bf16 v[12:15], v[68:71], v[136:139], v[12:15]
 ds_read_b64_tr_b16 v[56:57], v148 offset:49152
 ds_read_b64_tr_b16 v[58:59], v148 offset:49664
 buffer_load_dwordx4 v221, s[28:31], s42 offen offset:1024 sc1 lds
 v_mfma_f32_16x16x32_bf16 v[20:23], v[72:75], v[136:139], v[20:23]
 ds_read_b64_tr_b16 v[60:61], v149 offset:49152
 ds_read_b64_tr_b16 v[62:63], v149 offset:49664
 v_mfma_f32_16x16x32_bf16 v[24:27], v[72:75], v[140:143], v[24:27]
 ds_read_b128 a[0:3], v154 offset:0
 ds_read_b128 a[4:7], v154 offset:2048
 v_mfma_f32_16x16x32_bf16 v[32:35], v[76:79], v[140:143], v[32:35]
 ds_read_b128 v[92:95], v42 offset:1856
 v_mfma_f32_16x16x32_bf16 v[28:31], v[76:79], v[136:139], v[28:31]
 v_mfma_f32_16x16x16_bf16 v[112:115], v[108:109], a[8:9], 0
 v_cvt_pk_bf16_f32 v134, v124, v125
 v_cvt_pk_bf16_f32 v135, v126, v127
 v_mfma_f32_16x16x16_bf16 v[116:119], v[108:109], a[12:13], 0
 v_and_b32_dpp v104, v88, v162 quad_perm:[0,0,2,2] row_mask:0xf bank_mask:0xf
 v_and_b32_dpp v105, v89, v163 quad_perm:[0,0,2,2] row_mask:0xf bank_mask:0xf
 v_mfma_f32_16x16x16_bf16 v[120:123], v[110:111], a[10:11], 0
 v_and_b32_dpp v106, v90, v162 quad_perm:[0,0,2,2] row_mask:0xf bank_mask:0xf
 v_and_b32_dpp v107, v91, v163 quad_perm:[0,0,2,2] row_mask:0xf bank_mask:0xf
 v_mfma_f32_16x16x16_bf16 v[124:127], v[110:111], a[14:15], 0
 v_cvt_pk_bf16_f32 v136, v112, v113
 v_cvt_pk_bf16_f32 v137, v114, v115
 buffer_load_dwordx4 v221, s[28:31], s42 offen offset:2048 sc1 lds
 s_waitcnt lgkmcnt(0)
 v_mfma_f32_16x16x32_bf16 v[36:39], v[48:51], v[96:99], v[36:39]
 v_cvt_pk_bf16_f32 v140, v116, v117
 v_cvt_pk_bf16_f32 v141, v118, v119
 v_mfma_f32_16x16x32_bf16 v[4:7], v[48:51], v[128:131], v[4:7]
 v_cvt_pk_bf16_f32 v138, v120, v121
 v_cvt_pk_bf16_f32 v139, v122, v123
 v_mfma_f32_16x16x32_bf16 v[8:11], v[48:51], v[132:135], v[8:11]
 ds_read_b64_tr_b16 v[64:65], v146 offset:53248
 ds_read_b64_tr_b16 v[66:67], v146 offset:53760
 v_mfma_f32_16x16x32_bf16 v[16:19], v[52:55], v[132:135], v[16:19]
 ds_read_b64_tr_b16 v[68:69], v147 offset:53248
 ds_read_b64_tr_b16 v[70:71], v147 offset:53760
 buffer_load_dwordx4 v221, s[28:31], s42 offen offset:3072 sc1 lds
 v_mfma_f32_16x16x32_bf16 v[12:15], v[52:55], v[128:131], v[12:15]
 ds_read_b64_tr_b16 v[72:73], v148 offset:53248
 ds_read_b64_tr_b16 v[74:75], v148 offset:53760
 v_mfma_f32_16x16x32_bf16 v[20:23], v[56:59], v[128:131], v[20:23]
 ds_read_b64_tr_b16 v[76:77], v149 offset:53248
 ds_read_b64_tr_b16 v[78:79], v149 offset:53760
 v_mfma_f32_16x16x32_bf16 v[24:27], v[56:59], v[132:135], v[24:27]
 ds_read_b128 a[8:11], v155 offset:0
 ds_read_b128 a[12:15], v155 offset:2048
 v_mfma_f32_16x16x32_bf16 v[32:35], v[60:63], v[132:135], v[32:35]
 ds_read_b128 v[96:99], v42 offset:1920
 v_mfma_f32_16x16x32_bf16 v[28:31], v[60:63], v[128:131], v[28:31]
 v_mfma_f32_16x16x16_bf16 v[112:115], v[104:105], a[0:1], 0
 v_cvt_pk_bf16_f32 v142, v124, v125
 v_cvt_pk_bf16_f32 v143, v126, v127
 v_mfma_f32_16x16x16_bf16 v[116:119], v[104:105], a[4:5], 0
 v_and_b32_dpp v108, v92, v162 quad_perm:[0,0,2,2] row_mask:0xf bank_mask:0xf
 v_and_b32_dpp v109, v93, v163 quad_perm:[0,0,2,2] row_mask:0xf bank_mask:0xf
 v_mfma_f32_16x16x16_bf16 v[120:123], v[106:107], a[2:3], 0
 v_and_b32_dpp v110, v94, v162 quad_perm:[0,0,2,2] row_mask:0xf bank_mask:0xf
 v_and_b32_dpp v111, v95, v163 quad_perm:[0,0,2,2] row_mask:0xf bank_mask:0xf
 v_mfma_f32_16x16x16_bf16 v[124:127], v[106:107], a[6:7], 0
 v_cvt_pk_bf16_f32 v128, v112, v113
 v_cvt_pk_bf16_f32 v129, v114, v115
 s_waitcnt lgkmcnt(0)
 v_mfma_f32_16x16x32_bf16 v[36:39], v[64:67], v[100:103], v[36:39]
 v_cvt_pk_bf16_f32 v132, v116, v117
 v_cvt_pk_bf16_f32 v133, v118, v119
 v_mfma_f32_16x16x32_bf16 v[4:7], v[64:67], v[136:139], v[4:7]
 v_cvt_pk_bf16_f32 v130, v120, v121
 v_cvt_pk_bf16_f32 v131, v122, v123
 s_waitcnt vmcnt(13)
 s_barrier
 v_mfma_f32_16x16x32_bf16 v[8:11], v[64:67], v[140:143], v[8:11]
 ds_read_b64_tr_b16 v[48:49], v156 offset:0
 ds_read_b64_tr_b16 v[50:51], v156 offset:512
 s_add_u32 m0, s56, 32768
 s_add_u32 s42, s42, 16384
 buffer_load_dwordx4 v221, s[28:31], s42 offen offset:0 sc1 lds
 v_mfma_f32_16x16x32_bf16 v[16:19], v[68:71], v[140:143], v[16:19]
 ds_read_b64_tr_b16 v[52:53], v157 offset:0
 ds_read_b64_tr_b16 v[54:55], v157 offset:512
 v_mfma_f32_16x16x32_bf16 v[12:15], v[68:71], v[136:139], v[12:15]
 ds_read_b64_tr_b16 v[56:57], v158 offset:0
 ds_read_b64_tr_b16 v[58:59], v158 offset:512
 buffer_load_dwordx4 v221, s[28:31], s42 offen offset:1024 sc1 lds
 v_mfma_f32_16x16x32_bf16 v[20:23], v[72:75], v[136:139], v[20:23]
 ds_read_b64_tr_b16 v[60:61], v159 offset:0
 ds_read_b64_tr_b16 v[62:63], v159 offset:512
 v_mfma_f32_16x16x32_bf16 v[24:27], v[72:75], v[140:143], v[24:27]
 ds_read_b128 a[0:3], v154 offset:24576
 ds_read_b128 a[4:7], v154 offset:26624
 v_mfma_f32_16x16x32_bf16 v[32:35], v[76:79], v[140:143], v[32:35]
 ds_read_b128 v[100:103], v42 offset:1984
 v_mfma_f32_16x16x32_bf16 v[28:31], v[76:79], v[136:139], v[28:31]
 v_mfma_f32_16x16x16_bf16 v[112:115], v[108:109], a[8:9], 0
 v_cvt_pk_bf16_f32 v134, v124, v125
 v_cvt_pk_bf16_f32 v135, v126, v127
 v_mfma_f32_16x16x16_bf16 v[116:119], v[108:109], a[12:13], 0
 v_and_b32_dpp v104, v96, v162 quad_perm:[0,0,2,2] row_mask:0xf bank_mask:0xf
 v_and_b32_dpp v105, v97, v163 quad_perm:[0,0,2,2] row_mask:0xf bank_mask:0xf
 v_mfma_f32_16x16x16_bf16 v[120:123], v[110:111], a[10:11], 0
 v_and_b32_dpp v106, v98, v162 quad_perm:[0,0,2,2] row_mask:0xf bank_mask:0xf
 v_and_b32_dpp v107, v99, v163 quad_perm:[0,0,2,2] row_mask:0xf bank_mask:0xf
 v_mfma_f32_16x16x16_bf16 v[124:127], v[110:111], a[14:15], 0
 v_cvt_pk_bf16_f32 v136, v112, v113
 v_cvt_pk_bf16_f32 v137, v114, v115
 buffer_load_dwordx4 v221, s[28:31], s42 offen offset:2048 sc1 lds
 s_waitcnt lgkmcnt(0)
 v_mfma_f32_16x16x32_bf16 v[36:39], v[48:51], v[88:91], v[36:39]
 v_cvt_pk_bf16_f32 v140, v116, v117
 v_cvt_pk_bf16_f32 v141, v118, v119
 v_mfma_f32_16x16x32_bf16 v[4:7], v[48:51], v[128:131], v[4:7]
 v_cvt_pk_bf16_f32 v138, v120, v121
 v_cvt_pk_bf16_f32 v139, v122, v123
 v_mfma_f32_16x16x32_bf16 v[8:11], v[48:51], v[132:135], v[8:11]
 ds_read_b64_tr_b16 v[64:65], v156 offset:4096
 ds_read_b64_tr_b16 v[66:67], v156 offset:4608
 v_mfma_f32_16x16x32_bf16 v[16:19], v[52:55], v[132:135], v[16:19]
 ds_read_b64_tr_b16 v[68:69], v157 offset:4096
 ds_read_b64_tr_b16 v[70:71], v157 offset:4608
 buffer_load_dwordx4 v221, s[28:31], s42 offen offset:3072 sc1 lds
 v_mfma_f32_16x16x32_bf16 v[12:15], v[52:55], v[128:131], v[12:15]
 ds_read_b64_tr_b16 v[72:73], v158 offset:4096
 ds_read_b64_tr_b16 v[74:75], v158 offset:4608
 v_mfma_f32_16x16x32_bf16 v[20:23], v[56:59], v[128:131], v[20:23]
 ds_read_b64_tr_b16 v[76:77], v159 offset:4096
 ds_read_b64_tr_b16 v[78:79], v159 offset:4608
 v_mfma_f32_16x16x32_bf16 v[24:27], v[56:59], v[132:135], v[24:27]
 ds_read_b128 a[8:11], v155 offset:24576
 ds_read_b128 a[12:15], v155 offset:26624
 v_mfma_f32_16x16x32_bf16 v[32:35], v[60:63], v[132:135], v[32:35]
 v_mfma_f32_16x16x32_bf16 v[28:31], v[60:63], v[128:131], v[28:31]
 v_mfma_f32_16x16x16_bf16 v[112:115], v[104:105], a[0:1], 0
 v_cvt_pk_bf16_f32 v142, v124, v125
 v_cvt_pk_bf16_f32 v143, v126, v127
 v_mfma_f32_16x16x16_bf16 v[116:119], v[104:105], a[4:5], 0
 v_and_b32_dpp v108, v100, v162 quad_perm:[0,0,2,2] row_mask:0xf bank_mask:0xf
 v_and_b32_dpp v109, v101, v163 quad_perm:[0,0,2,2] row_mask:0xf bank_mask:0xf
 v_mfma_f32_16x16x16_bf16 v[120:123], v[106:107], a[2:3], 0
 v_and_b32_dpp v110, v102, v162 quad_perm:[0,0,2,2] row_mask:0xf bank_mask:0xf
 v_and_b32_dpp v111, v103, v163 quad_perm:[0,0,2,2] row_mask:0xf bank_mask:0xf
 v_mfma_f32_16x16x16_bf16 v[124:127], v[106:107], a[6:7], 0
 v_cvt_pk_bf16_f32 v128, v112, v113
 v_cvt_pk_bf16_f32 v129, v114, v115
 s_waitcnt lgkmcnt(0)
 v_mfma_f32_16x16x32_bf16 v[36:39], v[64:67], v[92:95], v[36:39]
 v_cvt_pk_bf16_f32 v132, v116, v117
 v_cvt_pk_bf16_f32 v133, v118, v119
 v_mfma_f32_16x16x32_bf16 v[4:7], v[64:67], v[136:139], v[4:7]
 v_cvt_pk_bf16_f32 v130, v120, v121
 v_cvt_pk_bf16_f32 v131, v122, v123
 s_waitcnt vmcnt(15)
 s_barrier
 v_mfma_f32_16x16x32_bf16 v[8:11], v[64:67], v[140:143], v[8:11]
 ds_read_b64_tr_b16 v[48:49], v156 offset:24576
 ds_read_b64_tr_b16 v[50:51], v156 offset:25088
 s_add_u32 m0, s56, 49152
 s_add_u32 s42, s42, 16384
 buffer_load_dwordx4 v221, s[28:31], s42 offen offset:0 sc1 lds
 v_mfma_f32_16x16x32_bf16 v[16:19], v[68:71], v[140:143], v[16:19]
 ds_read_b64_tr_b16 v[52:53], v157 offset:24576
 ds_read_b64_tr_b16 v[54:55], v157 offset:25088
 v_mfma_f32_16x16x32_bf16 v[12:15], v[68:71], v[136:139], v[12:15]
 ds_read_b64_tr_b16 v[56:57], v158 offset:24576
 ds_read_b64_tr_b16 v[58:59], v158 offset:25088
 buffer_load_dwordx4 v221, s[28:31], s42 offen offset:1024 sc1 lds
 v_mfma_f32_16x16x32_bf16 v[20:23], v[72:75], v[136:139], v[20:23]
 ds_read_b64_tr_b16 v[60:61], v159 offset:24576
 ds_read_b64_tr_b16 v[62:63], v159 offset:25088
 v_mfma_f32_16x16x32_bf16 v[24:27], v[72:75], v[140:143], v[24:27]
 v_mfma_f32_16x16x32_bf16 v[32:35], v[76:79], v[140:143], v[32:35]
 v_mfma_f32_16x16x32_bf16 v[28:31], v[76:79], v[136:139], v[28:31]
 v_mfma_f32_16x16x16_bf16 v[112:115], v[108:109], a[8:9], 0
 v_cvt_pk_bf16_f32 v134, v124, v125
 v_cvt_pk_bf16_f32 v135, v126, v127
 v_mfma_f32_16x16x16_bf16 v[116:119], v[108:109], a[12:13], 0
 v_mfma_f32_16x16x16_bf16 v[120:123], v[110:111], a[10:11], 0
 v_mfma_f32_16x16x16_bf16 v[124:127], v[110:111], a[14:15], 0
 s_nop 2
 v_cvt_pk_bf16_f32 v136, v112, v113
 v_cvt_pk_bf16_f32 v137, v114, v115
 buffer_load_dwordx4 v221, s[28:31], s42 offen offset:2048 sc1 lds
 s_waitcnt lgkmcnt(0)
 v_mfma_f32_16x16x32_bf16 v[36:39], v[48:51], v[96:99], v[36:39]
 v_cvt_pk_bf16_f32 v140, v116, v117
 v_cvt_pk_bf16_f32 v141, v118, v119
 v_mfma_f32_16x16x32_bf16 v[4:7], v[48:51], v[128:131], v[4:7]
 v_cvt_pk_bf16_f32 v138, v120, v121
 v_cvt_pk_bf16_f32 v139, v122, v123
 v_mfma_f32_16x16x32_bf16 v[8:11], v[48:51], v[132:135], v[8:11]
 ds_read_b64_tr_b16 v[64:65], v156 offset:28672
 ds_read_b64_tr_b16 v[66:67], v156 offset:29184
 v_mfma_f32_16x16x32_bf16 v[16:19], v[52:55], v[132:135], v[16:19]
 ds_read_b64_tr_b16 v[68:69], v157 offset:28672
 ds_read_b64_tr_b16 v[70:71], v157 offset:29184
 buffer_load_dwordx4 v221, s[28:31], s42 offen offset:3072 sc1 lds
 v_mfma_f32_16x16x32_bf16 v[12:15], v[52:55], v[128:131], v[12:15]
 ds_read_b64_tr_b16 v[72:73], v158 offset:28672
 ds_read_b64_tr_b16 v[74:75], v158 offset:29184
 v_mfma_f32_16x16x32_bf16 v[20:23], v[56:59], v[128:131], v[20:23]
 ds_read_b64_tr_b16 v[76:77], v159 offset:28672
 ds_read_b64_tr_b16 v[78:79], v159 offset:29184
 v_mfma_f32_16x16x32_bf16 v[24:27], v[56:59], v[132:135], v[24:27]
 v_mfma_f32_16x16x32_bf16 v[32:35], v[60:63], v[132:135], v[32:35]
 v_mfma_f32_16x16x32_bf16 v[28:31], v[60:63], v[128:131], v[28:31]
 v_cvt_pk_bf16_f32 v142, v124, v125
 v_cvt_pk_bf16_f32 v143, v126, v127
 s_waitcnt lgkmcnt(0)
 v_mfma_f32_16x16x32_bf16 v[36:39], v[64:67], v[100:103], v[36:39]
 v_mfma_f32_16x16x32_bf16 v[4:7], v[64:67], v[136:139], v[4:7]
 v_mul_f32 v189, s4, v188
 v_mul_f32 v188, s4, v188
 v_mul_f32 v191, s4, v190
 v_mul_f32 v190, s4, v190
 v_mfma_f32_16x16x32_bf16 v[8:11], v[64:67], v[140:143], v[8:11]
 v_mul_f32 v193, s4, v192
 v_mul_f32 v192, s4, v192
 v_mul_f32 v195, s4, v194
 v_mul_f32 v194, s4, v194
 v_mfma_f32_16x16x32_bf16 v[16:19], v[68:71], v[140:143], v[16:19]
 v_mul_f32 v36, v36, v44
 v_mul_f32 v37, v37, v44
 v_mul_f32 v38, v38, v44
 v_mul_f32 v39, v39, v44
 v_mfma_f32_16x16x32_bf16 v[12:15], v[68:71], v[136:139], v[12:15]
 s_mov_b32 exec_lo, 0x00030003
 s_mov_b32 exec_hi, 0x00030003
 ds_write_b128 v45, v[36:39]
 s_mov_b64 exec, -1
 v_mfma_f32_16x16x32_bf16 v[20:23], v[72:75], v[136:139], v[20:23]
 v_mfma_f32_16x16x32_bf16 v[24:27], v[72:75], v[140:143], v[24:27]
 v_mfma_f32_16x16x32_bf16 v[32:35], v[76:79], v[140:143], v[32:35]
 v_mfma_f32_16x16x32_bf16 v[28:31], v[76:79], v[136:139], v[28:31]
 s_waitcnt lgkmcnt(0)
 s_barrier
 ds_read_b128 v[48:51], v180 offset:0
 ds_read_b128 v[52:55], v180 offset:64
 ds_read_b128 v[56:59], v181 offset:0
 ds_read_b128 v[60:63], v181 offset:64
 ds_read_b128 v[64:67], v182 offset:0
 ds_read_b128 v[68:71], v182 offset:64
 ds_read_b128 v[72:75], v183 offset:0
 ds_read_b128 v[76:79], v183 offset:64
 s_waitcnt lgkmcnt(6)
 v_pk_fma_f32 v[80:81], v[48:49], v[190:191], v[52:53]
 v_pk_fma_f32 v[82:83], v[50:51], v[190:191], v[54:55]
 v_pk_fma_f32 v[4:5], v[4:5], v[188:189], v[80:81]
 v_pk_fma_f32 v[6:7], v[6:7], v[188:189], v[82:83]
 v_cvt_pk_bf16_f32 v168, v4, v5
 v_cvt_pk_bf16_f32 v169, v6, v7
 v_pk_fma_f32 v[84:85], v[48:49], v[194:195], v[52:53]
 v_pk_fma_f32 v[86:87], v[50:51], v[194:195], v[54:55]
 v_pk_fma_f32 v[8:9], v[8:9], v[192:193], v[84:85]
 v_pk_fma_f32 v[10:11], v[10:11], v[192:193], v[86:87]
 v_cvt_pk_bf16_f32 v170, v8, v9
 v_cvt_pk_bf16_f32 v171, v10, v11
 s_nop 0
 v_permlane16_swap_b32 v168, v170
 v_permlane16_swap_b32 v169, v171
 s_waitcnt lgkmcnt(4)
 v_pk_fma_f32 v[80:81], v[56:57], v[190:191], v[60:61]
 v_pk_fma_f32 v[82:83], v[58:59], v[190:191], v[62:63]
 v_pk_fma_f32 v[12:13], v[12:13], v[188:189], v[80:81]
 v_pk_fma_f32 v[14:15], v[14:15], v[188:189], v[82:83]
 v_cvt_pk_bf16_f32 v172, v12, v13
 v_cvt_pk_bf16_f32 v173, v14, v15
 v_pk_fma_f32 v[84:85], v[56:57], v[194:195], v[60:61]
 v_pk_fma_f32 v[86:87], v[58:59], v[194:195], v[62:63]
 v_pk_fma_f32 v[16:17], v[16:17], v[192:193], v[84:85]
 v_pk_fma_f32 v[18:19], v[18:19], v[192:193], v[86:87]
 v_cvt_pk_bf16_f32 v174, v16, v17
 v_cvt_pk_bf16_f32 v175, v18, v19
 s_nop 0
 v_permlane16_swap_b32 v172, v174
 v_permlane16_swap_b32 v173, v175
 s_waitcnt lgkmcnt(2)
 v_pk_fma_f32 v[80:81], v[64:65], v[190:191], v[68:69]
 v_pk_fma_f32 v[82:83], v[66:67], v[190:191], v[70:71]
 v_pk_fma_f32 v[20:21], v[20:21], v[188:189], v[80:81]
 v_pk_fma_f32 v[22:23], v[22:23], v[188:189], v[82:83]
 v_cvt_pk_bf16_f32 v176, v20, v21
 v_cvt_pk_bf16_f32 v177, v22, v23
 v_pk_fma_f32 v[84:85], v[64:65], v[194:195], v[68:69]
 v_pk_fma_f32 v[86:87], v[66:67], v[194:195], v[70:71]
 v_pk_fma_f32 v[24:25], v[24:25], v[192:193], v[84:85]
 v_pk_fma_f32 v[26:27], v[26:27], v[192:193], v[86:87]
 v_cvt_pk_bf16_f32 v178, v24, v25
 v_cvt_pk_bf16_f32 v179, v26, v27
 s_nop 0
 v_permlane16_swap_b32 v176, v178
 v_permlane16_swap_b32 v177, v179
 s_waitcnt lgkmcnt(0)
 v_pk_fma_f32 v[80:81], v[72:73], v[190:191], v[76:77]
 v_pk_fma_f32 v[82:83], v[74:75], v[190:191], v[78:79]
 v_pk_fma_f32 v[28:29], v[28:29], v[188:189], v[80:81]
 v_pk_fma_f32 v[30:31], v[30:31], v[188:189], v[82:83]
 v_cvt_pk_bf16_f32 v180, v28, v29
 v_cvt_pk_bf16_f32 v181, v30, v31
 v_pk_fma_f32 v[84:85], v[72:73], v[194:195], v[76:77]
 v_pk_fma_f32 v[86:87], v[74:75], v[194:195], v[78:79]
 v_pk_fma_f32 v[32:33], v[32:33], v[192:193], v[84:85]
 v_pk_fma_f32 v[34:35], v[34:35], v[192:193], v[86:87]
 v_cvt_pk_bf16_f32 v182, v32, v33
 v_cvt_pk_bf16_f32 v183, v34, v35
 s_nop 0
 v_permlane16_swap_b32 v180, v182
 v_permlane16_swap_b32 v181, v183
 s_bitcmp1_b32 s3, 0
 s_cbranch_scc0 m_kernel_qs0
 v_swap_b32 v168, v172
 v_swap_b32 v169, v173
 v_swap_b32 v170, v174
 v_swap_b32 v171, v175
 v_swap_b32 v176, v180
 v_swap_b32 v177, v181
 v_swap_b32 v178, v182
 v_swap_b32 v179, v183
m_kernel_qs0:
 s_nop 1
 s_bitcmp1_b32 s3, 1
 s_cbranch_scc0 m_kernel_qs1
 v_swap_b32 v168, v176
 v_swap_b32 v169, v177
 v_swap_b32 v170, v178
 v_swap_b32 v171, v179
 v_swap_b32 v172, v180
 v_swap_b32 v173, v181
 v_swap_b32 v174, v182
 v_swap_b32 v175, v183
m_kernel_qs1:
 s_nop 1
 s_waitcnt vmcnt(18)
 v_mfma_f32_32x32x16_bf16 v[48:63], v[212:215], v[168:171], 0
 v_mfma_f32_32x32x16_bf16 v[64:79], v[212:215], v[176:179], 0
 s_waitcnt vmcnt(17)
 v_mfma_f32_32x32x16_bf16 v[48:63], v[216:219], v[172:175], v[48:63]
 v_mfma_f32_32x32x16_bf16 v[64:79], v[216:219], v[180:183], v[64:79]
 s_nop 10
 v_max3_f32 v1, v48, v49, v50
 v_max3_f32 v1, v51, v52, v1
 v_max3_f32 v1, v53, v54, v1
 v_max3_f32 v1, v55, v56, v1
 v_max3_f32 v1, v57, v58, v1
 v_max3_f32 v1, v59, v60, v1
 v_max3_f32 v1, v61, v62, v1
 v_max_f32 v1, v63, v1
 v_mov_b32 v3, v1
 s_nop 1
 v_permlane32_swap_b32 v1, v3
 v_max_f32 v1, v1, v3
 v_sub_f32 v80, 0xc2800000, v1
 v_mov_b32 v81, v80
 v_mov_b32 v82, v80
 v_mov_b32 v83, v80
 v_mov_b32 v84, v80
 v_mov_b32 v85, v80
 v_mov_b32 v86, v80
 v_mov_b32 v87, v80
 v_mov_b32 v88, v80
 v_mov_b32 v89, v80
 v_mov_b32 v90, v80
 v_mov_b32 v91, v80
 v_mov_b32 v92, v80
 v_mov_b32 v93, v80
 v_mov_b32 v94, v80
 v_mov_b32 v95, v80
 v_max3_f32 v2, v64, v65, v66
 v_max3_f32 v2, v67, v68, v2
 v_max3_f32 v2, v69, v70, v2
 v_max3_f32 v2, v71, v72, v2
 v_max3_f32 v2, v73, v74, v2
 v_max3_f32 v2, v75, v76, v2
 v_max3_f32 v2, v77, v78, v2
 v_max_f32 v2, v79, v2
 v_mov_b32 v3, v2
 s_nop 1
 v_permlane32_swap_b32 v2, v3
 v_max_f32 v2, v2, v3
 v_sub_f32 v96, 0xc2800000, v2
 v_mov_b32 v97, v96
 v_mov_b32 v98, v96
 v_mov_b32 v99, v96
 v_mov_b32 v100, v96
 v_mov_b32 v101, v96
 v_mov_b32 v102, v96
 v_mov_b32 v103, v96
 v_mov_b32 v104, v96
 v_mov_b32 v105, v96
 v_mov_b32 v106, v96
 v_mov_b32 v107, v96
 v_mov_b32 v108, v96
 v_mov_b32 v109, v96
 v_mov_b32 v110, v96
 v_mov_b32 v111, v96
m_kernel_att:
 v_mfma_f32_32x32x16_bf16 v[48:63], v[212:215], v[168:171], v[80:95]
 v_mfma_f32_32x32x16_bf16 v[48:63], v[216:219], v[172:175], v[48:63]
 v_mov_b32 v136, 0
 v_mov_b32 v137, 0
 v_mov_b32 v138, 0
 v_mov_b32 v139, 0
 v_mov_b32 v140, 0
 v_mov_b32 v141, 0
 v_mov_b32 v142, 0
 v_mov_b32 v143, 0
 v_mov_b32 v144, 0
 v_mov_b32 v145, 0
 v_mov_b32 v146, 0
 v_mov_b32 v147, 0
 v_mov_b32 v148, 0
 v_mov_b32 v149, 0
 v_mov_b32 v150, 0
 v_mov_b32 v151, 0
 v_mov_b32 v128, 0
 v_mov_b32 v129, 0
 v_mov_b32 v130, 0
 v_mov_b32 v131, 0
 v_mov_b32 v152, 0
 v_mov_b32 v153, 0
 v_mov_b32 v154, 0
 v_mov_b32 v155, 0
 v_mov_b32 v156, 0
 v_mov_b32 v157, 0
 v_mov_b32 v158, 0
 v_mov_b32 v159, 0
 v_mov_b32 v160, 0
 v_mov_b32 v161, 0
 v_mov_b32 v162, 0
 v_mov_b32 v163, 0
 v_mov_b32 v164, 0
 v_mov_b32 v165, 0
 v_mov_b32 v166, 0
 v_mov_b32 v167, 0
 v_mov_b32 v132, 0
 v_mov_b32 v133, 0
 v_mov_b32 v134, 0
 v_mov_b32 v135, 0
 s_mov_b32 s43, 0
 v_mov_b32 v220, v231
 s_lshl_b32 s57, s3, 14
 s_lshl_b32 s58, s10, 2
 s_add_u32 s58, s58, s3
 s_mul_i32 s58, s58, 458752
 s_lshl_b32 s16, s11, 8
 s_add_u32 s58, s58, s16
 s_and_b32 s50, s2, 7
 s_lshl_b32 s50, s50, 5
 s_lshr_b32 s49, s2, 3
 s_add_u32 s50, s50, s49
 s_lshl_b32 s50, s50, 5
 s_and_b32 s49, s49, 3
 s_lshl_b32 s49, s49, 1
 s_mul_i32 s51, s3, 3145728
 s_add_u32 s50, s50, s51
 s_add_u32 s50, s50, 4096
 s_lshl_b32 s51, s3, 10
 s_add_u32 s51, s51, 131072
 s_waitcnt vmcnt(12)
 s_barrier
 ds_read_b128 v[196:199], v220 offset:2048
 ds_read_b128 v[188:191], v220 offset:0
 ds_read_b128 v[200:203], v220 offset:3072
 ds_read_b128 v[192:195], v220 offset:1024
 v_mfma_f32_32x32x16_bf16 v[64:79], v[212:215], v[176:179], v[96:111]
 v_exp_f32 v48, v48
 v_exp_f32 v49, v49
 v_exp_f32 v50, v50
 v_exp_f32 v51, v51
 v_cvt_pk_bf16_f32 v112, v48, v49
 v_exp_f32 v52, v52
 v_exp_f32 v53, v53
 v_cvt_pk_bf16_f32 v113, v50, v51
 v_exp_f32 v54, v54
 v_exp_f32 v55, v55
 v_mfma_f32_32x32x16_bf16 v[64:79], v[216:219], v[180:183], v[64:79]
 s_waitcnt lgkmcnt(0)
 v_cvt_pk_bf16_f32 v114, v52, v53
 v_exp_f32 v56, v56
 v_exp_f32 v57, v57
 v_cvt_pk_bf16_f32 v115, v54, v55
 v_exp_f32 v58, v58
 v_exp_f32 v59, v59
 v_cvt_pk_bf16_f32 v116, v56, v57
 v_exp_f32 v60, v60
 v_exp_f32 v61, v61
 v_cvt_pk_bf16_f32 v117, v58, v59
 v_exp_f32_e64 v62, v62
 v_exp_f32 v63, v63
 v_cvt_pk_bf16_f32 v118, v60, v61
 v_cvt_pk_bf16_f32 v119, v62, v63
 v_mfma_f32_32x32x16_bf16 v[48:63], v[196:199], v[168:171], v[80:95]
 v_exp_f32 v64, v64
 v_exp_f32 v65, v65
 v_exp_f32 v66, v66
 v_exp_f32 v67, v67
 v_mfma_f32_32x32x16_bf16 v[136:151], v[188:191], v[112:115], v[136:151]
 ds_read_b128 v[212:215], v220 offset:6144
 v_cvt_pk_bf16_f32 v120, v64, v65
 v_exp_f32 v68, v68
 v_exp_f32 v69, v69
 v_cvt_pk_bf16_f32 v121, v66, v67
 v_mfma_f32_16x16x32_bf16 v[128:131], v[184:187], v[112:115], v[128:131]
 ds_read_b128 v[204:207], v220 offset:4096
 v_exp_f32 v70, v70
 v_exp_f32 v71, v71
 v_cvt_pk_bf16_f32 v122, v68, v69
 v_exp_f32_e64 v72, v72
 v_mfma_f32_32x32x16_bf16 v[48:63], v[200:203], v[172:175], v[48:63]
 ds_read_b128 v[216:219], v220 offset:7168
 v_exp_f32_e64 v73, v73
 v_cvt_pk_bf16_f32 v123, v70, v71
 v_exp_f32 v74, v74
 v_exp_f32 v75, v75
 v_mfma_f32_32x32x16_bf16 v[136:151], v[192:195], v[116:119], v[136:151]
 ds_read_b128 v[208:211], v220 offset:5120
 v_cvt_pk_bf16_f32 v124, v72, v73
 v_exp_f32 v76, v76
 v_exp_f32 v77, v77
 v_cvt_pk_bf16_f32 v125, v74, v75
 v_mfma_f32_16x16x32_bf16 v[128:131], v[184:187], v[116:119], v[128:131]
 s_mov_b32 m0, s57
 v_exp_f32_e64 v78, v78
 v_exp_f32 v79, v79
 v_cvt_pk_bf16_f32 v126, v76, v77
 v_cvt_pk_bf16_f32 v127, v78, v79
 v_mfma_f32_32x32x16_bf16 v[64:79], v[196:199], v[176:179], v[96:111]
 s_add_u32 s57, s57, 2048
 v_exp_f32 v48, v48
 v_exp_f32 v49, v49
 v_exp_f32 v50, v50
 v_exp_f32 v51, v51
 v_mfma_f32_32x32x16_bf16 v[152:167], v[188:191], v[120:123], v[152:167]
 buffer_load_dwordx4 v222, s[32:35], s58 offen lds
 v_cvt_pk_bf16_f32 v112, v48, v49
 v_exp_f32 v52, v52
 v_exp_f32 v53, v53
 v_cvt_pk_bf16_f32 v113, v50, v51
 v_mfma_f32_16x16x32_bf16 v[132:135], v[184:187], v[120:123], v[132:135]
 buffer_load_dwordx4 v223, s[32:35], s58 offen offset:1024 lds
 v_exp_f32 v54, v54
 v_exp_f32 v55, v55
 v_cvt_pk_bf16_f32 v114, v52, v53
 v_exp_f32_e64 v56, v56
 v_mfma_f32_32x32x16_bf16 v[64:79], v[200:203], v[180:183], v[64:79]
 s_add_u32 s58, s58, 57344
 v_exp_f32_e64 v57, v57
 v_cvt_pk_bf16_f32 v115, v54, v55
 v_exp_f32 v58, v58
 v_exp_f32 v59, v59
 v_mfma_f32_32x32x16_bf16 v[152:167], v[192:195], v[124:127], v[152:167]
 s_waitcnt lgkmcnt(0)
 s_nop 0
 v_cvt_pk_bf16_f32 v116, v56, v57
 v_exp_f32 v60, v60
 v_exp_f32 v61, v61
 v_cvt_pk_bf16_f32 v117, v58, v59
 v_mfma_f32_16x16x32_bf16 v[132:135], v[184:187], v[124:127], v[132:135]
 v_exp_f32 v62, v62
 v_exp_f32 v63, v63
 v_cvt_pk_bf16_f32 v118, v60, v61
 v_cvt_pk_bf16_f32 v119, v62, v63
 v_mfma_f32_32x32x16_bf16 v[48:63], v[212:215], v[168:171], v[80:95]
 s_xor_b32 s16, s49, 0
 v_exp_f32_e64 v64, v64
 v_exp_f32 v65, v65
 v_exp_f32 v66, v66
 v_exp_f32 v67, v67
 v_mfma_f32_32x32x16_bf16 v[136:151], v[204:207], v[112:115], v[136:151]
 ds_read_b128 v[196:199], v220 offset:10240
 s_mul_i32 s17, s16, 393216
 v_cvt_pk_bf16_f32 v120, v64, v65
 v_exp_f32 v68, v68
 v_exp_f32 v69, v69
 v_cvt_pk_bf16_f32 v121, v66, v67
 v_mfma_f32_16x16x32_bf16 v[128:131], v[184:187], v[112:115], v[128:131]
 ds_read_b128 v[188:191], v220 offset:8192
 v_exp_f32 v70, v70
 v_exp_f32 v71, v71
 v_cvt_pk_bf16_f32 v122, v68, v69
 v_exp_f32_e64 v72, v72
 v_mfma_f32_32x32x16_bf16 v[48:63], v[216:219], v[172:175], v[48:63]
 ds_read_b128 v[200:203], v220 offset:11264
 s_add_u32 s17, s17, s50
 v_exp_f32 v73, v73
 v_cvt_pk_bf16_f32 v123, v70, v71
 v_exp_f32 v74, v74
 v_exp_f32 v75, v75
 v_mfma_f32_32x32x16_bf16 v[136:151], v[208:211], v[116:119], v[136:151]
 ds_read_b128 v[192:195], v220 offset:9216
 v_cvt_pk_bf16_f32 v124, v72, v73
 v_exp_f32 v76, v76
 v_exp_f32 v77, v77
 v_cvt_pk_bf16_f32 v125, v74, v75
 v_mfma_f32_16x16x32_bf16 v[128:131], v[184:187], v[116:119], v[128:131]
 s_lshl_b32 s16, s16, 12
 v_exp_f32_e64 v78, v78
 v_exp_f32 v79, v79
 v_cvt_pk_bf16_f32 v126, v76, v77
 v_cvt_pk_bf16_f32 v127, v78, v79
 v_mfma_f32_32x32x16_bf16 v[64:79], v[212:215], v[176:179], v[96:111]
 s_add_u32 m0, s16, s51
 v_exp_f32_e64 v48, v48
 v_exp_f32 v49, v49
 v_exp_f32 v50, v50
 v_exp_f32 v51, v51
 v_mfma_f32_32x32x16_bf16 v[152:167], v[204:207], v[120:123], v[152:167]
 v_cvt_pk_bf16_f32 v112, v48, v49
 v_exp_f32 v52, v52
 v_exp_f32 v53, v53
 v_cvt_pk_bf16_f32 v113, v50, v51
 v_mfma_f32_16x16x32_bf16 v[132:135], v[184:187], v[120:123], v[132:135]
 buffer_load_dwordx4 v40, s[36:39], s17 offen lds
 v_exp_f32 v54, v54
 v_exp_f32 v55, v55
 v_cvt_pk_bf16_f32 v114, v52, v53
 v_exp_f32_e64 v56, v56
 v_mfma_f32_32x32x16_bf16 v[64:79], v[216:219], v[180:183], v[64:79]
 v_exp_f32_e64 v57, v57
 v_cvt_pk_bf16_f32 v115, v54, v55
 v_exp_f32 v58, v58
 v_exp_f32 v59, v59
 v_mfma_f32_32x32x16_bf16 v[152:167], v[208:211], v[124:127], v[152:167]
 s_waitcnt lgkmcnt(0)
 s_nop 0
 v_cvt_pk_bf16_f32 v116, v56, v57
 v_exp_f32 v60, v60
 v_exp_f32 v61, v61
 v_cvt_pk_bf16_f32 v117, v58, v59
 v_mfma_f32_16x16x32_bf16 v[132:135], v[184:187], v[124:127], v[132:135]
 v_exp_f32 v62, v62
 v_exp_f32 v63, v63
 v_cvt_pk_bf16_f32 v118, v60, v61
 v_cvt_pk_bf16_f32 v119, v62, v63
 v_mfma_f32_32x32x16_bf16 v[48:63], v[196:199], v[168:171], v[80:95]
 v_exp_f32 v64, v64
 v_exp_f32 v65, v65
 v_exp_f32 v66, v66
 v_exp_f32 v67, v67
 v_mfma_f32_32x32x16_bf16 v[136:151], v[188:191], v[112:115], v[136:151]
 ds_read_b128 v[212:215], v220 offset:14336
 v_cvt_pk_bf16_f32 v120, v64, v65
 v_exp_f32 v68, v68
 v_exp_f32 v69, v69
 v_cvt_pk_bf16_f32 v121, v66, v67
 v_mfma_f32_16x16x32_bf16 v[128:131], v[184:187], v[112:115], v[128:131]
 ds_read_b128 v[204:207], v220 offset:12288
 v_exp_f32 v70, v70
 v_exp_f32 v71, v71
 v_cvt_pk_bf16_f32 v122, v68, v69
 v_exp_f32_e64 v72, v72
 v_mfma_f32_32x32x16_bf16 v[48:63], v[200:203], v[172:175], v[48:63]
 ds_read_b128 v[216:219], v220 offset:15360
 v_exp_f32_e64 v73, v73
 v_cvt_pk_bf16_f32 v123, v70, v71
 v_exp_f32 v74, v74
 v_exp_f32 v75, v75
 v_mfma_f32_32x32x16_bf16 v[136:151], v[192:195], v[116:119], v[136:151]
 ds_read_b128 v[208:211], v220 offset:13312
 v_cvt_pk_bf16_f32 v124, v72, v73
 v_exp_f32 v76, v76
 v_exp_f32 v77, v77
 v_cvt_pk_bf16_f32 v125, v74, v75
 v_mfma_f32_16x16x32_bf16 v[128:131], v[184:187], v[116:119], v[128:131]
 s_add_u32 s42, s42, 16384
 v_exp_f32 v78, v78
 v_exp_f32 v79, v79
 v_cvt_pk_bf16_f32 v126, v76, v77
 v_cvt_pk_bf16_f32 v127, v78, v79
 v_mfma_f32_32x32x16_bf16 v[64:79], v[196:199], v[176:179], v[96:111]
 s_add_u32 m0, s43, s56
 v_exp_f32_e64 v48, v48
 v_exp_f32 v49, v49
 v_exp_f32 v50, v50
 v_exp_f32 v51, v51
 v_mfma_f32_32x32x16_bf16 v[152:167], v[188:191], v[120:123], v[152:167]
 s_add_u32 s43, s43, 16384
 v_cvt_pk_bf16_f32 v112, v48, v49
 v_exp_f32 v52, v52
 v_exp_f32 v53, v53
 v_cvt_pk_bf16_f32 v113, v50, v51
 v_mfma_f32_16x16x32_bf16 v[132:135], v[184:187], v[120:123], v[132:135]
 s_and_b32 s43, s43, 0xffff
 v_exp_f32 v54, v54
 v_exp_f32 v55, v55
 v_cvt_pk_bf16_f32 v114, v52, v53
 v_exp_f32_e64 v56, v56
 v_mfma_f32_32x32x16_bf16 v[64:79], v[200:203], v[180:183], v[64:79]
 v_exp_f32_e64 v57, v57
 v_cvt_pk_bf16_f32 v115, v54, v55
 v_exp_f32 v58, v58
 v_exp_f32 v59, v59
 v_mfma_f32_32x32x16_bf16 v[152:167], v[192:195], v[124:127], v[152:167]
 s_waitcnt lgkmcnt(0)
 s_nop 0
 v_cvt_pk_bf16_f32 v116, v56, v57
 v_exp_f32 v60, v60
 v_exp_f32 v61, v61
 v_cvt_pk_bf16_f32 v117, v58, v59
 v_mfma_f32_16x16x32_bf16 v[132:135], v[184:187], v[124:127], v[132:135]
 v_exp_f32 v62, v62
 v_exp_f32 v63, v63
 v_cvt_pk_bf16_f32 v118, v60, v61
 v_cvt_pk_bf16_f32 v119, v62, v63
 v_mfma_f32_32x32x16_bf16 v[48:63], v[212:215], v[168:171], v[80:95]
 s_waitcnt vmcnt(11)
 v_exp_f32_e64 v64, v64
 v_exp_f32 v65, v65
 v_exp_f32 v66, v66
 v_exp_f32 v67, v67
 v_mfma_f32_32x32x16_bf16 v[136:151], v[204:207], v[112:115], v[136:151]
 s_barrier
 s_nop 0
 v_cvt_pk_bf16_f32 v120, v64, v65
 v_exp_f32 v68, v68
 v_exp_f32 v69, v69
 v_cvt_pk_bf16_f32 v121, v66, v67
 v_mfma_f32_16x16x32_bf16 v[128:131], v[184:187], v[112:115], v[128:131]
 ds_read_b128 v[196:199], v220 offset:18432
 v_exp_f32 v70, v70
 v_exp_f32 v71, v71
 v_cvt_pk_bf16_f32 v122, v68, v69
 v_exp_f32_e64 v72, v72
 v_mfma_f32_32x32x16_bf16 v[48:63], v[216:219], v[172:175], v[48:63]
 ds_read_b128 v[188:191], v220 offset:16384
 v_exp_f32_e64 v73, v73
 v_cvt_pk_bf16_f32 v123, v70, v71
 v_exp_f32 v74, v74
 v_exp_f32 v75, v75
 v_mfma_f32_32x32x16_bf16 v[136:151], v[208:211], v[116:119], v[136:151]
 ds_read_b128 v[200:203], v220 offset:19456
 v_cvt_pk_bf16_f32 v124, v72, v73
 v_exp_f32 v76, v76
 v_exp_f32 v77, v77
 v_cvt_pk_bf16_f32 v125, v74, v75
 v_mfma_f32_16x16x32_bf16 v[128:131], v[184:187], v[116:119], v[128:131]
 ds_read_b128 v[192:195], v220 offset:17408
 v_exp_f32 v78, v78
 v_exp_f32 v79, v79
 v_cvt_pk_bf16_f32 v126, v76, v77
 v_cvt_pk_bf16_f32 v127, v78, v79
 v_mfma_f32_32x32x16_bf16 v[64:79], v[212:215], v[176:179], v[96:111]
 buffer_load_dwordx4 v221, s[28:31], s42 offen offset:0 sc1 lds
 v_exp_f32 v48, v48
 v_exp_f32 v49, v49
 v_exp_f32 v50, v50
 v_exp_f32 v51, v51
 v_mfma_f32_32x32x16_bf16 v[152:167], v[204:207], v[120:123], v[152:167]
 buffer_load_dwordx4 v221, s[28:31], s42 offen offset:1024 sc1 lds
 v_cvt_pk_bf16_f32 v112, v48, v49
 v_exp_f32 v52, v52
 v_exp_f32 v53, v53
 v_cvt_pk_bf16_f32 v113, v50, v51
 v_mfma_f32_16x16x32_bf16 v[132:135], v[184:187], v[120:123], v[132:135]
 buffer_load_dwordx4 v221, s[28:31], s42 offen offset:2048 sc1 lds
 v_exp_f32 v54, v54
 v_exp_f32 v55, v55
 v_cvt_pk_bf16_f32 v114, v52, v53
 v_exp_f32_e64 v56, v56
 v_mfma_f32_32x32x16_bf16 v[64:79], v[216:219], v[180:183], v[64:79]
 buffer_load_dwordx4 v221, s[28:31], s42 offen offset:3072 sc1 lds
 v_exp_f32_e64 v57, v57
 v_cvt_pk_bf16_f32 v115, v54, v55
 v_exp_f32 v58, v58
 v_exp_f32 v59, v59
 v_mfma_f32_32x32x16_bf16 v[152:167], v[208:211], v[124:127], v[152:167]
 s_waitcnt lgkmcnt(0)
 s_nop 0
 v_cvt_pk_bf16_f32 v116, v56, v57
 v_exp_f32 v60, v60
 v_exp_f32 v61, v61
 v_cvt_pk_bf16_f32 v117, v58, v59
 v_mfma_f32_16x16x32_bf16 v[132:135], v[184:187], v[124:127], v[132:135]
 v_exp_f32 v62, v62
 v_exp_f32 v63, v63
 v_cvt_pk_bf16_f32 v118, v60, v61
 v_cvt_pk_bf16_f32 v119, v62, v63
 v_mfma_f32_32x32x16_bf16 v[48:63], v[196:199], v[168:171], v[80:95]
 v_exp_f32 v64, v64
 v_exp_f32 v65, v65
 v_exp_f32 v66, v66
 v_exp_f32 v67, v67
 v_mfma_f32_32x32x16_bf16 v[136:151], v[188:191], v[112:115], v[136:151]
 ds_read_b128 v[212:215], v220 offset:22528
 v_cvt_pk_bf16_f32 v120, v64, v65
 v_exp_f32 v68, v68
 v_exp_f32 v69, v69
 v_cvt_pk_bf16_f32 v121, v66, v67
 v_mfma_f32_16x16x32_bf16 v[128:131], v[184:187], v[112:115], v[128:131]
 ds_read_b128 v[204:207], v220 offset:20480
 v_exp_f32 v70, v70
 v_exp_f32 v71, v71
 v_cvt_pk_bf16_f32 v122, v68, v69
 v_exp_f32_e64 v72, v72
 v_mfma_f32_32x32x16_bf16 v[48:63], v[200:203], v[172:175], v[48:63]
 ds_read_b128 v[216:219], v220 offset:23552
 v_exp_f32_e64 v73, v73
 v_cvt_pk_bf16_f32 v123, v70, v71
 v_exp_f32 v74, v74
 v_exp_f32 v75, v75
 v_mfma_f32_32x32x16_bf16 v[136:151], v[192:195], v[116:119], v[136:151]
 ds_read_b128 v[208:211], v220 offset:21504
 v_cvt_pk_bf16_f32 v124, v72, v73
 v_exp_f32 v76, v76
 v_exp_f32 v77, v77
 v_cvt_pk_bf16_f32 v125, v74, v75
 v_mfma_f32_16x16x32_bf16 v[128:131], v[184:187], v[116:119], v[128:131]
 s_mov_b32 m0, s57
 v_exp_f32_e64 v78, v78
 v_exp_f32 v79, v79
 v_cvt_pk_bf16_f32 v126, v76, v77
 v_cvt_pk_bf16_f32 v127, v78, v79
 v_mfma_f32_32x32x16_bf16 v[64:79], v[196:199], v[176:179], v[96:111]
 s_add_u32 s57, s57, 2048
 v_exp_f32 v48, v48
 v_exp_f32 v49, v49
 v_exp_f32 v50, v50
 v_exp_f32 v51, v51
 v_mfma_f32_32x32x16_bf16 v[152:167], v[188:191], v[120:123], v[152:167]
 buffer_load_dwordx4 v222, s[32:35], s58 offen lds
 v_cvt_pk_bf16_f32 v112, v48, v49
 v_exp_f32 v52, v52
 v_exp_f32 v53, v53
 v_cvt_pk_bf16_f32 v113, v50, v51
 v_mfma_f32_16x16x32_bf16 v[132:135], v[184:187], v[120:123], v[132:135]
 buffer_load_dwordx4 v223, s[32:35], s58 offen offset:1024 lds
 v_exp_f32 v54, v54
 v_exp_f32 v55, v55
 v_cvt_pk_bf16_f32 v114, v52, v53
 v_exp_f32_e64 v56, v56
 v_mfma_f32_32x32x16_bf16 v[64:79], v[200:203], v[180:183], v[64:79]
 s_add_u32 s58, s58, 57344
 v_exp_f32_e64 v57, v57
 v_cvt_pk_bf16_f32 v115, v54, v55
 v_exp_f32 v58, v58
 v_exp_f32 v59, v59
 v_mfma_f32_32x32x16_bf16 v[152:167], v[192:195], v[124:127], v[152:167]
 s_waitcnt lgkmcnt(0)
 s_nop 0
 v_cvt_pk_bf16_f32 v116, v56, v57
 v_exp_f32 v60, v60
 v_exp_f32 v61, v61
 v_cvt_pk_bf16_f32 v117, v58, v59
 v_mfma_f32_16x16x32_bf16 v[132:135], v[184:187], v[124:127], v[132:135]
 v_exp_f32 v62, v62
 v_exp_f32 v63, v63
 v_cvt_pk_bf16_f32 v118, v60, v61
 v_cvt_pk_bf16_f32 v119, v62, v63
 v_mfma_f32_32x32x16_bf16 v[48:63], v[212:215], v[168:171], v[80:95]
 s_xor_b32 s16, s49, 1
 v_exp_f32_e64 v64, v64
 v_exp_f32 v65, v65
 v_exp_f32 v66, v66
 v_exp_f32 v67, v67
 v_mfma_f32_32x32x16_bf16 v[136:151], v[204:207], v[112:115], v[136:151]
 ds_read_b128 v[196:199], v220 offset:26624
 s_mul_i32 s17, s16, 393216
 v_cvt_pk_bf16_f32 v120, v64, v65
 v_exp_f32 v68, v68
 v_exp_f32 v69, v69
 v_cvt_pk_bf16_f32 v121, v66, v67
 v_mfma_f32_16x16x32_bf16 v[128:131], v[184:187], v[112:115], v[128:131]
 ds_read_b128 v[188:191], v220 offset:24576
 v_exp_f32 v70, v70
 v_exp_f32 v71, v71
 v_cvt_pk_bf16_f32 v122, v68, v69
 v_exp_f32_e64 v72, v72
 v_mfma_f32_32x32x16_bf16 v[48:63], v[216:219], v[172:175], v[48:63]
 ds_read_b128 v[200:203], v220 offset:27648
 s_add_u32 s17, s17, s50
 v_exp_f32 v73, v73
 v_cvt_pk_bf16_f32 v123, v70, v71
 v_exp_f32 v74, v74
 v_exp_f32 v75, v75
 v_mfma_f32_32x32x16_bf16 v[136:151], v[208:211], v[116:119], v[136:151]
 ds_read_b128 v[192:195], v220 offset:25600
 v_cvt_pk_bf16_f32 v124, v72, v73
 v_exp_f32 v76, v76
 v_exp_f32 v77, v77
 v_cvt_pk_bf16_f32 v125, v74, v75
 v_mfma_f32_16x16x32_bf16 v[128:131], v[184:187], v[116:119], v[128:131]
 s_lshl_b32 s16, s16, 12
 v_exp_f32_e64 v78, v78
 v_exp_f32 v79, v79
 v_cvt_pk_bf16_f32 v126, v76, v77
 v_cvt_pk_bf16_f32 v127, v78, v79
 v_mfma_f32_32x32x16_bf16 v[64:79], v[212:215], v[176:179], v[96:111]
 s_add_u32 m0, s16, s51
 v_exp_f32_e64 v48, v48
 v_exp_f32 v49, v49
 v_exp_f32 v50, v50
 v_exp_f32 v51, v51
 v_mfma_f32_32x32x16_bf16 v[152:167], v[204:207], v[120:123], v[152:167]
 v_cvt_pk_bf16_f32 v112, v48, v49
 v_exp_f32 v52, v52
 v_exp_f32 v53, v53
 v_cvt_pk_bf16_f32 v113, v50, v51
 v_mfma_f32_16x16x32_bf16 v[132:135], v[184:187], v[120:123], v[132:135]
 buffer_load_dwordx4 v40, s[36:39], s17 offen lds
 v_exp_f32 v54, v54
 v_exp_f32 v55, v55
 v_cvt_pk_bf16_f32 v114, v52, v53
 v_exp_f32_e64 v56, v56
 v_mfma_f32_32x32x16_bf16 v[64:79], v[216:219], v[180:183], v[64:79]
 v_exp_f32_e64 v57, v57
 v_cvt_pk_bf16_f32 v115, v54, v55
 v_exp_f32 v58, v58
 v_exp_f32 v59, v59
 v_mfma_f32_32x32x16_bf16 v[152:167], v[208:211], v[124:127], v[152:167]
 s_waitcnt lgkmcnt(0)
 s_nop 0
 v_cvt_pk_bf16_f32 v116, v56, v57
 v_exp_f32 v60, v60
 v_exp_f32 v61, v61
 v_cvt_pk_bf16_f32 v117, v58, v59
 v_mfma_f32_16x16x32_bf16 v[132:135], v[184:187], v[124:127], v[132:135]
 v_exp_f32 v62, v62
 v_exp_f32 v63, v63
 v_cvt_pk_bf16_f32 v118, v60, v61
 v_cvt_pk_bf16_f32 v119, v62, v63
 v_mfma_f32_32x32x16_bf16 v[48:63], v[196:199], v[168:171], v[80:95]
 v_exp_f32 v64, v64
 v_exp_f32 v65, v65
 v_exp_f32 v66, v66
 v_exp_f32 v67, v67
 v_mfma_f32_32x32x16_bf16 v[136:151], v[188:191], v[112:115], v[136:151]
 ds_read_b128 v[212:215], v220 offset:30720
 v_cvt_pk_bf16_f32 v120, v64, v65
 v_exp_f32 v68, v68
 v_exp_f32 v69, v69
 v_cvt_pk_bf16_f32 v121, v66, v67
 v_mfma_f32_16x16x32_bf16 v[128:131], v[184:187], v[112:115], v[128:131]
 ds_read_b128 v[204:207], v220 offset:28672
 v_exp_f32 v70, v70
 v_exp_f32 v71, v71
 v_cvt_pk_bf16_f32 v122, v68, v69
 v_exp_f32_e64 v72, v72
 v_mfma_f32_32x32x16_bf16 v[48:63], v[200:203], v[172:175], v[48:63]
 ds_read_b128 v[216:219], v220 offset:31744
 v_exp_f32_e64 v73, v73
 v_cvt_pk_bf16_f32 v123, v70, v71
 v_exp_f32 v74, v74
 v_exp_f32 v75, v75
 v_mfma_f32_32x32x16_bf16 v[136:151], v[192:195], v[116:119], v[136:151]
 ds_read_b128 v[208:211], v220 offset:29696
 v_cvt_pk_bf16_f32 v124, v72, v73
 v_exp_f32 v76, v76
 v_exp_f32 v77, v77
 v_cvt_pk_bf16_f32 v125, v74, v75
 v_mfma_f32_16x16x32_bf16 v[128:131], v[184:187], v[116:119], v[128:131]
 s_add_u32 s42, s42, 16384
 v_exp_f32 v78, v78
 v_exp_f32 v79, v79
 v_cvt_pk_bf16_f32 v126, v76, v77
 v_cvt_pk_bf16_f32 v127, v78, v79
 v_mfma_f32_32x32x16_bf16 v[64:79], v[196:199], v[176:179], v[96:111]
 s_add_u32 m0, s43, s56
 v_exp_f32_e64 v48, v48
 v_exp_f32 v49, v49
 v_exp_f32 v50, v50
 v_exp_f32 v51, v51
 v_mfma_f32_32x32x16_bf16 v[152:167], v[188:191], v[120:123], v[152:167]
 s_add_u32 s43, s43, 16384
 v_cvt_pk_bf16_f32 v112, v48, v49
 v_exp_f32 v52, v52
 v_exp_f32 v53, v53
 v_cvt_pk_bf16_f32 v113, v50, v51
 v_mfma_f32_16x16x32_bf16 v[132:135], v[184:187], v[120:123], v[132:135]
 s_and_b32 s43, s43, 0xffff
 v_exp_f32 v54, v54
 v_exp_f32 v55, v55
 v_cvt_pk_bf16_f32 v114, v52, v53
 v_exp_f32_e64 v56, v56
 v_mfma_f32_32x32x16_bf16 v[64:79], v[200:203], v[180:183], v[64:79]
 v_exp_f32_e64 v57, v57
 v_cvt_pk_bf16_f32 v115, v54, v55
 v_exp_f32_e64 v58, v58
 v_exp_f32 v59, v59
 v_add_u32 v220, s43, v231
 v_mfma_f32_32x32x16_bf16 v[152:167], v[192:195], v[124:127], v[152:167]
 s_waitcnt lgkmcnt(0)
 s_nop 0
 v_cvt_pk_bf16_f32 v116, v56, v57
 v_exp_f32 v60, v60
 v_exp_f32 v61, v61
 v_cvt_pk_bf16_f32 v117, v58, v59
 v_mfma_f32_16x16x32_bf16 v[132:135], v[184:187], v[124:127], v[132:135]
 v_exp_f32 v62, v62
 v_exp_f32 v63, v63
 v_cvt_pk_bf16_f32 v118, v60, v61
 v_cvt_pk_bf16_f32 v119, v62, v63
 v_mfma_f32_32x32x16_bf16 v[48:63], v[212:215], v[168:171], v[80:95]
 s_waitcnt vmcnt(14)
 v_exp_f32_e64 v64, v64
 v_exp_f32 v65, v65
 v_exp_f32 v66, v66
 v_exp_f32 v67, v67
 v_mfma_f32_32x32x16_bf16 v[136:151], v[204:207], v[112:115], v[136:151]
 s_barrier
 s_nop 0
 v_cvt_pk_bf16_f32 v120, v64, v65
 v_exp_f32 v68, v68
 v_exp_f32 v69, v69
 v_cvt_pk_bf16_f32 v121, v66, v67
 v_mfma_f32_16x16x32_bf16 v[128:131], v[184:187], v[112:115], v[128:131]
 ds_read_b128 v[196:199], v220 offset:2048
 v_exp_f32 v70, v70
 v_exp_f32 v71, v71
 v_cvt_pk_bf16_f32 v122, v68, v69
 v_exp_f32_e64 v72, v72
 v_mfma_f32_32x32x16_bf16 v[48:63], v[216:219], v[172:175], v[48:63]
 ds_read_b128 v[188:191], v220 offset:0
 v_exp_f32_e64 v73, v73
 v_cvt_pk_bf16_f32 v123, v70, v71
 v_exp_f32 v74, v74
 v_exp_f32 v75, v75
 v_mfma_f32_32x32x16_bf16 v[136:151], v[208:211], v[116:119], v[136:151]
 ds_read_b128 v[200:203], v220 offset:3072
 v_cvt_pk_bf16_f32 v124, v72, v73
 v_exp_f32 v76, v76
 v_exp_f32 v77, v77
 v_cvt_pk_bf16_f32 v125, v74, v75
 v_mfma_f32_16x16x32_bf16 v[128:131], v[184:187], v[116:119], v[128:131]
 ds_read_b128 v[192:195], v220 offset:1024
 v_exp_f32 v78, v78
 v_exp_f32 v79, v79
 v_cvt_pk_bf16_f32 v126, v76, v77
 v_cvt_pk_bf16_f32 v127, v78, v79
 v_mfma_f32_32x32x16_bf16 v[64:79], v[212:215], v[176:179], v[96:111]
 buffer_load_dwordx4 v221, s[28:31], s42 offen offset:0 sc1 lds
 v_exp_f32 v48, v48
 v_exp_f32 v49, v49
 v_exp_f32 v50, v50
 v_exp_f32 v51, v51
 v_mfma_f32_32x32x16_bf16 v[152:167], v[204:207], v[120:123], v[152:167]
 buffer_load_dwordx4 v221, s[28:31], s42 offen offset:1024 sc1 lds
 v_cvt_pk_bf16_f32 v112, v48, v49
 v_exp_f32 v52, v52
 v_exp_f32 v53, v53
 v_cvt_pk_bf16_f32 v113, v50, v51
 v_mfma_f32_16x16x32_bf16 v[132:135], v[184:187], v[120:123], v[132:135]
 buffer_load_dwordx4 v221, s[28:31], s42 offen offset:2048 sc1 lds
 v_exp_f32 v54, v54
 v_exp_f32 v55, v55
 v_cvt_pk_bf16_f32 v114, v52, v53
 v_exp_f32_e64 v56, v56
 v_mfma_f32_32x32x16_bf16 v[64:79], v[216:219], v[180:183], v[64:79]
 buffer_load_dwordx4 v221, s[28:31], s42 offen offset:3072 sc1 lds
 v_exp_f32_e64 v57, v57
 v_cvt_pk_bf16_f32 v115, v54, v55
 v_exp_f32 v58, v58
 v_exp_f32 v59, v59
 v_mfma_f32_32x32x16_bf16 v[152:167], v[208:211], v[124:127], v[152:167]
 s_waitcnt lgkmcnt(0)
 s_nop 0
 v_cvt_pk_bf16_f32 v116, v56, v57
 v_exp_f32 v60, v60
 v_exp_f32 v61, v61
 v_cvt_pk_bf16_f32 v117, v58, v59
 v_mfma_f32_16x16x32_bf16 v[132:135], v[184:187], v[124:127], v[132:135]
 v_exp_f32 v62, v62
 v_exp_f32 v63, v63
 v_cvt_pk_bf16_f32 v118, v60, v61
 v_cvt_pk_bf16_f32 v119, v62, v63
 v_mfma_f32_32x32x16_bf16 v[48:63], v[196:199], v[168:171], v[80:95]
 v_exp_f32 v64, v64
 v_exp_f32 v65, v65
 v_exp_f32 v66, v66
 v_exp_f32 v67, v67
 v_mfma_f32_32x32x16_bf16 v[136:151], v[188:191], v[112:115], v[136:151]
 ds_read_b128 v[212:215], v220 offset:6144
 v_cvt_pk_bf16_f32 v120, v64, v65
 v_exp_f32 v68, v68
 v_exp_f32 v69, v69
 v_cvt_pk_bf16_f32 v121, v66, v67
 v_mfma_f32_16x16x32_bf16 v[128:131], v[184:187], v[112:115], v[128:131]
 ds_read_b128 v[204:207], v220 offset:4096
 v_exp_f32 v70, v70
 v_exp_f32 v71, v71
 v_cvt_pk_bf16_f32 v122, v68, v69
 v_exp_f32_e64 v72, v72
 v_mfma_f32_32x32x16_bf16 v[48:63], v[200:203], v[172:175], v[48:63]
 ds_read_b128 v[216:219], v220 offset:7168
 v_exp_f32_e64 v73, v73
 v_cvt_pk_bf16_f32 v123, v70, v71
 v_exp_f32 v74, v74
 v_exp_f32 v75, v75
 v_mfma_f32_32x32x16_bf16 v[136:151], v[192:195], v[116:119], v[136:151]
 ds_read_b128 v[208:211], v220 offset:5120
 v_cvt_pk_bf16_f32 v124, v72, v73
 v_exp_f32 v76, v76
 v_exp_f32 v77, v77
 v_cvt_pk_bf16_f32 v125, v74, v75
 v_mfma_f32_16x16x32_bf16 v[128:131], v[184:187], v[116:119], v[128:131]
 s_mov_b32 m0, s57
 v_exp_f32_e64 v78, v78
 v_exp_f32 v79, v79
 v_cvt_pk_bf16_f32 v126, v76, v77
 v_cvt_pk_bf16_f32 v127, v78, v79
 v_mfma_f32_32x32x16_bf16 v[64:79], v[196:199], v[176:179], v[96:111]
 s_add_u32 s57, s57, 2048
 v_exp_f32 v48, v48
 v_exp_f32 v49, v49
 v_exp_f32 v50, v50
 v_exp_f32 v51, v51
 v_mfma_f32_32x32x16_bf16 v[152:167], v[188:191], v[120:123], v[152:167]
 buffer_load_dwordx4 v222, s[32:35], s58 offen lds
 v_cvt_pk_bf16_f32 v112, v48, v49
 v_exp_f32 v52, v52
 v_exp_f32 v53, v53
 v_cvt_pk_bf16_f32 v113, v50, v51
 v_mfma_f32_16x16x32_bf16 v[132:135], v[184:187], v[120:123], v[132:135]
 buffer_load_dwordx4 v223, s[32:35], s58 offen offset:1024 lds
 v_exp_f32 v54, v54
 v_exp_f32 v55, v55
 v_cvt_pk_bf16_f32 v114, v52, v53
 v_exp_f32_e64 v56, v56
 v_mfma_f32_32x32x16_bf16 v[64:79], v[200:203], v[180:183], v[64:79]
 s_add_u32 s58, s58, 57344
 v_exp_f32_e64 v57, v57
 v_cvt_pk_bf16_f32 v115, v54, v55
 v_exp_f32 v58, v58
 v_exp_f32 v59, v59
 v_mfma_f32_32x32x16_bf16 v[152:167], v[192:195], v[124:127], v[152:167]
 s_waitcnt lgkmcnt(0)
 s_nop 0
 v_cvt_pk_bf16_f32 v116, v56, v57
 v_exp_f32 v60, v60
 v_exp_f32 v61, v61
 v_cvt_pk_bf16_f32 v117, v58, v59
 v_mfma_f32_16x16x32_bf16 v[132:135], v[184:187], v[124:127], v[132:135]
 v_exp_f32 v62, v62
 v_exp_f32 v63, v63
 v_cvt_pk_bf16_f32 v118, v60, v61
 v_cvt_pk_bf16_f32 v119, v62, v63
 v_mfma_f32_32x32x16_bf16 v[48:63], v[212:215], v[168:171], v[80:95]
 s_xor_b32 s16, s49, 2
 v_exp_f32_e64 v64, v64
 v_exp_f32 v65, v65
 v_exp_f32 v66, v66
 v_exp_f32 v67, v67
 v_mfma_f32_32x32x16_bf16 v[136:151], v[204:207], v[112:115], v[136:151]
 ds_read_b128 v[196:199], v220 offset:10240
 s_mul_i32 s17, s16, 393216
 v_cvt_pk_bf16_f32 v120, v64, v65
 v_exp_f32 v68, v68
 v_exp_f32 v69, v69
 v_cvt_pk_bf16_f32 v121, v66, v67
 v_mfma_f32_16x16x32_bf16 v[128:131], v[184:187], v[112:115], v[128:131]
 ds_read_b128 v[188:191], v220 offset:8192
 s_add_u32 s17, s17, s50
 v_exp_f32_e64 v70, v70
 v_exp_f32 v71, v71
 v_cvt_pk_bf16_f32 v122, v68, v69
 v_exp_f32_e64 v72, v72
 v_mfma_f32_32x32x16_bf16 v[48:63], v[216:219], v[172:175], v[48:63]
 ds_read_b128 v[200:203], v220 offset:11264
 s_lshl_b32 s16, s16, 12
 v_exp_f32 v73, v73
 v_cvt_pk_bf16_f32 v123, v70, v71
 v_exp_f32 v74, v74
 v_exp_f32 v75, v75
 v_mfma_f32_32x32x16_bf16 v[136:151], v[208:211], v[116:119], v[136:151]
 ds_read_b128 v[192:195], v220 offset:9216
 s_add_u32 m0, s16, s51
 s_nop 0
 v_cvt_pk_bf16_f32 v124, v72, v73
 v_exp_f32 v76, v76
 v_exp_f32 v77, v77
 v_cvt_pk_bf16_f32 v125, v74, v75
 v_mfma_f32_16x16x32_bf16 v[128:131], v[184:187], v[116:119], v[128:131]
 buffer_load_dwordx4 v40, s[36:39], s17 offen lds
 v_exp_f32 v78, v78
 v_exp_f32 v79, v79
 v_cvt_pk_bf16_f32 v126, v76, v77
 v_cvt_pk_bf16_f32 v127, v78, v79
 v_mfma_f32_32x32x16_bf16 v[64:79], v[212:215], v[176:179], v[96:111]
 s_xor_b32 s16, s49, 3
 v_exp_f32_e64 v48, v48
 v_exp_f32 v49, v49
 v_exp_f32 v50, v50
 v_exp_f32 v51, v51
 v_mfma_f32_32x32x16_bf16 v[152:167], v[204:207], v[120:123], v[152:167]
 s_mul_i32 s17, s16, 393216
 v_cvt_pk_bf16_f32 v112, v48, v49
 v_exp_f32 v52, v52
 v_exp_f32 v53, v53
 v_cvt_pk_bf16_f32 v113, v50, v51
 v_mfma_f32_16x16x32_bf16 v[132:135], v[184:187], v[120:123], v[132:135]
 s_add_u32 s17, s17, s50
 v_exp_f32_e64 v54, v54
 v_exp_f32 v55, v55
 v_cvt_pk_bf16_f32 v114, v52, v53
 v_exp_f32_e64 v56, v56
 v_mfma_f32_32x32x16_bf16 v[64:79], v[216:219], v[180:183], v[64:79]
 s_lshl_b32 s16, s16, 12
 v_exp_f32 v57, v57
 v_cvt_pk_bf16_f32 v115, v54, v55
 v_exp_f32 v58, v58
 v_exp_f32 v59, v59
 v_mfma_f32_32x32x16_bf16 v[152:167], v[208:211], v[124:127], v[152:167]
 s_waitcnt lgkmcnt(0)
 s_add_u32 m0, s16, s51
 v_cvt_pk_bf16_f32 v116, v56, v57
 v_exp_f32 v60, v60
 v_exp_f32 v61, v61
 v_cvt_pk_bf16_f32 v117, v58, v59
 v_mfma_f32_16x16x32_bf16 v[132:135], v[184:187], v[124:127], v[132:135]
 v_exp_f32 v62, v62
 v_exp_f32 v63, v63
 v_cvt_pk_bf16_f32 v118, v60, v61
 v_cvt_pk_bf16_f32 v119, v62, v63
 v_mfma_f32_32x32x16_bf16 v[48:63], v[196:199], v[168:171], v[80:95]
 v_exp_f32 v64, v64
 v_exp_f32 v65, v65
 v_exp_f32 v66, v66
 v_exp_f32 v67, v67
 v_mfma_f32_32x32x16_bf16 v[136:151], v[188:191], v[112:115], v[136:151]
 ds_read_b128 v[212:215], v220 offset:14336
 buffer_load_dwordx4 v40, s[36:39], s17 offen lds
 v_cvt_pk_bf16_f32 v120, v64, v65
 v_exp_f32 v68, v68
 v_exp_f32 v69, v69
 v_cvt_pk_bf16_f32 v121, v66, v67
 v_mfma_f32_16x16x32_bf16 v[128:131], v[184:187], v[112:115], v[128:131]
 ds_read_b128 v[204:207], v220 offset:12288
 v_exp_f32 v70, v70
 v_exp_f32 v71, v71
 v_cvt_pk_bf16_f32 v122, v68, v69
 v_exp_f32_e64 v72, v72
 v_mfma_f32_32x32x16_bf16 v[48:63], v[200:203], v[172:175], v[48:63]
 ds_read_b128 v[216:219], v220 offset:15360
 v_exp_f32_e64 v73, v73
 v_cvt_pk_bf16_f32 v123, v70, v71
 v_exp_f32 v74, v74
 v_exp_f32 v75, v75
 v_mfma_f32_32x32x16_bf16 v[136:151], v[192:195], v[116:119], v[136:151]
 ds_read_b128 v[208:211], v220 offset:13312
 v_cvt_pk_bf16_f32 v124, v72, v73
 v_exp_f32 v76, v76
 v_exp_f32 v77, v77
 v_cvt_pk_bf16_f32 v125, v74, v75
 v_mfma_f32_16x16x32_bf16 v[128:131], v[184:187], v[116:119], v[128:131]
 s_add_u32 s42, s42, 16384
 v_exp_f32 v78, v78
 v_exp_f32 v79, v79
 v_cvt_pk_bf16_f32 v126, v76, v77
 v_cvt_pk_bf16_f32 v127, v78, v79
 v_mfma_f32_32x32x16_bf16 v[64:79], v[196:199], v[176:179], v[96:111]
 s_add_u32 m0, s43, s56
 v_exp_f32_e64 v48, v48
 v_exp_f32 v49, v49
 v_exp_f32 v50, v50
 v_exp_f32 v51, v51
 v_mfma_f32_32x32x16_bf16 v[152:167], v[188:191], v[120:123], v[152:167]
 s_add_u32 s43, s43, 16384
 v_cvt_pk_bf16_f32 v112, v48, v49
 v_exp_f32 v52, v52
 v_exp_f32 v53, v53
 v_cvt_pk_bf16_f32 v113, v50, v51
 v_mfma_f32_16x16x32_bf16 v[132:135], v[184:187], v[120:123], v[132:135]
 s_and_b32 s43, s43, 0xffff
 v_exp_f32 v54, v54
 v_exp_f32 v55, v55
 v_cvt_pk_bf16_f32 v114, v52, v53
 v_exp_f32_e64 v56, v56
 v_mfma_f32_32x32x16_bf16 v[64:79], v[200:203], v[180:183], v[64:79]
 v_exp_f32_e64 v57, v57
 v_cvt_pk_bf16_f32 v115, v54, v55
 v_exp_f32 v58, v58
 v_exp_f32 v59, v59
 v_mfma_f32_32x32x16_bf16 v[152:167], v[192:195], v[124:127], v[152:167]
 s_waitcnt lgkmcnt(0)
 s_nop 0
 v_cvt_pk_bf16_f32 v116, v56, v57
 v_exp_f32 v60, v60
 v_exp_f32 v61, v61
 v_cvt_pk_bf16_f32 v117, v58, v59
 v_mfma_f32_16x16x32_bf16 v[132:135], v[184:187], v[124:127], v[132:135]
 v_exp_f32 v62, v62
 v_exp_f32 v63, v63
 v_cvt_pk_bf16_f32 v118, v60, v61
 v_cvt_pk_bf16_f32 v119, v62, v63
 v_mfma_f32_32x32x16_bf16 v[48:63], v[212:215], v[168:171], v[80:95]
 s_waitcnt vmcnt(18)
 v_exp_f32_e64 v64, v64
 v_exp_f32 v65, v65
 v_exp_f32 v66, v66
 v_exp_f32 v67, v67
 v_mfma_f32_32x32x16_bf16 v[136:151], v[204:207], v[112:115], v[136:151]
 s_barrier
 s_nop 0
 v_cvt_pk_bf16_f32 v120, v64, v65
 v_exp_f32 v68, v68
 v_exp_f32 v69, v69
 v_cvt_pk_bf16_f32 v121, v66, v67
 v_mfma_f32_16x16x32_bf16 v[128:131], v[184:187], v[112:115], v[128:131]
 ds_read_b128 v[196:199], v220 offset:18432
 v_exp_f32 v70, v70
 v_exp_f32 v71, v71
 v_cvt_pk_bf16_f32 v122, v68, v69
 v_exp_f32_e64 v72, v72
 v_mfma_f32_32x32x16_bf16 v[48:63], v[216:219], v[172:175], v[48:63]
 ds_read_b128 v[188:191], v220 offset:16384
 v_exp_f32_e64 v73, v73
 v_cvt_pk_bf16_f32 v123, v70, v71
 v_exp_f32 v74, v74
 v_exp_f32 v75, v75
 v_mfma_f32_32x32x16_bf16 v[136:151], v[208:211], v[116:119], v[136:151]
 ds_read_b128 v[200:203], v220 offset:19456
 v_cvt_pk_bf16_f32 v124, v72, v73
 v_exp_f32 v76, v76
 v_exp_f32 v77, v77
 v_cvt_pk_bf16_f32 v125, v74, v75
 v_mfma_f32_16x16x32_bf16 v[128:131], v[184:187], v[116:119], v[128:131]
 ds_read_b128 v[192:195], v220 offset:17408
 v_exp_f32 v78, v78
 v_exp_f32 v79, v79
 v_cvt_pk_bf16_f32 v126, v76, v77
 v_cvt_pk_bf16_f32 v127, v78, v79
 v_mfma_f32_32x32x16_bf16 v[64:79], v[212:215], v[176:179], v[96:111]
 buffer_load_dwordx4 v221, s[28:31], s42 offen offset:0 sc1 lds
 v_exp_f32 v48, v48
 v_exp_f32 v49, v49
 v_exp_f32 v50, v50
 v_exp_f32 v51, v51
 v_mfma_f32_32x32x16_bf16 v[152:167], v[204:207], v[120:123], v[152:167]
 buffer_load_dwordx4 v221, s[28:31], s42 offen offset:1024 sc1 lds
 v_cvt_pk_bf16_f32 v112, v48, v49
 v_exp_f32 v52, v52
 v_exp_f32 v53, v53
 v_cvt_pk_bf16_f32 v113, v50, v51
 v_mfma_f32_16x16x32_bf16 v[132:135], v[184:187], v[120:123], v[132:135]
 buffer_load_dwordx4 v221, s[28:31], s42 offen offset:2048 sc1 lds
 v_exp_f32 v54, v54
 v_exp_f32 v55, v55
 v_cvt_pk_bf16_f32 v114, v52, v53
 v_exp_f32_e64 v56, v56
 v_mfma_f32_32x32x16_bf16 v[64:79], v[216:219], v[180:183], v[64:79]
 buffer_load_dwordx4 v221, s[28:31], s42 offen offset:3072 sc1 lds
 v_exp_f32_e64 v57, v57
 v_cvt_pk_bf16_f32 v115, v54, v55
 v_exp_f32 v58, v58
 v_exp_f32 v59, v59
 v_mfma_f32_32x32x16_bf16 v[152:167], v[208:211], v[124:127], v[152:167]
 s_waitcnt lgkmcnt(0)
 s_nop 0
 v_cvt_pk_bf16_f32 v116, v56, v57
 v_exp_f32 v60, v60
 v_exp_f32 v61, v61
 v_cvt_pk_bf16_f32 v117, v58, v59
 v_mfma_f32_16x16x32_bf16 v[132:135], v[184:187], v[124:127], v[132:135]
 v_exp_f32 v62, v62
 v_exp_f32 v63, v63
 v_cvt_pk_bf16_f32 v118, v60, v61
 v_cvt_pk_bf16_f32 v119, v62, v63
 v_mfma_f32_32x32x16_bf16 v[48:63], v[196:199], v[168:171], v[80:95]
 v_exp_f32 v64, v64
 v_exp_f32 v65, v65
 v_exp_f32 v66, v66
 v_exp_f32 v67, v67
 v_mfma_f32_32x32x16_bf16 v[136:151], v[188:191], v[112:115], v[136:151]
 ds_read_b128 v[212:215], v220 offset:22528
 v_cvt_pk_bf16_f32 v120, v64, v65
 v_exp_f32 v68, v68
 v_exp_f32 v69, v69
 v_cvt_pk_bf16_f32 v121, v66, v67
 v_mfma_f32_16x16x32_bf16 v[128:131], v[184:187], v[112:115], v[128:131]
 ds_read_b128 v[204:207], v220 offset:20480
 v_exp_f32 v70, v70
 v_exp_f32 v71, v71
 v_cvt_pk_bf16_f32 v122, v68, v69
 v_exp_f32_e64 v72, v72
 v_mfma_f32_32x32x16_bf16 v[48:63], v[200:203], v[172:175], v[48:63]
 ds_read_b128 v[216:219], v220 offset:23552
 v_exp_f32_e64 v73, v73
 v_cvt_pk_bf16_f32 v123, v70, v71
 v_exp_f32 v74, v74
 v_exp_f32 v75, v75
 v_mfma_f32_32x32x16_bf16 v[136:151], v[192:195], v[116:119], v[136:151]
 ds_read_b128 v[208:211], v220 offset:21504
 v_cvt_pk_bf16_f32 v124, v72, v73
 v_exp_f32 v76, v76
 v_exp_f32 v77, v77
 v_cvt_pk_bf16_f32 v125, v74, v75
 v_mfma_f32_16x16x32_bf16 v[128:131], v[184:187], v[116:119], v[128:131]
 s_mov_b32 m0, s57
 v_exp_f32_e64 v78, v78
 v_exp_f32 v79, v79
 v_cvt_pk_bf16_f32 v126, v76, v77
 v_cvt_pk_bf16_f32 v127, v78, v79
 v_mfma_f32_32x32x16_bf16 v[64:79], v[196:199], v[176:179], v[96:111]
 s_add_u32 s57, s57, 2048
 v_exp_f32 v48, v48
 v_exp_f32 v49, v49
 v_exp_f32 v50, v50
 v_exp_f32 v51, v51
 v_mfma_f32_32x32x16_bf16 v[152:167], v[188:191], v[120:123], v[152:167]
 buffer_load_dwordx4 v222, s[32:35], s58 offen lds
 v_cvt_pk_bf16_f32 v112, v48, v49
 v_exp_f32 v52, v52
 v_exp_f32 v53, v53
 v_cvt_pk_bf16_f32 v113, v50, v51
 v_mfma_f32_16x16x32_bf16 v[132:135], v[184:187], v[120:123], v[132:135]
 buffer_load_dwordx4 v223, s[32:35], s58 offen offset:1024 lds
 v_exp_f32 v54, v54
 v_exp_f32 v55, v55
 v_cvt_pk_bf16_f32 v114, v52, v53
 v_exp_f32_e64 v56, v56
 v_mfma_f32_32x32x16_bf16 v[64:79], v[200:203], v[180:183], v[64:79]
 s_add_u32 s58, s58, 57344
 v_exp_f32_e64 v57, v57
 v_cvt_pk_bf16_f32 v115, v54, v55
 v_exp_f32 v58, v58
 v_exp_f32 v59, v59
 v_mfma_f32_32x32x16_bf16 v[152:167], v[192:195], v[124:127], v[152:167]
 s_waitcnt lgkmcnt(0)
 s_nop 0
 v_cvt_pk_bf16_f32 v116, v56, v57
 v_exp_f32 v60, v60
 v_exp_f32 v61, v61
 v_cvt_pk_bf16_f32 v117, v58, v59
 v_mfma_f32_16x16x32_bf16 v[132:135], v[184:187], v[124:127], v[132:135]
 v_exp_f32 v62, v62
 v_exp_f32 v63, v63
 v_cvt_pk_bf16_f32 v118, v60, v61
 v_cvt_pk_bf16_f32 v119, v62, v63
 v_mfma_f32_32x32x16_bf16 v[48:63], v[212:215], v[168:171], v[80:95]
 s_xor_b32 s16, s49, 4
 v_exp_f32_e64 v64, v64
 v_exp_f32 v65, v65
 v_exp_f32 v66, v66
 v_exp_f32 v67, v67
 v_mfma_f32_32x32x16_bf16 v[136:151], v[204:207], v[112:115], v[136:151]
 ds_read_b128 v[196:199], v220 offset:26624
 s_mul_i32 s17, s16, 393216
 v_cvt_pk_bf16_f32 v120, v64, v65
 v_exp_f32 v68, v68
 v_exp_f32 v69, v69
 v_cvt_pk_bf16_f32 v121, v66, v67
 v_mfma_f32_16x16x32_bf16 v[128:131], v[184:187], v[112:115], v[128:131]
 ds_read_b128 v[188:191], v220 offset:24576
 s_add_u32 s17, s17, s50
 v_exp_f32_e64 v70, v70
 v_exp_f32 v71, v71
 v_cvt_pk_bf16_f32 v122, v68, v69
 v_exp_f32_e64 v72, v72
 v_mfma_f32_32x32x16_bf16 v[48:63], v[216:219], v[172:175], v[48:63]
 ds_read_b128 v[200:203], v220 offset:27648
 s_lshl_b32 s16, s16, 12
 v_exp_f32 v73, v73
 v_cvt_pk_bf16_f32 v123, v70, v71
 v_exp_f32 v74, v74
 v_exp_f32 v75, v75
 v_mfma_f32_32x32x16_bf16 v[136:151], v[208:211], v[116:119], v[136:151]
 ds_read_b128 v[192:195], v220 offset:25600
 s_add_u32 m0, s16, s51
 s_nop 0
 v_cvt_pk_bf16_f32 v124, v72, v73
 v_exp_f32 v76, v76
 v_exp_f32 v77, v77
 v_cvt_pk_bf16_f32 v125, v74, v75
 v_mfma_f32_16x16x32_bf16 v[128:131], v[184:187], v[116:119], v[128:131]
 buffer_load_dwordx4 v40, s[36:39], s17 offen lds
 v_exp_f32 v78, v78
 v_exp_f32 v79, v79
 v_cvt_pk_bf16_f32 v126, v76, v77
 v_cvt_pk_bf16_f32 v127, v78, v79
 v_mfma_f32_32x32x16_bf16 v[64:79], v[212:215], v[176:179], v[96:111]
 s_xor_b32 s16, s49, 5
 v_exp_f32_e64 v48, v48
 v_exp_f32 v49, v49
 v_exp_f32 v50, v50
 v_exp_f32 v51, v51
 v_mfma_f32_32x32x16_bf16 v[152:167], v[204:207], v[120:123], v[152:167]
 s_mul_i32 s17, s16, 393216
 v_cvt_pk_bf16_f32 v112, v48, v49
 v_exp_f32 v52, v52
 v_exp_f32 v53, v53
 v_cvt_pk_bf16_f32 v113, v50, v51
 v_mfma_f32_16x16x32_bf16 v[132:135], v[184:187], v[120:123], v[132:135]
 s_add_u32 s17, s17, s50
 v_exp_f32_e64 v54, v54
 v_exp_f32 v55, v55
 v_cvt_pk_bf16_f32 v114, v52, v53
 v_exp_f32_e64 v56, v56
 v_mfma_f32_32x32x16_bf16 v[64:79], v[216:219], v[180:183], v[64:79]
 s_lshl_b32 s16, s16, 12
 v_exp_f32 v57, v57
 v_cvt_pk_bf16_f32 v115, v54, v55
 v_exp_f32 v58, v58
 v_exp_f32 v59, v59
 v_mfma_f32_32x32x16_bf16 v[152:167], v[208:211], v[124:127], v[152:167]
 s_waitcnt lgkmcnt(0)
 s_add_u32 m0, s16, s51
 v_cvt_pk_bf16_f32 v116, v56, v57
 v_exp_f32 v60, v60
 v_exp_f32 v61, v61
 v_cvt_pk_bf16_f32 v117, v58, v59
 v_mfma_f32_16x16x32_bf16 v[132:135], v[184:187], v[124:127], v[132:135]
 v_exp_f32 v62, v62
 v_exp_f32 v63, v63
 v_cvt_pk_bf16_f32 v118, v60, v61
 v_cvt_pk_bf16_f32 v119, v62, v63
 v_mfma_f32_32x32x16_bf16 v[48:63], v[196:199], v[168:171], v[80:95]
 v_exp_f32 v64, v64
 v_exp_f32 v65, v65
 v_exp_f32 v66, v66
 v_exp_f32 v67, v67
 v_mfma_f32_32x32x16_bf16 v[136:151], v[188:191], v[112:115], v[136:151]
 ds_read_b128 v[212:215], v220 offset:30720
 buffer_load_dwordx4 v40, s[36:39], s17 offen lds
 v_cvt_pk_bf16_f32 v120, v64, v65
 v_exp_f32 v68, v68
 v_exp_f32 v69, v69
 v_cvt_pk_bf16_f32 v121, v66, v67
 v_mfma_f32_16x16x32_bf16 v[128:131], v[184:187], v[112:115], v[128:131]
 ds_read_b128 v[204:207], v220 offset:28672
 v_exp_f32 v70, v70
 v_exp_f32 v71, v71
 v_cvt_pk_bf16_f32 v122, v68, v69
 v_exp_f32_e64 v72, v72
 v_mfma_f32_32x32x16_bf16 v[48:63], v[200:203], v[172:175], v[48:63]
 ds_read_b128 v[216:219], v220 offset:31744
 v_exp_f32_e64 v73, v73
 v_cvt_pk_bf16_f32 v123, v70, v71
 v_exp_f32 v74, v74
 v_exp_f32 v75, v75
 v_mfma_f32_32x32x16_bf16 v[136:151], v[192:195], v[116:119], v[136:151]
 ds_read_b128 v[208:211], v220 offset:29696
 v_cvt_pk_bf16_f32 v124, v72, v73
 v_exp_f32 v76, v76
 v_exp_f32 v77, v77
 v_cvt_pk_bf16_f32 v125, v74, v75
 v_mfma_f32_16x16x32_bf16 v[128:131], v[184:187], v[116:119], v[128:131]
 s_add_u32 s42, s42, 16384
 v_exp_f32 v78, v78
 v_exp_f32 v79, v79
 v_cvt_pk_bf16_f32 v126, v76, v77
 v_cvt_pk_bf16_f32 v127, v78, v79
 v_mfma_f32_32x32x16_bf16 v[64:79], v[196:199], v[176:179], v[96:111]
 s_add_u32 m0, s43, s56
 v_exp_f32_e64 v48, v48
 v_exp_f32 v49, v49
 v_exp_f32 v50, v50
 v_exp_f32 v51, v51
 v_mfma_f32_32x32x16_bf16 v[152:167], v[188:191], v[120:123], v[152:167]
 s_add_u32 s43, s43, 16384
 v_cvt_pk_bf16_f32 v112, v48, v49
 v_exp_f32 v52, v52
 v_exp_f32 v53, v53
 v_cvt_pk_bf16_f32 v113, v50, v51
 v_mfma_f32_16x16x32_bf16 v[132:135], v[184:187], v[120:123], v[132:135]
 s_and_b32 s43, s43, 0xffff
 v_exp_f32 v54, v54
 v_exp_f32 v55, v55
 v_cvt_pk_bf16_f32 v114, v52, v53
 v_exp_f32_e64 v56, v56
 v_mfma_f32_32x32x16_bf16 v[64:79], v[200:203], v[180:183], v[64:79]
 v_exp_f32_e64 v57, v57
 v_cvt_pk_bf16_f32 v115, v54, v55
 v_exp_f32_e64 v58, v58
 v_exp_f32 v59, v59
 v_add_u32 v220, s43, v231
 v_mfma_f32_32x32x16_bf16 v[152:167], v[192:195], v[124:127], v[152:167]
 s_waitcnt lgkmcnt(0)
 s_nop 0
 v_cvt_pk_bf16_f32 v116, v56, v57
 v_exp_f32 v60, v60
 v_exp_f32 v61, v61
 v_cvt_pk_bf16_f32 v117, v58, v59
 v_mfma_f32_16x16x32_bf16 v[132:135], v[184:187], v[124:127], v[132:135]
 v_exp_f32 v62, v62
 v_exp_f32 v63, v63
 v_cvt_pk_bf16_f32 v118, v60, v61
 v_cvt_pk_bf16_f32 v119, v62, v63
 v_mfma_f32_32x32x16_bf16 v[48:63], v[212:215], v[168:171], v[80:95]
 s_waitcnt vmcnt(19)
 v_exp_f32_e64 v64, v64
 v_exp_f32 v65, v65
 v_exp_f32 v66, v66
 v_exp_f32 v67, v67
 v_mfma_f32_32x32x16_bf16 v[136:151], v[204:207], v[112:115], v[136:151]
 s_barrier
 s_nop 0
 v_cvt_pk_bf16_f32 v120, v64, v65
 v_exp_f32 v68, v68
 v_exp_f32 v69, v69
 v_cvt_pk_bf16_f32 v121, v66, v67
 v_mfma_f32_16x16x32_bf16 v[128:131], v[184:187], v[112:115], v[128:131]
 ds_read_b128 v[196:199], v220 offset:2048
 v_exp_f32 v70, v70
 v_exp_f32 v71, v71
 v_cvt_pk_bf16_f32 v122, v68, v69
 v_exp_f32_e64 v72, v72
 v_mfma_f32_32x32x16_bf16 v[48:63], v[216:219], v[172:175], v[48:63]
 ds_read_b128 v[188:191], v220 offset:0
 v_exp_f32_e64 v73, v73
 v_cvt_pk_bf16_f32 v123, v70, v71
 v_exp_f32 v74, v74
 v_exp_f32 v75, v75
 v_mfma_f32_32x32x16_bf16 v[136:151], v[208:211], v[116:119], v[136:151]
 ds_read_b128 v[200:203], v220 offset:3072
 v_cvt_pk_bf16_f32 v124, v72, v73
 v_exp_f32 v76, v76
 v_exp_f32 v77, v77
 v_cvt_pk_bf16_f32 v125, v74, v75
 v_mfma_f32_16x16x32_bf16 v[128:131], v[184:187], v[116:119], v[128:131]
 ds_read_b128 v[192:195], v220 offset:1024
 v_exp_f32 v78, v78
 v_exp_f32 v79, v79
 v_cvt_pk_bf16_f32 v126, v76, v77
 v_cvt_pk_bf16_f32 v127, v78, v79
 v_mfma_f32_32x32x16_bf16 v[64:79], v[212:215], v[176:179], v[96:111]
 buffer_load_dwordx4 v221, s[28:31], s42 offen offset:0 sc1 lds
 v_exp_f32 v48, v48
 v_exp_f32 v49, v49
 v_exp_f32 v50, v50
 v_exp_f32 v51, v51
 v_mfma_f32_32x32x16_bf16 v[152:167], v[204:207], v[120:123], v[152:167]
 buffer_load_dwordx4 v221, s[28:31], s42 offen offset:1024 sc1 lds
 v_cvt_pk_bf16_f32 v112, v48, v49
 v_exp_f32 v52, v52
 v_exp_f32 v53, v53
 v_cvt_pk_bf16_f32 v113, v50, v51
 v_mfma_f32_16x16x32_bf16 v[132:135], v[184:187], v[120:123], v[132:135]
 buffer_load_dwordx4 v221, s[28:31], s42 offen offset:2048 sc1 lds
 v_exp_f32 v54, v54
 v_exp_f32 v55, v55
 v_cvt_pk_bf16_f32 v114, v52, v53
 v_exp_f32_e64 v56, v56
 v_mfma_f32_32x32x16_bf16 v[64:79], v[216:219], v[180:183], v[64:79]
 buffer_load_dwordx4 v221, s[28:31], s42 offen offset:3072 sc1 lds
 v_exp_f32_e64 v57, v57
 v_cvt_pk_bf16_f32 v115, v54, v55
 v_exp_f32 v58, v58
 v_exp_f32 v59, v59
 v_mfma_f32_32x32x16_bf16 v[152:167], v[208:211], v[124:127], v[152:167]
 s_waitcnt lgkmcnt(0)
 s_nop 0
 v_cvt_pk_bf16_f32 v116, v56, v57
 v_exp_f32 v60, v60
 v_exp_f32 v61, v61
 v_cvt_pk_bf16_f32 v117, v58, v59
 v_mfma_f32_16x16x32_bf16 v[132:135], v[184:187], v[124:127], v[132:135]
 v_exp_f32 v62, v62
 v_exp_f32 v63, v63
 v_cvt_pk_bf16_f32 v118, v60, v61
 v_cvt_pk_bf16_f32 v119, v62, v63
 v_mfma_f32_32x32x16_bf16 v[48:63], v[196:199], v[168:171], v[80:95]
 v_exp_f32 v64, v64
 v_exp_f32 v65, v65
 v_exp_f32 v66, v66
 v_exp_f32 v67, v67
 v_mfma_f32_32x32x16_bf16 v[136:151], v[188:191], v[112:115], v[136:151]
 ds_read_b128 v[212:215], v220 offset:6144
 v_cvt_pk_bf16_f32 v120, v64, v65
 v_exp_f32 v68, v68
 v_exp_f32 v69, v69
 v_cvt_pk_bf16_f32 v121, v66, v67
 v_mfma_f32_16x16x32_bf16 v[128:131], v[184:187], v[112:115], v[128:131]
 ds_read_b128 v[204:207], v220 offset:4096
 v_exp_f32 v70, v70
 v_exp_f32 v71, v71
 v_cvt_pk_bf16_f32 v122, v68, v69
 v_exp_f32_e64 v72, v72
 v_mfma_f32_32x32x16_bf16 v[48:63], v[200:203], v[172:175], v[48:63]
 ds_read_b128 v[216:219], v220 offset:7168
 v_exp_f32_e64 v73, v73
 v_cvt_pk_bf16_f32 v123, v70, v71
 v_exp_f32 v74, v74
 v_exp_f32 v75, v75
 v_mfma_f32_32x32x16_bf16 v[136:151], v[192:195], v[116:119], v[136:151]
 ds_read_b128 v[208:211], v220 offset:5120
 v_cvt_pk_bf16_f32 v124, v72, v73
 v_exp_f32 v76, v76
 v_exp_f32 v77, v77
 v_cvt_pk_bf16_f32 v125, v74, v75
 v_mfma_f32_16x16x32_bf16 v[128:131], v[184:187], v[116:119], v[128:131]
 s_mov_b32 m0, s57
 v_exp_f32_e64 v78, v78
 v_exp_f32 v79, v79
 v_cvt_pk_bf16_f32 v126, v76, v77
 v_cvt_pk_bf16_f32 v127, v78, v79
 v_mfma_f32_32x32x16_bf16 v[64:79], v[196:199], v[176:179], v[96:111]
 s_add_u32 s57, s57, 2048
 v_exp_f32 v48, v48
 v_exp_f32 v49, v49
 v_exp_f32 v50, v50
 v_exp_f32 v51, v51
 v_mfma_f32_32x32x16_bf16 v[152:167], v[188:191], v[120:123], v[152:167]
 buffer_load_dwordx4 v222, s[32:35], s58 offen lds
 v_cvt_pk_bf16_f32 v112, v48, v49
 v_exp_f32 v52, v52
 v_exp_f32 v53, v53
 v_cvt_pk_bf16_f32 v113, v50, v51
 v_mfma_f32_16x16x32_bf16 v[132:135], v[184:187], v[120:123], v[132:135]
 buffer_load_dwordx4 v223, s[32:35], s58 offen offset:1024 lds
 v_exp_f32 v54, v54
 v_exp_f32 v55, v55
 v_cvt_pk_bf16_f32 v114, v52, v53
 v_exp_f32_e64 v56, v56
 v_mfma_f32_32x32x16_bf16 v[64:79], v[200:203], v[180:183], v[64:79]
 s_add_u32 s58, s58, 57344
 v_exp_f32_e64 v57, v57
 v_cvt_pk_bf16_f32 v115, v54, v55
 v_exp_f32 v58, v58
 v_exp_f32 v59, v59
 v_mfma_f32_32x32x16_bf16 v[152:167], v[192:195], v[124:127], v[152:167]
 s_waitcnt lgkmcnt(0)
 s_nop 0
 v_cvt_pk_bf16_f32 v116, v56, v57
 v_exp_f32 v60, v60
 v_exp_f32 v61, v61
 v_cvt_pk_bf16_f32 v117, v58, v59
 v_mfma_f32_16x16x32_bf16 v[132:135], v[184:187], v[124:127], v[132:135]
 v_exp_f32 v62, v62
 v_exp_f32 v63, v63
 v_cvt_pk_bf16_f32 v118, v60, v61
 v_cvt_pk_bf16_f32 v119, v62, v63
 v_mfma_f32_32x32x16_bf16 v[48:63], v[212:215], v[168:171], v[80:95]
 s_xor_b32 s16, s49, 6
 v_exp_f32_e64 v64, v64
 v_exp_f32 v65, v65
 v_exp_f32 v66, v66
 v_exp_f32 v67, v67
 v_mfma_f32_32x32x16_bf16 v[136:151], v[204:207], v[112:115], v[136:151]
 ds_read_b128 v[196:199], v220 offset:10240
 s_mul_i32 s17, s16, 393216
 v_cvt_pk_bf16_f32 v120, v64, v65
 v_exp_f32 v68, v68
 v_exp_f32 v69, v69
 v_cvt_pk_bf16_f32 v121, v66, v67
 v_mfma_f32_16x16x32_bf16 v[128:131], v[184:187], v[112:115], v[128:131]
 ds_read_b128 v[188:191], v220 offset:8192
 s_add_u32 s17, s17, s50
 v_exp_f32_e64 v70, v70
 v_exp_f32 v71, v71
 v_cvt_pk_bf16_f32 v122, v68, v69
 v_exp_f32_e64 v72, v72
 v_mfma_f32_32x32x16_bf16 v[48:63], v[216:219], v[172:175], v[48:63]
 ds_read_b128 v[200:203], v220 offset:11264
 s_lshl_b32 s16, s16, 12
 v_exp_f32 v73, v73
 v_cvt_pk_bf16_f32 v123, v70, v71
 v_exp_f32 v74, v74
 v_exp_f32 v75, v75
 v_mfma_f32_32x32x16_bf16 v[136:151], v[208:211], v[116:119], v[136:151]
 ds_read_b128 v[192:195], v220 offset:9216
 s_add_u32 m0, s16, s51
 s_nop 0
 v_cvt_pk_bf16_f32 v124, v72, v73
 v_exp_f32 v76, v76
 v_exp_f32 v77, v77
 v_cvt_pk_bf16_f32 v125, v74, v75
 v_mfma_f32_16x16x32_bf16 v[128:131], v[184:187], v[116:119], v[128:131]
 buffer_load_dwordx4 v40, s[36:39], s17 offen lds
 v_exp_f32 v78, v78
 v_exp_f32 v79, v79
 v_cvt_pk_bf16_f32 v126, v76, v77
 v_cvt_pk_bf16_f32 v127, v78, v79
 v_mfma_f32_32x32x16_bf16 v[64:79], v[212:215], v[176:179], v[96:111]
 s_xor_b32 s16, s49, 7
 v_exp_f32_e64 v48, v48
 v_exp_f32 v49, v49
 v_exp_f32 v50, v50
 v_exp_f32 v51, v51
 v_mfma_f32_32x32x16_bf16 v[152:167], v[204:207], v[120:123], v[152:167]
 s_mul_i32 s17, s16, 393216
 v_cvt_pk_bf16_f32 v112, v48, v49
 v_exp_f32 v52, v52
 v_exp_f32 v53, v53
 v_cvt_pk_bf16_f32 v113, v50, v51
 v_mfma_f32_16x16x32_bf16 v[132:135], v[184:187], v[120:123], v[132:135]
 s_add_u32 s17, s17, s50
 v_exp_f32_e64 v54, v54
 v_exp_f32 v55, v55
 v_cvt_pk_bf16_f32 v114, v52, v53
 v_exp_f32_e64 v56, v56
 v_mfma_f32_32x32x16_bf16 v[64:79], v[216:219], v[180:183], v[64:79]
 s_lshl_b32 s16, s16, 12
 v_exp_f32 v57, v57
 v_cvt_pk_bf16_f32 v115, v54, v55
 v_exp_f32 v58, v58
 v_exp_f32 v59, v59
 v_mfma_f32_32x32x16_bf16 v[152:167], v[208:211], v[124:127], v[152:167]
 s_waitcnt lgkmcnt(0)
 s_add_u32 m0, s16, s51
 v_cvt_pk_bf16_f32 v116, v56, v57
 v_exp_f32 v60, v60
 v_exp_f32 v61, v61
 v_cvt_pk_bf16_f32 v117, v58, v59
 v_mfma_f32_16x16x32_bf16 v[132:135], v[184:187], v[124:127], v[132:135]
 v_exp_f32 v62, v62
 v_exp_f32 v63, v63
 v_cvt_pk_bf16_f32 v118, v60, v61
 v_cvt_pk_bf16_f32 v119, v62, v63
 v_mfma_f32_32x32x16_bf16 v[48:63], v[196:199], v[168:171], v[80:95]
 v_exp_f32 v64, v64
 v_exp_f32 v65, v65
 v_exp_f32 v66, v66
 v_exp_f32 v67, v67
 v_mfma_f32_32x32x16_bf16 v[136:151], v[188:191], v[112:115], v[136:151]
 ds_read_b128 v[212:215], v220 offset:14336
 buffer_load_dwordx4 v40, s[36:39], s17 offen lds
 v_cvt_pk_bf16_f32 v120, v64, v65
 v_exp_f32 v68, v68
 v_exp_f32 v69, v69
 v_cvt_pk_bf16_f32 v121, v66, v67
 v_mfma_f32_16x16x32_bf16 v[128:131], v[184:187], v[112:115], v[128:131]
 ds_read_b128 v[204:207], v220 offset:12288
 v_exp_f32 v70, v70
 v_exp_f32 v71, v71
 v_cvt_pk_bf16_f32 v122, v68, v69
 v_exp_f32_e64 v72, v72
 v_mfma_f32_32x32x16_bf16 v[48:63], v[200:203], v[172:175], v[48:63]
 ds_read_b128 v[216:219], v220 offset:15360
 v_exp_f32_e64 v73, v73
 v_cvt_pk_bf16_f32 v123, v70, v71
 v_exp_f32 v74, v74
 v_exp_f32 v75, v75
 v_mfma_f32_32x32x16_bf16 v[136:151], v[192:195], v[116:119], v[136:151]
 ds_read_b128 v[208:211], v220 offset:13312
 v_cvt_pk_bf16_f32 v124, v72, v73
 v_exp_f32 v76, v76
 v_exp_f32 v77, v77
 v_cvt_pk_bf16_f32 v125, v74, v75
 v_mfma_f32_16x16x32_bf16 v[128:131], v[184:187], v[116:119], v[128:131]
 s_add_u32 s42, s42, 16384
 v_exp_f32 v78, v78
 v_exp_f32 v79, v79
 v_cvt_pk_bf16_f32 v126, v76, v77
 v_cvt_pk_bf16_f32 v127, v78, v79
 v_mfma_f32_32x32x16_bf16 v[64:79], v[196:199], v[176:179], v[96:111]
 s_add_u32 m0, s43, s56
 v_exp_f32_e64 v48, v48
 v_exp_f32 v49, v49
 v_exp_f32 v50, v50
 v_exp_f32 v51, v51
 v_mfma_f32_32x32x16_bf16 v[152:167], v[188:191], v[120:123], v[152:167]
 s_add_u32 s43, s43, 16384
 v_cvt_pk_bf16_f32 v112, v48, v49
 v_exp_f32 v52, v52
 v_exp_f32 v53, v53
 v_cvt_pk_bf16_f32 v113, v50, v51
 v_mfma_f32_16x16x32_bf16 v[132:135], v[184:187], v[120:123], v[132:135]
 s_and_b32 s43, s43, 0xffff
 v_exp_f32 v54, v54
 v_exp_f32 v55, v55
 v_cvt_pk_bf16_f32 v114, v52, v53
 v_exp_f32_e64 v56, v56
 v_mfma_f32_32x32x16_bf16 v[64:79], v[200:203], v[180:183], v[64:79]
 v_exp_f32_e64 v57, v57
 v_cvt_pk_bf16_f32 v115, v54, v55
 v_exp_f32 v58, v58
 v_exp_f32 v59, v59
 v_mfma_f32_32x32x16_bf16 v[152:167], v[192:195], v[124:127], v[152:167]
 s_waitcnt lgkmcnt(0)
 s_nop 0
 v_cvt_pk_bf16_f32 v116, v56, v57
 v_exp_f32 v60, v60
 v_exp_f32 v61, v61
 v_cvt_pk_bf16_f32 v117, v58, v59
 v_mfma_f32_16x16x32_bf16 v[132:135], v[184:187], v[124:127], v[132:135]
 v_exp_f32 v62, v62
 v_exp_f32 v63, v63
 v_cvt_pk_bf16_f32 v118, v60, v61
 v_cvt_pk_bf16_f32 v119, v62, v63
 v_mfma_f32_32x32x16_bf16 v[48:63], v[212:215], v[168:171], v[80:95]
 s_waitcnt vmcnt(20)
 v_exp_f32_e64 v64, v64
 v_exp_f32 v65, v65
 v_exp_f32 v66, v66
 v_exp_f32 v67, v67
 v_mfma_f32_32x32x16_bf16 v[136:151], v[204:207], v[112:115], v[136:151]
 s_barrier
 s_nop 0
 v_cvt_pk_bf16_f32 v120, v64, v65
 v_exp_f32 v68, v68
 v_exp_f32 v69, v69
 v_cvt_pk_bf16_f32 v121, v66, v67
 v_mfma_f32_16x16x32_bf16 v[128:131], v[184:187], v[112:115], v[128:131]
 ds_read_b128 v[196:199], v220 offset:18432
 v_exp_f32 v70, v70
 v_exp_f32 v71, v71
 v_cvt_pk_bf16_f32 v122, v68, v69
 v_exp_f32_e64 v72, v72
 v_mfma_f32_32x32x16_bf16 v[48:63], v[216:219], v[172:175], v[48:63]
 ds_read_b128 v[188:191], v220 offset:16384
 v_exp_f32_e64 v73, v73
 v_cvt_pk_bf16_f32 v123, v70, v71
 v_exp_f32 v74, v74
 v_exp_f32 v75, v75
 v_mfma_f32_32x32x16_bf16 v[136:151], v[208:211], v[116:119], v[136:151]
 ds_read_b128 v[200:203], v220 offset:19456
 v_cvt_pk_bf16_f32 v124, v72, v73
 v_exp_f32 v76, v76
 v_exp_f32 v77, v77
 v_cvt_pk_bf16_f32 v125, v74, v75
 v_mfma_f32_16x16x32_bf16 v[128:131], v[184:187], v[116:119], v[128:131]
 ds_read_b128 v[192:195], v220 offset:17408
 v_exp_f32 v78, v78
 v_exp_f32 v79, v79
 v_cvt_pk_bf16_f32 v126, v76, v77
 v_cvt_pk_bf16_f32 v127, v78, v79
 v_mfma_f32_32x32x16_bf16 v[64:79], v[212:215], v[176:179], v[96:111]
 buffer_load_dwordx4 v221, s[28:31], s42 offen offset:0 sc1 lds
 v_exp_f32 v48, v48
 v_exp_f32 v49, v49
 v_exp_f32 v50, v50
 v_exp_f32 v51, v51
 v_mfma_f32_32x32x16_bf16 v[152:167], v[204:207], v[120:123], v[152:167]
 buffer_load_dwordx4 v221, s[28:31], s42 offen offset:1024 sc1 lds
 v_cvt_pk_bf16_f32 v112, v48, v49
 v_exp_f32 v52, v52
 v_exp_f32 v53, v53
 v_cvt_pk_bf16_f32 v113, v50, v51
 v_mfma_f32_16x16x32_bf16 v[132:135], v[184:187], v[120:123], v[132:135]
 buffer_load_dwordx4 v221, s[28:31], s42 offen offset:2048 sc1 lds
 v_exp_f32 v54, v54
 v_exp_f32 v55, v55
 v_cvt_pk_bf16_f32 v114, v52, v53
 v_exp_f32_e64 v56, v56
 v_mfma_f32_32x32x16_bf16 v[64:79], v[216:219], v[180:183], v[64:79]
 buffer_load_dwordx4 v221, s[28:31], s42 offen offset:3072 sc1 lds
 v_exp_f32_e64 v57, v57
 v_cvt_pk_bf16_f32 v115, v54, v55
 v_exp_f32 v58, v58
 v_exp_f32 v59, v59
 v_mfma_f32_32x32x16_bf16 v[152:167], v[208:211], v[124:127], v[152:167]
 s_waitcnt lgkmcnt(0)
 s_nop 0
 v_cvt_pk_bf16_f32 v116, v56, v57
 v_exp_f32 v60, v60
 v_exp_f32 v61, v61
 v_cvt_pk_bf16_f32 v117, v58, v59
 v_mfma_f32_16x16x32_bf16 v[132:135], v[184:187], v[124:127], v[132:135]
 v_exp_f32 v62, v62
 v_exp_f32 v63, v63
 v_cvt_pk_bf16_f32 v118, v60, v61
 v_cvt_pk_bf16_f32 v119, v62, v63
 v_mfma_f32_32x32x16_bf16 v[48:63], v[196:199], v[168:171], v[80:95]
 v_lshrrev_b32 v3, 4, v0
 v_lshlrev_b32 v1, 3, v3
 v_bfe_u32 v2, v0, 2, 2
 v_exp_f32 v64, v64
 v_exp_f32 v65, v65
 v_exp_f32 v66, v66
 v_exp_f32 v67, v67
 v_mfma_f32_32x32x16_bf16 v[136:151], v[188:191], v[112:115], v[136:151]
 ds_read_b128 v[212:215], v220 offset:22528
 v_add_u32 v1, v1, v2
 v_and_b32 v2, 3, v0
 v_cvt_pk_bf16_f32 v120, v64, v65
 v_exp_f32 v68, v68
 v_exp_f32 v69, v69
 v_cvt_pk_bf16_f32 v121, v66, v67
 v_mfma_f32_16x16x32_bf16 v[128:131], v[184:187], v[112:115], v[128:131]
 ds_read_b128 v[204:207], v220 offset:20480
 v_lshlrev_b32_e64 v2, 3, v2
 v_lshl_add_u32 v1, v1, 5, v2
 v_add_u32_e64 v1, s51, v1
 v_exp_f32 v70, v70
 v_exp_f32 v71, v71
 v_cvt_pk_bf16_f32 v122, v68, v69
 v_exp_f32_e64 v72, v72
 v_mfma_f32_32x32x16_bf16 v[48:63], v[200:203], v[172:175], v[48:63]
 ds_read_b128 v[216:219], v220 offset:23552
 s_waitcnt vmcnt(4)
 s_nop 0
 ds_read_b64_tr_b16 v[12:13], v1 offset:0
 ds_read_b64_tr_b16 v[14:15], v1 offset:128
 v_exp_f32_e64 v73, v73
 v_cvt_pk_bf16_f32 v123, v70, v71
 v_exp_f32 v74, v74
 v_exp_f32 v75, v75
 v_mfma_f32_32x32x16_bf16 v[136:151], v[192:195], v[116:119], v[136:151]
 ds_read_b128 v[208:211], v220 offset:21504
 ds_read_b64_tr_b16 v[16:17], v1 offset:4096
 ds_read_b64_tr_b16 v[18:19], v1 offset:4224
 v_cvt_pk_bf16_f32 v124, v72, v73
 v_exp_f32 v76, v76
 v_exp_f32 v77, v77
 v_cvt_pk_bf16_f32 v125, v74, v75
 v_mfma_f32_16x16x32_bf16 v[128:131], v[184:187], v[116:119], v[128:131]
 s_mov_b32 m0, s57
 s_nop 0
 ds_read_b64_tr_b16 v[20:21], v1 offset:8192
 ds_read_b64_tr_b16 v[22:23], v1 offset:8320
 ds_read_b64_tr_b16 v[24:25], v1 offset:12288
 v_exp_f32 v78, v78
 v_exp_f32 v79, v79
 v_cvt_pk_bf16_f32 v126, v76, v77
 v_cvt_pk_bf16_f32 v127, v78, v79
 v_mfma_f32_32x32x16_bf16 v[64:79], v[196:199], v[176:179], v[96:111]
 s_add_u32 s57, s57, 2048
 ds_read_b64_tr_b16 v[26:27], v1 offset:12416
 ds_read_b64_tr_b16 v[28:29], v1 offset:16384
 v_exp_f32 v48, v48
 v_exp_f32 v49, v49
 v_exp_f32 v50, v50
 v_exp_f32 v51, v51
 v_mfma_f32_32x32x16_bf16 v[152:167], v[188:191], v[120:123], v[152:167]
 buffer_load_dwordx4 v222, s[32:35], s58 offen lds
 ds_read_b64_tr_b16 v[30:31], v1 offset:16512
 ds_read_b64_tr_b16 v[32:33], v1 offset:20480
 ds_read_b64_tr_b16 v[34:35], v1 offset:20608
 v_cvt_pk_bf16_f32 v112, v48, v49
 v_exp_f32 v52, v52
 v_exp_f32 v53, v53
 v_cvt_pk_bf16_f32 v113, v50, v51
 v_mfma_f32_16x16x32_bf16 v[132:135], v[184:187], v[120:123], v[132:135]
 buffer_load_dwordx4 v223, s[32:35], s58 offen offset:1024 lds
 ds_read_b64_tr_b16 v[36:37], v1 offset:24576
 ds_read_b64_tr_b16 v[38:39], v1 offset:24704
 v_exp_f32 v54, v54
 v_exp_f32 v55, v55
 v_cvt_pk_bf16_f32 v114, v52, v53
 v_exp_f32_e64 v56, v56
 v_mfma_f32_32x32x16_bf16 v[64:79], v[200:203], v[180:183], v[64:79]
 s_add_u32 s58, s58, 57344
 ds_read_b64_tr_b16 v[40:41], v1 offset:28672
 ds_read_b64_tr_b16 v[42:43], v1 offset:28800
 v_exp_f32_e64 v57, v57
 v_cvt_pk_bf16_f32 v115, v54, v55
 v_exp_f32 v58, v58
 v_exp_f32 v59, v59
 v_mfma_f32_32x32x16_bf16 v[152:167], v[192:195], v[124:127], v[152:167]
 s_waitcnt lgkmcnt(0)
 s_nop 0
 v_cvt_pk_bf16_f32 v116, v56, v57
 v_exp_f32 v60, v60
 v_exp_f32 v61, v61
 v_cvt_pk_bf16_f32 v117, v58, v59
 v_mfma_f32_16x16x32_bf16 v[132:135], v[184:187], v[124:127], v[132:135]
 v_exp_f32 v62, v62
 v_exp_f32 v63, v63
 v_cvt_pk_bf16_f32 v118, v60, v61
 v_cvt_pk_bf16_f32 v119, v62, v63
 v_mfma_f32_32x32x16_bf16 v[48:63], v[212:215], v[168:171], v[80:95]
 v_mfma_f32_16x16x32_bf16 v[4:7], v[12:15], a[224:227], 0
 v_mfma_f32_16x16x32_bf16 v[8:11], v[16:19], a[228:231], 0
 v_exp_f32 v64, v64
 v_exp_f32 v65, v65
 v_exp_f32 v66, v66
 v_exp_f32 v67, v67
 v_mfma_f32_32x32x16_bf16 v[136:151], v[204:207], v[112:115], v[136:151]
 ds_read_b128 v[196:199], v220 offset:26624
 v_mfma_f32_16x16x32_bf16 v[4:7], v[20:23], a[232:235], v[4:7]
 v_cvt_pk_bf16_f32 v120, v64, v65
 v_exp_f32 v68, v68
 v_exp_f32 v69, v69
 v_cvt_pk_bf16_f32 v121, v66, v67
 v_mfma_f32_16x16x32_bf16 v[128:131], v[184:187], v[112:115], v[128:131]
 ds_read_b128 v[188:191], v220 offset:24576
 v_mfma_f32_16x16x32_bf16 v[8:11], v[24:27], a[236:239], v[8:11]
 v_exp_f32 v70, v70
 v_exp_f32 v71, v71
 v_cvt_pk_bf16_f32 v122, v68, v69
 v_exp_f32_e64 v72, v72
 v_mfma_f32_32x32x16_bf16 v[48:63], v[216:219], v[172:175], v[48:63]
 ds_read_b128 v[200:203], v220 offset:27648
 v_mfma_f32_16x16x32_bf16 v[4:7], v[28:31], a[240:243], v[4:7]
 v_exp_f32_e64 v73, v73
 v_cvt_pk_bf16_f32 v123, v70, v71
 v_exp_f32 v74, v74
 v_exp_f32 v75, v75
 v_mfma_f32_32x32x16_bf16 v[136:151], v[208:211], v[116:119], v[136:151]
 ds_read_b128 v[192:195], v220 offset:25600
 v_mfma_f32_16x16x32_bf16 v[8:11], v[32:35], a[244:247], v[8:11]
 v_cvt_pk_bf16_f32 v124, v72, v73
 v_exp_f32 v76, v76
 v_exp_f32 v77, v77
 v_cvt_pk_bf16_f32 v125, v74, v75
 v_mfma_f32_16x16x32_bf16 v[128:131], v[184:187], v[116:119], v[128:131]
 v_mfma_f32_16x16x32_bf16 v[4:7], v[36:39], a[248:251], v[4:7]
 v_mfma_f32_16x16x32_bf16 v[8:11], v[40:43], a[252:255], v[8:11]
 v_exp_f32 v78, v78
 v_exp_f32 v79, v79
 v_cvt_pk_bf16_f32 v126, v76, v77
 v_cvt_pk_bf16_f32 v127, v78, v79
 v_mfma_f32_32x32x16_bf16 v[64:79], v[212:215], v[176:179], v[96:111]
 v_lshl_add_u32 v1, v3, 4, s51
 v_exp_f32 v48, v48
 v_exp_f32 v49, v49
 v_exp_f32 v50, v50
 v_exp_f32 v51, v51
 v_mfma_f32_32x32x16_bf16 v[152:167], v[204:207], v[120:123], v[152:167]
 v_and_b32_e64 v2, 7, v0
 v_cvt_pk_bf16_f32 v112, v48, v49
 v_exp_f32 v52, v52
 v_exp_f32 v53, v53
 v_cvt_pk_bf16_f32 v113, v50, v51
 v_mfma_f32_16x16x32_bf16 v[132:135], v[184:187], v[120:123], v[132:135]
 v_lshlrev_b32_e64 v2, 3, v2
 v_exp_f32 v54, v54
 v_exp_f32 v55, v55
 v_cvt_pk_bf16_f32 v114, v52, v53
 v_exp_f32_e64 v56, v56
 v_mfma_f32_32x32x16_bf16 v[64:79], v[216:219], v[180:183], v[64:79]
 v_add_u32 v3, 131072, v2
 v_exp_f32_e64 v57, v57
 v_cvt_pk_bf16_f32 v115, v54, v55
 v_exp_f32 v58, v58
 v_exp_f32 v59, v59
 v_mfma_f32_32x32x16_bf16 v[152:167], v[208:211], v[124:127], v[152:167]
 s_waitcnt lgkmcnt(0)
 s_nop 0
 v_cvt_pk_bf16_f32 v116, v56, v57
 v_exp_f32 v60, v60
 v_exp_f32 v61, v61
 v_cvt_pk_bf16_f32 v117, v58, v59
 v_mfma_f32_16x16x32_bf16 v[132:135], v[184:187], v[124:127], v[132:135]
 v_exp_f32 v62, v62
 v_exp_f32 v63, v63
 v_cvt_pk_bf16_f32 v118, v60, v61
 v_cvt_pk_bf16_f32 v119, v62, v63
 v_mfma_f32_32x32x16_bf16 v[48:63], v[196:199], v[168:171], v[80:95]
 v_exp_f32 v64, v64
 v_exp_f32 v65, v65
 v_exp_f32 v66, v66
 v_exp_f32 v67, v67
 v_mfma_f32_32x32x16_bf16 v[136:151], v[188:191], v[112:115], v[136:151]
 ds_read_b128 v[212:215], v220 offset:30720
 v_add_f32_e64 v4, v4, v8
 v_cvt_pk_bf16_f32 v120, v64, v65
 v_exp_f32 v68, v68
 v_exp_f32 v69, v69
 v_cvt_pk_bf16_f32 v121, v66, v67
 v_mfma_f32_16x16x32_bf16 v[128:131], v[184:187], v[112:115], v[128:131]
 ds_read_b128 v[204:207], v220 offset:28672
 v_add_f32_e64 v5, v5, v9
 v_exp_f32 v70, v70
 v_exp_f32 v71, v71
 v_cvt_pk_bf16_f32 v122, v68, v69
 v_exp_f32_e64 v72, v72
 v_mfma_f32_32x32x16_bf16 v[48:63], v[200:203], v[172:175], v[48:63]
 ds_read_b128 v[216:219], v220 offset:31744
 v_add_f32 v6, v6, v10
 v_exp_f32 v73, v73
 v_cvt_pk_bf16_f32 v123, v70, v71
 v_exp_f32 v74, v74
 v_exp_f32 v75, v75
 v_mfma_f32_32x32x16_bf16 v[136:151], v[192:195], v[116:119], v[136:151]
 ds_read_b128 v[208:211], v220 offset:29696
 v_cvt_pk_bf16_f32 v124, v72, v73
 v_exp_f32 v76, v76
 v_exp_f32 v77, v77
 v_cvt_pk_bf16_f32 v125, v74, v75
 v_mfma_f32_16x16x32_bf16 v[128:131], v[184:187], v[116:119], v[128:131]
 s_add_u32 s42, s42, 16384
 v_add_f32_e64 v7, v7, v11
 v_exp_f32 v78, v78
 v_exp_f32 v79, v79
 v_cvt_pk_bf16_f32 v126, v76, v77
 v_cvt_pk_bf16_f32 v127, v78, v79
 v_mfma_f32_32x32x16_bf16 v[64:79], v[196:199], v[176:179], v[96:111]
 s_add_u32 m0, s43, s56
 s_nop 0
 s_mov_b32 exec_lo, 0x00010001
 s_mov_b32 exec_hi, 0x00010001
 ds_write_b128 v1, v[4:7]
 s_mov_b64 exec, -1
 v_exp_f32_e64 v48, v48
 v_exp_f32 v49, v49
 v_exp_f32 v50, v50
 v_exp_f32 v51, v51
 v_mfma_f32_32x32x16_bf16 v[152:167], v[188:191], v[120:123], v[152:167]
 s_add_u32 s43, s43, 16384
 v_cvt_pk_bf16_f32 v112, v48, v49
 v_exp_f32 v52, v52
 v_exp_f32 v53, v53
 v_cvt_pk_bf16_f32 v113, v50, v51
 v_mfma_f32_16x16x32_bf16 v[132:135], v[184:187], v[120:123], v[132:135]
 s_and_b32 s43, s43, 0xffff
 v_exp_f32 v54, v54
 v_exp_f32 v55, v55
 v_cvt_pk_bf16_f32 v114, v52, v53
 v_exp_f32_e64 v56, v56
 v_mfma_f32_32x32x16_bf16 v[64:79], v[200:203], v[180:183], v[64:79]
 v_exp_f32_e64 v57, v57
 v_cvt_pk_bf16_f32 v115, v54, v55
 v_exp_f32_e64 v58, v58
 v_exp_f32 v59, v59
 v_add_u32 v220, s43, v231
 v_mfma_f32_32x32x16_bf16 v[152:167], v[192:195], v[124:127], v[152:167]
 s_waitcnt lgkmcnt(0)
 s_nop 0
 v_cvt_pk_bf16_f32 v116, v56, v57
 v_exp_f32 v60, v60
 v_exp_f32 v61, v61
 v_cvt_pk_bf16_f32 v117, v58, v59
 v_mfma_f32_16x16x32_bf16 v[132:135], v[184:187], v[124:127], v[132:135]
 v_exp_f32 v62, v62
 v_exp_f32 v63, v63
 v_cvt_pk_bf16_f32 v118, v60, v61
 v_cvt_pk_bf16_f32 v119, v62, v63
 v_mfma_f32_32x32x16_bf16 v[48:63], v[212:215], v[168:171], v[80:95]
 v_exp_f32 v64, v64
 v_exp_f32 v65, v65
 v_exp_f32 v66, v66
 v_exp_f32 v67, v67
 v_mfma_f32_32x32x16_bf16 v[136:151], v[204:207], v[112:115], v[136:151]
 s_barrier
 s_nop 0
 v_cvt_pk_bf16_f32 v120, v64, v65
 v_exp_f32 v68, v68
 v_exp_f32 v69, v69
 v_cvt_pk_bf16_f32 v121, v66, v67
 v_mfma_f32_16x16x32_bf16 v[128:131], v[184:187], v[112:115], v[128:131]
 ds_read_b128 v[196:199], v220 offset:2048
 v_exp_f32 v70, v70
 v_exp_f32 v71, v71
 v_cvt_pk_bf16_f32 v122, v68, v69
 v_exp_f32_e64 v72, v72
 v_mfma_f32_32x32x16_bf16 v[48:63], v[216:219], v[172:175], v[48:63]
 ds_read_b128 v[188:191], v220 offset:0
 v_exp_f32_e64 v73, v73
 v_cvt_pk_bf16_f32 v123, v70, v71
 v_exp_f32 v74, v74
 v_exp_f32 v75, v75
 v_mfma_f32_32x32x16_bf16 v[136:151], v[208:211], v[116:119], v[136:151]
 ds_read_b128 v[200:203], v220 offset:3072
 v_cvt_pk_bf16_f32 v124, v72, v73
 v_exp_f32 v76, v76
 v_exp_f32 v77, v77
 v_cvt_pk_bf16_f32 v125, v74, v75
 v_mfma_f32_16x16x32_bf16 v[128:131], v[184:187], v[116:119], v[128:131]
 ds_read_b128 v[192:195], v220 offset:1024
 v_exp_f32 v78, v78
 v_exp_f32 v79, v79
 v_cvt_pk_bf16_f32 v126, v76, v77
 v_cvt_pk_bf16_f32 v127, v78, v79
 v_mfma_f32_32x32x16_bf16 v[64:79], v[212:215], v[176:179], v[96:111]
 buffer_load_dwordx4 v221, s[28:31], s42 offen offset:0 sc1 lds
 v_exp_f32 v48, v48
 v_exp_f32 v49, v49
 v_exp_f32 v50, v50
 v_exp_f32 v51, v51
 v_mfma_f32_32x32x16_bf16 v[152:167], v[204:207], v[120:123], v[152:167]
 buffer_load_dwordx4 v221, s[28:31], s42 offen offset:1024 sc1 lds
 v_cvt_pk_bf16_f32 v112, v48, v49
 v_exp_f32 v52, v52
 v_exp_f32 v53, v53
 v_cvt_pk_bf16_f32 v113, v50, v51
 v_mfma_f32_16x16x32_bf16 v[132:135], v[184:187], v[120:123], v[132:135]
 buffer_load_dwordx4 v221, s[28:31], s42 offen offset:2048 sc1 lds
 v_exp_f32 v54, v54
 v_exp_f32 v55, v55
 v_cvt_pk_bf16_f32 v114, v52, v53
 v_exp_f32_e64 v56, v56
 v_mfma_f32_32x32x16_bf16 v[64:79], v[216:219], v[180:183], v[64:79]
 buffer_load_dwordx4 v221, s[28:31], s42 offen offset:3072 sc1 lds
 v_exp_f32_e64 v57, v57
 v_cvt_pk_bf16_f32 v115, v54, v55
 v_exp_f32 v58, v58
 v_exp_f32 v59, v59
 v_mfma_f32_32x32x16_bf16 v[152:167], v[208:211], v[124:127], v[152:167]
 s_waitcnt lgkmcnt(0)
 s_nop 0
 v_cvt_pk_bf16_f32 v116, v56, v57
 v_exp_f32 v60, v60
 v_exp_f32 v61, v61
 v_cvt_pk_bf16_f32 v117, v58, v59
 v_mfma_f32_16x16x32_bf16 v[132:135], v[184:187], v[124:127], v[132:135]
 v_exp_f32 v62, v62
 v_exp_f32 v63, v63
 v_cvt_pk_bf16_f32 v118, v60, v61
 v_cvt_pk_bf16_f32 v119, v62, v63
 v_mfma_f32_32x32x16_bf16 v[48:63], v[196:199], v[168:171], v[80:95]
 ds_read_b64 v[8:9], v3 offset:0
 ds_read_b64 v[10:11], v3 offset:1024
 ds_read_b64 v[12:13], v3 offset:2048
 v_exp_f32 v64, v64
 v_exp_f32 v65, v65
 v_exp_f32 v66, v66
 v_exp_f32 v67, v67
 v_mfma_f32_32x32x16_bf16 v[136:151], v[188:191], v[112:115], v[136:151]
 ds_read_b128 v[212:215], v220 offset:6144
 ds_read_b64 v[14:15], v3 offset:3072
 s_and_b32 s16, s2, 7
 s_lshl_b32 s16, s16, 5
 v_cvt_pk_bf16_f32 v120, v64, v65
 v_exp_f32 v68, v68
 v_exp_f32 v69, v69
 v_cvt_pk_bf16_f32 v121, v66, v67
 v_mfma_f32_16x16x32_bf16 v[128:131], v[184:187], v[112:115], v[128:131]
 ds_read_b128 v[204:207], v220 offset:4096
 s_lshr_b32 s17, s2, 3
 s_add_u32 s16, s16, s17
 s_lshl_b32 s19, s16, 2
 v_exp_f32_e64 v70, v70
 v_exp_f32 v71, v71
 v_cvt_pk_bf16_f32 v122, v68, v69
 v_exp_f32_e64 v72, v72
 v_mfma_f32_32x32x16_bf16 v[48:63], v[200:203], v[172:175], v[48:63]
 ds_read_b128 v[216:219], v220 offset:7168
 s_lshr_b32 s17, s16, 6
 s_cmp_eq_u32 s17, 2
 s_cselect_b32 s17, 1.0, 0
 s_lshl_b32 s16, s16, 6
 v_exp_f32_e64 v73, v73
 v_cvt_pk_bf16_f32 v123, v70, v71
 v_exp_f32 v74, v74
 v_exp_f32 v75, v75
 v_mfma_f32_32x32x16_bf16 v[136:151], v[192:195], v[116:119], v[136:151]
 ds_read_b128 v[208:211], v220 offset:5120
 s_add_u32 s16, s16, 8192
 s_or_b32 s18, s3, s12
 s_cselect_b32 s16, 1073741824, s16
 v_add_u32_e64 v2, s16, v2
 v_cvt_pk_bf16_f32 v124, v72, v73
 v_exp_f32 v76, v76
 v_exp_f32 v77, v77
 v_cvt_pk_bf16_f32 v125, v74, v75
 v_mfma_f32_16x16x32_bf16 v[128:131], v[184:187], v[116:119], v[128:131]
 s_mov_b32 m0, s57
 v_cmp_gt_u32 vcc, 8, v0
 v_mov_b32_e64 v20, 1073741824
 s_nop 0
 v_cndmask_b32 v2, v20, v2, vcc
 v_exp_f32 v78, v78
 v_exp_f32 v79, v79
 v_cvt_pk_bf16_f32 v126, v76, v77
 v_cvt_pk_bf16_f32 v127, v78, v79
 v_mfma_f32_32x32x16_bf16 v[64:79], v[196:199], v[176:179], v[96:111]
 s_add_u32 s57, s57, 2048
 v_lshrrev_b32_e64 v16, 1, v2
 v_add_u32 v16, 32768, v16
 v_and_b32_e64 v17, 0x18, v16
 v_exp_f32 v48, v48
 v_exp_f32 v49, v49
 v_exp_f32 v50, v50
 v_exp_f32 v51, v51
 v_mfma_f32_32x32x16_bf16 v[152:167], v[188:191], v[120:123], v[152:167]
 buffer_load_dwordx4 v222, s[32:35], s58 offen lds
 v_bfe_u32 v18, v16, 5, 1
 v_and_b32 v16, 0xffffffc7, v16
 v_lshl_add_u32 v16, v17, 1, v16
 v_cvt_pk_bf16_f32 v112, v48, v49
 v_exp_f32 v52, v52
 v_exp_f32 v53, v53
 v_cvt_pk_bf16_f32 v113, v50, v51
 v_mfma_f32_16x16x32_bf16 v[132:135], v[184:187], v[120:123], v[132:135]
 buffer_load_dwordx4 v223, s[32:35], s58 offen offset:1024 lds
 v_lshl_add_u32 v16, v18, 3, v16
 s_mov_b32 s20, s8
 s_mov_b32 s21, s9
 v_exp_f32 v54, v54
 v_exp_f32 v55, v55
 v_cvt_pk_bf16_f32 v114, v52, v53
 v_exp_f32_e64 v56, v56
 v_mfma_f32_32x32x16_bf16 v[64:79], v[200:203], v[180:183], v[64:79]
 s_add_u32 s58, s58, 57344
 s_mov_b32 s22, 0xb000
 s_mov_b32 s23, 0x00020000
 v_exp_f32_e64 v57, v57
 v_cvt_pk_bf16_f32 v115, v54, v55
 v_exp_f32 v58, v58
 v_exp_f32 v59, v59
 v_mfma_f32_32x32x16_bf16 v[152:167], v[192:195], v[124:127], v[152:167]
 s_waitcnt lgkmcnt(0)
 s_nop 0
 v_cvt_pk_bf16_f32 v116, v56, v57
 v_exp_f32 v60, v60
 v_exp_f32 v61, v61
 v_cvt_pk_bf16_f32 v117, v58, v59
 v_mfma_f32_16x16x32_bf16 v[132:135], v[184:187], v[124:127], v[132:135]
 v_exp_f32 v62, v62
 v_exp_f32 v63, v63
 v_cvt_pk_bf16_f32 v118, v60, v61
 v_cvt_pk_bf16_f32 v119, v62, v63
 v_mfma_f32_32x32x16_bf16 v[48:63], v[212:215], v[168:171], v[80:95]
 v_add_f32_e64 v8, v8, v10
 v_add_f32 v9, v9, v11
 v_add_f32 v12, v12, v14
 v_exp_f32 v64, v64
 v_exp_f32 v65, v65
 v_exp_f32 v66, v66
 v_exp_f32 v67, v67
 v_mfma_f32_32x32x16_bf16 v[136:151], v[204:207], v[112:115], v[136:151]
 ds_read_b128 v[196:199], v220 offset:10240
 v_add_f32 v13, v13, v15
 v_add_f32 v8, v8, v12
 v_cvt_pk_bf16_f32 v120, v64, v65
 v_exp_f32 v68, v68
 v_exp_f32 v69, v69
 v_cvt_pk_bf16_f32 v121, v66, v67
 v_mfma_f32_16x16x32_bf16 v[128:131], v[184:187], v[112:115], v[128:131]
 ds_read_b128 v[188:191], v220 offset:8192
 v_add_f32_e64 v9, v9, v13
 v_cvt_pk_bf16_f32 v10, v8, v9
 v_exp_f32 v70, v70
 v_exp_f32 v71, v71
 v_cvt_pk_bf16_f32 v122, v68, v69
 v_exp_f32_e64 v72, v72
 v_mfma_f32_32x32x16_bf16 v[48:63], v[216:219], v[172:175], v[48:63]
 ds_read_b128 v[200:203], v220 offset:11264
 v_lshlrev_b32_e64 v8, 16, v10
 v_and_b32 v9, 0xffff0000, v10
 v_exp_f32_e64 v73, v73
 v_cvt_pk_bf16_f32 v123, v70, v71
 v_exp_f32 v74, v74
 v_exp_f32 v75, v75
 v_mfma_f32_32x32x16_bf16 v[136:151], v[208:211], v[116:119], v[136:151]
 ds_read_b128 v[192:195], v220 offset:9216
 v_add_f32 v8, s17, v8
 v_add_f32 v9, s17, v9
 v_cvt_pk_bf16_f32 v124, v72, v73
 v_exp_f32 v76, v76
 v_exp_f32 v77, v77
 v_cvt_pk_bf16_f32 v125, v74, v75
 v_mfma_f32_16x16x32_bf16 v[128:131], v[184:187], v[116:119], v[128:131]
 v_cvt_pk_bf16_f32 v10, v8, v9
 v_lshlrev_b32_e64 v8, 16, v10
 v_and_b32 v9, 0xffff0000, v10
 v_exp_f32 v78, v78
 v_exp_f32 v79, v79
 v_cvt_pk_bf16_f32 v126, v76, v77
 v_cvt_pk_bf16_f32 v127, v78, v79
 v_mfma_f32_32x32x16_bf16 v[64:79], v[212:215], v[176:179], v[96:111]
 buffer_store_dwordx2 v[8:9], v2, s[20:23], 0 offen sc1
 buffer_store_dword v10, v16, s[20:23], 0 offen sc1
 v_exp_f32 v48, v48
 v_exp_f32 v49, v49
 v_exp_f32 v50, v50
 v_exp_f32 v51, v51
 v_mfma_f32_32x32x16_bf16 v[152:167], v[204:207], v[120:123], v[152:167]
 s_add_u32 s19, s19, 229376
 s_cmp_lg_u32 s3, 0
 s_cselect_b32 s19, 1073741824, s19
 v_cvt_pk_bf16_f32 v112, v48, v49
 v_exp_f32 v52, v52
 v_exp_f32 v53, v53
 v_cvt_pk_bf16_f32 v113, v50, v51
 v_mfma_f32_16x16x32_bf16 v[132:135], v[184:187], v[120:123], v[132:135]
 v_mov_b32 v4, s19
 v_cmp_eq_u32 vcc, 0, v0
 v_exp_f32 v54, v54
 v_exp_f32 v55, v55
 v_cvt_pk_bf16_f32 v114, v52, v53
 v_exp_f32_e64 v56, v56
 v_mfma_f32_32x32x16_bf16 v[64:79], v[216:219], v[180:183], v[64:79]
 v_cndmask_b32 v4, v20, v4, vcc
 v_mov_b32_e64 v5, s59
 v_exp_f32 v57, v57
 v_cvt_pk_bf16_f32 v115, v54, v55
 v_exp_f32 v58, v58
 v_exp_f32 v59, v59
 v_mfma_f32_32x32x16_bf16 v[152:167], v[208:211], v[124:127], v[152:167]
 s_waitcnt lgkmcnt(0)
 s_nop 0
 v_cvt_pk_bf16_f32 v116, v56, v57
 v_exp_f32 v60, v60
 v_exp_f32 v61, v61
 v_cvt_pk_bf16_f32 v117, v58, v59
 v_mfma_f32_16x16x32_bf16 v[132:135], v[184:187], v[124:127], v[132:135]
 v_exp_f32 v62, v62
 v_exp_f32 v63, v63
 v_cvt_pk_bf16_f32 v118, v60, v61
 v_cvt_pk_bf16_f32 v119, v62, v63
 v_mfma_f32_32x32x16_bf16 v[48:63], v[196:199], v[168:171], v[80:95]
 s_mov_b32 s24, s64
 s_mov_b32 s25, s65
 v_exp_f32 v64, v64
 v_exp_f32 v65, v65
 v_exp_f32 v66, v66
 v_exp_f32 v67, v67
 v_mfma_f32_32x32x16_bf16 v[136:151], v[188:191], v[112:115], v[136:151]
 ds_read_b128 v[212:215], v220 offset:14336
 s_mov_b32 s26, 0x400000
 v_cvt_pk_bf16_f32 v120, v64, v65
 v_exp_f32 v68, v68
 v_exp_f32 v69, v69
 v_cvt_pk_bf16_f32 v121, v66, v67
 v_mfma_f32_16x16x32_bf16 v[128:131], v[184:187], v[112:115], v[128:131]
 ds_read_b128 v[204:207], v220 offset:12288
 s_mov_b32 s27, 0x00020000
 v_and_b32_e64 v6, 15, v0
 v_exp_f32 v70, v70
 v_exp_f32 v71, v71
 v_cvt_pk_bf16_f32 v122, v68, v69
 v_exp_f32_e64 v72, v72
 v_mfma_f32_32x32x16_bf16 v[48:63], v[200:203], v[172:175], v[48:63]
 ds_read_b128 v[216:219], v220 offset:15360
 v_lshlrev_b32 v6, 11, v6
 v_exp_f32 v73, v73
 v_cvt_pk_bf16_f32 v123, v70, v71
 v_exp_f32 v74, v74
 v_exp_f32 v75, v75
 v_mfma_f32_32x32x16_bf16 v[136:151], v[192:195], v[116:119], v[136:151]
 ds_read_b128 v[208:211], v220 offset:13312
 v_bfe_u32 v2, v0, 4, 1
 v_cvt_pk_bf16_f32 v124, v72, v73
 v_exp_f32 v76, v76
 v_exp_f32 v77, v77
 v_cvt_pk_bf16_f32 v125, v74, v75
 v_mfma_f32_16x16x32_bf16 v[128:131], v[184:187], v[116:119], v[128:131]
 s_add_u32 s42, s42, 16384
 v_lshl_add_u32 v6, v2, 5, v6
 v_lshrrev_b32_e64 v2, 5, v0
 v_exp_f32 v78, v78
 v_exp_f32 v79, v79
 v_cvt_pk_bf16_f32 v126, v76, v77
 v_cvt_pk_bf16_f32 v127, v78, v79
 v_mfma_f32_32x32x16_bf16 v[64:79], v[196:199], v[176:179], v[96:111]
 s_add_u32 m0, s43, s56
 s_nop 0
 v_lshl_add_u32 v6, v2, 4, v6
 v_exp_f32 v48, v48
 v_exp_f32 v49, v49
 v_exp_f32 v50, v50
 v_exp_f32 v51, v51
 v_mfma_f32_32x32x16_bf16 v[152:167], v[188:191], v[120:123], v[152:167]
 s_add_u32 s43, s43, 16384
 s_lshl_b32 s18, s15, 15
 s_add_u32 s18, s18, s14
 v_cvt_pk_bf16_f32 v112, v48, v49
 v_exp_f32 v52, v52
 v_exp_f32 v53, v53
 v_cvt_pk_bf16_f32 v113, v50, v51
 v_mfma_f32_16x16x32_bf16 v[132:135], v[184:187], v[120:123], v[132:135]
 s_and_b32 s43, s43, 0xffff
 s_add_u32 s19, s18, 32768
 v_exp_f32 v54, v54
 v_exp_f32 v55, v55
 v_cvt_pk_bf16_f32 v114, v52, v53
 v_exp_f32_e64 v56, v56
 v_mfma_f32_32x32x16_bf16 v[64:79], v[200:203], v[180:183], v[64:79]
 buffer_load_dwordx4 a[208:211], v6, s[24:27], s18 offen offset:0
 v_exp_f32_e64 v57, v57
 v_cvt_pk_bf16_f32 v115, v54, v55
 v_exp_f32 v58, v58
 v_exp_f32 v59, v59
 v_mfma_f32_32x32x16_bf16 v[152:167], v[192:195], v[124:127], v[152:167]
 s_waitcnt lgkmcnt(0)
 s_nop 0
 v_cvt_pk_bf16_f32 v116, v56, v57
 v_exp_f32 v60, v60
 v_exp_f32 v61, v61
 v_cvt_pk_bf16_f32 v117, v58, v59
 v_mfma_f32_16x16x32_bf16 v[132:135], v[184:187], v[124:127], v[132:135]
 v_exp_f32 v62, v62
 v_exp_f32 v63, v63
 v_cvt_pk_bf16_f32 v118, v60, v61
 v_cvt_pk_bf16_f32 v119, v62, v63
 v_mfma_f32_32x32x16_bf16 v[48:63], v[212:215], v[168:171], v[80:95]
 v_exp_f32 v64, v64
 v_exp_f32 v65, v65
 v_exp_f32 v66, v66
 v_exp_f32 v67, v67
 v_mfma_f32_32x32x16_bf16 v[136:151], v[204:207], v[112:115], v[136:151]
 s_barrier
 s_nop 0
 v_cvt_pk_bf16_f32 v120, v64, v65
 v_exp_f32 v68, v68
 v_exp_f32 v69, v69
 v_cvt_pk_bf16_f32 v121, v66, v67
 v_mfma_f32_16x16x32_bf16 v[128:131], v[184:187], v[112:115], v[128:131]
 ds_read_b128 v[196:199], v220 offset:18432
 v_exp_f32 v70, v70
 v_exp_f32 v71, v71
 v_cvt_pk_bf16_f32 v122, v68, v69
 v_exp_f32_e64 v72, v72
 v_mfma_f32_32x32x16_bf16 v[48:63], v[216:219], v[172:175], v[48:63]
 ds_read_b128 v[188:191], v220 offset:16384
 v_exp_f32_e64 v73, v73
 v_cvt_pk_bf16_f32 v123, v70, v71
 v_exp_f32 v74, v74
 v_exp_f32 v75, v75
 v_mfma_f32_32x32x16_bf16 v[136:151], v[208:211], v[116:119], v[136:151]
 ds_read_b128 v[200:203], v220 offset:19456
 v_cvt_pk_bf16_f32 v124, v72, v73
 v_exp_f32 v76, v76
 v_exp_f32 v77, v77
 v_cvt_pk_bf16_f32 v125, v74, v75
 v_mfma_f32_16x16x32_bf16 v[128:131], v[184:187], v[116:119], v[128:131]
 ds_read_b128 v[192:195], v220 offset:17408
 v_exp_f32 v78, v78
 v_exp_f32 v79, v79
 v_cvt_pk_bf16_f32 v126, v76, v77
 v_cvt_pk_bf16_f32 v127, v78, v79
 v_mfma_f32_32x32x16_bf16 v[64:79], v[212:215], v[176:179], v[96:111]
 buffer_load_dwordx4 v221, s[28:31], s42 offen offset:0 sc1 lds
 v_exp_f32 v48, v48
 v_exp_f32 v49, v49
 v_exp_f32 v50, v50
 v_exp_f32 v51, v51
 v_mfma_f32_32x32x16_bf16 v[152:167], v[204:207], v[120:123], v[152:167]
 buffer_load_dwordx4 v221, s[28:31], s42 offen offset:1024 sc1 lds
 v_cvt_pk_bf16_f32 v112, v48, v49
 v_exp_f32 v52, v52
 v_exp_f32 v53, v53
 v_cvt_pk_bf16_f32 v113, v50, v51
 v_mfma_f32_16x16x32_bf16 v[132:135], v[184:187], v[120:123], v[132:135]
 buffer_load_dwordx4 v221, s[28:31], s42 offen offset:2048 sc1 lds
 v_exp_f32 v54, v54
 v_exp_f32 v55, v55
 v_cvt_pk_bf16_f32 v114, v52, v53
 v_exp_f32_e64 v56, v56
 v_mfma_f32_32x32x16_bf16 v[64:79], v[216:219], v[180:183], v[64:79]
 buffer_load_dwordx4 v221, s[28:31], s42 offen offset:3072 sc1 lds
 v_exp_f32_e64 v57, v57
 v_cvt_pk_bf16_f32 v115, v54, v55
 v_exp_f32 v58, v58
 v_exp_f32 v59, v59
 v_mfma_f32_32x32x16_bf16 v[152:167], v[208:211], v[124:127], v[152:167]
 s_waitcnt lgkmcnt(0)
 s_nop 0
 v_cvt_pk_bf16_f32 v116, v56, v57
 v_exp_f32 v60, v60
 v_exp_f32 v61, v61
 v_cvt_pk_bf16_f32 v117, v58, v59
 v_mfma_f32_16x16x32_bf16 v[132:135], v[184:187], v[124:127], v[132:135]
 v_exp_f32 v62, v62
 v_exp_f32 v63, v63
 v_cvt_pk_bf16_f32 v118, v60, v61
 v_cvt_pk_bf16_f32 v119, v62, v63
 v_mfma_f32_32x32x16_bf16 v[48:63], v[196:199], v[168:171], v[80:95]
 v_exp_f32 v64, v64
 v_exp_f32 v65, v65
 v_exp_f32 v66, v66
 v_exp_f32 v67, v67
 v_mfma_f32_32x32x16_bf16 v[136:151], v[188:191], v[112:115], v[136:151]
 ds_read_b128 v[212:215], v220 offset:22528
 v_cvt_pk_bf16_f32 v120, v64, v65
 v_exp_f32 v68, v68
 v_exp_f32 v69, v69
 v_cvt_pk_bf16_f32 v121, v66, v67
 v_mfma_f32_16x16x32_bf16 v[128:131], v[184:187], v[112:115], v[128:131]
 ds_read_b128 v[204:207], v220 offset:20480
 v_exp_f32 v70, v70
 v_exp_f32 v71, v71
 v_cvt_pk_bf16_f32 v122, v68, v69
 v_exp_f32_e64 v72, v72
 v_mfma_f32_32x32x16_bf16 v[48:63], v[200:203], v[172:175], v[48:63]
 ds_read_b128 v[216:219], v220 offset:23552
 v_exp_f32_e64 v73, v73
 v_cvt_pk_bf16_f32 v123, v70, v71
 v_exp_f32 v74, v74
 v_exp_f32 v75, v75
 v_mfma_f32_32x32x16_bf16 v[136:151], v[192:195], v[116:119], v[136:151]
 ds_read_b128 v[208:211], v220 offset:21504
 v_cvt_pk_bf16_f32 v124, v72, v73
 v_exp_f32 v76, v76
 v_exp_f32 v77, v77
 v_cvt_pk_bf16_f32 v125, v74, v75
 v_mfma_f32_16x16x32_bf16 v[128:131], v[184:187], v[116:119], v[128:131]
 s_mov_b32 m0, s57
 v_exp_f32_e64 v78, v78
 v_exp_f32 v79, v79
 v_cvt_pk_bf16_f32 v126, v76, v77
 v_cvt_pk_bf16_f32 v127, v78, v79
 v_mfma_f32_32x32x16_bf16 v[64:79], v[196:199], v[176:179], v[96:111]
 s_add_u32 s57, s57, 2048
 v_exp_f32 v48, v48
 v_exp_f32 v49, v49
 v_exp_f32 v50, v50
 v_exp_f32 v51, v51
 v_mfma_f32_32x32x16_bf16 v[152:167], v[188:191], v[120:123], v[152:167]
 buffer_load_dwordx4 v222, s[32:35], s58 offen lds
 v_cvt_pk_bf16_f32 v112, v48, v49
 v_exp_f32 v52, v52
 v_exp_f32 v53, v53
 v_cvt_pk_bf16_f32 v113, v50, v51
 v_mfma_f32_16x16x32_bf16 v[132:135], v[184:187], v[120:123], v[132:135]
 buffer_load_dwordx4 v223, s[32:35], s58 offen offset:1024 lds
 v_exp_f32 v54, v54
 v_exp_f32 v55, v55
 v_cvt_pk_bf16_f32 v114, v52, v53
 v_exp_f32_e64 v56, v56
 v_mfma_f32_32x32x16_bf16 v[64:79], v[200:203], v[180:183], v[64:79]
 s_add_u32 s58, s58, 57344
 v_exp_f32_e64 v57, v57
 v_cvt_pk_bf16_f32 v115, v54, v55
 v_exp_f32 v58, v58
 v_exp_f32 v59, v59
 v_mfma_f32_32x32x16_bf16 v[152:167], v[192:195], v[124:127], v[152:167]
 s_waitcnt lgkmcnt(0)
 s_nop 0
 v_cvt_pk_bf16_f32 v116, v56, v57
 v_exp_f32 v60, v60
 v_exp_f32 v61, v61
 v_cvt_pk_bf16_f32 v117, v58, v59
 v_mfma_f32_16x16x32_bf16 v[132:135], v[184:187], v[124:127], v[132:135]
 v_exp_f32 v62, v62
 v_exp_f32 v63, v63
 v_cvt_pk_bf16_f32 v118, v60, v61
 v_cvt_pk_bf16_f32 v119, v62, v63
 v_mfma_f32_32x32x16_bf16 v[48:63], v[212:215], v[168:171], v[80:95]
 buffer_load_dwordx4 a[212:215], v6, s[24:27], s18 offen offset:64
 v_exp_f32 v64, v64
 v_exp_f32 v65, v65
 v_exp_f32 v66, v66
 v_exp_f32 v67, v67
 v_mfma_f32_32x32x16_bf16 v[136:151], v[204:207], v[112:115], v[136:151]
 ds_read_b128 v[196:199], v220 offset:26624
 v_cvt_pk_bf16_f32 v120, v64, v65
 v_exp_f32 v68, v68
 v_exp_f32 v69, v69
 v_cvt_pk_bf16_f32 v121, v66, v67
 v_mfma_f32_16x16x32_bf16 v[128:131], v[184:187], v[112:115], v[128:131]
 ds_read_b128 v[188:191], v220 offset:24576
 v_exp_f32 v70, v70
 v_exp_f32 v71, v71
 v_cvt_pk_bf16_f32 v122, v68, v69
 v_exp_f32_e64 v72, v72
 v_mfma_f32_32x32x16_bf16 v[48:63], v[216:219], v[172:175], v[48:63]
 ds_read_b128 v[200:203], v220 offset:27648
 v_exp_f32_e64 v73, v73
 v_cvt_pk_bf16_f32 v123, v70, v71
 v_exp_f32 v74, v74
 v_exp_f32 v75, v75
 v_mfma_f32_32x32x16_bf16 v[136:151], v[208:211], v[116:119], v[136:151]
 ds_read_b128 v[192:195], v220 offset:25600
 v_cvt_pk_bf16_f32 v124, v72, v73
 v_exp_f32 v76, v76
 v_exp_f32 v77, v77
 v_cvt_pk_bf16_f32 v125, v74, v75
 v_mfma_f32_16x16x32_bf16 v[128:131], v[184:187], v[116:119], v[128:131]
 v_exp_f32 v78, v78
 v_exp_f32 v79, v79
 v_cvt_pk_bf16_f32 v126, v76, v77
 v_cvt_pk_bf16_f32 v127, v78, v79
 v_mfma_f32_32x32x16_bf16 v[64:79], v[212:215], v[176:179], v[96:111]
 v_exp_f32 v48, v48
 v_exp_f32 v49, v49
 v_exp_f32 v50, v50
 v_exp_f32 v51, v51
 v_mfma_f32_32x32x16_bf16 v[152:167], v[204:207], v[120:123], v[152:167]
 v_cvt_pk_bf16_f32 v112, v48, v49
 v_exp_f32 v52, v52
 v_exp_f32 v53, v53
 v_cvt_pk_bf16_f32 v113, v50, v51
 v_mfma_f32_16x16x32_bf16 v[132:135], v[184:187], v[120:123], v[132:135]
 v_exp_f32 v54, v54
 v_exp_f32 v55, v55
 v_cvt_pk_bf16_f32 v114, v52, v53
 v_exp_f32_e64 v56, v56
 v_mfma_f32_32x32x16_bf16 v[64:79], v[216:219], v[180:183], v[64:79]
 v_exp_f32_e64 v57, v57
 v_cvt_pk_bf16_f32 v115, v54, v55
 v_exp_f32 v58, v58
 v_exp_f32 v59, v59
 v_mfma_f32_32x32x16_bf16 v[152:167], v[208:211], v[124:127], v[152:167]
 s_waitcnt lgkmcnt(0)
 s_nop 0
 v_cvt_pk_bf16_f32 v116, v56, v57
 v_exp_f32 v60, v60
 v_exp_f32 v61, v61
 v_cvt_pk_bf16_f32 v117, v58, v59
 v_mfma_f32_16x16x32_bf16 v[132:135], v[184:187], v[124:127], v[132:135]
 v_exp_f32 v62, v62
 v_exp_f32 v63, v63
 v_cvt_pk_bf16_f32 v118, v60, v61
 v_cvt_pk_bf16_f32 v119, v62, v63
 v_mfma_f32_32x32x16_bf16 v[48:63], v[196:199], v[168:171], v[80:95]
 s_add_u32 s44, s8, 0x20000
 s_addc_u32 s45, s9, 0
 v_exp_f32_e64 v64, v64
 v_exp_f32 v65, v65
 v_exp_f32 v66, v66
 v_exp_f32 v67, v67
 v_mfma_f32_32x32x16_bf16 v[136:151], v[188:191], v[112:115], v[136:151]
 ds_read_b128 v[212:215], v220 offset:30720
 v_cvt_pk_bf16_f32 v120, v64, v65
 v_exp_f32 v68, v68
 v_exp_f32 v69, v69
 v_cvt_pk_bf16_f32 v121, v66, v67
 v_mfma_f32_16x16x32_bf16 v[128:131], v[184:187], v[112:115], v[128:131]
 ds_read_b128 v[204:207], v220 offset:28672
 s_mov_b32 s46, 0x50080
 v_exp_f32 v70, v70
 v_exp_f32 v71, v71
 v_cvt_pk_bf16_f32 v122, v68, v69
 v_exp_f32_e64 v72, v72
 v_mfma_f32_32x32x16_bf16 v[48:63], v[200:203], v[172:175], v[48:63]
 ds_read_b128 v[216:219], v220 offset:31744
 v_exp_f32_e64 v73, v73
 v_cvt_pk_bf16_f32 v123, v70, v71
 v_exp_f32 v74, v74
 v_exp_f32 v75, v75
 v_mfma_f32_32x32x16_bf16 v[136:151], v[192:195], v[116:119], v[136:151]
 ds_read_b128 v[208:211], v220 offset:29696
 s_mov_b32 s47, 0x00020000
 v_cvt_pk_bf16_f32 v124, v72, v73
 v_exp_f32 v76, v76
 v_exp_f32 v77, v77
 v_cvt_pk_bf16_f32 v125, v74, v75
 v_mfma_f32_16x16x32_bf16 v[128:131], v[184:187], v[116:119], v[128:131]
 s_add_u32 s42, s42, 16384
 v_exp_f32 v78, v78
 v_exp_f32 v79, v79
 v_cvt_pk_bf16_f32 v126, v76, v77
 v_cvt_pk_bf16_f32 v127, v78, v79
 v_mfma_f32_32x32x16_bf16 v[64:79], v[196:199], v[176:179], v[96:111]
 s_add_u32 m0, s43, s56
 s_waitcnt vmcnt(8)
 buffer_store_dword v5, v4, s[44:47], 0 offen sc1
 v_exp_f32 v48, v48
 v_exp_f32 v49, v49
 v_exp_f32 v50, v50
 v_exp_f32 v51, v51
 v_mfma_f32_32x32x16_bf16 v[152:167], v[188:191], v[120:123], v[152:167]
 s_add_u32 s43, s43, 16384
 v_cvt_pk_bf16_f32 v112, v48, v49
 v_exp_f32 v52, v52
 v_exp_f32 v53, v53
 v_cvt_pk_bf16_f32 v113, v50, v51
 v_mfma_f32_16x16x32_bf16 v[132:135], v[184:187], v[120:123], v[132:135]
 s_and_b32 s43, s43, 0xffff
 v_add_u32 v4, 229376, v221
 v_exp_f32 v54, v54
 v_exp_f32 v55, v55
 v_cvt_pk_bf16_f32 v114, v52, v53
 v_exp_f32_e64 v56, v56
 v_mfma_f32_32x32x16_bf16 v[64:79], v[200:203], v[180:183], v[64:79]
 v_exp_f32_e64 v57, v57
 v_cvt_pk_bf16_f32 v115, v54, v55
 v_exp_f32_e64 v58, v58
 v_exp_f32 v59, v59
 v_add_u32 v220, s43, v231
 v_mfma_f32_32x32x16_bf16 v[152:167], v[192:195], v[124:127], v[152:167]
 s_waitcnt lgkmcnt(0)
 s_nop 0
 v_cvt_pk_bf16_f32 v116, v56, v57
 v_exp_f32 v60, v60
 v_exp_f32 v61, v61
 v_cvt_pk_bf16_f32 v117, v58, v59
 v_mfma_f32_16x16x32_bf16 v[132:135], v[184:187], v[124:127], v[132:135]
 v_exp_f32 v62, v62
 v_exp_f32 v63, v63
 v_cvt_pk_bf16_f32 v118, v60, v61
 v_cvt_pk_bf16_f32 v119, v62, v63
 v_mfma_f32_32x32x16_bf16 v[48:63], v[212:215], v[168:171], v[80:95]
 v_exp_f32 v64, v64
 v_exp_f32 v65, v65
 v_exp_f32 v66, v66
 v_exp_f32 v67, v67
 v_mfma_f32_32x32x16_bf16 v[136:151], v[204:207], v[112:115], v[136:151]
 s_barrier
 s_nop 0
 v_cvt_pk_bf16_f32 v120, v64, v65
 v_exp_f32 v68, v68
 v_exp_f32 v69, v69
 v_cvt_pk_bf16_f32 v121, v66, v67
 v_mfma_f32_16x16x32_bf16 v[128:131], v[184:187], v[112:115], v[128:131]
 ds_read_b128 v[196:199], v220 offset:2048
 v_exp_f32 v70, v70
 v_exp_f32 v71, v71
 v_cvt_pk_bf16_f32 v122, v68, v69
 v_exp_f32_e64 v72, v72
 v_mfma_f32_32x32x16_bf16 v[48:63], v[216:219], v[172:175], v[48:63]
 ds_read_b128 v[188:191], v220 offset:0
 v_exp_f32_e64 v73, v73
 v_cvt_pk_bf16_f32 v123, v70, v71
 v_exp_f32 v74, v74
 v_exp_f32 v75, v75
 v_mfma_f32_32x32x16_bf16 v[136:151], v[208:211], v[116:119], v[136:151]
 ds_read_b128 v[200:203], v220 offset:3072
 v_cvt_pk_bf16_f32 v124, v72, v73
 v_exp_f32 v76, v76
 v_exp_f32 v77, v77
 v_cvt_pk_bf16_f32 v125, v74, v75
 v_mfma_f32_16x16x32_bf16 v[128:131], v[184:187], v[116:119], v[128:131]
 ds_read_b128 v[192:195], v220 offset:1024
 v_exp_f32 v78, v78
 v_exp_f32 v79, v79
 v_cvt_pk_bf16_f32 v126, v76, v77
 v_cvt_pk_bf16_f32 v127, v78, v79
 v_mfma_f32_32x32x16_bf16 v[64:79], v[212:215], v[176:179], v[96:111]
 buffer_load_dwordx4 v221, s[28:31], s42 offen offset:0 sc1 lds
 v_exp_f32 v48, v48
 v_exp_f32 v49, v49
 v_exp_f32 v50, v50
 v_exp_f32 v51, v51
 v_mfma_f32_32x32x16_bf16 v[152:167], v[204:207], v[120:123], v[152:167]
 buffer_load_dwordx4 v221, s[28:31], s42 offen offset:1024 sc1 lds
 v_cvt_pk_bf16_f32 v112, v48, v49
 v_exp_f32 v52, v52
 v_exp_f32 v53, v53
 v_cvt_pk_bf16_f32 v113, v50, v51
 v_mfma_f32_16x16x32_bf16 v[132:135], v[184:187], v[120:123], v[132:135]
 buffer_load_dwordx4 v221, s[28:31], s42 offen offset:2048 sc1 lds
 v_exp_f32 v54, v54
 v_exp_f32 v55, v55
 v_cvt_pk_bf16_f32 v114, v52, v53
 v_exp_f32_e64 v56, v56
 v_mfma_f32_32x32x16_bf16 v[64:79], v[216:219], v[180:183], v[64:79]
 buffer_load_dwordx4 v221, s[28:31], s42 offen offset:3072 sc1 lds
 v_exp_f32_e64 v57, v57
 v_cvt_pk_bf16_f32 v115, v54, v55
 v_exp_f32 v58, v58
 v_exp_f32 v59, v59
 v_mfma_f32_32x32x16_bf16 v[152:167], v[208:211], v[124:127], v[152:167]
 s_waitcnt lgkmcnt(0)
 s_nop 0
 v_cvt_pk_bf16_f32 v116, v56, v57
 v_exp_f32 v60, v60
 v_exp_f32 v61, v61
 v_cvt_pk_bf16_f32 v117, v58, v59
 v_mfma_f32_16x16x32_bf16 v[132:135], v[184:187], v[124:127], v[132:135]
 v_exp_f32 v62, v62
 v_exp_f32 v63, v63
 v_cvt_pk_bf16_f32 v118, v60, v61
 v_cvt_pk_bf16_f32 v119, v62, v63
 v_mfma_f32_32x32x16_bf16 v[48:63], v[196:199], v[168:171], v[80:95]
 buffer_load_dword v237, v232, s[52:55], s7 offen
 v_exp_f32 v64, v64
 v_exp_f32 v65, v65
 v_exp_f32 v66, v66
 v_exp_f32 v67, v67
 v_mfma_f32_32x32x16_bf16 v[136:151], v[188:191], v[112:115], v[136:151]
 ds_read_b128 v[212:215], v220 offset:6144
 v_cvt_pk_bf16_f32 v120, v64, v65
 v_exp_f32 v68, v68
 v_exp_f32 v69, v69
 v_cvt_pk_bf16_f32 v121, v66, v67
 v_mfma_f32_16x16x32_bf16 v[128:131], v[184:187], v[112:115], v[128:131]
 ds_read_b128 v[204:207], v220 offset:4096
 v_exp_f32 v70, v70
 v_exp_f32 v71, v71
 v_cvt_pk_bf16_f32 v122, v68, v69
 v_exp_f32_e64 v72, v72
 v_mfma_f32_32x32x16_bf16 v[48:63], v[200:203], v[172:175], v[48:63]
 ds_read_b128 v[216:219], v220 offset:7168
 v_exp_f32_e64 v73, v73
 v_cvt_pk_bf16_f32 v123, v70, v71
 v_exp_f32 v74, v74
 v_exp_f32 v75, v75
 v_mfma_f32_32x32x16_bf16 v[136:151], v[192:195], v[116:119], v[136:151]
 ds_read_b128 v[208:211], v220 offset:5120
 v_cvt_pk_bf16_f32 v124, v72, v73
 v_exp_f32 v76, v76
 v_exp_f32 v77, v77
 v_cvt_pk_bf16_f32 v125, v74, v75
 v_mfma_f32_16x16x32_bf16 v[128:131], v[184:187], v[116:119], v[128:131]
 v_exp_f32 v78, v78
 v_exp_f32 v79, v79
 v_cvt_pk_bf16_f32 v126, v76, v77
 v_cvt_pk_bf16_f32 v127, v78, v79
 v_mfma_f32_32x32x16_bf16 v[64:79], v[196:199], v[176:179], v[96:111]
 v_exp_f32 v48, v48
 v_exp_f32 v49, v49
 v_exp_f32 v50, v50
 v_exp_f32 v51, v51
 v_mfma_f32_32x32x16_bf16 v[152:167], v[188:191], v[120:123], v[152:167]
 v_cvt_pk_bf16_f32 v112, v48, v49
 v_exp_f32 v52, v52
 v_exp_f32 v53, v53
 v_cvt_pk_bf16_f32 v113, v50, v51
 v_mfma_f32_16x16x32_bf16 v[132:135], v[184:187], v[120:123], v[132:135]
 v_exp_f32 v54, v54
 v_exp_f32 v55, v55
 v_cvt_pk_bf16_f32 v114, v52, v53
 v_exp_f32_e64 v56, v56
 v_mfma_f32_32x32x16_bf16 v[64:79], v[200:203], v[180:183], v[64:79]
 v_exp_f32_e64 v57, v57
 v_cvt_pk_bf16_f32 v115, v54, v55
 v_exp_f32 v58, v58
 v_exp_f32 v59, v59
 v_mfma_f32_32x32x16_bf16 v[152:167], v[192:195], v[124:127], v[152:167]
 s_waitcnt lgkmcnt(0)
 s_nop 0
 v_cvt_pk_bf16_f32 v116, v56, v57
 v_exp_f32 v60, v60
 v_exp_f32 v61, v61
 v_cvt_pk_bf16_f32 v117, v58, v59
 v_mfma_f32_16x16x32_bf16 v[132:135], v[184:187], v[124:127], v[132:135]
 v_exp_f32 v62, v62
 v_exp_f32 v63, v63
 v_cvt_pk_bf16_f32 v118, v60, v61
 v_cvt_pk_bf16_f32 v119, v62, v63
 v_mfma_f32_32x32x16_bf16 v[48:63], v[212:215], v[168:171], v[80:95]
 buffer_load_dwordx4 a[216:219], v6, s[24:27], s19 offen offset:0
 v_exp_f32 v64, v64
 v_exp_f32 v65, v65
 v_exp_f32 v66, v66
 v_exp_f32 v67, v67
 v_mfma_f32_32x32x16_bf16 v[136:151], v[204:207], v[112:115], v[136:151]
 ds_read_b128 v[196:199], v220 offset:10240
 v_cvt_pk_bf16_f32 v120, v64, v65
 v_exp_f32 v68, v68
 v_exp_f32 v69, v69
 v_cvt_pk_bf16_f32 v121, v66, v67
 v_mfma_f32_16x16x32_bf16 v[128:131], v[184:187], v[112:115], v[128:131]
 ds_read_b128 v[188:191], v220 offset:8192
 v_exp_f32 v70, v70
 v_exp_f32 v71, v71
 v_cvt_pk_bf16_f32 v122, v68, v69
 v_exp_f32_e64 v72, v72
 v_mfma_f32_32x32x16_bf16 v[48:63], v[216:219], v[172:175], v[48:63]
 ds_read_b128 v[200:203], v220 offset:11264
 v_exp_f32_e64 v73, v73
 v_cvt_pk_bf16_f32 v123, v70, v71
 v_exp_f32 v74, v74
 v_exp_f32 v75, v75
 v_mfma_f32_32x32x16_bf16 v[136:151], v[208:211], v[116:119], v[136:151]
 ds_read_b128 v[192:195], v220 offset:9216
 v_cvt_pk_bf16_f32 v124, v72, v73
 v_exp_f32 v76, v76
 v_exp_f32 v77, v77
 v_cvt_pk_bf16_f32 v125, v74, v75
 v_mfma_f32_16x16x32_bf16 v[128:131], v[184:187], v[116:119], v[128:131]
 v_exp_f32 v78, v78
 v_exp_f32 v79, v79
 v_cvt_pk_bf16_f32 v126, v76, v77
 v_cvt_pk_bf16_f32 v127, v78, v79
 v_mfma_f32_32x32x16_bf16 v[64:79], v[212:215], v[176:179], v[96:111]
 v_exp_f32 v48, v48
 v_exp_f32 v49, v49
 v_exp_f32 v50, v50
 v_exp_f32 v51, v51
 v_mfma_f32_32x32x16_bf16 v[152:167], v[204:207], v[120:123], v[152:167]
 v_cvt_pk_bf16_f32 v112, v48, v49
 v_exp_f32 v52, v52
 v_exp_f32 v53, v53
 v_cvt_pk_bf16_f32 v113, v50, v51
 v_mfma_f32_16x16x32_bf16 v[132:135], v[184:187], v[120:123], v[132:135]
 v_exp_f32 v54, v54
 v_exp_f32 v55, v55
 v_cvt_pk_bf16_f32 v114, v52, v53
 v_exp_f32_e64 v56, v56
 v_mfma_f32_32x32x16_bf16 v[64:79], v[216:219], v[180:183], v[64:79]
 v_exp_f32_e64 v57, v57
 v_cvt_pk_bf16_f32 v115, v54, v55
 v_exp_f32 v58, v58
 v_exp_f32 v59, v59
 v_mfma_f32_32x32x16_bf16 v[152:167], v[208:211], v[124:127], v[152:167]
 s_waitcnt lgkmcnt(0)
 s_nop 0
 v_cvt_pk_bf16_f32 v116, v56, v57
 v_exp_f32 v60, v60
 v_exp_f32 v61, v61
 v_cvt_pk_bf16_f32 v117, v58, v59
 v_mfma_f32_16x16x32_bf16 v[132:135], v[184:187], v[124:127], v[132:135]
 v_exp_f32 v62, v62
 v_exp_f32 v63, v63
 v_cvt_pk_bf16_f32 v118, v60, v61
 v_cvt_pk_bf16_f32 v119, v62, v63
 v_mfma_f32_32x32x16_bf16 v[48:63], v[196:199], v[168:171], v[80:95]
 s_mov_b32 s20, s100
 v_exp_f32_e64 v64, v64
 v_exp_f32 v65, v65
 v_exp_f32 v66, v66
 v_exp_f32 v67, v67
 v_mfma_f32_32x32x16_bf16 v[136:151], v[188:191], v[112:115], v[136:151]
 ds_read_b128 v[212:215], v220 offset:14336
 s_mov_b32 s21, s101
 s_nop 0
 v_cvt_pk_bf16_f32 v120, v64, v65
 v_exp_f32 v68, v68
 v_exp_f32 v69, v69
 v_cvt_pk_bf16_f32 v121, v66, v67
 v_mfma_f32_16x16x32_bf16 v[128:131], v[184:187], v[112:115], v[128:131]
 ds_read_b128 v[204:207], v220 offset:12288
 s_mov_b32 s22, 0x700000
 v_exp_f32 v70, v70
 v_exp_f32 v71, v71
 v_cvt_pk_bf16_f32 v122, v68, v69
 v_exp_f32_e64 v72, v72
 v_mfma_f32_32x32x16_bf16 v[48:63], v[200:203], v[172:175], v[48:63]
 ds_read_b128 v[216:219], v220 offset:15360
 v_exp_f32_e64 v73, v73
 v_cvt_pk_bf16_f32 v123, v70, v71
 v_exp_f32 v74, v74
 v_exp_f32 v75, v75
 v_mfma_f32_32x32x16_bf16 v[136:151], v[192:195], v[116:119], v[136:151]
 ds_read_b128 v[208:211], v220 offset:13312
 s_mov_b32 s23, 0x00020000
 v_cvt_pk_bf16_f32 v124, v72, v73
 v_exp_f32 v76, v76
 v_exp_f32 v77, v77
 v_cvt_pk_bf16_f32 v125, v74, v75
 v_mfma_f32_16x16x32_bf16 v[128:131], v[184:187], v[116:119], v[128:131]
 s_add_u32 s42, s42, 16384
 s_lshl_b32 s16, s7, 2
 v_exp_f32_e64 v78, v78
 v_exp_f32 v79, v79
 v_cvt_pk_bf16_f32 v126, v76, v77
 v_cvt_pk_bf16_f32 v127, v78, v79
 v_mfma_f32_32x32x16_bf16 v[64:79], v[196:199], v[176:179], v[96:111]
 s_add_u32 m0, s43, s56
 v_exp_f32_e64 v48, v48
 v_exp_f32 v49, v49
 v_exp_f32 v50, v50
 v_exp_f32 v51, v51
 v_mfma_f32_32x32x16_bf16 v[152:167], v[188:191], v[120:123], v[152:167]
 s_add_u32 s43, s43, 16384
 v_lshlrev_b32_e64 v1, 1, v232
 v_cvt_pk_bf16_f32 v112, v48, v49
 v_exp_f32 v52, v52
 v_exp_f32 v53, v53
 v_cvt_pk_bf16_f32 v113, v50, v51
 v_mfma_f32_16x16x32_bf16 v[132:135], v[184:187], v[120:123], v[132:135]
 s_and_b32 s43, s43, 0xffff
 buffer_load_dword v238, v1, s[20:23], s16 offen
 v_exp_f32 v54, v54
 v_exp_f32 v55, v55
 v_cvt_pk_bf16_f32 v114, v52, v53
 v_exp_f32_e64 v56, v56
 v_mfma_f32_32x32x16_bf16 v[64:79], v[200:203], v[180:183], v[64:79]
 v_exp_f32_e64 v57, v57
 v_cvt_pk_bf16_f32 v115, v54, v55
 v_exp_f32 v58, v58
 v_exp_f32 v59, v59
 v_mfma_f32_32x32x16_bf16 v[152:167], v[192:195], v[124:127], v[152:167]
 s_waitcnt lgkmcnt(0)
 s_nop 0
 v_cvt_pk_bf16_f32 v116, v56, v57
 v_exp_f32 v60, v60
 v_exp_f32 v61, v61
 v_cvt_pk_bf16_f32 v117, v58, v59
 v_mfma_f32_16x16x32_bf16 v[132:135], v[184:187], v[124:127], v[132:135]
 v_exp_f32 v62, v62
 v_exp_f32 v63, v63
 v_cvt_pk_bf16_f32 v118, v60, v61
 v_cvt_pk_bf16_f32 v119, v62, v63
 v_mfma_f32_32x32x16_bf16 v[48:63], v[212:215], v[168:171], v[80:95]
 v_exp_f32 v64, v64
 v_exp_f32 v65, v65
 v_exp_f32 v66, v66
 v_exp_f32 v67, v67
 v_mfma_f32_32x32x16_bf16 v[136:151], v[204:207], v[112:115], v[136:151]
 s_barrier
 s_nop 0
 v_cvt_pk_bf16_f32 v120, v64, v65
 v_exp_f32 v68, v68
 v_exp_f32 v69, v69
 v_cvt_pk_bf16_f32 v121, v66, v67
 v_mfma_f32_16x16x32_bf16 v[128:131], v[184:187], v[112:115], v[128:131]
 ds_read_b128 v[196:199], v220 offset:18432
 v_exp_f32 v70, v70
 v_exp_f32 v71, v71
 v_cvt_pk_bf16_f32 v122, v68, v69
 v_exp_f32_e64 v72, v72
 v_mfma_f32_32x32x16_bf16 v[48:63], v[216:219], v[172:175], v[48:63]
 ds_read_b128 v[188:191], v220 offset:16384
 v_exp_f32_e64 v73, v73
 v_cvt_pk_bf16_f32 v123, v70, v71
 v_exp_f32 v74, v74
 v_exp_f32 v75, v75
 v_mfma_f32_32x32x16_bf16 v[136:151], v[208:211], v[116:119], v[136:151]
 ds_read_b128 v[200:203], v220 offset:19456
 v_cvt_pk_bf16_f32 v124, v72, v73
 v_exp_f32 v76, v76
 v_exp_f32 v77, v77
 v_cvt_pk_bf16_f32 v125, v74, v75
 v_mfma_f32_16x16x32_bf16 v[128:131], v[184:187], v[116:119], v[128:131]
 ds_read_b128 v[192:195], v220 offset:17408
 v_exp_f32 v78, v78
 v_exp_f32 v79, v79
 v_cvt_pk_bf16_f32 v126, v76, v77
 v_cvt_pk_bf16_f32 v127, v78, v79
 v_mfma_f32_32x32x16_bf16 v[64:79], v[212:215], v[176:179], v[96:111]
 buffer_load_dwordx4 v221, s[28:31], s42 offen offset:0 sc1 lds
 v_exp_f32 v48, v48
 v_exp_f32 v49, v49
 v_exp_f32 v50, v50
 v_exp_f32 v51, v51
 v_mfma_f32_32x32x16_bf16 v[152:167], v[204:207], v[120:123], v[152:167]
 buffer_load_dwordx4 v221, s[28:31], s42 offen offset:1024 sc1 lds
 v_cvt_pk_bf16_f32 v112, v48, v49
 v_exp_f32 v52, v52
 v_exp_f32 v53, v53
 v_cvt_pk_bf16_f32 v113, v50, v51
 v_mfma_f32_16x16x32_bf16 v[132:135], v[184:187], v[120:123], v[132:135]
 buffer_load_dwordx4 v221, s[28:31], s42 offen offset:2048 sc1 lds
 v_exp_f32 v54, v54
 v_exp_f32 v55, v55
 v_cvt_pk_bf16_f32 v114, v52, v53
 v_exp_f32_e64 v56, v56
 v_mfma_f32_32x32x16_bf16 v[64:79], v[216:219], v[180:183], v[64:79]
 buffer_load_dwordx4 v221, s[28:31], s42 offen offset:3072 sc1 lds
 v_exp_f32_e64 v57, v57
 v_cvt_pk_bf16_f32 v115, v54, v55
 v_exp_f32 v58, v58
 v_exp_f32 v59, v59
 v_mfma_f32_32x32x16_bf16 v[152:167], v[208:211], v[124:127], v[152:167]
 s_waitcnt lgkmcnt(0)
 s_nop 0
 v_cvt_pk_bf16_f32 v116, v56, v57
 v_exp_f32 v60, v60
 v_exp_f32 v61, v61
 v_cvt_pk_bf16_f32 v117, v58, v59
 v_mfma_f32_16x16x32_bf16 v[132:135], v[184:187], v[124:127], v[132:135]
 v_exp_f32 v62, v62
 v_exp_f32 v63, v63
 v_cvt_pk_bf16_f32 v118, v60, v61
 v_cvt_pk_bf16_f32 v119, v62, v63
 v_mfma_f32_32x32x16_bf16 v[48:63], v[196:199], v[168:171], v[80:95]
 s_add_u32 s16, s16, 4096
 v_exp_f32 v64, v64
 v_exp_f32 v65, v65
 v_exp_f32 v66, v66
 v_exp_f32 v67, v67
 v_mfma_f32_32x32x16_bf16 v[136:151], v[188:191], v[112:115], v[136:151]
 ds_read_b128 v[212:215], v220 offset:22528
 v_cvt_pk_bf16_f32 v120, v64, v65
 v_exp_f32 v68, v68
 v_exp_f32 v69, v69
 v_cvt_pk_bf16_f32 v121, v66, v67
 v_mfma_f32_16x16x32_bf16 v[128:131], v[184:187], v[112:115], v[128:131]
 ds_read_b128 v[204:207], v220 offset:20480
 v_exp_f32 v70, v70
 v_exp_f32 v71, v71
 v_cvt_pk_bf16_f32 v122, v68, v69
 v_exp_f32_e64 v72, v72
 v_mfma_f32_32x32x16_bf16 v[48:63], v[200:203], v[172:175], v[48:63]
 ds_read_b128 v[216:219], v220 offset:23552
 v_exp_f32_e64 v73, v73
 v_cvt_pk_bf16_f32 v123, v70, v71
 v_exp_f32 v74, v74
 v_exp_f32 v75, v75
 v_mfma_f32_32x32x16_bf16 v[136:151], v[192:195], v[116:119], v[136:151]
 ds_read_b128 v[208:211], v220 offset:21504
 v_cvt_pk_bf16_f32 v124, v72, v73
 v_exp_f32 v76, v76
 v_exp_f32 v77, v77
 v_cvt_pk_bf16_f32 v125, v74, v75
 v_mfma_f32_16x16x32_bf16 v[128:131], v[184:187], v[116:119], v[128:131]
 buffer_load_dword v239, v1, s[20:23], s16 offen
 v_exp_f32 v78, v78
 v_exp_f32 v79, v79
 v_cvt_pk_bf16_f32 v126, v76, v77
 v_cvt_pk_bf16_f32 v127, v78, v79
 v_mfma_f32_32x32x16_bf16 v[64:79], v[196:199], v[176:179], v[96:111]
 v_exp_f32 v48, v48
 v_exp_f32 v49, v49
 v_exp_f32 v50, v50
 v_exp_f32 v51, v51
 v_mfma_f32_32x32x16_bf16 v[152:167], v[188:191], v[120:123], v[152:167]
 v_cvt_pk_bf16_f32 v112, v48, v49
 v_exp_f32 v52, v52
 v_exp_f32 v53, v53
 v_cvt_pk_bf16_f32 v113, v50, v51
 v_mfma_f32_16x16x32_bf16 v[132:135], v[184:187], v[120:123], v[132:135]
 v_exp_f32 v54, v54
 v_exp_f32 v55, v55
 v_cvt_pk_bf16_f32 v114, v52, v53
 v_exp_f32_e64 v56, v56
 v_mfma_f32_32x32x16_bf16 v[64:79], v[200:203], v[180:183], v[64:79]
 v_exp_f32_e64 v57, v57
 v_cvt_pk_bf16_f32 v115, v54, v55
 v_exp_f32 v58, v58
 v_exp_f32 v59, v59
 v_mfma_f32_32x32x16_bf16 v[152:167], v[192:195], v[124:127], v[152:167]
 s_waitcnt lgkmcnt(0)
 s_nop 0
 v_cvt_pk_bf16_f32 v116, v56, v57
 v_exp_f32 v60, v60
 v_exp_f32 v61, v61
 v_cvt_pk_bf16_f32 v117, v58, v59
 v_mfma_f32_16x16x32_bf16 v[132:135], v[184:187], v[124:127], v[132:135]
 v_exp_f32 v62, v62
 v_exp_f32 v63, v63
 v_cvt_pk_bf16_f32 v118, v60, v61
 v_cvt_pk_bf16_f32 v119, v62, v63
 v_mfma_f32_32x32x16_bf16 v[48:63], v[212:215], v[168:171], v[80:95]
 buffer_load_dwordx4 a[220:223], v6, s[24:27], s19 offen offset:64
 v_exp_f32 v64, v64
 v_exp_f32 v65, v65
 v_exp_f32 v66, v66
 v_exp_f32 v67, v67
 v_mfma_f32_32x32x16_bf16 v[136:151], v[204:207], v[112:115], v[136:151]
 ds_read_b128 v[196:199], v220 offset:26624
 v_cvt_pk_bf16_f32 v120, v64, v65
 v_exp_f32 v68, v68
 v_exp_f32 v69, v69
 v_cvt_pk_bf16_f32 v121, v66, v67
 v_mfma_f32_16x16x32_bf16 v[128:131], v[184:187], v[112:115], v[128:131]
 ds_read_b128 v[188:191], v220 offset:24576
 v_exp_f32 v70, v70
 v_exp_f32 v71, v71
 v_cvt_pk_bf16_f32 v122, v68, v69
 v_exp_f32_e64 v72, v72
 v_mfma_f32_32x32x16_bf16 v[48:63], v[216:219], v[172:175], v[48:63]
 ds_read_b128 v[200:203], v220 offset:27648
 v_exp_f32_e64 v73, v73
 v_cvt_pk_bf16_f32 v123, v70, v71
 v_exp_f32 v74, v74
 v_exp_f32 v75, v75
 v_mfma_f32_32x32x16_bf16 v[136:151], v[208:211], v[116:119], v[136:151]
 ds_read_b128 v[192:195], v220 offset:25600
 v_cvt_pk_bf16_f32 v124, v72, v73
 v_exp_f32 v76, v76
 v_exp_f32 v77, v77
 v_cvt_pk_bf16_f32 v125, v74, v75
 v_mfma_f32_16x16x32_bf16 v[128:131], v[184:187], v[116:119], v[128:131]
 v_exp_f32 v78, v78
 v_exp_f32 v79, v79
 v_cvt_pk_bf16_f32 v126, v76, v77
 v_cvt_pk_bf16_f32 v127, v78, v79
 v_mfma_f32_32x32x16_bf16 v[64:79], v[212:215], v[176:179], v[96:111]
 v_exp_f32 v48, v48
 v_exp_f32 v49, v49
 v_exp_f32 v50, v50
 v_exp_f32 v51, v51
 v_mfma_f32_32x32x16_bf16 v[152:167], v[204:207], v[120:123], v[152:167]
 v_cvt_pk_bf16_f32 v112, v48, v49
 v_exp_f32 v52, v52
 v_exp_f32 v53, v53
 v_cvt_pk_bf16_f32 v113, v50, v51
 v_mfma_f32_16x16x32_bf16 v[132:135], v[184:187], v[120:123], v[132:135]
 v_exp_f32 v54, v54
 v_exp_f32 v55, v55
 v_cvt_pk_bf16_f32 v114, v52, v53
 v_exp_f32_e64 v56, v56
 v_mfma_f32_32x32x16_bf16 v[64:79], v[216:219], v[180:183], v[64:79]
 v_exp_f32_e64 v57, v57
 v_cvt_pk_bf16_f32 v115, v54, v55
 v_exp_f32 v58, v58
 v_exp_f32 v59, v59
 v_mfma_f32_32x32x16_bf16 v[152:167], v[208:211], v[124:127], v[152:167]
 s_waitcnt lgkmcnt(0)
 s_nop 0
 v_cvt_pk_bf16_f32 v116, v56, v57
 v_exp_f32 v60, v60
 v_exp_f32 v61, v61
 v_cvt_pk_bf16_f32 v117, v58, v59
 v_mfma_f32_16x16x32_bf16 v[132:135], v[184:187], v[124:127], v[132:135]
 v_exp_f32 v62, v62
 v_exp_f32 v63, v63
 v_cvt_pk_bf16_f32 v118, v60, v61
 v_cvt_pk_bf16_f32 v119, v62, v63
 v_mfma_f32_32x32x16_bf16 v[48:63], v[196:199], v[168:171], v[80:95]
 buffer_load_dwordx4 v[8:11], v4, s[44:47], 0 offen sc1
 v_exp_f32 v64, v64
 v_exp_f32 v65, v65
 v_exp_f32 v66, v66
 v_exp_f32 v67, v67
 v_mfma_f32_32x32x16_bf16 v[136:151], v[188:191], v[112:115], v[136:151]
 ds_read_b128 v[212:215], v220 offset:30720
 v_cvt_pk_bf16_f32 v120, v64, v65
 v_exp_f32 v68, v68
 v_exp_f32 v69, v69
 v_cvt_pk_bf16_f32 v121, v66, v67
 v_mfma_f32_16x16x32_bf16 v[128:131], v[184:187], v[112:115], v[128:131]
 ds_read_b128 v[204:207], v220 offset:28672
 v_exp_f32 v70, v70
 v_exp_f32 v71, v71
 v_cvt_pk_bf16_f32 v122, v68, v69
 v_exp_f32_e64 v72, v72
 v_mfma_f32_32x32x16_bf16 v[48:63], v[200:203], v[172:175], v[48:63]
 ds_read_b128 v[216:219], v220 offset:31744
 v_exp_f32_e64 v73, v73
 v_cvt_pk_bf16_f32 v123, v70, v71
 v_exp_f32 v74, v74
 v_exp_f32 v75, v75
 v_mfma_f32_32x32x16_bf16 v[136:151], v[192:195], v[116:119], v[136:151]
 ds_read_b128 v[208:211], v220 offset:29696
 v_cvt_pk_bf16_f32 v124, v72, v73
 v_exp_f32 v76, v76
 v_exp_f32 v77, v77
 v_cvt_pk_bf16_f32 v125, v74, v75
 v_mfma_f32_16x16x32_bf16 v[128:131], v[184:187], v[116:119], v[128:131]
 s_add_u32 s42, s42, 16384
 v_exp_f32 v78, v78
 v_exp_f32 v79, v79
 v_cvt_pk_bf16_f32 v126, v76, v77
 v_cvt_pk_bf16_f32 v127, v78, v79
 v_mfma_f32_32x32x16_bf16 v[64:79], v[196:199], v[176:179], v[96:111]
 s_add_u32 m0, s43, s56
 v_exp_f32_e64 v48, v48
 v_exp_f32 v49, v49
 v_exp_f32 v50, v50
 v_exp_f32 v51, v51
 v_mfma_f32_32x32x16_bf16 v[152:167], v[188:191], v[120:123], v[152:167]
 s_add_u32 s43, s43, 16384
 v_cvt_pk_bf16_f32 v112, v48, v49
 v_exp_f32 v52, v52
 v_exp_f32 v53, v53
 v_cvt_pk_bf16_f32 v113, v50, v51
 v_mfma_f32_16x16x32_bf16 v[132:135], v[184:187], v[120:123], v[132:135]
 s_and_b32 s43, s43, 0xffff
 v_exp_f32 v54, v54
 v_exp_f32 v55, v55
 v_cvt_pk_bf16_f32 v114, v52, v53
 v_exp_f32_e64 v56, v56
 v_mfma_f32_32x32x16_bf16 v[64:79], v[200:203], v[180:183], v[64:79]
 v_exp_f32_e64 v57, v57
 v_cvt_pk_bf16_f32 v115, v54, v55
 v_exp_f32_e64 v58, v58
 v_exp_f32 v59, v59
 v_add_u32 v220, s43, v231
 v_mfma_f32_32x32x16_bf16 v[152:167], v[192:195], v[124:127], v[152:167]
 s_waitcnt lgkmcnt(0)
 s_nop 0
 v_cvt_pk_bf16_f32 v116, v56, v57
 v_exp_f32 v60, v60
 v_exp_f32 v61, v61
 v_cvt_pk_bf16_f32 v117, v58, v59
 v_mfma_f32_16x16x32_bf16 v[132:135], v[184:187], v[124:127], v[132:135]
 v_exp_f32 v62, v62
 v_exp_f32 v63, v63
 v_cvt_pk_bf16_f32 v118, v60, v61
 v_cvt_pk_bf16_f32 v119, v62, v63
 v_mfma_f32_32x32x16_bf16 v[48:63], v[212:215], v[168:171], v[80:95]
 s_waitcnt vmcnt(18)
 v_exp_f32_e64 v64, v64
 v_exp_f32 v65, v65
 v_exp_f32 v66, v66
 v_exp_f32 v67, v67
 v_mfma_f32_32x32x16_bf16 v[136:151], v[204:207], v[112:115], v[136:151]
 s_barrier
 s_nop 0
 v_cvt_pk_bf16_f32 v120, v64, v65
 v_exp_f32 v68, v68
 v_exp_f32 v69, v69
 v_cvt_pk_bf16_f32 v121, v66, v67
 v_mfma_f32_16x16x32_bf16 v[128:131], v[184:187], v[112:115], v[128:131]
 ds_read_b128 v[196:199], v220 offset:2048
 v_exp_f32 v70, v70
 v_exp_f32 v71, v71
 v_cvt_pk_bf16_f32 v122, v68, v69
 v_exp_f32_e64 v72, v72
 v_mfma_f32_32x32x16_bf16 v[48:63], v[216:219], v[172:175], v[48:63]
 ds_read_b128 v[188:191], v220 offset:0
 v_exp_f32_e64 v73, v73
 v_cvt_pk_bf16_f32 v123, v70, v71
 v_exp_f32 v74, v74
 v_exp_f32 v75, v75
 v_mfma_f32_32x32x16_bf16 v[136:151], v[208:211], v[116:119], v[136:151]
 ds_read_b128 v[200:203], v220 offset:3072
 v_cvt_pk_bf16_f32 v124, v72, v73
 v_exp_f32 v76, v76
 v_exp_f32 v77, v77
 v_cvt_pk_bf16_f32 v125, v74, v75
 v_mfma_f32_16x16x32_bf16 v[128:131], v[184:187], v[116:119], v[128:131]
 ds_read_b128 v[192:195], v220 offset:1024
 v_exp_f32 v78, v78
 v_exp_f32 v79, v79
 v_cvt_pk_bf16_f32 v126, v76, v77
 v_cvt_pk_bf16_f32 v127, v78, v79
 v_mfma_f32_32x32x16_bf16 v[64:79], v[212:215], v[176:179], v[96:111]
 buffer_load_dwordx4 v221, s[28:31], s42 offen offset:0 sc1 lds
 v_exp_f32 v48, v48
 v_exp_f32 v49, v49
 v_exp_f32 v50, v50
 v_exp_f32 v51, v51
 v_mfma_f32_32x32x16_bf16 v[152:167], v[204:207], v[120:123], v[152:167]
 buffer_load_dwordx4 v221, s[28:31], s42 offen offset:1024 sc1 lds
 v_cvt_pk_bf16_f32 v112, v48, v49
 v_exp_f32 v52, v52
 v_exp_f32 v53, v53
 v_cvt_pk_bf16_f32 v113, v50, v51
 v_mfma_f32_16x16x32_bf16 v[132:135], v[184:187], v[120:123], v[132:135]
 buffer_load_dwordx4 v221, s[28:31], s42 offen offset:2048 sc1 lds
 v_exp_f32 v54, v54
 v_exp_f32 v55, v55
 v_cvt_pk_bf16_f32 v114, v52, v53
 v_exp_f32_e64 v56, v56
 v_mfma_f32_32x32x16_bf16 v[64:79], v[216:219], v[180:183], v[64:79]
 buffer_load_dwordx4 v221, s[28:31], s42 offen offset:3072 sc1 lds
 v_exp_f32_e64 v57, v57
 v_cvt_pk_bf16_f32 v115, v54, v55
 v_exp_f32 v58, v58
 v_exp_f32 v59, v59
 v_mfma_f32_32x32x16_bf16 v[152:167], v[208:211], v[124:127], v[152:167]
 s_waitcnt lgkmcnt(0)
 s_nop 0
 v_cvt_pk_bf16_f32 v116, v56, v57
 v_exp_f32 v60, v60
 v_exp_f32 v61, v61
 v_cvt_pk_bf16_f32 v117, v58, v59
 v_mfma_f32_16x16x32_bf16 v[132:135], v[184:187], v[124:127], v[132:135]
 v_exp_f32 v62, v62
 v_exp_f32 v63, v63
 v_cvt_pk_bf16_f32 v118, v60, v61
 v_cvt_pk_bf16_f32 v119, v62, v63
 v_mfma_f32_32x32x16_bf16 v[48:63], v[196:199], v[168:171], v[80:95]
 v_exp_f32 v64, v64
 v_exp_f32 v65, v65
 v_exp_f32 v66, v66
 v_exp_f32 v67, v67
 v_mfma_f32_32x32x16_bf16 v[136:151], v[188:191], v[112:115], v[136:151]
 ds_read_b128 v[212:215], v220 offset:6144
 v_cvt_pk_bf16_f32 v120, v64, v65
 v_exp_f32 v68, v68
 v_exp_f32 v69, v69
 v_cvt_pk_bf16_f32 v121, v66, v67
 v_mfma_f32_16x16x32_bf16 v[128:131], v[184:187], v[112:115], v[128:131]
 ds_read_b128 v[204:207], v220 offset:4096
 s_mov_b32 s16, 0x8000
 s_waitcnt vmcnt(4)
 v_cmp_ne_u32 vcc, s59, v8
 v_cmp_ne_u32 s[18:19], s59, v9
 s_nop 0
 s_or_b64 vcc, vcc, s[18:19]
 v_cmp_ne_u32 s[18:19], s59, v10
 s_nop 0
 s_or_b64 vcc, vcc, s[18:19]
 v_cmp_ne_u32 s[18:19], s59, v11
 s_nop 0
 s_or_b64 vcc, vcc, s[18:19]
 s_cbranch_vccz m_kernel_spin4x
m_kernel_spin4:
 s_nop 0
 buffer_load_dwordx4 v[8:11], v4, s[44:47], 0 offen sc1
 s_waitcnt vmcnt(0)
 v_cmp_ne_u32 vcc, s59, v8
 v_cmp_ne_u32 s[18:19], s59, v9
 s_nop 0
 s_or_b64 vcc, vcc, s[18:19]
 v_cmp_ne_u32 s[18:19], s59, v10
 s_nop 0
 s_or_b64 vcc, vcc, s[18:19]
 v_cmp_ne_u32 s[18:19], s59, v11
 s_nop 0
 s_or_b64 vcc, vcc, s[18:19]
 s_sub_u32 s16, s16, 1
 s_cselect_b64 vcc, 0, vcc
 s_cbranch_vccnz m_kernel_spin4
m_kernel_spin4x:
 s_nop 0
 s_add_u32 s36, s8, 0x800000
 s_addc_u32 s37, s9, 0
 s_nop 0
 s_mov_b32 s38, 0x400000
 v_exp_f32 v70, v70
 v_exp_f32 v71, v71
 v_cvt_pk_bf16_f32 v122, v68, v69
 v_exp_f32_e64 v72, v72
 v_mfma_f32_32x32x16_bf16 v[48:63], v[200:203], v[172:175], v[48:63]
 ds_read_b128 v[216:219], v220 offset:7168
 s_mov_b32 s39, 0x00020000
 v_exp_f32_e64 v73, v73
 v_cvt_pk_bf16_f32 v123, v70, v71
 v_exp_f32 v74, v74
 v_exp_f32 v75, v75
 v_mfma_f32_32x32x16_bf16 v[136:151], v[192:195], v[116:119], v[136:151]
 ds_read_b128 v[208:211], v220 offset:5120
 s_add_u32 s44, s8, 0x8000
 s_addc_u32 s45, s9, 0
 s_nop 0
 v_cvt_pk_bf16_f32 v124, v72, v73
 v_exp_f32 v76, v76
 v_exp_f32 v77, v77
 v_cvt_pk_bf16_f32 v125, v74, v75
 v_mfma_f32_16x16x32_bf16 v[128:131], v[184:187], v[116:119], v[128:131]
 s_mov_b32 s46, 0x3000
 v_exp_f32 v78, v78
 v_exp_f32 v79, v79
 v_cvt_pk_bf16_f32 v126, v76, v77
 v_cvt_pk_bf16_f32 v127, v78, v79
 v_mfma_f32_32x32x16_bf16 v[64:79], v[196:199], v[176:179], v[96:111]
 s_mov_b32 s47, 0x00020000
 v_exp_f32 v48, v48
 v_exp_f32 v49, v49
 v_exp_f32 v50, v50
 v_exp_f32 v51, v51
 v_mfma_f32_32x32x16_bf16 v[152:167], v[188:191], v[120:123], v[152:167]
 s_add_u32 s48, s8, 0x100000
 s_addc_u32 s49, s9, 0
 s_nop 0
 s_mov_b32 s50, 0x38000
 v_cvt_pk_bf16_f32 v112, v48, v49
 v_exp_f32 v52, v52
 v_exp_f32 v53, v53
 v_cvt_pk_bf16_f32 v113, v50, v51
 v_mfma_f32_16x16x32_bf16 v[132:135], v[184:187], v[120:123], v[132:135]
 s_mov_b32 s51, 0x00020000
 v_exp_f32 v54, v54
 v_exp_f32 v55, v55
 v_cvt_pk_bf16_f32 v114, v52, v53
 v_exp_f32_e64 v56, v56
 v_mfma_f32_32x32x16_bf16 v[64:79], v[200:203], v[180:183], v[64:79]
 buffer_load_dwordx4 a[0:3], v236, s[44:47], 0 offen offset:0 sc1
 v_exp_f32_e64 v57, v57
 v_cvt_pk_bf16_f32 v115, v54, v55
 v_exp_f32 v58, v58
 v_exp_f32 v59, v59
 v_mfma_f32_32x32x16_bf16 v[152:167], v[192:195], v[124:127], v[152:167]
 s_waitcnt lgkmcnt(0)
 s_nop 0
 buffer_load_dwordx4 a[4:7], v236, s[44:47], 0 offen offset:64 sc1
 v_cvt_pk_bf16_f32 v116, v56, v57
 v_exp_f32 v60, v60
 v_exp_f32 v61, v61
 v_cvt_pk_bf16_f32 v117, v58, v59
 v_mfma_f32_16x16x32_bf16 v[132:135], v[184:187], v[124:127], v[132:135]
 buffer_load_dwordx4 a[8:11], v236, s[44:47], 0 offen offset:128 sc1
 v_exp_f32 v62, v62
 v_exp_f32 v63, v63
 v_cvt_pk_bf16_f32 v118, v60, v61
 v_cvt_pk_bf16_f32 v119, v62, v63
 v_mfma_f32_32x32x16_bf16 v[48:63], v[212:215], v[168:171], v[80:95]
 buffer_load_dwordx4 a[12:15], v236, s[44:47], 0 offen offset:192 sc1
 buffer_load_dwordx4 a[16:19], v236, s[44:47], 0 offen offset:256 sc1
 v_exp_f32 v64, v64
 v_exp_f32 v65, v65
 v_exp_f32 v66, v66
 v_exp_f32 v67, v67
 v_mfma_f32_32x32x16_bf16 v[136:151], v[204:207], v[112:115], v[136:151]
 ds_read_b128 v[196:199], v220 offset:10240
 buffer_load_dwordx4 a[20:23], v236, s[44:47], 0 offen offset:320 sc1
 v_cvt_pk_bf16_f32 v120, v64, v65
 v_exp_f32 v68, v68
 v_exp_f32 v69, v69
 v_cvt_pk_bf16_f32 v121, v66, v67
 v_mfma_f32_16x16x32_bf16 v[128:131], v[184:187], v[112:115], v[128:131]
 ds_read_b128 v[188:191], v220 offset:8192
 buffer_load_dwordx4 a[24:27], v236, s[44:47], 0 offen offset:384 sc1
 v_exp_f32 v70, v70
 v_exp_f32 v71, v71
 v_cvt_pk_bf16_f32 v122, v68, v69
 v_exp_f32_e64 v72, v72
 v_mfma_f32_32x32x16_bf16 v[48:63], v[216:219], v[172:175], v[48:63]
 ds_read_b128 v[200:203], v220 offset:11264
 buffer_load_dwordx4 a[28:31], v236, s[44:47], 0 offen offset:448 sc1
 v_exp_f32_e64 v73, v73
 v_cvt_pk_bf16_f32 v123, v70, v71
 v_exp_f32 v74, v74
 v_exp_f32 v75, v75
 v_mfma_f32_32x32x16_bf16 v[136:151], v[208:211], v[116:119], v[136:151]
 ds_read_b128 v[192:195], v220 offset:9216
 v_lshrrev_b32_e64 v2, 4, v0
 v_cvt_pk_bf16_f32 v124, v72, v73
 v_exp_f32 v76, v76
 v_exp_f32 v77, v77
 v_cvt_pk_bf16_f32 v125, v74, v75
 v_mfma_f32_16x16x32_bf16 v[128:131], v[184:187], v[116:119], v[128:131]
 v_lshlrev_b32_e64 v2, 4, v2
 v_exp_f32 v78, v78
 v_exp_f32 v79, v79
 v_cvt_pk_bf16_f32 v126, v76, v77
 v_cvt_pk_bf16_f32 v127, v78, v79
 v_mfma_f32_32x32x16_bf16 v[64:79], v[212:215], v[176:179], v[96:111]
 s_add_u32 s17, s14, 8192
 v_exp_f32 v48, v48
 v_exp_f32 v49, v49
 v_exp_f32 v50, v50
 v_exp_f32 v51, v51
 v_mfma_f32_32x32x16_bf16 v[152:167], v[204:207], v[120:123], v[152:167]
 s_add_u32 s16, s14, 4096
 v_cvt_pk_bf16_f32 v112, v48, v49
 v_exp_f32 v52, v52
 v_exp_f32 v53, v53
 v_cvt_pk_bf16_f32 v113, v50, v51
 v_mfma_f32_16x16x32_bf16 v[132:135], v[184:187], v[120:123], v[132:135]
 buffer_load_dwordx4 a[224:227], v2, s[44:47], s16 offen offset:0 sc1
 v_exp_f32 v54, v54
 v_exp_f32 v55, v55
 v_cvt_pk_bf16_f32 v114, v52, v53
 v_exp_f32_e64 v56, v56
 v_mfma_f32_32x32x16_bf16 v[64:79], v[216:219], v[180:183], v[64:79]
 buffer_load_dwordx4 a[228:231], v2, s[44:47], s16 offen offset:64 sc1
 v_exp_f32_e64 v57, v57
 v_cvt_pk_bf16_f32 v115, v54, v55
 v_exp_f32 v58, v58
 v_exp_f32 v59, v59
 v_mfma_f32_32x32x16_bf16 v[152:167], v[208:211], v[124:127], v[152:167]
 s_waitcnt lgkmcnt(0)
 s_nop 0
 buffer_load_dwordx4 a[232:235], v2, s[44:47], s17 offen offset:0 sc1
 v_cvt_pk_bf16_f32 v116, v56, v57
 v_exp_f32 v60, v60
 v_exp_f32 v61, v61
 v_cvt_pk_bf16_f32 v117, v58, v59
 v_mfma_f32_16x16x32_bf16 v[132:135], v[184:187], v[124:127], v[132:135]
 buffer_load_dwordx4 a[236:239], v2, s[44:47], s17 offen offset:64 sc1
 v_exp_f32 v62, v62
 v_exp_f32 v63, v63
 v_cvt_pk_bf16_f32 v118, v60, v61
 v_cvt_pk_bf16_f32 v119, v62, v63
 v_mfma_f32_32x32x16_bf16 v[48:63], v[196:199], v[168:171], v[80:95]
 s_add_u32 m0, s96, 131072
 s_mov_b32 s19, 0
 s_nop 0
 buffer_load_dwordx4 v224, s[60:63], s19 offen lds
 v_exp_f32 v64, v64
 v_exp_f32 v65, v65
 v_exp_f32 v66, v66
 v_exp_f32 v67, v67
 v_mfma_f32_32x32x16_bf16 v[136:151], v[188:191], v[112:115], v[136:151]
 ds_read_b128 v[212:215], v220 offset:14336
 v_cvt_pk_bf16_f32 v120, v64, v65
 v_exp_f32 v68, v68
 v_exp_f32 v69, v69
 v_cvt_pk_bf16_f32 v121, v66, v67
 v_mfma_f32_16x16x32_bf16 v[128:131], v[184:187], v[112:115], v[128:131]
 ds_read_b128 v[204:207], v220 offset:12288
 buffer_load_dwordx4 v225, s[60:63], s19 offen offset:1024 lds
 v_exp_f32 v70, v70
 v_exp_f32 v71, v71
 v_cvt_pk_bf16_f32 v122, v68, v69
 v_exp_f32_e64 v72, v72
 v_mfma_f32_32x32x16_bf16 v[48:63], v[200:203], v[172:175], v[48:63]
 ds_read_b128 v[216:219], v220 offset:15360
 v_exp_f32_e64 v73, v73
 v_cvt_pk_bf16_f32 v123, v70, v71
 v_exp_f32 v74, v74
 v_exp_f32 v75, v75
 v_mfma_f32_32x32x16_bf16 v[136:151], v[192:195], v[116:119], v[136:151]
 ds_read_b128 v[208:211], v220 offset:13312
 v_cvt_pk_bf16_f32 v124, v72, v73
 v_exp_f32 v76, v76
 v_exp_f32 v77, v77
 v_cvt_pk_bf16_f32 v125, v74, v75
 v_mfma_f32_16x16x32_bf16 v[128:131], v[184:187], v[116:119], v[128:131]
 s_add_u32 s42, s42, 16384
 v_exp_f32 v78, v78
 v_exp_f32 v79, v79
 v_cvt_pk_bf16_f32 v126, v76, v77
 v_cvt_pk_bf16_f32 v127, v78, v79
 v_mfma_f32_32x32x16_bf16 v[64:79], v[196:199], v[176:179], v[96:111]
 s_add_u32 m0, s43, s56
 v_exp_f32_e64 v48, v48
 v_exp_f32 v49, v49
 v_exp_f32 v50, v50
 v_exp_f32 v51, v51
 v_mfma_f32_32x32x16_bf16 v[152:167], v[188:191], v[120:123], v[152:167]
 s_add_u32 s43, s43, 16384
 v_cvt_pk_bf16_f32 v112, v48, v49
 v_exp_f32 v52, v52
 v_exp_f32 v53, v53
 v_cvt_pk_bf16_f32 v113, v50, v51
 v_mfma_f32_16x16x32_bf16 v[132:135], v[184:187], v[120:123], v[132:135]
 s_and_b32 s43, s43, 0xffff
 v_exp_f32 v54, v54
 v_exp_f32 v55, v55
 v_cvt_pk_bf16_f32 v114, v52, v53
 v_exp_f32_e64 v56, v56
 v_mfma_f32_32x32x16_bf16 v[64:79], v[200:203], v[180:183], v[64:79]
 v_exp_f32_e64 v57, v57
 v_cvt_pk_bf16_f32 v115, v54, v55
 v_exp_f32 v58, v58
 v_exp_f32 v59, v59
 v_mfma_f32_32x32x16_bf16 v[152:167], v[192:195], v[124:127], v[152:167]
 s_waitcnt lgkmcnt(0)
 s_nop 0
 v_cvt_pk_bf16_f32 v116, v56, v57
 v_exp_f32 v60, v60
 v_exp_f32 v61, v61
 v_cvt_pk_bf16_f32 v117, v58, v59
 v_mfma_f32_16x16x32_bf16 v[132:135], v[184:187], v[124:127], v[132:135]
 v_exp_f32 v62, v62
 v_exp_f32 v63, v63
 v_cvt_pk_bf16_f32 v118, v60, v61
 v_cvt_pk_bf16_f32 v119, v62, v63
 v_mfma_f32_32x32x16_bf16 v[48:63], v[212:215], v[168:171], v[80:95]
 v_exp_f32 v64, v64
 v_exp_f32 v65, v65
 v_exp_f32 v66, v66
 v_exp_f32 v67, v67
 v_mfma_f32_32x32x16_bf16 v[136:151], v[204:207], v[112:115], v[136:151]
 s_barrier
 s_nop 0
 v_cvt_pk_bf16_f32 v120, v64, v65
 v_exp_f32 v68, v68
 v_exp_f32 v69, v69
 v_cvt_pk_bf16_f32 v121, v66, v67
 v_mfma_f32_16x16x32_bf16 v[128:131], v[184:187], v[112:115], v[128:131]
 ds_read_b128 v[196:199], v220 offset:18432
 v_exp_f32 v70, v70
 v_exp_f32 v71, v71
 v_cvt_pk_bf16_f32 v122, v68, v69
 v_exp_f32_e64 v72, v72
 v_mfma_f32_32x32x16_bf16 v[48:63], v[216:219], v[172:175], v[48:63]
 ds_read_b128 v[188:191], v220 offset:16384
 v_exp_f32_e64 v73, v73
 v_cvt_pk_bf16_f32 v123, v70, v71
 v_exp_f32 v74, v74
 v_exp_f32 v75, v75
 v_mfma_f32_32x32x16_bf16 v[136:151], v[208:211], v[116:119], v[136:151]
 ds_read_b128 v[200:203], v220 offset:19456
 v_cvt_pk_bf16_f32 v124, v72, v73
 v_exp_f32 v76, v76
 v_exp_f32 v77, v77
 v_cvt_pk_bf16_f32 v125, v74, v75
 v_mfma_f32_16x16x32_bf16 v[128:131], v[184:187], v[116:119], v[128:131]
 ds_read_b128 v[192:195], v220 offset:17408
 v_exp_f32 v78, v78
 v_exp_f32 v79, v79
 v_cvt_pk_bf16_f32 v126, v76, v77
 v_cvt_pk_bf16_f32 v127, v78, v79
 v_mfma_f32_32x32x16_bf16 v[64:79], v[212:215], v[176:179], v[96:111]
 buffer_load_dwordx4 v221, s[28:31], s42 offen offset:0 sc1 lds
 v_exp_f32 v48, v48
 v_exp_f32 v49, v49
 v_exp_f32 v50, v50
 v_exp_f32 v51, v51
 v_mfma_f32_32x32x16_bf16 v[152:167], v[204:207], v[120:123], v[152:167]
 buffer_load_dwordx4 v221, s[28:31], s42 offen offset:1024 sc1 lds
 v_cvt_pk_bf16_f32 v112, v48, v49
 v_exp_f32 v52, v52
 v_exp_f32 v53, v53
 v_cvt_pk_bf16_f32 v113, v50, v51
 v_mfma_f32_16x16x32_bf16 v[132:135], v[184:187], v[120:123], v[132:135]
 buffer_load_dwordx4 v221, s[28:31], s42 offen offset:2048 sc1 lds
 v_exp_f32 v54, v54
 v_exp_f32 v55, v55
 v_cvt_pk_bf16_f32 v114, v52, v53
 v_exp_f32_e64 v56, v56
 v_mfma_f32_32x32x16_bf16 v[64:79], v[216:219], v[180:183], v[64:79]
 buffer_load_dwordx4 v221, s[28:31], s42 offen offset:3072 sc1 lds
 v_exp_f32_e64 v57, v57
 v_cvt_pk_bf16_f32 v115, v54, v55
 v_exp_f32 v58, v58
 v_exp_f32 v59, v59
 v_mfma_f32_32x32x16_bf16 v[152:167], v[208:211], v[124:127], v[152:167]
 s_waitcnt lgkmcnt(0)
 s_nop 0
 v_cvt_pk_bf16_f32 v116, v56, v57
 v_exp_f32 v60, v60
 v_exp_f32 v61, v61
 v_cvt_pk_bf16_f32 v117, v58, v59
 v_mfma_f32_16x16x32_bf16 v[132:135], v[184:187], v[124:127], v[132:135]
 v_exp_f32 v62, v62
 v_exp_f32 v63, v63
 v_cvt_pk_bf16_f32 v118, v60, v61
 v_cvt_pk_bf16_f32 v119, v62, v63
 v_mfma_f32_32x32x16_bf16 v[48:63], v[196:199], v[168:171], v[80:95]
 ds_read_b64_tr_b16 a[32:33], v234 offset:0
 ds_read_b64_tr_b16 a[34:35], v234 offset:4096
 v_exp_f32 v64, v64
 v_exp_f32 v65, v65
 v_exp_f32 v66, v66
 v_exp_f32 v67, v67
 v_mfma_f32_32x32x16_bf16 v[136:151], v[188:191], v[112:115], v[136:151]
 ds_read_b128 v[212:215], v220 offset:22528
 ds_read_b64_tr_b16 a[36:37], v235 offset:0
 v_cvt_pk_bf16_f32 v120, v64, v65
 v_exp_f32 v68, v68
 v_exp_f32 v69, v69
 v_cvt_pk_bf16_f32 v121, v66, v67
 v_mfma_f32_16x16x32_bf16 v[128:131], v[184:187], v[112:115], v[128:131]
 ds_read_b128 v[204:207], v220 offset:20480
 ds_read_b64_tr_b16 a[38:39], v235 offset:4096
 ds_read_b64_tr_b16 a[40:41], v234 offset:8192
 v_exp_f32 v70, v70
 v_exp_f32 v71, v71
 v_cvt_pk_bf16_f32 v122, v68, v69
 v_exp_f32_e64 v72, v72
 v_mfma_f32_32x32x16_bf16 v[48:63], v[200:203], v[172:175], v[48:63]
 ds_read_b128 v[216:219], v220 offset:23552
 ds_read_b64_tr_b16 a[42:43], v234 offset:12288
 v_exp_f32_e64 v73, v73
 v_cvt_pk_bf16_f32 v123, v70, v71
 v_exp_f32 v74, v74
 v_exp_f32 v75, v75
 v_mfma_f32_32x32x16_bf16 v[136:151], v[192:195], v[116:119], v[136:151]
 ds_read_b128 v[208:211], v220 offset:21504
 ds_read_b64_tr_b16 a[44:45], v235 offset:8192
 ds_read_b64_tr_b16 a[46:47], v235 offset:12288
 v_cvt_pk_bf16_f32 v124, v72, v73
 v_exp_f32 v76, v76
 v_exp_f32 v77, v77
 v_cvt_pk_bf16_f32 v125, v74, v75
 v_mfma_f32_16x16x32_bf16 v[128:131], v[184:187], v[116:119], v[128:131]
 ds_read_b64_tr_b16 a[48:49], v234 offset:16384
 v_exp_f32 v78, v78
 v_exp_f32 v79, v79
 v_cvt_pk_bf16_f32 v126, v76, v77
 v_cvt_pk_bf16_f32 v127, v78, v79
 v_mfma_f32_32x32x16_bf16 v[64:79], v[196:199], v[176:179], v[96:111]
 ds_read_b64_tr_b16 a[50:51], v234 offset:20480
 ds_read_b64_tr_b16 a[52:53], v235 offset:16384
 v_exp_f32 v48, v48
 v_exp_f32 v49, v49
 v_exp_f32 v50, v50
 v_exp_f32 v51, v51
 v_mfma_f32_32x32x16_bf16 v[152:167], v[188:191], v[120:123], v[152:167]
 ds_read_b64_tr_b16 a[54:55], v235 offset:20480
 v_cvt_pk_bf16_f32 v112, v48, v49
 v_exp_f32 v52, v52
 v_exp_f32 v53, v53
 v_cvt_pk_bf16_f32 v113, v50, v51
 v_mfma_f32_16x16x32_bf16 v[132:135], v[184:187], v[120:123], v[132:135]
 ds_read_b64_tr_b16 a[56:57], v234 offset:24576
 ds_read_b64_tr_b16 a[58:59], v234 offset:28672
 v_exp_f32 v54, v54
 v_exp_f32 v55, v55
 v_cvt_pk_bf16_f32 v114, v52, v53
 v_exp_f32_e64 v56, v56
 v_mfma_f32_32x32x16_bf16 v[64:79], v[200:203], v[180:183], v[64:79]
 ds_read_b64_tr_b16 a[60:61], v235 offset:24576
 v_exp_f32_e64 v57, v57
 v_cvt_pk_bf16_f32 v115, v54, v55
 v_exp_f32 v58, v58
 v_exp_f32 v59, v59
 v_mfma_f32_32x32x16_bf16 v[152:167], v[192:195], v[124:127], v[152:167]
 s_waitcnt lgkmcnt(0)
 s_nop 0
 ds_read_b64_tr_b16 a[62:63], v235 offset:28672
 s_add_u32 m0, s96, 131072
 s_nop 0
 s_nop 0
 buffer_load_dwordx4 v226, s[60:63], s19 offen offset:2048 lds
 v_cvt_pk_bf16_f32 v116, v56, v57
 v_exp_f32 v60, v60
 v_exp_f32 v61, v61
 v_cvt_pk_bf16_f32 v117, v58, v59
 v_mfma_f32_16x16x32_bf16 v[132:135], v[184:187], v[124:127], v[132:135]
 buffer_load_dwordx4 v227, s[60:63], s19 offen offset:3072 lds
 s_add_u32 m0, s96, 135168
 v_exp_f32 v62, v62
 v_exp_f32 v63, v63
 v_cvt_pk_bf16_f32 v118, v60, v61
 v_cvt_pk_bf16_f32 v119, v62, v63
 v_mfma_f32_32x32x16_bf16 v[48:63], v[212:215], v[168:171], v[80:95]
 buffer_load_dwordx4 v228, s[60:63], s19 offen lds
 buffer_load_dwordx4 v229, s[60:63], s19 offen offset:1024 lds
 v_exp_f32 v64, v64
 v_exp_f32 v65, v65
 v_exp_f32 v66, v66
 v_exp_f32 v67, v67
 v_mfma_f32_32x32x16_bf16 v[136:151], v[204:207], v[112:115], v[136:151]
 ds_read_b128 v[196:199], v220 offset:26624
 buffer_load_dwordx4 v230, s[60:63], s19 offen offset:2048 lds
 s_add_u32 s19, s19, 458752
 s_add_u32 m0, s96, 0
 s_nop 0
 ds_read_b64_tr_b16 a[64:65], v234 offset:32768
 v_cvt_pk_bf16_f32 v120, v64, v65
 v_exp_f32 v68, v68
 v_exp_f32 v69, v69
 v_cvt_pk_bf16_f32 v121, v66, v67
 v_mfma_f32_16x16x32_bf16 v[128:131], v[184:187], v[112:115], v[128:131]
 ds_read_b128 v[188:191], v220 offset:24576
 ds_read_b64_tr_b16 a[66:67], v234 offset:36864
 ds_read_b64_tr_b16 a[68:69], v235 offset:32768
 v_exp_f32 v70, v70
 v_exp_f32 v71, v71
 v_cvt_pk_bf16_f32 v122, v68, v69
 v_exp_f32_e64 v72, v72
 v_mfma_f32_32x32x16_bf16 v[48:63], v[216:219], v[172:175], v[48:63]
 ds_read_b128 v[200:203], v220 offset:27648
 ds_read_b64_tr_b16 a[70:71], v235 offset:36864
 ds_read_b64_tr_b16 a[72:73], v234 offset:40960
 v_exp_f32_e64 v73, v73
 v_cvt_pk_bf16_f32 v123, v70, v71
 v_exp_f32 v74, v74
 v_exp_f32 v75, v75
 v_mfma_f32_32x32x16_bf16 v[136:151], v[208:211], v[116:119], v[136:151]
 ds_read_b128 v[192:195], v220 offset:25600
 ds_read_b64_tr_b16 a[74:75], v234 offset:45056
 ds_read_b64_tr_b16 a[76:77], v235 offset:40960
 v_cvt_pk_bf16_f32 v124, v72, v73
 v_exp_f32 v76, v76
 v_exp_f32 v77, v77
 v_cvt_pk_bf16_f32 v125, v74, v75
 v_mfma_f32_16x16x32_bf16 v[128:131], v[184:187], v[116:119], v[128:131]
 ds_read_b64_tr_b16 a[78:79], v235 offset:45056
 ds_read_b64_tr_b16 a[80:81], v234 offset:49152
 v_exp_f32 v78, v78
 v_exp_f32 v79, v79
 v_cvt_pk_bf16_f32 v126, v76, v77
 v_cvt_pk_bf16_f32 v127, v78, v79
 v_mfma_f32_32x32x16_bf16 v[64:79], v[212:215], v[176:179], v[96:111]
 ds_read_b64_tr_b16 a[82:83], v234 offset:53248
 ds_read_b64_tr_b16 a[84:85], v235 offset:49152
 v_exp_f32 v48, v48
 v_exp_f32 v49, v49
 v_exp_f32 v50, v50
 v_exp_f32 v51, v51
 v_mfma_f32_32x32x16_bf16 v[152:167], v[204:207], v[120:123], v[152:167]
 ds_read_b64_tr_b16 a[86:87], v235 offset:53248
 ds_read_b64_tr_b16 a[88:89], v234 offset:57344
 v_cvt_pk_bf16_f32 v112, v48, v49
 v_exp_f32 v52, v52
 v_exp_f32 v53, v53
 v_cvt_pk_bf16_f32 v113, v50, v51
 v_mfma_f32_16x16x32_bf16 v[132:135], v[184:187], v[120:123], v[132:135]
 ds_read_b64_tr_b16 a[90:91], v234 offset:61440
 ds_read_b64_tr_b16 a[92:93], v235 offset:57344
 v_exp_f32 v54, v54
 v_exp_f32 v55, v55
 v_cvt_pk_bf16_f32 v114, v52, v53
 v_exp_f32_e64 v56, v56
 v_mfma_f32_32x32x16_bf16 v[64:79], v[216:219], v[180:183], v[64:79]
 ds_read_b64_tr_b16 a[94:95], v235 offset:61440
 v_exp_f32_e64 v57, v57
 v_cvt_pk_bf16_f32 v115, v54, v55
 v_exp_f32 v58, v58
 v_exp_f32 v59, v59
 v_mfma_f32_32x32x16_bf16 v[152:167], v[208:211], v[124:127], v[152:167]
 s_waitcnt lgkmcnt(0)
 s_nop 0
 v_cvt_pk_bf16_f32 v116, v56, v57
 v_exp_f32 v60, v60
 v_exp_f32 v61, v61
 v_cvt_pk_bf16_f32 v117, v58, v59
 v_mfma_f32_16x16x32_bf16 v[132:135], v[184:187], v[124:127], v[132:135]
 v_exp_f32 v62, v62
 v_exp_f32 v63, v63
 v_cvt_pk_bf16_f32 v118, v60, v61
 v_cvt_pk_bf16_f32 v119, v62, v63
 v_mfma_f32_32x32x16_bf16 v[48:63], v[196:199], v[168:171], v[80:95]
 s_waitcnt vmcnt(22)
 s_nop 0
 v_mfma_f32_16x16x32_bf16 v[8:11], a[0:3], a[32:35], 0
 v_mfma_f32_16x16x32_bf16 v[12:15], a[0:3], a[36:39], 0
 v_exp_f32 v64, v64
 v_exp_f32 v65, v65
 v_exp_f32 v66, v66
 v_exp_f32 v67, v67
 v_mfma_f32_32x32x16_bf16 v[136:151], v[188:191], v[112:115], v[136:151]
 ds_read_b128 v[212:215], v220 offset:30720
 s_waitcnt vmcnt(21)
 s_nop 0
 v_mfma_f32_16x16x32_bf16 v[8:11], a[4:7], a[40:43], v[8:11]
 v_cvt_pk_bf16_f32 v120, v64, v65
 v_exp_f32 v68, v68
 v_exp_f32 v69, v69
 v_cvt_pk_bf16_f32 v121, v66, v67
 v_mfma_f32_16x16x32_bf16 v[128:131], v[184:187], v[112:115], v[128:131]
 ds_read_b128 v[204:207], v220 offset:28672
 v_mfma_f32_16x16x32_bf16 v[12:15], a[4:7], a[44:47], v[12:15]
 v_exp_f32 v70, v70
 v_exp_f32 v71, v71
 v_cvt_pk_bf16_f32 v122, v68, v69
 v_exp_f32_e64 v72, v72
 v_mfma_f32_32x32x16_bf16 v[48:63], v[200:203], v[172:175], v[48:63]
 ds_read_b128 v[216:219], v220 offset:31744
 s_waitcnt vmcnt(20)
 s_nop 0
 v_mfma_f32_16x16x32_bf16 v[8:11], a[8:11], a[48:51], v[8:11]
 v_mfma_f32_16x16x32_bf16 v[12:15], a[8:11], a[52:55], v[12:15]
 v_exp_f32_e64 v73, v73
 v_cvt_pk_bf16_f32 v123, v70, v71
 v_exp_f32 v74, v74
 v_exp_f32 v75, v75
 v_mfma_f32_32x32x16_bf16 v[136:151], v[192:195], v[116:119], v[136:151]
 ds_read_b128 v[208:211], v220 offset:29696
 s_waitcnt vmcnt(19)
 s_nop 0
 v_mfma_f32_16x16x32_bf16 v[8:11], a[12:15], a[56:59], v[8:11]
 v_cvt_pk_bf16_f32 v124, v72, v73
 v_exp_f32 v76, v76
 v_exp_f32 v77, v77
 v_cvt_pk_bf16_f32 v125, v74, v75
 v_mfma_f32_16x16x32_bf16 v[128:131], v[184:187], v[116:119], v[128:131]
 s_add_u32 s42, s42, 16384
 v_mfma_f32_16x16x32_bf16 v[12:15], a[12:15], a[60:63], v[12:15]
 v_exp_f32 v78, v78
 v_exp_f32 v79, v79
 v_cvt_pk_bf16_f32 v126, v76, v77
 v_cvt_pk_bf16_f32 v127, v78, v79
 v_mfma_f32_32x32x16_bf16 v[64:79], v[196:199], v[176:179], v[96:111]
 s_add_u32 m0, s43, s56
 s_waitcnt vmcnt(18)
 v_mfma_f32_16x16x32_bf16 v[8:11], a[16:19], a[64:67], v[8:11]
 v_mfma_f32_16x16x32_bf16 v[12:15], a[16:19], a[68:71], v[12:15]
 v_exp_f32 v48, v48
 v_exp_f32 v49, v49
 v_exp_f32 v50, v50
 v_exp_f32 v51, v51
 v_mfma_f32_32x32x16_bf16 v[152:167], v[188:191], v[120:123], v[152:167]
 s_add_u32 s43, s43, 16384
 s_waitcnt vmcnt(17)
 s_nop 0
 v_mfma_f32_16x16x32_bf16 v[8:11], a[20:23], a[72:75], v[8:11]
 v_cvt_pk_bf16_f32 v112, v48, v49
 v_exp_f32 v52, v52
 v_exp_f32 v53, v53
 v_cvt_pk_bf16_f32 v113, v50, v51
 v_mfma_f32_16x16x32_bf16 v[132:135], v[184:187], v[120:123], v[132:135]
 s_and_b32 s43, s43, 0xffff
 v_mfma_f32_16x16x32_bf16 v[12:15], a[20:23], a[76:79], v[12:15]
 v_exp_f32 v54, v54
 v_exp_f32 v55, v55
 v_cvt_pk_bf16_f32 v114, v52, v53
 v_exp_f32_e64 v56, v56
 v_mfma_f32_32x32x16_bf16 v[64:79], v[200:203], v[180:183], v[64:79]
 s_waitcnt vmcnt(16)
 s_nop 0
 v_mfma_f32_16x16x32_bf16 v[8:11], a[24:27], a[80:83], v[8:11]
 v_mfma_f32_16x16x32_bf16 v[12:15], a[24:27], a[84:87], v[12:15]
 v_exp_f32_e64 v57, v57
 v_cvt_pk_bf16_f32 v115, v54, v55
 v_exp_f32_e64 v58, v58
 v_exp_f32 v59, v59
 v_add_u32 v220, s43, v231
 v_mfma_f32_32x32x16_bf16 v[152:167], v[192:195], v[124:127], v[152:167]
 s_waitcnt lgkmcnt(0)
 s_waitcnt vmcnt(15)
 v_mfma_f32_16x16x32_bf16 v[8:11], a[28:31], a[88:91], v[8:11]
 v_cvt_pk_bf16_f32 v116, v56, v57
 v_exp_f32 v60, v60
 v_exp_f32 v61, v61
 v_cvt_pk_bf16_f32 v117, v58, v59
 v_mfma_f32_16x16x32_bf16 v[132:135], v[184:187], v[124:127], v[132:135]
 v_mfma_f32_16x16x32_bf16 v[12:15], a[28:31], a[92:95], v[12:15]
 v_exp_f32 v62, v62
 v_exp_f32 v63, v63
 v_cvt_pk_bf16_f32 v118, v60, v61
 v_cvt_pk_bf16_f32 v119, v62, v63
 v_mfma_f32_32x32x16_bf16 v[48:63], v[212:215], v[168:171], v[80:95]
 v_exp_f32 v64, v64
 v_exp_f32 v65, v65
 v_exp_f32 v66, v66
 v_exp_f32 v67, v67
 v_mfma_f32_32x32x16_bf16 v[136:151], v[204:207], v[112:115], v[136:151]
 s_barrier
 s_nop 0
 v_cvt_pk_bf16_f32 v120, v64, v65
 v_exp_f32 v68, v68
 v_exp_f32 v69, v69
 v_cvt_pk_bf16_f32 v121, v66, v67
 v_mfma_f32_16x16x32_bf16 v[128:131], v[184:187], v[112:115], v[128:131]
 ds_read_b128 v[196:199], v220 offset:2048
 s_lshl_b32 s16, s11, 3
 s_lshl_b32 s17, s3, 1
 v_exp_f32 v70, v70
 v_exp_f32 v71, v71
 v_cvt_pk_bf16_f32 v122, v68, v69
 v_exp_f32_e64 v72, v72
 v_mfma_f32_32x32x16_bf16 v[48:63], v[216:219], v[172:175], v[48:63]
 ds_read_b128 v[188:191], v220 offset:0
 s_add_u32 s16, s16, s17
 s_lshl_b32 s16, s16, 10
 v_exp_f32_e64 v73, v73
 v_cvt_pk_bf16_f32 v123, v70, v71
 v_exp_f32 v74, v74
 v_exp_f32 v75, v75
 v_mfma_f32_32x32x16_bf16 v[136:151], v[208:211], v[116:119], v[136:151]
 ds_read_b128 v[200:203], v220 offset:3072
 s_lshl_b32 s17, s10, 8
 s_add_u32 s16, s16, s17
 v_cvt_pk_bf16_f32 v124, v72, v73
 v_exp_f32 v76, v76
 v_exp_f32 v77, v77
 v_cvt_pk_bf16_f32 v125, v74, v75
 v_mfma_f32_16x16x32_bf16 v[128:131], v[184:187], v[116:119], v[128:131]
 ds_read_b128 v[192:195], v220 offset:1024
 s_add_u32 s16, s16, s97
 s_nop 0
 s_cmp_ge_u32 s2, 224
 s_cselect_b32 s50, 0, s50
 v_exp_f32_e64 v78, v78
 v_exp_f32 v79, v79
 v_cvt_pk_bf16_f32 v126, v76, v77
 v_cvt_pk_bf16_f32 v127, v78, v79
 v_mfma_f32_32x32x16_bf16 v[64:79], v[212:215], v[176:179], v[96:111]
 buffer_load_dwordx4 v221, s[28:31], s42 offen offset:0 sc1 lds
 v_cvt_pk_bf16_f32 v10, v8, v9
 v_and_b32 v8, 0xffff0000, v10
 v_exp_f32 v48, v48
 v_exp_f32 v49, v49
 v_exp_f32 v50, v50
 v_exp_f32 v51, v51
 v_mfma_f32_32x32x16_bf16 v[152:167], v[204:207], v[120:123], v[152:167]
 buffer_load_dwordx4 v221, s[28:31], s42 offen offset:1024 sc1 lds
 v_sub_f32_e64 v9, v9, v8
 v_cvt_pk_bf16_f32 v11, v9, v8
 v_cvt_pk_bf16_f32 v112, v48, v49
 v_exp_f32 v52, v52
 v_exp_f32 v53, v53
 v_cvt_pk_bf16_f32 v113, v50, v51
 v_mfma_f32_16x16x32_bf16 v[132:135], v[184:187], v[120:123], v[132:135]
 buffer_load_dwordx4 v221, s[28:31], s42 offen offset:2048 sc1 lds
 v_cvt_pk_bf16_f32 v14, v12, v13
 v_and_b32 v12, 0xffff0000, v14
 v_exp_f32 v54, v54
 v_exp_f32 v55, v55
 v_cvt_pk_bf16_f32 v114, v52, v53
 v_exp_f32_e64 v56, v56
 v_mfma_f32_32x32x16_bf16 v[64:79], v[216:219], v[180:183], v[64:79]
 buffer_load_dwordx4 v221, s[28:31], s42 offen offset:3072 sc1 lds
 v_sub_f32_e64 v13, v13, v12
 v_cvt_pk_bf16_f32 v15, v13, v12
 v_exp_f32_e64 v57, v57
 v_cvt_pk_bf16_f32 v115, v54, v55
 v_exp_f32 v58, v58
 v_exp_f32 v59, v59
 v_mfma_f32_32x32x16_bf16 v[152:167], v[208:211], v[124:127], v[152:167]
 s_waitcnt lgkmcnt(0)
 s_nop 0
 s_mov_b64 exec, 0xffff
 buffer_store_dwordx2 v[10:11], v221, s[48:51], s16 offen offset:0 sc1
 buffer_store_dwordx2 v[14:15], v221, s[48:51], s16 offen offset:1024 sc1
 s_mov_b64 exec, -1
 s_nop 0
 v_cvt_pk_bf16_f32 v116, v56, v57
 v_exp_f32 v60, v60
 v_exp_f32 v61, v61
 v_cvt_pk_bf16_f32 v117, v58, v59
 v_mfma_f32_16x16x32_bf16 v[132:135], v[184:187], v[124:127], v[132:135]
 s_lshl_b32 s57, s3, 12
 s_mov_b32 s16, 0
 s_mov_b32 s18, 2
.p2align 6
m_kernel_l4:
 v_exp_f32 v62, v62
 v_exp_f32 v63, v63
 v_cvt_pk_bf16_f32 v118, v60, v61
 v_cvt_pk_bf16_f32 v119, v62, v63
 v_mfma_f32_32x32x16_bf16 v[48:63], v[196:199], v[168:171], v[80:95]
 v_readlane_b32 s58, v240, s16
 v_exp_f32 v64, v64
 v_exp_f32 v65, v65
 v_exp_f32 v66, v66
 v_exp_f32 v67, v67
 v_mfma_f32_32x32x16_bf16 v[136:151], v[188:191], v[112:115], v[136:151]
 ds_read_b128 v[212:215], v220 offset:6144
 v_cvt_pk_bf16_f32 v120, v64, v65
 v_exp_f32 v68, v68
 v_exp_f32 v69, v69
 v_cvt_pk_bf16_f32 v121, v66, v67
 v_mfma_f32_16x16x32_bf16 v[128:131], v[184:187], v[112:115], v[128:131]
 ds_read_b128 v[204:207], v220 offset:4096
 v_exp_f32 v70, v70
 v_exp_f32 v71, v71
 v_cvt_pk_bf16_f32 v122, v68, v69
 v_exp_f32_e64 v72, v72
 v_mfma_f32_32x32x16_bf16 v[48:63], v[200:203], v[172:175], v[48:63]
 ds_read_b128 v[216:219], v220 offset:7168
 v_exp_f32_e64 v73, v73
 v_cvt_pk_bf16_f32 v123, v70, v71
 v_exp_f32 v74, v74
 v_exp_f32 v75, v75
 v_mfma_f32_32x32x16_bf16 v[136:151], v[192:195], v[116:119], v[136:151]
 ds_read_b128 v[208:211], v220 offset:5120
 v_cvt_pk_bf16_f32 v124, v72, v73
 v_exp_f32 v76, v76
 v_exp_f32 v77, v77
 v_cvt_pk_bf16_f32 v125, v74, v75
 v_mfma_f32_16x16x32_bf16 v[128:131], v[184:187], v[116:119], v[128:131]
 s_mov_b32 m0, s57
 v_exp_f32_e64 v78, v78
 v_exp_f32 v79, v79
 v_cvt_pk_bf16_f32 v126, v76, v77
 v_cvt_pk_bf16_f32 v127, v78, v79
 v_mfma_f32_32x32x16_bf16 v[64:79], v[196:199], v[176:179], v[96:111]
 buffer_load_dwordx4 v244, s[52:55], s58 offen offset:0 lds
 v_exp_f32 v48, v48
 v_exp_f32 v49, v49
 v_exp_f32 v50, v50
 v_exp_f32 v51, v51
 v_mfma_f32_32x32x16_bf16 v[152:167], v[188:191], v[120:123], v[152:167]
 buffer_load_dwordx4 v245, s[52:55], s58 offen offset:1024 lds
 v_cvt_pk_bf16_f32 v112, v48, v49
 v_exp_f32 v52, v52
 v_exp_f32 v53, v53
 v_cvt_pk_bf16_f32 v113, v50, v51
 v_mfma_f32_16x16x32_bf16 v[132:135], v[184:187], v[120:123], v[132:135]
 buffer_load_dwordx4 v246, s[52:55], s58 offen offset:2048 lds
 v_exp_f32 v54, v54
 v_exp_f32 v55, v55
 v_cvt_pk_bf16_f32 v114, v52, v53
 v_exp_f32_e64 v56, v56
 v_mfma_f32_32x32x16_bf16 v[64:79], v[200:203], v[180:183], v[64:79]
 buffer_load_dwordx4 v247, s[52:55], s58 offen offset:3072 lds
 v_exp_f32_e64 v57, v57
 v_cvt_pk_bf16_f32 v115, v54, v55
 v_exp_f32 v58, v58
 v_exp_f32 v59, v59
 v_mfma_f32_32x32x16_bf16 v[152:167], v[192:195], v[124:127], v[152:167]
 s_waitcnt lgkmcnt(0)
 s_nop 0
 v_cvt_pk_bf16_f32 v116, v56, v57
 v_exp_f32 v60, v60
 v_exp_f32 v61, v61
 v_cvt_pk_bf16_f32 v117, v58, v59
 v_mfma_f32_16x16x32_bf16 v[132:135], v[184:187], v[124:127], v[132:135]
 s_add_u32 s57, s57, 16384
 v_exp_f32 v62, v62
 v_exp_f32 v63, v63
 v_cvt_pk_bf16_f32 v118, v60, v61
 v_cvt_pk_bf16_f32 v119, v62, v63
 v_mfma_f32_32x32x16_bf16 v[48:63], v[212:215], v[168:171], v[80:95]
 v_exp_f32 v64, v64
 v_exp_f32 v65, v65
 v_exp_f32 v66, v66
 v_exp_f32 v67, v67
 v_mfma_f32_32x32x16_bf16 v[136:151], v[204:207], v[112:115], v[136:151]
 ds_read_b128 v[196:199], v220 offset:10240
 v_cvt_pk_bf16_f32 v120, v64, v65
 v_exp_f32 v68, v68
 v_exp_f32 v69, v69
 v_cvt_pk_bf16_f32 v121, v66, v67
 v_mfma_f32_16x16x32_bf16 v[128:131], v[184:187], v[112:115], v[128:131]
 ds_read_b128 v[188:191], v220 offset:8192
 v_exp_f32 v70, v70
 v_exp_f32 v71, v71
 v_cvt_pk_bf16_f32 v122, v68, v69
 v_exp_f32_e64 v72, v72
 v_mfma_f32_32x32x16_bf16 v[48:63], v[216:219], v[172:175], v[48:63]
 ds_read_b128 v[200:203], v220 offset:11264
 v_exp_f32_e64 v73, v73
 v_cvt_pk_bf16_f32 v123, v70, v71
 v_exp_f32 v74, v74
 v_exp_f32 v75, v75
 v_mfma_f32_32x32x16_bf16 v[136:151], v[208:211], v[116:119], v[136:151]
 ds_read_b128 v[192:195], v220 offset:9216
 v_cvt_pk_bf16_f32 v124, v72, v73
 v_exp_f32 v76, v76
 v_exp_f32 v77, v77
 v_cvt_pk_bf16_f32 v125, v74, v75
 v_mfma_f32_16x16x32_bf16 v[128:131], v[184:187], v[116:119], v[128:131]
 s_add_u32 s17, s16, 4
 v_exp_f32_e64 v78, v78
 v_exp_f32 v79, v79
 v_cvt_pk_bf16_f32 v126, v76, v77
 v_cvt_pk_bf16_f32 v127, v78, v79
 v_mfma_f32_32x32x16_bf16 v[64:79], v[212:215], v[176:179], v[96:111]
 s_add_u32 s16, s16, 1
 v_exp_f32_e64 v48, v48
 v_exp_f32 v49, v49
 v_exp_f32 v50, v50
 v_exp_f32 v51, v51
 v_mfma_f32_32x32x16_bf16 v[152:167], v[204:207], v[120:123], v[152:167]
 v_cvt_pk_bf16_f32 v112, v48, v49
 v_exp_f32 v52, v52
 v_exp_f32 v53, v53
 v_cvt_pk_bf16_f32 v113, v50, v51
 v_mfma_f32_16x16x32_bf16 v[132:135], v[184:187], v[120:123], v[132:135]
 v_exp_f32 v54, v54
 v_exp_f32 v55, v55
 v_cvt_pk_bf16_f32 v114, v52, v53
 v_exp_f32_e64 v56, v56
 v_mfma_f32_32x32x16_bf16 v[64:79], v[216:219], v[180:183], v[64:79]
 v_exp_f32_e64 v57, v57
 v_cvt_pk_bf16_f32 v115, v54, v55
 v_exp_f32 v58, v58
 v_exp_f32 v59, v59
 v_mfma_f32_32x32x16_bf16 v[152:167], v[208:211], v[124:127], v[152:167]
 s_waitcnt lgkmcnt(0)
 s_nop 0
 v_cvt_pk_bf16_f32 v116, v56, v57
 v_exp_f32 v60, v60
 v_exp_f32 v61, v61
 v_cvt_pk_bf16_f32 v117, v58, v59
 v_mfma_f32_16x16x32_bf16 v[132:135], v[184:187], v[124:127], v[132:135]
 v_exp_f32 v62, v62
 v_exp_f32 v63, v63
 v_cvt_pk_bf16_f32 v118, v60, v61
 v_cvt_pk_bf16_f32 v119, v62, v63
 v_mfma_f32_32x32x16_bf16 v[48:63], v[196:199], v[168:171], v[80:95]
 v_exp_f32 v64, v64
 v_exp_f32 v65, v65
 v_exp_f32 v66, v66
 v_exp_f32 v67, v67
 v_mfma_f32_32x32x16_bf16 v[136:151], v[188:191], v[112:115], v[136:151]
 ds_read_b128 v[212:215], v220 offset:14336
 v_cvt_pk_bf16_f32 v120, v64, v65
 v_exp_f32 v68, v68
 v_exp_f32 v69, v69
 v_cvt_pk_bf16_f32 v121, v66, v67
 v_mfma_f32_16x16x32_bf16 v[128:131], v[184:187], v[112:115], v[128:131]
 ds_read_b128 v[204:207], v220 offset:12288
 v_exp_f32 v70, v70
 v_exp_f32 v71, v71
 v_cvt_pk_bf16_f32 v122, v68, v69
 v_exp_f32_e64 v72, v72
 v_mfma_f32_32x32x16_bf16 v[48:63], v[200:203], v[172:175], v[48:63]
 ds_read_b128 v[216:219], v220 offset:15360
 v_exp_f32_e64 v73, v73
 v_cvt_pk_bf16_f32 v123, v70, v71
 v_exp_f32 v74, v74
 v_exp_f32 v75, v75
 v_mfma_f32_32x32x16_bf16 v[136:151], v[192:195], v[116:119], v[136:151]
 ds_read_b128 v[208:211], v220 offset:13312
 v_cvt_pk_bf16_f32 v124, v72, v73
 v_exp_f32 v76, v76
 v_exp_f32 v77, v77
 v_cvt_pk_bf16_f32 v125, v74, v75
 v_mfma_f32_16x16x32_bf16 v[128:131], v[184:187], v[116:119], v[128:131]
 v_readlane_b32 s42, v240, s17
 v_exp_f32 v78, v78
 v_exp_f32 v79, v79
 v_cvt_pk_bf16_f32 v126, v76, v77
 v_cvt_pk_bf16_f32 v127, v78, v79
 v_mfma_f32_32x32x16_bf16 v[64:79], v[196:199], v[176:179], v[96:111]
 s_add_u32 m0, s43, s56
 v_exp_f32_e64 v48, v48
 v_exp_f32 v49, v49
 v_exp_f32 v50, v50
 v_exp_f32 v51, v51
 v_mfma_f32_32x32x16_bf16 v[152:167], v[188:191], v[120:123], v[152:167]
 s_add_u32 s43, s43, 16384
 v_cvt_pk_bf16_f32 v112, v48, v49
 v_exp_f32 v52, v52
 v_exp_f32 v53, v53
 v_cvt_pk_bf16_f32 v113, v50, v51
 v_mfma_f32_16x16x32_bf16 v[132:135], v[184:187], v[120:123], v[132:135]
 s_and_b32 s43, s43, 0xffff
 v_exp_f32 v54, v54
 v_exp_f32 v55, v55
 v_cvt_pk_bf16_f32 v114, v52, v53
 v_exp_f32_e64 v56, v56
 v_mfma_f32_32x32x16_bf16 v[64:79], v[200:203], v[180:183], v[64:79]
 v_exp_f32_e64 v57, v57
 v_cvt_pk_bf16_f32 v115, v54, v55
 v_exp_f32 v58, v58
 v_exp_f32 v59, v59
 v_mfma_f32_32x32x16_bf16 v[152:167], v[192:195], v[124:127], v[152:167]
 s_waitcnt lgkmcnt(0)
 s_nop 0
 v_cvt_pk_bf16_f32 v116, v56, v57
 v_exp_f32 v60, v60
 v_exp_f32 v61, v61
 v_cvt_pk_bf16_f32 v117, v58, v59
 v_mfma_f32_16x16x32_bf16 v[132:135], v[184:187], v[124:127], v[132:135]
 v_exp_f32 v62, v62
 v_exp_f32 v63, v63
 v_cvt_pk_bf16_f32 v118, v60, v61
 v_cvt_pk_bf16_f32 v119, v62, v63
 v_mfma_f32_32x32x16_bf16 v[48:63], v[212:215], v[168:171], v[80:95]
 s_waitcnt vmcnt(19)
 v_exp_f32_e64 v64, v64
 v_exp_f32 v65, v65
 v_exp_f32 v66, v66
 v_exp_f32 v67, v67
 v_mfma_f32_32x32x16_bf16 v[136:151], v[204:207], v[112:115], v[136:151]
 s_barrier
 s_nop 0
 v_cvt_pk_bf16_f32 v120, v64, v65
 v_exp_f32 v68, v68
 v_exp_f32 v69, v69
 v_cvt_pk_bf16_f32 v121, v66, v67
 v_mfma_f32_16x16x32_bf16 v[128:131], v[184:187], v[112:115], v[128:131]
 ds_read_b128 v[196:199], v220 offset:18432
 v_exp_f32 v70, v70
 v_exp_f32 v71, v71
 v_cvt_pk_bf16_f32 v122, v68, v69
 v_exp_f32_e64 v72, v72
 v_mfma_f32_32x32x16_bf16 v[48:63], v[216:219], v[172:175], v[48:63]
 ds_read_b128 v[188:191], v220 offset:16384
 v_exp_f32_e64 v73, v73
 v_cvt_pk_bf16_f32 v123, v70, v71
 v_exp_f32 v74, v74
 v_exp_f32 v75, v75
 v_mfma_f32_32x32x16_bf16 v[136:151], v[208:211], v[116:119], v[136:151]
 ds_read_b128 v[200:203], v220 offset:19456
 v_cvt_pk_bf16_f32 v124, v72, v73
 v_exp_f32 v76, v76
 v_exp_f32 v77, v77
 v_cvt_pk_bf16_f32 v125, v74, v75
 v_mfma_f32_16x16x32_bf16 v[128:131], v[184:187], v[116:119], v[128:131]
 ds_read_b128 v[192:195], v220 offset:17408
 v_exp_f32 v78, v78
 v_exp_f32 v79, v79
 v_cvt_pk_bf16_f32 v126, v76, v77
 v_cvt_pk_bf16_f32 v127, v78, v79
 v_mfma_f32_32x32x16_bf16 v[64:79], v[212:215], v[176:179], v[96:111]
 buffer_load_dwordx4 v244, s[52:55], s42 offen offset:0 lds
 v_exp_f32 v48, v48
 v_exp_f32 v49, v49
 v_exp_f32 v50, v50
 v_exp_f32 v51, v51
 v_mfma_f32_32x32x16_bf16 v[152:167], v[204:207], v[120:123], v[152:167]
 buffer_load_dwordx4 v245, s[52:55], s42 offen offset:1024 lds
 v_cvt_pk_bf16_f32 v112, v48, v49
 v_exp_f32 v52, v52
 v_exp_f32 v53, v53
 v_cvt_pk_bf16_f32 v113, v50, v51
 v_mfma_f32_16x16x32_bf16 v[132:135], v[184:187], v[120:123], v[132:135]
 buffer_load_dwordx4 v246, s[52:55], s42 offen offset:2048 lds
 v_exp_f32 v54, v54
 v_exp_f32 v55, v55
 v_cvt_pk_bf16_f32 v114, v52, v53
 v_exp_f32_e64 v56, v56
 v_mfma_f32_32x32x16_bf16 v[64:79], v[216:219], v[180:183], v[64:79]
 buffer_load_dwordx4 v247, s[52:55], s42 offen offset:3072 lds
 v_exp_f32_e64 v57, v57
 v_cvt_pk_bf16_f32 v115, v54, v55
 v_exp_f32 v58, v58
 v_exp_f32 v59, v59
 v_mfma_f32_32x32x16_bf16 v[152:167], v[208:211], v[124:127], v[152:167]
 s_waitcnt lgkmcnt(0)
 s_nop 0
 v_cvt_pk_bf16_f32 v116, v56, v57
 v_exp_f32 v60, v60
 v_exp_f32 v61, v61
 v_cvt_pk_bf16_f32 v117, v58, v59
 v_mfma_f32_16x16x32_bf16 v[132:135], v[184:187], v[124:127], v[132:135]
 v_exp_f32 v62, v62
 v_exp_f32 v63, v63
 v_cvt_pk_bf16_f32 v118, v60, v61
 v_cvt_pk_bf16_f32 v119, v62, v63
 v_mfma_f32_32x32x16_bf16 v[48:63], v[196:199], v[168:171], v[80:95]
 v_readlane_b32 s58, v240, s16
 v_exp_f32 v64, v64
 v_exp_f32 v65, v65
 v_exp_f32 v66, v66
 v_exp_f32 v67, v67
 v_mfma_f32_32x32x16_bf16 v[136:151], v[188:191], v[112:115], v[136:151]
 ds_read_b128 v[212:215], v220 offset:22528
 v_cvt_pk_bf16_f32 v120, v64, v65
 v_exp_f32 v68, v68
 v_exp_f32 v69, v69
 v_cvt_pk_bf16_f32 v121, v66, v67
 v_mfma_f32_16x16x32_bf16 v[128:131], v[184:187], v[112:115], v[128:131]
 ds_read_b128 v[204:207], v220 offset:20480
 v_exp_f32 v70, v70
 v_exp_f32 v71, v71
 v_cvt_pk_bf16_f32 v122, v68, v69
 v_exp_f32_e64 v72, v72
 v_mfma_f32_32x32x16_bf16 v[48:63], v[200:203], v[172:175], v[48:63]
 ds_read_b128 v[216:219], v220 offset:23552
 v_exp_f32_e64 v73, v73
 v_cvt_pk_bf16_f32 v123, v70, v71
 v_exp_f32 v74, v74
 v_exp_f32 v75, v75
 v_mfma_f32_32x32x16_bf16 v[136:151], v[192:195], v[116:119], v[136:151]
 ds_read_b128 v[208:211], v220 offset:21504
 v_cvt_pk_bf16_f32 v124, v72, v73
 v_exp_f32 v76, v76
 v_exp_f32 v77, v77
 v_cvt_pk_bf16_f32 v125, v74, v75
 v_mfma_f32_16x16x32_bf16 v[128:131], v[184:187], v[116:119], v[128:131]
 s_mov_b32 m0, s57
 v_exp_f32_e64 v78, v78
 v_exp_f32 v79, v79
 v_cvt_pk_bf16_f32 v126, v76, v77
 v_cvt_pk_bf16_f32 v127, v78, v79
 v_mfma_f32_32x32x16_bf16 v[64:79], v[196:199], v[176:179], v[96:111]
 buffer_load_dwordx4 v244, s[52:55], s58 offen offset:0 lds
 v_exp_f32 v48, v48
 v_exp_f32 v49, v49
 v_exp_f32 v50, v50
 v_exp_f32 v51, v51
 v_mfma_f32_32x32x16_bf16 v[152:167], v[188:191], v[120:123], v[152:167]
 buffer_load_dwordx4 v245, s[52:55], s58 offen offset:1024 lds
 v_cvt_pk_bf16_f32 v112, v48, v49
 v_exp_f32 v52, v52
 v_exp_f32 v53, v53
 v_cvt_pk_bf16_f32 v113, v50, v51
 v_mfma_f32_16x16x32_bf16 v[132:135], v[184:187], v[120:123], v[132:135]
 buffer_load_dwordx4 v246, s[52:55], s58 offen offset:2048 lds
 v_exp_f32 v54, v54
 v_exp_f32 v55, v55
 v_cvt_pk_bf16_f32 v114, v52, v53
 v_exp_f32_e64 v56, v56
 v_mfma_f32_32x32x16_bf16 v[64:79], v[200:203], v[180:183], v[64:79]
 buffer_load_dwordx4 v247, s[52:55], s58 offen offset:3072 lds
 v_exp_f32_e64 v57, v57
 v_cvt_pk_bf16_f32 v115, v54, v55
 v_exp_f32 v58, v58
 v_exp_f32 v59, v59
 v_mfma_f32_32x32x16_bf16 v[152:167], v[192:195], v[124:127], v[152:167]
 s_waitcnt lgkmcnt(0)
 s_nop 0
 v_cvt_pk_bf16_f32 v116, v56, v57
 v_exp_f32 v60, v60
 v_exp_f32 v61, v61
 v_cvt_pk_bf16_f32 v117, v58, v59
 v_mfma_f32_16x16x32_bf16 v[132:135], v[184:187], v[124:127], v[132:135]
 s_add_u32 s57, s57, 16384
 v_exp_f32 v62, v62
 v_exp_f32 v63, v63
 v_cvt_pk_bf16_f32 v118, v60, v61
 v_cvt_pk_bf16_f32 v119, v62, v63
 v_mfma_f32_32x32x16_bf16 v[48:63], v[212:215], v[168:171], v[80:95]
 v_exp_f32 v64, v64
 v_exp_f32 v65, v65
 v_exp_f32 v66, v66
 v_exp_f32 v67, v67
 v_mfma_f32_32x32x16_bf16 v[136:151], v[204:207], v[112:115], v[136:151]
 ds_read_b128 v[196:199], v220 offset:26624
 v_cvt_pk_bf16_f32 v120, v64, v65
 v_exp_f32 v68, v68
 v_exp_f32 v69, v69
 v_cvt_pk_bf16_f32 v121, v66, v67
 v_mfma_f32_16x16x32_bf16 v[128:131], v[184:187], v[112:115], v[128:131]
 ds_read_b128 v[188:191], v220 offset:24576
 v_exp_f32 v70, v70
 v_exp_f32 v71, v71
 v_cvt_pk_bf16_f32 v122, v68, v69
 v_exp_f32_e64 v72, v72
 v_mfma_f32_32x32x16_bf16 v[48:63], v[216:219], v[172:175], v[48:63]
 ds_read_b128 v[200:203], v220 offset:27648
 v_exp_f32_e64 v73, v73
 v_cvt_pk_bf16_f32 v123, v70, v71
 v_exp_f32 v74, v74
 v_exp_f32 v75, v75
 v_mfma_f32_32x32x16_bf16 v[136:151], v[208:211], v[116:119], v[136:151]
 ds_read_b128 v[192:195], v220 offset:25600
 v_cvt_pk_bf16_f32 v124, v72, v73
 v_exp_f32 v76, v76
 v_exp_f32 v77, v77
 v_cvt_pk_bf16_f32 v125, v74, v75
 v_mfma_f32_16x16x32_bf16 v[128:131], v[184:187], v[116:119], v[128:131]
 s_add_u32 s17, s16, 4
 v_exp_f32_e64 v78, v78
 v_exp_f32 v79, v79
 v_cvt_pk_bf16_f32 v126, v76, v77
 v_cvt_pk_bf16_f32 v127, v78, v79
 v_mfma_f32_32x32x16_bf16 v[64:79], v[212:215], v[176:179], v[96:111]
 s_add_u32 s16, s16, 1
 v_exp_f32_e64 v48, v48
 v_exp_f32 v49, v49
 v_exp_f32 v50, v50
 v_exp_f32 v51, v51
 v_mfma_f32_32x32x16_bf16 v[152:167], v[204:207], v[120:123], v[152:167]
 v_cvt_pk_bf16_f32 v112, v48, v49
 v_exp_f32 v52, v52
 v_exp_f32 v53, v53
 v_cvt_pk_bf16_f32 v113, v50, v51
 v_mfma_f32_16x16x32_bf16 v[132:135], v[184:187], v[120:123], v[132:135]
 v_exp_f32 v54, v54
 v_exp_f32 v55, v55
 v_cvt_pk_bf16_f32 v114, v52, v53
 v_exp_f32_e64 v56, v56
 v_mfma_f32_32x32x16_bf16 v[64:79], v[216:219], v[180:183], v[64:79]
 v_exp_f32_e64 v57, v57
 v_cvt_pk_bf16_f32 v115, v54, v55
 v_exp_f32 v58, v58
 v_exp_f32 v59, v59
 v_mfma_f32_32x32x16_bf16 v[152:167], v[208:211], v[124:127], v[152:167]
 s_waitcnt lgkmcnt(0)
 s_nop 0
 v_cvt_pk_bf16_f32 v116, v56, v57
 v_exp_f32 v60, v60
 v_exp_f32 v61, v61
 v_cvt_pk_bf16_f32 v117, v58, v59
 v_mfma_f32_16x16x32_bf16 v[132:135], v[184:187], v[124:127], v[132:135]
 v_exp_f32 v62, v62
 v_exp_f32 v63, v63
 v_cvt_pk_bf16_f32 v118, v60, v61
 v_cvt_pk_bf16_f32 v119, v62, v63
 v_mfma_f32_32x32x16_bf16 v[48:63], v[196:199], v[168:171], v[80:95]
 v_exp_f32 v64, v64
 v_exp_f32 v65, v65
 v_exp_f32 v66, v66
 v_exp_f32 v67, v67
 v_mfma_f32_32x32x16_bf16 v[136:151], v[188:191], v[112:115], v[136:151]
 ds_read_b128 v[212:215], v220 offset:30720
 v_cvt_pk_bf16_f32 v120, v64, v65
 v_exp_f32 v68, v68
 v_exp_f32 v69, v69
 v_cvt_pk_bf16_f32 v121, v66, v67
 v_mfma_f32_16x16x32_bf16 v[128:131], v[184:187], v[112:115], v[128:131]
 ds_read_b128 v[204:207], v220 offset:28672
 v_exp_f32 v70, v70
 v_exp_f32 v71, v71
 v_cvt_pk_bf16_f32 v122, v68, v69
 v_exp_f32_e64 v72, v72
 v_mfma_f32_32x32x16_bf16 v[48:63], v[200:203], v[172:175], v[48:63]
 ds_read_b128 v[216:219], v220 offset:31744
 v_exp_f32_e64 v73, v73
 v_cvt_pk_bf16_f32 v123, v70, v71
 v_exp_f32 v74, v74
 v_exp_f32 v75, v75
 v_mfma_f32_32x32x16_bf16 v[136:151], v[192:195], v[116:119], v[136:151]
 ds_read_b128 v[208:211], v220 offset:29696
 v_cvt_pk_bf16_f32 v124, v72, v73
 v_exp_f32 v76, v76
 v_exp_f32 v77, v77
 v_cvt_pk_bf16_f32 v125, v74, v75
 v_mfma_f32_16x16x32_bf16 v[128:131], v[184:187], v[116:119], v[128:131]
 v_readlane_b32 s42, v240, s17
 v_exp_f32 v78, v78
 v_exp_f32 v79, v79
 v_cvt_pk_bf16_f32 v126, v76, v77
 v_cvt_pk_bf16_f32 v127, v78, v79
 v_mfma_f32_32x32x16_bf16 v[64:79], v[196:199], v[176:179], v[96:111]
 s_add_u32 m0, s43, s56
 v_exp_f32_e64 v48, v48
 v_exp_f32 v49, v49
 v_exp_f32 v50, v50
 v_exp_f32 v51, v51
 v_mfma_f32_32x32x16_bf16 v[152:167], v[188:191], v[120:123], v[152:167]
 s_add_u32 s43, s43, 16384
 v_cvt_pk_bf16_f32 v112, v48, v49
 v_exp_f32 v52, v52
 v_exp_f32 v53, v53
 v_cvt_pk_bf16_f32 v113, v50, v51
 v_mfma_f32_16x16x32_bf16 v[132:135], v[184:187], v[120:123], v[132:135]
 s_and_b32 s43, s43, 0xffff
 v_exp_f32 v54, v54
 v_exp_f32 v55, v55
 v_cvt_pk_bf16_f32 v114, v52, v53
 v_exp_f32_e64 v56, v56
 v_mfma_f32_32x32x16_bf16 v[64:79], v[200:203], v[180:183], v[64:79]
 s_sub_u32 s18, s18, 1
 v_exp_f32 v57, v57
 v_cvt_pk_bf16_f32 v115, v54, v55
 v_exp_f32_e64 v58, v58
 v_exp_f32 v59, v59
 v_add_u32 v220, s43, v231
 v_mfma_f32_32x32x16_bf16 v[152:167], v[192:195], v[124:127], v[152:167]
 s_waitcnt lgkmcnt(0)
 s_nop 0
 v_cvt_pk_bf16_f32 v116, v56, v57
 v_exp_f32 v60, v60
 v_exp_f32 v61, v61
 v_cvt_pk_bf16_f32 v117, v58, v59
 v_mfma_f32_16x16x32_bf16 v[132:135], v[184:187], v[124:127], v[132:135]
 s_cmp_lg_u32 s18, 0
 v_exp_f32_e64 v62, v62
 v_exp_f32 v63, v63
 v_cvt_pk_bf16_f32 v118, v60, v61
 v_cvt_pk_bf16_f32 v119, v62, v63
 v_mfma_f32_32x32x16_bf16 v[48:63], v[212:215], v[168:171], v[80:95]
 s_waitcnt vmcnt(19)
 v_exp_f32_e64 v64, v64
 v_exp_f32 v65, v65
 v_exp_f32 v66, v66
 v_exp_f32 v67, v67
 v_mfma_f32_32x32x16_bf16 v[136:151], v[204:207], v[112:115], v[136:151]
 s_barrier
 s_nop 0
 v_cvt_pk_bf16_f32 v120, v64, v65
 v_exp_f32 v68, v68
 v_exp_f32 v69, v69
 v_cvt_pk_bf16_f32 v121, v66, v67
 v_mfma_f32_16x16x32_bf16 v[128:131], v[184:187], v[112:115], v[128:131]
 ds_read_b128 v[196:199], v220 offset:2048
 v_exp_f32 v70, v70
 v_exp_f32 v71, v71
 v_cvt_pk_bf16_f32 v122, v68, v69
 v_exp_f32_e64 v72, v72
 v_mfma_f32_32x32x16_bf16 v[48:63], v[216:219], v[172:175], v[48:63]
 ds_read_b128 v[188:191], v220 offset:0
 v_exp_f32_e64 v73, v73
 v_cvt_pk_bf16_f32 v123, v70, v71
 v_exp_f32 v74, v74
 v_exp_f32 v75, v75
 v_mfma_f32_32x32x16_bf16 v[136:151], v[208:211], v[116:119], v[136:151]
 ds_read_b128 v[200:203], v220 offset:3072
 v_cvt_pk_bf16_f32 v124, v72, v73
 v_exp_f32 v76, v76
 v_exp_f32 v77, v77
 v_cvt_pk_bf16_f32 v125, v74, v75
 v_mfma_f32_16x16x32_bf16 v[128:131], v[184:187], v[116:119], v[128:131]
 ds_read_b128 v[192:195], v220 offset:1024
 v_exp_f32 v78, v78
 v_exp_f32 v79, v79
 v_cvt_pk_bf16_f32 v126, v76, v77
 v_cvt_pk_bf16_f32 v127, v78, v79
 v_mfma_f32_32x32x16_bf16 v[64:79], v[212:215], v[176:179], v[96:111]
 buffer_load_dwordx4 v244, s[52:55], s42 offen offset:0 lds
 v_exp_f32 v48, v48
 v_exp_f32 v49, v49
 v_exp_f32 v50, v50
 v_exp_f32 v51, v51
 v_mfma_f32_32x32x16_bf16 v[152:167], v[204:207], v[120:123], v[152:167]
 buffer_load_dwordx4 v245, s[52:55], s42 offen offset:1024 lds
 v_cvt_pk_bf16_f32 v112, v48, v49
 v_exp_f32 v52, v52
 v_exp_f32 v53, v53
 v_cvt_pk_bf16_f32 v113, v50, v51
 v_mfma_f32_16x16x32_bf16 v[132:135], v[184:187], v[120:123], v[132:135]
 buffer_load_dwordx4 v246, s[52:55], s42 offen offset:2048 lds
 v_exp_f32 v54, v54
 v_exp_f32 v55, v55
 v_cvt_pk_bf16_f32 v114, v52, v53
 v_exp_f32_e64 v56, v56
 v_mfma_f32_32x32x16_bf16 v[64:79], v[216:219], v[180:183], v[64:79]
 buffer_load_dwordx4 v247, s[52:55], s42 offen offset:3072 lds
 v_exp_f32_e64 v57, v57
 v_cvt_pk_bf16_f32 v115, v54, v55
 v_exp_f32 v58, v58
 v_exp_f32 v59, v59
 v_mfma_f32_32x32x16_bf16 v[152:167], v[208:211], v[124:127], v[152:167]
 s_waitcnt lgkmcnt(0)
 s_nop 0
 v_cvt_pk_bf16_f32 v116, v56, v57
 v_exp_f32 v60, v60
 v_exp_f32 v61, v61
 v_cvt_pk_bf16_f32 v117, v58, v59
 v_mfma_f32_16x16x32_bf16 v[132:135], v[184:187], v[124:127], v[132:135]
 s_cbranch_scc1 m_kernel_l4
 s_lshl_b32 s16, s15, 15
 s_lshl_b32 s17, s13, 11
 s_add_u32 s16, s16, s17
 v_rcp_f32 v4, v128
 s_nop 0
 v_mov_b32 v5, v4
 v_pk_mul_f32 v[136:137], v[136:137], v[4:5]
 v_pk_mul_f32 v[138:139], v[138:139], v[4:5]
 v_pk_mul_f32 v[140:141], v[140:141], v[4:5]
 v_pk_mul_f32 v[142:143], v[142:143], v[4:5]
 v_cvt_pk_bf16_f32 v136, v136, v137
 v_cvt_pk_bf16_f32 v137, v138, v139
 v_cvt_pk_bf16_f32 v138, v140, v141
 v_cvt_pk_bf16_f32 v139, v142, v143
 buffer_store_dwordx4 v[136:139], v233, s[36:39], s16 offen offset:0 sc1
 v_pk_mul_f32 v[144:145], v[144:145], v[4:5]
 v_pk_mul_f32 v[146:147], v[146:147], v[4:5]
 v_pk_mul_f32 v[148:149], v[148:149], v[4:5]
 v_pk_mul_f32 v[150:151], v[150:151], v[4:5]
 v_cvt_pk_bf16_f32 v144, v144, v145
 v_cvt_pk_bf16_f32 v145, v146, v147
 v_cvt_pk_bf16_f32 v146, v148, v149
 v_cvt_pk_bf16_f32 v147, v150, v151
 buffer_store_dwordx4 v[144:147], v233, s[36:39], s16 offen offset:512 sc1
 v_rcp_f32 v4, v132
 s_nop 0
 v_mov_b32 v5, v4
 v_pk_mul_f32 v[152:153], v[152:153], v[4:5]
 v_pk_mul_f32 v[154:155], v[154:155], v[4:5]
 v_pk_mul_f32 v[156:157], v[156:157], v[4:5]
 v_pk_mul_f32 v[158:159], v[158:159], v[4:5]
 v_cvt_pk_bf16_f32 v152, v152, v153
 v_cvt_pk_bf16_f32 v153, v154, v155
 v_cvt_pk_bf16_f32 v154, v156, v157
 v_cvt_pk_bf16_f32 v155, v158, v159
 buffer_store_dwordx4 v[152:155], v233, s[36:39], s16 offen offset:1024 sc1
 v_pk_mul_f32 v[160:161], v[160:161], v[4:5]
 v_pk_mul_f32 v[162:163], v[162:163], v[4:5]
 v_pk_mul_f32 v[164:165], v[164:165], v[4:5]
 v_pk_mul_f32 v[166:167], v[166:167], v[4:5]
 v_cvt_pk_bf16_f32 v160, v160, v161
 v_cvt_pk_bf16_f32 v161, v162, v163
 v_cvt_pk_bf16_f32 v162, v164, v165
 v_cvt_pk_bf16_f32 v163, v166, v167
 buffer_store_dwordx4 v[160:163], v233, s[36:39], s16 offen offset:1536 sc1
 v_lshl_add_u32 v51, v0, 4, s16
 s_mov_b32 s16, 0x5d800000
 v_cmp_nle_f32 vcc, v128, s16
 v_cmp_nle_f32 s[18:19], v132, s16
 s_nop 0
 s_or_b64 vcc, vcc, s[18:19]
 s_cmp_lg_u64 vcc, 0
 s_cselect_b32 s16, 1, 0
 v_mov_b32 v1, s16
 s_lshl_b32 s16, s3, 2
 s_add_u32 s16, s16, 159744
 v_mov_b32 v2, s16
 ds_write_b32 v2, v1
 s_mul_i32 s18, s15, 32768
 v_lshl_add_u32 v40, v0, 4, s18
 v_add_u32 v41, 32768, v40
 s_mov_b32 s41, 0
 v_lshrrev_b32 v1, 5, v0
 v_lshlrev_b32 v1, 4, v1
 v_bfe_u32 v2, v0, 4, 1
 v_lshl_add_u32 v1, v2, 2, v1
 v_bfe_u32 v2, v0, 2, 2
 v_add_u32 v1, v1, v2
 v_lshlrev_b32 v1, 7, v1
 v_and_b32 v2, 3, v0
 v_lshl_add_u32 v1, v2, 3, v1
 v_bfe_u32 v2, v0, 3, 2
 v_xor_b32 v42, 0, v2
 v_lshl_add_u32 v42, v42, 5, v1
 v_add_u32 v46, 65536, v42
 v_xor_b32 v43, 1, v2
 v_lshl_add_u32 v43, v43, 5, v1
 v_add_u32 v47, 65536, v43
 v_xor_b32 v44, 2, v2
 v_lshl_add_u32 v44, v44, 5, v1
 v_add_u32 v48, 65536, v44
 v_xor_b32 v45, 3, v2
 v_lshl_add_u32 v45, v45, 5, v1
 v_add_u32 v49, 65536, v45
 v_readlane_b32 s41, v241, 0
 s_add_u32 s28, s8, 0x20000
 s_addc_u32 s29, s9, 0
 s_mov_b32 s30, 0x30000
 s_mov_b32 s31, 0x00020000
 v_mov_b32 v2, 159744
 s_waitcnt vmcnt(0) lgkmcnt(0)
 s_barrier
 ds_read_b128 v[4:7], v2
 s_waitcnt lgkmcnt(0)
 v_or3_b32 v4, v4, v5, v6
 v_or_b32 v4, v4, v7
 s_nop 0
 v_readfirstlane_b32 s16, v4
 s_nop 0
 s_cmp_gt_u32 s16, s12
 s_cbranch_scc1 m_kernel_fb
 s_cmp_lg_u32 s3, 0
 s_cbranch_scc1 m_kernel_pub5
 v_mov_b32 v250, s59
 s_mov_b64 exec, 3
 buffer_store_dword v250, v248, s[28:31], 0 offen sc1
 s_mov_b64 exec, -1
m_kernel_pub5:
 s_mov_b32 s42, 32768
 v_accvgpr_read_b32 v52, a208
 v_accvgpr_read_b32 v53, a209
 v_accvgpr_read_b32 v54, a210
 v_accvgpr_read_b32 v55, a211
 v_accvgpr_read_b32 v56, a212
 v_accvgpr_read_b32 v57, a213
 v_accvgpr_read_b32 v58, a214
 v_accvgpr_read_b32 v59, a215
 v_accvgpr_read_b32 v60, a216
 v_accvgpr_read_b32 v61, a217
 v_accvgpr_read_b32 v62, a218
 v_accvgpr_read_b32 v63, a219
 v_accvgpr_read_b32 v64, a220
 v_accvgpr_read_b32 v65, a221
 v_accvgpr_read_b32 v66, a222
 v_accvgpr_read_b32 v67, a223
 v_accvgpr_read_b32 v68, a224
 v_and_b32 v69, 0xffff0000, v68
 v_lshlrev_b32 v68, 16, v68
 v_accvgpr_read_b32 v70, a225
 v_and_b32 v71, 0xffff0000, v70
 v_lshlrev_b32 v70, 16, v70
 v_accvgpr_read_b32 v72, a226
 v_and_b32 v73, 0xffff0000, v72
 v_lshlrev_b32 v72, 16, v72
 v_accvgpr_read_b32 v74, a227
 v_and_b32 v75, 0xffff0000, v74
 v_lshlrev_b32 v74, 16, v74
 v_accvgpr_read_b32 v76, a228
 v_and_b32 v77, 0xffff0000, v76
 v_lshlrev_b32 v76, 16, v76
 v_accvgpr_read_b32 v78, a229
 v_and_b32 v79, 0xffff0000, v78
 v_lshlrev_b32 v78, 16, v78
 v_accvgpr_read_b32 v80, a230
 v_and_b32 v81, 0xffff0000, v80
 v_lshlrev_b32 v80, 16, v80
 v_accvgpr_read_b32 v82, a231
 v_and_b32 v83, 0xffff0000, v82
 v_lshlrev_b32 v82, 16, v82
 v_accvgpr_read_b32 v84, a232
 v_and_b32 v85, 0xffff0000, v84
 v_lshlrev_b32 v84, 16, v84
 v_accvgpr_read_b32 v86, a233
 v_and_b32 v87, 0xffff0000, v86
 v_lshlrev_b32 v86, 16, v86
 v_accvgpr_read_b32 v88, a234
 v_and_b32 v89, 0xffff0000, v88
 v_lshlrev_b32 v88, 16, v88
 v_accvgpr_read_b32 v90, a235
 v_and_b32 v91, 0xffff0000, v90
 v_lshlrev_b32 v90, 16, v90
 v_accvgpr_read_b32 v92, a236
 v_and_b32 v93, 0xffff0000, v92
 v_lshlrev_b32 v92, 16, v92
 v_accvgpr_read_b32 v94, a237
 v_and_b32 v95, 0xffff0000, v94
 v_lshlrev_b32 v94, 16, v94
 v_accvgpr_read_b32 v96, a238
 v_and_b32 v97, 0xffff0000, v96
 v_lshlrev_b32 v96, 16, v96
 v_accvgpr_read_b32 v98, a239
 v_and_b32 v99, 0xffff0000, v98
 v_lshlrev_b32 v98, 16, v98
 s_mov_b32 s16, 0x8000
 s_cmp_lg_u32 s3, 1
 s_cbranch_scc1 m_kernel_poll6x
m_kernel_poll6:
 buffer_load_dword v250, v249, s[28:31], 0 offen sc1
 s_sub_u32 s16, s16, 1
 s_waitcnt vmcnt(0)
 v_cmp_ne_u32 vcc, s59, v250
 s_nop 0
 s_cselect_b64 vcc, 0, vcc
 s_cbranch_vccnz m_kernel_poll6
m_kernel_poll6x:
 s_barrier
 buffer_load_dwordx4 a[48:51], v40, s[36:39], s41 offen sc1
 buffer_load_dwordx4 a[52:55], v41, s[36:39], s41 offen sc1
 buffer_load_dwordx4 a[56:59], v40, s[36:39], s41 offen offset:1024 sc1
 buffer_load_dwordx4 a[60:63], v41, s[36:39], s41 offen offset:1024 sc1
 buffer_load_dwordx4 a[64:67], v40, s[36:39], s41 offen offset:2048 sc1
 buffer_load_dwordx4 a[68:71], v41, s[36:39], s41 offen offset:2048 sc1
 buffer_load_dwordx4 a[72:75], v40, s[36:39], s41 offen offset:3072 sc1
 buffer_load_dwordx4 a[76:79], v41, s[36:39], s41 offen offset:3072 sc1
 v_readlane_b32 s41, v241, 1
 s_nop 4
 buffer_load_dwordx4 a[80:83], v40, s[36:39], s41 offen sc1
 buffer_load_dwordx4 a[84:87], v41, s[36:39], s41 offen sc1
 buffer_load_dwordx4 a[88:91], v40, s[36:39], s41 offen offset:1024 sc1
 buffer_load_dwordx4 a[92:95], v41, s[36:39], s41 offen offset:1024 sc1
 buffer_load_dwordx4 a[96:99], v40, s[36:39], s41 offen offset:2048 sc1
 buffer_load_dwordx4 a[100:103], v41, s[36:39], s41 offen offset:2048 sc1
 buffer_load_dwordx4 a[104:107], v40, s[36:39], s41 offen offset:3072 sc1
 buffer_load_dwordx4 a[108:111], v41, s[36:39], s41 offen offset:3072 sc1
 v_readlane_b32 s41, v241, 2
 s_nop 4
 buffer_load_dwordx4 a[112:115], v40, s[36:39], s41 offen sc1
 buffer_load_dwordx4 a[116:119], v41, s[36:39], s41 offen sc1
 buffer_load_dwordx4 a[120:123], v40, s[36:39], s41 offen offset:1024 sc1
 buffer_load_dwordx4 a[124:127], v41, s[36:39], s41 offen offset:1024 sc1
 buffer_load_dwordx4 a[128:131], v40, s[36:39], s41 offen offset:2048 sc1
 buffer_load_dwordx4 a[132:135], v41, s[36:39], s41 offen offset:2048 sc1
 buffer_load_dwordx4 a[136:139], v40, s[36:39], s41 offen offset:3072 sc1
 buffer_load_dwordx4 a[140:143], v41, s[36:39], s41 offen offset:3072 sc1
 v_readlane_b32 s41, v241, 3
 s_nop 4
 buffer_load_dwordx4 a[144:147], v40, s[36:39], s41 offen sc1
 buffer_load_dwordx4 a[148:151], v41, s[36:39], s41 offen sc1
 buffer_load_dwordx4 a[152:155], v40, s[36:39], s41 offen offset:1024 sc1
 buffer_load_dwordx4 a[156:159], v41, s[36:39], s41 offen offset:1024 sc1
 buffer_load_dwordx4 a[160:163], v40, s[36:39], s41 offen offset:2048 sc1
 buffer_load_dwordx4 a[164:167], v41, s[36:39], s41 offen offset:2048 sc1
 buffer_load_dwordx4 a[168:171], v40, s[36:39], s41 offen offset:3072 sc1
 buffer_load_dwordx4 a[172:175], v41, s[36:39], s41 offen offset:3072 sc1
 v_readlane_b32 s41, v241, 4
 ds_read_b64_tr_b16 a[0:1], v42 offset:0
 ds_read_b64_tr_b16 a[2:3], v42 offset:1024
 ds_read_b64_tr_b16 a[4:5], v43 offset:0
 ds_read_b64_tr_b16 a[6:7], v43 offset:1024
 ds_read_b64_tr_b16 a[8:9], v44 offset:0
 ds_read_b64_tr_b16 a[10:11], v44 offset:1024
 ds_read_b64_tr_b16 a[12:13], v45 offset:0
 ds_read_b64_tr_b16 a[14:15], v45 offset:1024
 ds_read_b64_tr_b16 a[16:17], v42 offset:4096
 ds_read_b64_tr_b16 a[18:19], v42 offset:5120
 ds_read_b64_tr_b16 a[20:21], v43 offset:4096
 ds_read_b64_tr_b16 a[22:23], v43 offset:5120
 ds_read_b64_tr_b16 a[24:25], v44 offset:4096
 ds_read_b64_tr_b16 a[26:27], v44 offset:5120
 ds_read_b64_tr_b16 a[28:29], v45 offset:4096
 ds_read_b64_tr_b16 a[30:31], v45 offset:5120
 s_waitcnt vmcnt(30)
 s_waitcnt lgkmcnt(8)
 v_mfma_f32_16x16x32_bf16 v[4:7], a[0:3], a[48:51], 0
 ds_read_b64_tr_b16 a[32:33], v42 offset:8192
 v_mfma_f32_16x16x32_bf16 v[8:11], a[0:3], a[52:55], 0
 ds_read_b64_tr_b16 a[34:35], v42 offset:9216
 v_mfma_f32_16x16x32_bf16 v[16:19], a[4:7], a[52:55], 0
 ds_read_b64_tr_b16 a[36:37], v43 offset:8192
 v_mfma_f32_16x16x32_bf16 v[12:15], a[4:7], a[48:51], 0
 ds_read_b64_tr_b16 a[38:39], v43 offset:9216
 s_waitcnt vmcnt(28) lgkmcnt(4)
 v_mfma_f32_16x16x32_bf16 v[20:23], a[8:11], a[48:51], 0
 ds_read_b64_tr_b16 a[40:41], v44 offset:8192
 v_mfma_f32_16x16x32_bf16 v[24:27], a[8:11], a[52:55], 0
 ds_read_b64_tr_b16 a[42:43], v44 offset:9216
 v_mfma_f32_16x16x32_bf16 v[32:35], a[12:15], a[52:55], 0
 ds_read_b64_tr_b16 a[44:45], v45 offset:8192
 v_mfma_f32_16x16x32_bf16 v[28:31], a[12:15], a[48:51], 0
 ds_read_b64_tr_b16 a[46:47], v45 offset:9216
 v_mfma_f32_16x16x32_bf16 v[4:7], a[16:19], a[56:59], v[4:7]
 ds_read_b64_tr_b16 a[0:1], v42 offset:12288
 v_mfma_f32_16x16x32_bf16 v[8:11], a[16:19], a[60:63], v[8:11]
 ds_read_b64_tr_b16 a[2:3], v42 offset:13312
 v_mfma_f32_16x16x32_bf16 v[16:19], a[20:23], a[60:63], v[16:19]
 ds_read_b64_tr_b16 a[4:5], v43 offset:12288
 buffer_load_dwordx4 a[48:51], v40, s[36:39], s41 offen sc1
 v_mfma_f32_16x16x32_bf16 v[12:15], a[20:23], a[56:59], v[12:15]
 ds_read_b64_tr_b16 a[6:7], v43 offset:13312
 s_waitcnt vmcnt(27) lgkmcnt(4)
 v_mfma_f32_16x16x32_bf16 v[20:23], a[24:27], a[56:59], v[20:23]
 ds_read_b64_tr_b16 a[8:9], v44 offset:12288
 v_mfma_f32_16x16x32_bf16 v[24:27], a[24:27], a[60:63], v[24:27]
 ds_read_b64_tr_b16 a[10:11], v44 offset:13312
 buffer_load_dwordx4 a[52:55], v41, s[36:39], s41 offen sc1
 v_mfma_f32_16x16x32_bf16 v[32:35], a[28:31], a[60:63], v[32:35]
 ds_read_b64_tr_b16 a[12:13], v45 offset:12288
 v_mfma_f32_16x16x32_bf16 v[28:31], a[28:31], a[56:59], v[28:31]
 ds_read_b64_tr_b16 a[14:15], v45 offset:13312
 v_mfma_f32_16x16x32_bf16 v[4:7], a[32:35], a[64:67], v[4:7]
 ds_read_b64_tr_b16 a[16:17], v42 offset:16384
 v_mfma_f32_16x16x32_bf16 v[8:11], a[32:35], a[68:71], v[8:11]
 ds_read_b64_tr_b16 a[18:19], v42 offset:17408
 v_mfma_f32_16x16x32_bf16 v[16:19], a[36:39], a[68:71], v[16:19]
 ds_read_b64_tr_b16 a[20:21], v43 offset:16384
 buffer_load_dwordx4 a[56:59], v40, s[36:39], s41 offen offset:1024 sc1
 v_mfma_f32_16x16x32_bf16 v[12:15], a[36:39], a[64:67], v[12:15]
 ds_read_b64_tr_b16 a[22:23], v43 offset:17408
 s_waitcnt vmcnt(27) lgkmcnt(4)
 v_mfma_f32_16x16x32_bf16 v[20:23], a[40:43], a[64:67], v[20:23]
 ds_read_b64_tr_b16 a[24:25], v44 offset:16384
 v_mfma_f32_16x16x32_bf16 v[24:27], a[40:43], a[68:71], v[24:27]
 ds_read_b64_tr_b16 a[26:27], v44 offset:17408
 buffer_load_dwordx4 a[60:63], v41, s[36:39], s41 offen offset:1024 sc1
 v_mfma_f32_16x16x32_bf16 v[32:35], a[44:47], a[68:71], v[32:35]
 ds_read_b64_tr_b16 a[28:29], v45 offset:16384
 v_mfma_f32_16x16x32_bf16 v[28:31], a[44:47], a[64:67], v[28:31]
 ds_read_b64_tr_b16 a[30:31], v45 offset:17408
 v_mfma_f32_16x16x32_bf16 v[4:7], a[0:3], a[72:75], v[4:7]
 ds_read_b64_tr_b16 a[32:33], v42 offset:20480
 v_mfma_f32_16x16x32_bf16 v[8:11], a[0:3], a[76:79], v[8:11]
 ds_read_b64_tr_b16 a[34:35], v42 offset:21504
 v_mfma_f32_16x16x32_bf16 v[16:19], a[4:7], a[76:79], v[16:19]
 ds_read_b64_tr_b16 a[36:37], v43 offset:20480
 buffer_load_dwordx4 a[64:67], v40, s[36:39], s41 offen offset:2048 sc1
 v_mfma_f32_16x16x32_bf16 v[12:15], a[4:7], a[72:75], v[12:15]
 ds_read_b64_tr_b16 a[38:39], v43 offset:21504
 s_waitcnt vmcnt(27) lgkmcnt(4)
 v_mfma_f32_16x16x32_bf16 v[20:23], a[8:11], a[72:75], v[20:23]
 ds_read_b64_tr_b16 a[40:41], v44 offset:20480
 v_mfma_f32_16x16x32_bf16 v[24:27], a[8:11], a[76:79], v[24:27]
 ds_read_b64_tr_b16 a[42:43], v44 offset:21504
 buffer_load_dwordx4 a[68:71], v41, s[36:39], s41 offen offset:2048 sc1
 v_mfma_f32_16x16x32_bf16 v[32:35], a[12:15], a[76:79], v[32:35]
 ds_read_b64_tr_b16 a[44:45], v45 offset:20480
 v_mfma_f32_16x16x32_bf16 v[28:31], a[12:15], a[72:75], v[28:31]
 ds_read_b64_tr_b16 a[46:47], v45 offset:21504
 v_mfma_f32_16x16x32_bf16 v[4:7], a[16:19], a[80:83], v[4:7]
 ds_read_b64_tr_b16 a[0:1], v42 offset:24576
 v_mfma_f32_16x16x32_bf16 v[8:11], a[16:19], a[84:87], v[8:11]
 ds_read_b64_tr_b16 a[2:3], v42 offset:25600
 v_mfma_f32_16x16x32_bf16 v[16:19], a[20:23], a[84:87], v[16:19]
 ds_read_b64_tr_b16 a[4:5], v43 offset:24576
 buffer_load_dwordx4 a[72:75], v40, s[36:39], s41 offen offset:3072 sc1
 v_mfma_f32_16x16x32_bf16 v[12:15], a[20:23], a[80:83], v[12:15]
 ds_read_b64_tr_b16 a[6:7], v43 offset:25600
 s_waitcnt vmcnt(27) lgkmcnt(4)
 v_mfma_f32_16x16x32_bf16 v[20:23], a[24:27], a[80:83], v[20:23]
 ds_read_b64_tr_b16 a[8:9], v44 offset:24576
 v_mfma_f32_16x16x32_bf16 v[24:27], a[24:27], a[84:87], v[24:27]
 ds_read_b64_tr_b16 a[10:11], v44 offset:25600
 buffer_load_dwordx4 a[76:79], v41, s[36:39], s41 offen offset:3072 sc1
 v_readlane_b32 s41, v241, 5
 v_mfma_f32_16x16x32_bf16 v[32:35], a[28:31], a[84:87], v[32:35]
 ds_read_b64_tr_b16 a[12:13], v45 offset:24576
 v_mfma_f32_16x16x32_bf16 v[28:31], a[28:31], a[80:83], v[28:31]
 ds_read_b64_tr_b16 a[14:15], v45 offset:25600
 v_mfma_f32_16x16x32_bf16 v[4:7], a[32:35], a[88:91], v[4:7]
 ds_read_b64_tr_b16 a[16:17], v42 offset:28672
 v_mfma_f32_16x16x32_bf16 v[8:11], a[32:35], a[92:95], v[8:11]
 ds_read_b64_tr_b16 a[18:19], v42 offset:29696
 v_mfma_f32_16x16x32_bf16 v[16:19], a[36:39], a[92:95], v[16:19]
 ds_read_b64_tr_b16 a[20:21], v43 offset:28672
 buffer_load_dwordx4 a[80:83], v40, s[36:39], s41 offen sc1
 v_mfma_f32_16x16x32_bf16 v[12:15], a[36:39], a[88:91], v[12:15]
 ds_read_b64_tr_b16 a[22:23], v43 offset:29696
 s_waitcnt vmcnt(27) lgkmcnt(4)
 v_mfma_f32_16x16x32_bf16 v[20:23], a[40:43], a[88:91], v[20:23]
 ds_read_b64_tr_b16 a[24:25], v44 offset:28672
 v_mfma_f32_16x16x32_bf16 v[24:27], a[40:43], a[92:95], v[24:27]
 ds_read_b64_tr_b16 a[26:27], v44 offset:29696
 buffer_load_dwordx4 a[84:87], v41, s[36:39], s41 offen sc1
 v_mfma_f32_16x16x32_bf16 v[32:35], a[44:47], a[92:95], v[32:35]
 ds_read_b64_tr_b16 a[28:29], v45 offset:28672
 v_mfma_f32_16x16x32_bf16 v[28:31], a[44:47], a[88:91], v[28:31]
 ds_read_b64_tr_b16 a[30:31], v45 offset:29696
 v_mfma_f32_16x16x32_bf16 v[4:7], a[0:3], a[96:99], v[4:7]
 ds_read_b64_tr_b16 a[32:33], v42 offset:32768
 v_mfma_f32_16x16x32_bf16 v[8:11], a[0:3], a[100:103], v[8:11]
 ds_read_b64_tr_b16 a[34:35], v42 offset:33792
 v_mfma_f32_16x16x32_bf16 v[16:19], a[4:7], a[100:103], v[16:19]
 ds_read_b64_tr_b16 a[36:37], v43 offset:32768
 buffer_load_dwordx4 a[88:91], v40, s[36:39], s41 offen offset:1024 sc1
 v_mfma_f32_16x16x32_bf16 v[12:15], a[4:7], a[96:99], v[12:15]
 ds_read_b64_tr_b16 a[38:39], v43 offset:33792
 s_waitcnt vmcnt(27) lgkmcnt(4)
 v_mfma_f32_16x16x32_bf16 v[20:23], a[8:11], a[96:99], v[20:23]
 ds_read_b64_tr_b16 a[40:41], v44 offset:32768
 v_mfma_f32_16x16x32_bf16 v[24:27], a[8:11], a[100:103], v[24:27]
 ds_read_b64_tr_b16 a[42:43], v44 offset:33792
 buffer_load_dwordx4 a[92:95], v41, s[36:39], s41 offen offset:1024 sc1
 v_mfma_f32_16x16x32_bf16 v[32:35], a[12:15], a[100:103], v[32:35]
 ds_read_b64_tr_b16 a[44:45], v45 offset:32768
 v_mfma_f32_16x16x32_bf16 v[28:31], a[12:15], a[96:99], v[28:31]
 ds_read_b64_tr_b16 a[46:47], v45 offset:33792
 v_mfma_f32_16x16x32_bf16 v[4:7], a[16:19], a[104:107], v[4:7]
 ds_read_b64_tr_b16 a[0:1], v42 offset:36864
 v_mfma_f32_16x16x32_bf16 v[8:11], a[16:19], a[108:111], v[8:11]
 ds_read_b64_tr_b16 a[2:3], v42 offset:37888
 v_mfma_f32_16x16x32_bf16 v[16:19], a[20:23], a[108:111], v[16:19]
 ds_read_b64_tr_b16 a[4:5], v43 offset:36864
 buffer_load_dwordx4 a[96:99], v40, s[36:39], s41 offen offset:2048 sc1
 v_mfma_f32_16x16x32_bf16 v[12:15], a[20:23], a[104:107], v[12:15]
 ds_read_b64_tr_b16 a[6:7], v43 offset:37888
 s_waitcnt vmcnt(27) lgkmcnt(4)
 v_mfma_f32_16x16x32_bf16 v[20:23], a[24:27], a[104:107], v[20:23]
 ds_read_b64_tr_b16 a[8:9], v44 offset:36864
 v_mfma_f32_16x16x32_bf16 v[24:27], a[24:27], a[108:111], v[24:27]
 ds_read_b64_tr_b16 a[10:11], v44 offset:37888
 buffer_load_dwordx4 a[100:103], v41, s[36:39], s41 offen offset:2048 sc1
 v_mfma_f32_16x16x32_bf16 v[32:35], a[28:31], a[108:111], v[32:35]
 ds_read_b64_tr_b16 a[12:13], v45 offset:36864
 v_mfma_f32_16x16x32_bf16 v[28:31], a[28:31], a[104:107], v[28:31]
 ds_read_b64_tr_b16 a[14:15], v45 offset:37888
 v_mfma_f32_16x16x32_bf16 v[4:7], a[32:35], a[112:115], v[4:7]
 ds_read_b64_tr_b16 a[16:17], v42 offset:40960
 v_mfma_f32_16x16x32_bf16 v[8:11], a[32:35], a[116:119], v[8:11]
 ds_read_b64_tr_b16 a[18:19], v42 offset:41984
 v_mfma_f32_16x16x32_bf16 v[16:19], a[36:39], a[116:119], v[16:19]
 ds_read_b64_tr_b16 a[20:21], v43 offset:40960
 buffer_load_dwordx4 a[104:107], v40, s[36:39], s41 offen offset:3072 sc1
 v_mfma_f32_16x16x32_bf16 v[12:15], a[36:39], a[112:115], v[12:15]
 ds_read_b64_tr_b16 a[22:23], v43 offset:41984
 s_waitcnt vmcnt(27) lgkmcnt(4)
 v_mfma_f32_16x16x32_bf16 v[20:23], a[40:43], a[112:115], v[20:23]
 ds_read_b64_tr_b16 a[24:25], v44 offset:40960
 v_mfma_f32_16x16x32_bf16 v[24:27], a[40:43], a[116:119], v[24:27]
 ds_read_b64_tr_b16 a[26:27], v44 offset:41984
 buffer_load_dwordx4 a[108:111], v41, s[36:39], s41 offen offset:3072 sc1
 v_readlane_b32 s41, v241, 6
 v_mfma_f32_16x16x32_bf16 v[32:35], a[44:47], a[116:119], v[32:35]
 ds_read_b64_tr_b16 a[28:29], v45 offset:40960
 v_mfma_f32_16x16x32_bf16 v[28:31], a[44:47], a[112:115], v[28:31]
 ds_read_b64_tr_b16 a[30:31], v45 offset:41984
 v_mfma_f32_16x16x32_bf16 v[4:7], a[0:3], a[120:123], v[4:7]
 ds_read_b64_tr_b16 a[32:33], v42 offset:45056
 v_mfma_f32_16x16x32_bf16 v[8:11], a[0:3], a[124:127], v[8:11]
 ds_read_b64_tr_b16 a[34:35], v42 offset:46080
 v_mfma_f32_16x16x32_bf16 v[16:19], a[4:7], a[124:127], v[16:19]
 ds_read_b64_tr_b16 a[36:37], v43 offset:45056
 buffer_load_dwordx4 a[112:115], v40, s[36:39], s41 offen sc1
 v_mfma_f32_16x16x32_bf16 v[12:15], a[4:7], a[120:123], v[12:15]
 ds_read_b64_tr_b16 a[38:39], v43 offset:46080
 s_waitcnt vmcnt(27) lgkmcnt(4)
 v_mfma_f32_16x16x32_bf16 v[20:23], a[8:11], a[120:123], v[20:23]
 ds_read_b64_tr_b16 a[40:41], v44 offset:45056
 v_mfma_f32_16x16x32_bf16 v[24:27], a[8:11], a[124:127], v[24:27]
 ds_read_b64_tr_b16 a[42:43], v44 offset:46080
 buffer_load_dwordx4 a[116:119], v41, s[36:39], s41 offen sc1
 v_mfma_f32_16x16x32_bf16 v[32:35], a[12:15], a[124:127], v[32:35]
 ds_read_b64_tr_b16 a[44:45], v45 offset:45056
 v_mfma_f32_16x16x32_bf16 v[28:31], a[12:15], a[120:123], v[28:31]
 ds_read_b64_tr_b16 a[46:47], v45 offset:46080
 v_mfma_f32_16x16x32_bf16 v[4:7], a[16:19], a[128:131], v[4:7]
 ds_read_b64_tr_b16 a[0:1], v42 offset:49152
 v_mfma_f32_16x16x32_bf16 v[8:11], a[16:19], a[132:135], v[8:11]
 ds_read_b64_tr_b16 a[2:3], v42 offset:50176
 v_mfma_f32_16x16x32_bf16 v[16:19], a[20:23], a[132:135], v[16:19]
 ds_read_b64_tr_b16 a[4:5], v43 offset:49152
 buffer_load_dwordx4 a[120:123], v40, s[36:39], s41 offen offset:1024 sc1
 v_mfma_f32_16x16x32_bf16 v[12:15], a[20:23], a[128:131], v[12:15]
 ds_read_b64_tr_b16 a[6:7], v43 offset:50176
 s_waitcnt vmcnt(27) lgkmcnt(4)
 v_mfma_f32_16x16x32_bf16 v[20:23], a[24:27], a[128:131], v[20:23]
 ds_read_b64_tr_b16 a[8:9], v44 offset:49152
 v_mfma_f32_16x16x32_bf16 v[24:27], a[24:27], a[132:135], v[24:27]
 ds_read_b64_tr_b16 a[10:11], v44 offset:50176
 buffer_load_dwordx4 a[124:127], v41, s[36:39], s41 offen offset:1024 sc1
 v_mfma_f32_16x16x32_bf16 v[32:35], a[28:31], a[132:135], v[32:35]
 ds_read_b64_tr_b16 a[12:13], v45 offset:49152
 v_mfma_f32_16x16x32_bf16 v[28:31], a[28:31], a[128:131], v[28:31]
 ds_read_b64_tr_b16 a[14:15], v45 offset:50176
 v_mfma_f32_16x16x32_bf16 v[4:7], a[32:35], a[136:139], v[4:7]
 ds_read_b64_tr_b16 a[16:17], v42 offset:53248
 v_mfma_f32_16x16x32_bf16 v[8:11], a[32:35], a[140:143], v[8:11]
 ds_read_b64_tr_b16 a[18:19], v42 offset:54272
 v_mfma_f32_16x16x32_bf16 v[16:19], a[36:39], a[140:143], v[16:19]
 ds_read_b64_tr_b16 a[20:21], v43 offset:53248
 buffer_load_dwordx4 a[128:131], v40, s[36:39], s41 offen offset:2048 sc1
 v_mfma_f32_16x16x32_bf16 v[12:15], a[36:39], a[136:139], v[12:15]
 ds_read_b64_tr_b16 a[22:23], v43 offset:54272
 s_waitcnt vmcnt(27) lgkmcnt(4)
 v_mfma_f32_16x16x32_bf16 v[20:23], a[40:43], a[136:139], v[20:23]
 ds_read_b64_tr_b16 a[24:25], v44 offset:53248
 v_mfma_f32_16x16x32_bf16 v[24:27], a[40:43], a[140:143], v[24:27]
 ds_read_b64_tr_b16 a[26:27], v44 offset:54272
 buffer_load_dwordx4 a[132:135], v41, s[36:39], s41 offen offset:2048 sc1
 v_mfma_f32_16x16x32_bf16 v[32:35], a[44:47], a[140:143], v[32:35]
 ds_read_b64_tr_b16 a[28:29], v45 offset:53248
 v_mfma_f32_16x16x32_bf16 v[28:31], a[44:47], a[136:139], v[28:31]
 ds_read_b64_tr_b16 a[30:31], v45 offset:54272
 v_mfma_f32_16x16x32_bf16 v[4:7], a[0:3], a[144:147], v[4:7]
 ds_read_b64_tr_b16 a[32:33], v42 offset:57344
 v_mfma_f32_16x16x32_bf16 v[8:11], a[0:3], a[148:151], v[8:11]
 ds_read_b64_tr_b16 a[34:35], v42 offset:58368
 v_mfma_f32_16x16x32_bf16 v[16:19], a[4:7], a[148:151], v[16:19]
 ds_read_b64_tr_b16 a[36:37], v43 offset:57344
 buffer_load_dwordx4 a[136:139], v40, s[36:39], s41 offen offset:3072 sc1
 v_mfma_f32_16x16x32_bf16 v[12:15], a[4:7], a[144:147], v[12:15]
 ds_read_b64_tr_b16 a[38:39], v43 offset:58368
 s_waitcnt vmcnt(27) lgkmcnt(4)
 v_mfma_f32_16x16x32_bf16 v[20:23], a[8:11], a[144:147], v[20:23]
 ds_read_b64_tr_b16 a[40:41], v44 offset:57344
 v_mfma_f32_16x16x32_bf16 v[24:27], a[8:11], a[148:151], v[24:27]
 ds_read_b64_tr_b16 a[42:43], v44 offset:58368
 buffer_load_dwordx4 a[140:143], v41, s[36:39], s41 offen offset:3072 sc1
 v_readlane_b32 s41, v241, 7
 v_mfma_f32_16x16x32_bf16 v[32:35], a[12:15], a[148:151], v[32:35]
 ds_read_b64_tr_b16 a[44:45], v45 offset:57344
 v_mfma_f32_16x16x32_bf16 v[28:31], a[12:15], a[144:147], v[28:31]
 ds_read_b64_tr_b16 a[46:47], v45 offset:58368
 v_mfma_f32_16x16x32_bf16 v[4:7], a[16:19], a[152:155], v[4:7]
 ds_read_b64_tr_b16 a[0:1], v42 offset:61440
 v_mfma_f32_16x16x32_bf16 v[8:11], a[16:19], a[156:159], v[8:11]
 ds_read_b64_tr_b16 a[2:3], v42 offset:62464
 v_mfma_f32_16x16x32_bf16 v[16:19], a[20:23], a[156:159], v[16:19]
 ds_read_b64_tr_b16 a[4:5], v43 offset:61440
 buffer_load_dwordx4 a[144:147], v40, s[36:39], s41 offen sc1
 v_mfma_f32_16x16x32_bf16 v[12:15], a[20:23], a[152:155], v[12:15]
 ds_read_b64_tr_b16 a[6:7], v43 offset:62464
 s_waitcnt vmcnt(27) lgkmcnt(4)
 v_mfma_f32_16x16x32_bf16 v[20:23], a[24:27], a[152:155], v[20:23]
 ds_read_b64_tr_b16 a[8:9], v44 offset:61440
 v_mfma_f32_16x16x32_bf16 v[24:27], a[24:27], a[156:159], v[24:27]
 ds_read_b64_tr_b16 a[10:11], v44 offset:62464
 buffer_load_dwordx4 a[148:151], v41, s[36:39], s41 offen sc1
 v_mfma_f32_16x16x32_bf16 v[32:35], a[28:31], a[156:159], v[32:35]
 ds_read_b64_tr_b16 a[12:13], v45 offset:61440
 v_mfma_f32_16x16x32_bf16 v[28:31], a[28:31], a[152:155], v[28:31]
 ds_read_b64_tr_b16 a[14:15], v45 offset:62464
 v_mfma_f32_16x16x32_bf16 v[4:7], a[32:35], a[160:163], v[4:7]
 ds_read_b64_tr_b16 a[16:17], v46 offset:0
 v_mfma_f32_16x16x32_bf16 v[8:11], a[32:35], a[164:167], v[8:11]
 ds_read_b64_tr_b16 a[18:19], v46 offset:1024
 v_mfma_f32_16x16x32_bf16 v[16:19], a[36:39], a[164:167], v[16:19]
 ds_read_b64_tr_b16 a[20:21], v47 offset:0
 buffer_load_dwordx4 a[152:155], v40, s[36:39], s41 offen offset:1024 sc1
 v_mfma_f32_16x16x32_bf16 v[12:15], a[36:39], a[160:163], v[12:15]
 ds_read_b64_tr_b16 a[22:23], v47 offset:1024
 s_waitcnt vmcnt(27) lgkmcnt(4)
 v_mfma_f32_16x16x32_bf16 v[20:23], a[40:43], a[160:163], v[20:23]
 ds_read_b64_tr_b16 a[24:25], v48 offset:0
 v_mfma_f32_16x16x32_bf16 v[24:27], a[40:43], a[164:167], v[24:27]
 ds_read_b64_tr_b16 a[26:27], v48 offset:1024
 buffer_load_dwordx4 a[156:159], v41, s[36:39], s41 offen offset:1024 sc1
 v_mfma_f32_16x16x32_bf16 v[32:35], a[44:47], a[164:167], v[32:35]
 ds_read_b64_tr_b16 a[28:29], v49 offset:0
 v_mfma_f32_16x16x32_bf16 v[28:31], a[44:47], a[160:163], v[28:31]
 ds_read_b64_tr_b16 a[30:31], v49 offset:1024
 v_mfma_f32_16x16x32_bf16 v[4:7], a[0:3], a[168:171], v[4:7]
 ds_read_b64_tr_b16 a[32:33], v46 offset:4096
 s_barrier
 v_mfma_f32_16x16x32_bf16 v[8:11], a[0:3], a[172:175], v[8:11]
 ds_read_b64_tr_b16 a[34:35], v46 offset:5120
 v_mfma_f32_16x16x32_bf16 v[16:19], a[4:7], a[172:175], v[16:19]
 ds_read_b64_tr_b16 a[36:37], v47 offset:4096
 buffer_load_dwordx4 a[160:163], v40, s[36:39], s41 offen offset:2048 sc1
 v_mfma_f32_16x16x32_bf16 v[12:15], a[4:7], a[168:171], v[12:15]
 ds_read_b64_tr_b16 a[38:39], v47 offset:5120
 s_waitcnt vmcnt(27) lgkmcnt(4)
 v_mfma_f32_16x16x32_bf16 v[20:23], a[8:11], a[168:171], v[20:23]
 ds_read_b64_tr_b16 a[40:41], v48 offset:4096
 v_mfma_f32_16x16x32_bf16 v[24:27], a[8:11], a[172:175], v[24:27]
 ds_read_b64_tr_b16 a[42:43], v48 offset:5120
 buffer_load_dwordx4 a[164:167], v41, s[36:39], s41 offen offset:2048 sc1
 v_mfma_f32_16x16x32_bf16 v[32:35], a[12:15], a[172:175], v[32:35]
 ds_read_b64_tr_b16 a[44:45], v49 offset:4096
 v_mfma_f32_16x16x32_bf16 v[28:31], a[12:15], a[168:171], v[28:31]
 ds_read_b64_tr_b16 a[46:47], v49 offset:5120
 v_mfma_f32_16x16x32_bf16 v[4:7], a[16:19], a[48:51], v[4:7]
 ds_read_b64_tr_b16 a[0:1], v46 offset:8192
 v_mfma_f32_16x16x32_bf16 v[8:11], a[16:19], a[52:55], v[8:11]
 ds_read_b64_tr_b16 a[2:3], v46 offset:9216
 v_mfma_f32_16x16x32_bf16 v[16:19], a[20:23], a[52:55], v[16:19]
 ds_read_b64_tr_b16 a[4:5], v47 offset:8192
 buffer_load_dwordx4 a[168:171], v40, s[36:39], s41 offen offset:3072 sc1
 v_mfma_f32_16x16x32_bf16 v[12:15], a[20:23], a[48:51], v[12:15]
 ds_read_b64_tr_b16 a[6:7], v47 offset:9216
 s_waitcnt vmcnt(27) lgkmcnt(4)
 v_mfma_f32_16x16x32_bf16 v[20:23], a[24:27], a[48:51], v[20:23]
 ds_read_b64_tr_b16 a[8:9], v48 offset:8192
 v_mfma_f32_16x16x32_bf16 v[24:27], a[24:27], a[52:55], v[24:27]
 ds_read_b64_tr_b16 a[10:11], v48 offset:9216
 buffer_load_dwordx4 a[172:175], v41, s[36:39], s41 offen offset:3072 sc1
 v_mfma_f32_16x16x32_bf16 v[32:35], a[28:31], a[52:55], v[32:35]
 ds_read_b64_tr_b16 a[12:13], v49 offset:8192
 v_mfma_f32_16x16x32_bf16 v[28:31], a[28:31], a[48:51], v[28:31]
 ds_read_b64_tr_b16 a[14:15], v49 offset:9216
 v_mfma_f32_16x16x32_bf16 v[4:7], a[32:35], a[56:59], v[4:7]
 ds_read_b64_tr_b16 a[16:17], v46 offset:12288
 s_add_u32 m0, s96, 0
 s_mov_b32 s16, 458752
 buffer_load_dwordx4 v224, s[60:63], s16 offen lds
 v_mfma_f32_16x16x32_bf16 v[8:11], a[32:35], a[60:63], v[8:11]
 ds_read_b64_tr_b16 a[18:19], v46 offset:13312
 buffer_load_dwordx4 v225, s[60:63], s16 offen offset:1024 lds
 v_mfma_f32_16x16x32_bf16 v[16:19], a[36:39], a[60:63], v[16:19]
 ds_read_b64_tr_b16 a[20:21], v47 offset:12288
 v_mfma_f32_16x16x32_bf16 v[12:15], a[36:39], a[56:59], v[12:15]
 ds_read_b64_tr_b16 a[22:23], v47 offset:13312
 s_waitcnt vmcnt(28) lgkmcnt(4)
 v_mfma_f32_16x16x32_bf16 v[20:23], a[40:43], a[56:59], v[20:23]
 ds_read_b64_tr_b16 a[24:25], v48 offset:12288
 v_mfma_f32_16x16x32_bf16 v[24:27], a[40:43], a[60:63], v[24:27]
 ds_read_b64_tr_b16 a[26:27], v48 offset:13312
 v_mfma_f32_16x16x32_bf16 v[32:35], a[44:47], a[60:63], v[32:35]
 ds_read_b64_tr_b16 a[28:29], v49 offset:12288
 v_mfma_f32_16x16x32_bf16 v[28:31], a[44:47], a[56:59], v[28:31]
 ds_read_b64_tr_b16 a[30:31], v49 offset:13312
 v_mfma_f32_16x16x32_bf16 v[4:7], a[0:3], a[64:67], v[4:7]
 ds_read_b64_tr_b16 a[32:33], v46 offset:16384
 buffer_load_dwordx4 v226, s[60:63], s16 offen offset:2048 lds
 v_mfma_f32_16x16x32_bf16 v[8:11], a[0:3], a[68:71], v[8:11]
 ds_read_b64_tr_b16 a[34:35], v46 offset:17408
 buffer_load_dwordx4 v227, s[60:63], s16 offen offset:3072 lds
 s_add_u32 m0, s96, 4096
 v_mfma_f32_16x16x32_bf16 v[16:19], a[4:7], a[68:71], v[16:19]
 ds_read_b64_tr_b16 a[36:37], v47 offset:16384
 v_mfma_f32_16x16x32_bf16 v[12:15], a[4:7], a[64:67], v[12:15]
 ds_read_b64_tr_b16 a[38:39], v47 offset:17408
 s_waitcnt vmcnt(28) lgkmcnt(4)
 v_mfma_f32_16x16x32_bf16 v[20:23], a[8:11], a[64:67], v[20:23]
 ds_read_b64_tr_b16 a[40:41], v48 offset:16384
 v_mfma_f32_16x16x32_bf16 v[24:27], a[8:11], a[68:71], v[24:27]
 ds_read_b64_tr_b16 a[42:43], v48 offset:17408
 v_mfma_f32_16x16x32_bf16 v[32:35], a[12:15], a[68:71], v[32:35]
 ds_read_b64_tr_b16 a[44:45], v49 offset:16384
 v_mfma_f32_16x16x32_bf16 v[28:31], a[12:15], a[64:67], v[28:31]
 ds_read_b64_tr_b16 a[46:47], v49 offset:17408
 v_mfma_f32_16x16x32_bf16 v[4:7], a[16:19], a[72:75], v[4:7]
 ds_read_b64_tr_b16 a[0:1], v46 offset:20480
 buffer_load_dwordx4 v228, s[60:63], s16 offen lds
 v_mfma_f32_16x16x32_bf16 v[8:11], a[16:19], a[76:79], v[8:11]
 ds_read_b64_tr_b16 a[2:3], v46 offset:21504
 buffer_load_dwordx4 v229, s[60:63], s16 offen offset:1024 lds
 v_mfma_f32_16x16x32_bf16 v[16:19], a[20:23], a[76:79], v[16:19]
 ds_read_b64_tr_b16 a[4:5], v47 offset:20480
 v_mfma_f32_16x16x32_bf16 v[12:15], a[20:23], a[72:75], v[12:15]
 ds_read_b64_tr_b16 a[6:7], v47 offset:21504
 s_waitcnt vmcnt(28) lgkmcnt(4)
 v_mfma_f32_16x16x32_bf16 v[20:23], a[24:27], a[72:75], v[20:23]
 ds_read_b64_tr_b16 a[8:9], v48 offset:20480
 v_mfma_f32_16x16x32_bf16 v[24:27], a[24:27], a[76:79], v[24:27]
 ds_read_b64_tr_b16 a[10:11], v48 offset:21504
 v_mfma_f32_16x16x32_bf16 v[32:35], a[28:31], a[76:79], v[32:35]
 ds_read_b64_tr_b16 a[12:13], v49 offset:20480
 v_mfma_f32_16x16x32_bf16 v[28:31], a[28:31], a[72:75], v[28:31]
 ds_read_b64_tr_b16 a[14:15], v49 offset:21504
 v_mfma_f32_16x16x32_bf16 v[4:7], a[32:35], a[80:83], v[4:7]
 ds_read_b64_tr_b16 a[16:17], v46 offset:24576
 buffer_load_dwordx4 v230, s[60:63], s16 offen offset:2048 lds
 s_add_u32 s16, s16, 458752
 s_add_u32 m0, s96, 28672
 v_mfma_f32_16x16x32_bf16 v[8:11], a[32:35], a[84:87], v[8:11]
 ds_read_b64_tr_b16 a[18:19], v46 offset:25600
 buffer_load_dwordx4 v224, s[60:63], s16 offen lds
 v_mfma_f32_16x16x32_bf16 v[16:19], a[36:39], a[84:87], v[16:19]
 ds_read_b64_tr_b16 a[20:21], v47 offset:24576
 v_mfma_f32_16x16x32_bf16 v[12:15], a[36:39], a[80:83], v[12:15]
 ds_read_b64_tr_b16 a[22:23], v47 offset:25600
 s_waitcnt vmcnt(28) lgkmcnt(4)
 v_mfma_f32_16x16x32_bf16 v[20:23], a[40:43], a[80:83], v[20:23]
 ds_read_b64_tr_b16 a[24:25], v48 offset:24576
 v_mfma_f32_16x16x32_bf16 v[24:27], a[40:43], a[84:87], v[24:27]
 ds_read_b64_tr_b16 a[26:27], v48 offset:25600
 v_mfma_f32_16x16x32_bf16 v[32:35], a[44:47], a[84:87], v[32:35]
 ds_read_b64_tr_b16 a[28:29], v49 offset:24576
 v_mfma_f32_16x16x32_bf16 v[28:31], a[44:47], a[80:83], v[28:31]
 ds_read_b64_tr_b16 a[30:31], v49 offset:25600
 v_mfma_f32_16x16x32_bf16 v[4:7], a[0:3], a[88:91], v[4:7]
 ds_read_b64_tr_b16 a[32:33], v46 offset:28672
 buffer_load_dwordx4 v225, s[60:63], s16 offen offset:1024 lds
 v_mfma_f32_16x16x32_bf16 v[8:11], a[0:3], a[92:95], v[8:11]
 ds_read_b64_tr_b16 a[34:35], v46 offset:29696
 buffer_load_dwordx4 v226, s[60:63], s16 offen offset:2048 lds
 v_mfma_f32_16x16x32_bf16 v[16:19], a[4:7], a[92:95], v[16:19]
 ds_read_b64_tr_b16 a[36:37], v47 offset:28672
 v_mfma_f32_16x16x32_bf16 v[12:15], a[4:7], a[88:91], v[12:15]
 ds_read_b64_tr_b16 a[38:39], v47 offset:29696
 s_waitcnt vmcnt(28) lgkmcnt(4)
 v_mfma_f32_16x16x32_bf16 v[20:23], a[8:11], a[88:91], v[20:23]
 ds_read_b64_tr_b16 a[40:41], v48 offset:28672
 v_mfma_f32_16x16x32_bf16 v[24:27], a[8:11], a[92:95], v[24:27]
 ds_read_b64_tr_b16 a[42:43], v48 offset:29696
 v_mfma_f32_16x16x32_bf16 v[32:35], a[12:15], a[92:95], v[32:35]
 ds_read_b64_tr_b16 a[44:45], v49 offset:28672
 v_mfma_f32_16x16x32_bf16 v[28:31], a[12:15], a[88:91], v[28:31]
 ds_read_b64_tr_b16 a[46:47], v49 offset:29696
 v_mfma_f32_16x16x32_bf16 v[4:7], a[16:19], a[96:99], v[4:7]
 ds_read_b64_tr_b16 a[0:1], v46 offset:32768
 buffer_load_dwordx4 v227, s[60:63], s16 offen offset:3072 lds
 s_add_u32 m0, s96, 32768
 v_mfma_f32_16x16x32_bf16 v[8:11], a[16:19], a[100:103], v[8:11]
 ds_read_b64_tr_b16 a[2:3], v46 offset:33792
 buffer_load_dwordx4 v228, s[60:63], s16 offen lds
 v_mfma_f32_16x16x32_bf16 v[16:19], a[20:23], a[100:103], v[16:19]
 ds_read_b64_tr_b16 a[4:5], v47 offset:32768
 v_mfma_f32_16x16x32_bf16 v[12:15], a[20:23], a[96:99], v[12:15]
 ds_read_b64_tr_b16 a[6:7], v47 offset:33792
 s_waitcnt vmcnt(28) lgkmcnt(4)
 v_mfma_f32_16x16x32_bf16 v[20:23], a[24:27], a[96:99], v[20:23]
 ds_read_b64_tr_b16 a[8:9], v48 offset:32768
 v_mfma_f32_16x16x32_bf16 v[24:27], a[24:27], a[100:103], v[24:27]
 ds_read_b64_tr_b16 a[10:11], v48 offset:33792
 v_mfma_f32_16x16x32_bf16 v[32:35], a[28:31], a[100:103], v[32:35]
 ds_read_b64_tr_b16 a[12:13], v49 offset:32768
 v_mfma_f32_16x16x32_bf16 v[28:31], a[28:31], a[96:99], v[28:31]
 ds_read_b64_tr_b16 a[14:15], v49 offset:33792
 v_mfma_f32_16x16x32_bf16 v[4:7], a[32:35], a[104:107], v[4:7]
 ds_read_b64_tr_b16 a[16:17], v46 offset:36864
 buffer_load_dwordx4 v229, s[60:63], s16 offen offset:1024 lds
 v_mfma_f32_16x16x32_bf16 v[8:11], a[32:35], a[108:111], v[8:11]
 ds_read_b64_tr_b16 a[18:19], v46 offset:37888
 buffer_load_dwordx4 v230, s[60:63], s16 offen offset:2048 lds
 s_add_u32 s16, s16, 458752
 s_add_u32 m0, s96, 57344
 v_mfma_f32_16x16x32_bf16 v[16:19], a[36:39], a[108:111], v[16:19]
 ds_read_b64_tr_b16 a[20:21], v47 offset:36864
 v_mfma_f32_16x16x32_bf16 v[12:15], a[36:39], a[104:107], v[12:15]
 ds_read_b64_tr_b16 a[22:23], v47 offset:37888
 s_waitcnt vmcnt(28) lgkmcnt(4)
 v_mfma_f32_16x16x32_bf16 v[20:23], a[40:43], a[104:107], v[20:23]
 ds_read_b64_tr_b16 a[24:25], v48 offset:36864
 v_mfma_f32_16x16x32_bf16 v[24:27], a[40:43], a[108:111], v[24:27]
 ds_read_b64_tr_b16 a[26:27], v48 offset:37888
 v_mfma_f32_16x16x32_bf16 v[32:35], a[44:47], a[108:111], v[32:35]
 ds_read_b64_tr_b16 a[28:29], v49 offset:36864
 v_mfma_f32_16x16x32_bf16 v[28:31], a[44:47], a[104:107], v[28:31]
 ds_read_b64_tr_b16 a[30:31], v49 offset:37888
 v_mfma_f32_16x16x32_bf16 v[4:7], a[0:3], a[112:115], v[4:7]
 ds_read_b64_tr_b16 a[32:33], v46 offset:40960
 v_mfma_f32_16x16x32_bf16 v[8:11], a[0:3], a[116:119], v[8:11]
 ds_read_b64_tr_b16 a[34:35], v46 offset:41984
 v_mfma_f32_16x16x32_bf16 v[16:19], a[4:7], a[116:119], v[16:19]
 ds_read_b64_tr_b16 a[36:37], v47 offset:40960
 v_mfma_f32_16x16x32_bf16 v[12:15], a[4:7], a[112:115], v[12:15]
 ds_read_b64_tr_b16 a[38:39], v47 offset:41984
 s_waitcnt vmcnt(26) lgkmcnt(4)
 v_mfma_f32_16x16x32_bf16 v[20:23], a[8:11], a[112:115], v[20:23]
 ds_read_b64_tr_b16 a[40:41], v48 offset:40960
 v_mfma_f32_16x16x32_bf16 v[24:27], a[8:11], a[116:119], v[24:27]
 ds_read_b64_tr_b16 a[42:43], v48 offset:41984
 v_mfma_f32_16x16x32_bf16 v[32:35], a[12:15], a[116:119], v[32:35]
 ds_read_b64_tr_b16 a[44:45], v49 offset:40960
 v_mfma_f32_16x16x32_bf16 v[28:31], a[12:15], a[112:115], v[28:31]
 ds_read_b64_tr_b16 a[46:47], v49 offset:41984
 v_mfma_f32_16x16x32_bf16 v[4:7], a[16:19], a[120:123], v[4:7]
 ds_read_b64_tr_b16 a[0:1], v46 offset:45056
 v_mfma_f32_16x16x32_bf16 v[8:11], a[16:19], a[124:127], v[8:11]
 ds_read_b64_tr_b16 a[2:3], v46 offset:46080
 v_mfma_f32_16x16x32_bf16 v[16:19], a[20:23], a[124:127], v[16:19]
 ds_read_b64_tr_b16 a[4:5], v47 offset:45056
 v_mfma_f32_16x16x32_bf16 v[12:15], a[20:23], a[120:123], v[12:15]
 ds_read_b64_tr_b16 a[6:7], v47 offset:46080
 s_waitcnt vmcnt(24) lgkmcnt(4)
 v_mfma_f32_16x16x32_bf16 v[20:23], a[24:27], a[120:123], v[20:23]
 ds_read_b64_tr_b16 a[8:9], v48 offset:45056
 v_mfma_f32_16x16x32_bf16 v[24:27], a[24:27], a[124:127], v[24:27]
 ds_read_b64_tr_b16 a[10:11], v48 offset:46080
 v_mfma_f32_16x16x32_bf16 v[32:35], a[28:31], a[124:127], v[32:35]
 ds_read_b64_tr_b16 a[12:13], v49 offset:45056
 v_mfma_f32_16x16x32_bf16 v[28:31], a[28:31], a[120:123], v[28:31]
 ds_read_b64_tr_b16 a[14:15], v49 offset:46080
 v_mfma_f32_16x16x32_bf16 v[4:7], a[32:35], a[128:131], v[4:7]
 ds_read_b64_tr_b16 a[16:17], v46 offset:49152
 v_mfma_f32_16x16x32_bf16 v[8:11], a[32:35], a[132:135], v[8:11]
 ds_read_b64_tr_b16 a[18:19], v46 offset:50176
 v_mfma_f32_16x16x32_bf16 v[16:19], a[36:39], a[132:135], v[16:19]
 ds_read_b64_tr_b16 a[20:21], v47 offset:49152
 v_mfma_f32_16x16x32_bf16 v[12:15], a[36:39], a[128:131], v[12:15]
 ds_read_b64_tr_b16 a[22:23], v47 offset:50176
 s_waitcnt vmcnt(22) lgkmcnt(4)
 v_mfma_f32_16x16x32_bf16 v[20:23], a[40:43], a[128:131], v[20:23]
 ds_read_b64_tr_b16 a[24:25], v48 offset:49152
 v_mfma_f32_16x16x32_bf16 v[24:27], a[40:43], a[132:135], v[24:27]
 ds_read_b64_tr_b16 a[26:27], v48 offset:50176
 v_mfma_f32_16x16x32_bf16 v[32:35], a[44:47], a[132:135], v[32:35]
 ds_read_b64_tr_b16 a[28:29], v49 offset:49152
 v_mfma_f32_16x16x32_bf16 v[28:31], a[44:47], a[128:131], v[28:31]
 ds_read_b64_tr_b16 a[30:31], v49 offset:50176
 v_mfma_f32_16x16x32_bf16 v[4:7], a[0:3], a[136:139], v[4:7]
 ds_read_b64_tr_b16 a[32:33], v46 offset:53248
 v_mfma_f32_16x16x32_bf16 v[8:11], a[0:3], a[140:143], v[8:11]
 ds_read_b64_tr_b16 a[34:35], v46 offset:54272
 v_mfma_f32_16x16x32_bf16 v[16:19], a[4:7], a[140:143], v[16:19]
 ds_read_b64_tr_b16 a[36:37], v47 offset:53248
 v_mfma_f32_16x16x32_bf16 v[12:15], a[4:7], a[136:139], v[12:15]
 ds_read_b64_tr_b16 a[38:39], v47 offset:54272
 s_waitcnt vmcnt(20) lgkmcnt(4)
 v_mfma_f32_16x16x32_bf16 v[20:23], a[8:11], a[136:139], v[20:23]
 ds_read_b64_tr_b16 a[40:41], v48 offset:53248
 v_mfma_f32_16x16x32_bf16 v[24:27], a[8:11], a[140:143], v[24:27]
 ds_read_b64_tr_b16 a[42:43], v48 offset:54272
 v_mfma_f32_16x16x32_bf16 v[32:35], a[12:15], a[140:143], v[32:35]
 ds_read_b64_tr_b16 a[44:45], v49 offset:53248
 v_mfma_f32_16x16x32_bf16 v[28:31], a[12:15], a[136:139], v[28:31]
 ds_read_b64_tr_b16 a[46:47], v49 offset:54272
 v_mfma_f32_16x16x32_bf16 v[4:7], a[16:19], a[144:147], v[4:7]
 ds_read_b64_tr_b16 a[0:1], v46 offset:57344
 v_mfma_f32_16x16x32_bf16 v[8:11], a[16:19], a[148:151], v[8:11]
 ds_read_b64_tr_b16 a[2:3], v46 offset:58368
 v_mfma_f32_16x16x32_bf16 v[16:19], a[20:23], a[148:151], v[16:19]
 ds_read_b64_tr_b16 a[4:5], v47 offset:57344
 v_mfma_f32_16x16x32_bf16 v[12:15], a[20:23], a[144:147], v[12:15]
 ds_read_b64_tr_b16 a[6:7], v47 offset:58368
 s_waitcnt vmcnt(18) lgkmcnt(4)
 v_mfma_f32_16x16x32_bf16 v[20:23], a[24:27], a[144:147], v[20:23]
 ds_read_b64_tr_b16 a[8:9], v48 offset:57344
 v_mfma_f32_16x16x32_bf16 v[24:27], a[24:27], a[148:151], v[24:27]
 ds_read_b64_tr_b16 a[10:11], v48 offset:58368
 v_mfma_f32_16x16x32_bf16 v[32:35], a[28:31], a[148:151], v[32:35]
 ds_read_b64_tr_b16 a[12:13], v49 offset:57344
 v_mfma_f32_16x16x32_bf16 v[28:31], a[28:31], a[144:147], v[28:31]
 ds_read_b64_tr_b16 a[14:15], v49 offset:58368
 v_mfma_f32_16x16x32_bf16 v[4:7], a[32:35], a[152:155], v[4:7]
 ds_read_b64_tr_b16 a[16:17], v46 offset:61440
 v_mfma_f32_16x16x32_bf16 v[8:11], a[32:35], a[156:159], v[8:11]
 ds_read_b64_tr_b16 a[18:19], v46 offset:62464
 v_mfma_f32_16x16x32_bf16 v[16:19], a[36:39], a[156:159], v[16:19]
 ds_read_b64_tr_b16 a[20:21], v47 offset:61440
 v_mfma_f32_16x16x32_bf16 v[12:15], a[36:39], a[152:155], v[12:15]
 ds_read_b64_tr_b16 a[22:23], v47 offset:62464
 s_waitcnt vmcnt(16) lgkmcnt(4)
 v_mfma_f32_16x16x32_bf16 v[20:23], a[40:43], a[152:155], v[20:23]
 ds_read_b64_tr_b16 a[24:25], v48 offset:61440
 v_mfma_f32_16x16x32_bf16 v[24:27], a[40:43], a[156:159], v[24:27]
 ds_read_b64_tr_b16 a[26:27], v48 offset:62464
 v_mfma_f32_16x16x32_bf16 v[32:35], a[44:47], a[156:159], v[32:35]
 ds_read_b64_tr_b16 a[28:29], v49 offset:61440
 v_mfma_f32_16x16x32_bf16 v[28:31], a[44:47], a[152:155], v[28:31]
 ds_read_b64_tr_b16 a[30:31], v49 offset:62464
 v_mfma_f32_16x16x32_bf16 v[4:7], a[0:3], a[160:163], v[4:7]
 v_mfma_f32_16x16x32_bf16 v[8:11], a[0:3], a[164:167], v[8:11]
 v_mfma_f32_16x16x32_bf16 v[16:19], a[4:7], a[164:167], v[16:19]
 v_mfma_f32_16x16x32_bf16 v[12:15], a[4:7], a[160:163], v[12:15]
 s_waitcnt vmcnt(14) lgkmcnt(0)
 v_mfma_f32_16x16x32_bf16 v[20:23], a[8:11], a[160:163], v[20:23]
 v_mfma_f32_16x16x32_bf16 v[24:27], a[8:11], a[164:167], v[24:27]
 v_mfma_f32_16x16x32_bf16 v[32:35], a[12:15], a[164:167], v[32:35]
 v_mfma_f32_16x16x32_bf16 v[28:31], a[12:15], a[160:163], v[28:31]
 v_mfma_f32_16x16x32_bf16 v[4:7], a[16:19], a[168:171], v[4:7]
 v_mfma_f32_16x16x32_bf16 v[8:11], a[16:19], a[172:175], v[8:11]
 v_mfma_f32_16x16x32_bf16 v[16:19], a[20:23], a[172:175], v[16:19]
 v_mfma_f32_16x16x32_bf16 v[12:15], a[20:23], a[168:171], v[12:15]
 v_mfma_f32_16x16x32_bf16 v[20:23], a[24:27], a[168:171], v[20:23]
 v_mfma_f32_16x16x32_bf16 v[24:27], a[24:27], a[172:175], v[24:27]
 v_mfma_f32_16x16x32_bf16 v[32:35], a[28:31], a[172:175], v[32:35]
 v_mfma_f32_16x16x32_bf16 v[28:31], a[28:31], a[168:171], v[28:31]
 s_add_u32 s44, s8, 0x1000000
 s_addc_u32 s45, s9, 0
 s_mov_b32 s46, 0x400000
 s_mov_b32 s47, 0x00020000
 s_add_u32 s48, s8, 0x200000
 s_addc_u32 s49, s9, 0
 s_mov_b32 s50, 0x40000
 s_mov_b32 s51, 0x00020000
 v_permlane16_swap_b32 v52, v54
 v_permlane16_swap_b32 v53, v55
 v_lshlrev_b32 v100, 16, v52
 v_and_b32 v101, 0xffff0000, v52
 v_lshlrev_b32 v102, 16, v53
 v_and_b32 v103, 0xffff0000, v53
 v_pk_fma_f32 v[4:5], v[4:5], v[68:69], v[100:101]
 v_pk_fma_f32 v[6:7], v[6:7], v[70:71], v[102:103]
 v_pk_mul_f32 v[100:101], v[4:5], v[84:85]
 v_pk_mul_f32 v[102:103], v[6:7], v[86:87]
 v_cvt_pk_bf16_f32 v116, v100, v101
 v_cvt_pk_bf16_f32 v117, v102, v103
 v_lshlrev_b32 v100, 16, v54
 v_and_b32 v101, 0xffff0000, v54
 v_lshlrev_b32 v102, 16, v55
 v_and_b32 v103, 0xffff0000, v55
 v_pk_fma_f32 v[12:13], v[12:13], v[72:73], v[100:101]
 v_pk_fma_f32 v[14:15], v[14:15], v[74:75], v[102:103]
 v_pk_mul_f32 v[100:101], v[12:13], v[88:89]
 v_pk_mul_f32 v[102:103], v[14:15], v[90:91]
 v_cvt_pk_bf16_f32 v118, v100, v101
 v_cvt_pk_bf16_f32 v119, v102, v103
 buffer_store_dwordx4 v[116:119], v51, s[44:47], 0 offen offset:0 sc1
 v_permlane16_swap_b32 v56, v58
 v_permlane16_swap_b32 v57, v59
 v_lshlrev_b32 v100, 16, v56
 v_and_b32 v101, 0xffff0000, v56
 v_lshlrev_b32 v102, 16, v57
 v_and_b32 v103, 0xffff0000, v57
 v_pk_fma_f32 v[20:21], v[20:21], v[76:77], v[100:101]
 v_pk_fma_f32 v[22:23], v[22:23], v[78:79], v[102:103]
 v_pk_mul_f32 v[100:101], v[20:21], v[92:93]
 v_pk_mul_f32 v[102:103], v[22:23], v[94:95]
 v_cvt_pk_bf16_f32 v120, v100, v101
 v_cvt_pk_bf16_f32 v121, v102, v103
 v_lshlrev_b32 v100, 16, v58
 v_and_b32 v101, 0xffff0000, v58
 v_lshlrev_b32 v102, 16, v59
 v_and_b32 v103, 0xffff0000, v59
 v_pk_fma_f32 v[28:29], v[28:29], v[80:81], v[100:101]
 v_pk_fma_f32 v[30:31], v[30:31], v[82:83], v[102:103]
 v_pk_mul_f32 v[100:101], v[28:29], v[96:97]
 v_pk_mul_f32 v[102:103], v[30:31], v[98:99]
 v_cvt_pk_bf16_f32 v122, v100, v101
 v_cvt_pk_bf16_f32 v123, v102, v103
 buffer_store_dwordx4 v[120:123], v51, s[44:47], 0 offen offset:1024 sc1
 v_permlane16_swap_b32 v60, v62
 v_permlane16_swap_b32 v61, v63
 v_lshlrev_b32 v100, 16, v60
 v_and_b32 v101, 0xffff0000, v60
 v_lshlrev_b32 v102, 16, v61
 v_and_b32 v103, 0xffff0000, v61
 v_pk_fma_f32 v[8:9], v[8:9], v[68:69], v[100:101]
 v_pk_fma_f32 v[10:11], v[10:11], v[70:71], v[102:103]
 v_pk_mul_f32 v[100:101], v[8:9], v[84:85]
 v_pk_mul_f32 v[102:103], v[10:11], v[86:87]
 v_cvt_pk_bf16_f32 v116, v100, v101
 v_cvt_pk_bf16_f32 v117, v102, v103
 v_lshlrev_b32 v100, 16, v62
 v_and_b32 v101, 0xffff0000, v62
 v_lshlrev_b32 v102, 16, v63
 v_and_b32 v103, 0xffff0000, v63
 v_pk_fma_f32 v[16:17], v[16:17], v[72:73], v[100:101]
 v_pk_fma_f32 v[18:19], v[18:19], v[74:75], v[102:103]
 v_pk_mul_f32 v[100:101], v[16:17], v[88:89]
 v_pk_mul_f32 v[102:103], v[18:19], v[90:91]
 v_cvt_pk_bf16_f32 v118, v100, v101
 v_cvt_pk_bf16_f32 v119, v102, v103
 buffer_store_dwordx4 v[116:119], v51, s[44:47], s42 offen offset:0 sc1
 v_permlane16_swap_b32 v64, v66
 v_permlane16_swap_b32 v65, v67
 v_lshlrev_b32 v100, 16, v64
 v_and_b32 v101, 0xffff0000, v64
 v_lshlrev_b32 v102, 16, v65
 v_and_b32 v103, 0xffff0000, v65
 v_pk_fma_f32 v[24:25], v[24:25], v[76:77], v[100:101]
 v_pk_fma_f32 v[26:27], v[26:27], v[78:79], v[102:103]
 v_pk_mul_f32 v[100:101], v[24:25], v[92:93]
 v_pk_mul_f32 v[102:103], v[26:27], v[94:95]
 v_cvt_pk_bf16_f32 v120, v100, v101
 v_cvt_pk_bf16_f32 v121, v102, v103
 v_lshlrev_b32 v100, 16, v66
 v_and_b32 v101, 0xffff0000, v66
 v_lshlrev_b32 v102, 16, v67
 v_and_b32 v103, 0xffff0000, v67
 v_pk_fma_f32 v[32:33], v[32:33], v[80:81], v[100:101]
 v_pk_fma_f32 v[34:35], v[34:35], v[82:83], v[102:103]
 v_pk_mul_f32 v[100:101], v[32:33], v[96:97]
 v_pk_mul_f32 v[102:103], v[34:35], v[98:99]
 v_cvt_pk_bf16_f32 v122, v100, v101
 v_cvt_pk_bf16_f32 v123, v102, v103
 buffer_store_dwordx4 v[120:123], v51, s[44:47], s42 offen offset:1024 sc1
 v_pk_add_f32 v[108:109], v[4:5], v[6:7]
 v_pk_mul_f32 v[110:111], v[4:5], v[4:5]
 v_pk_fma_f32 v[110:111], v[6:7], v[6:7], v[110:111]
 v_pk_add_f32 v[108:109], v[108:109], v[12:13]
 v_pk_fma_f32 v[110:111], v[12:13], v[12:13], v[110:111]
 v_pk_add_f32 v[108:109], v[108:109], v[14:15]
 v_pk_fma_f32 v[110:111], v[14:15], v[14:15], v[110:111]
 v_pk_add_f32 v[108:109], v[108:109], v[20:21]
 v_pk_fma_f32 v[110:111], v[20:21], v[20:21], v[110:111]
 v_pk_add_f32 v[108:109], v[108:109], v[22:23]
 v_pk_fma_f32 v[110:111], v[22:23], v[22:23], v[110:111]
 v_pk_add_f32 v[108:109], v[108:109], v[28:29]
 v_pk_fma_f32 v[110:111], v[28:29], v[28:29], v[110:111]
 v_pk_add_f32 v[108:109], v[108:109], v[30:31]
 v_pk_fma_f32 v[110:111], v[30:31], v[30:31], v[110:111]
 v_pk_add_f32 v[112:113], v[8:9], v[10:11]
 v_pk_mul_f32 v[114:115], v[8:9], v[8:9]
 v_pk_fma_f32 v[114:115], v[10:11], v[10:11], v[114:115]
 v_pk_add_f32 v[112:113], v[112:113], v[16:17]
 v_pk_fma_f32 v[114:115], v[16:17], v[16:17], v[114:115]
 v_pk_add_f32 v[112:113], v[112:113], v[18:19]
 v_pk_fma_f32 v[114:115], v[18:19], v[18:19], v[114:115]
 v_pk_add_f32 v[112:113], v[112:113], v[24:25]
 v_pk_fma_f32 v[114:115], v[24:25], v[24:25], v[114:115]
 v_pk_add_f32 v[112:113], v[112:113], v[26:27]
 v_pk_fma_f32 v[114:115], v[26:27], v[26:27], v[114:115]
 v_pk_add_f32 v[112:113], v[112:113], v[32:33]
 v_pk_fma_f32 v[114:115], v[32:33], v[32:33], v[114:115]
 v_pk_add_f32 v[112:113], v[112:113], v[34:35]
 v_pk_fma_f32 v[114:115], v[34:35], v[34:35], v[114:115]
 v_add_f32 v108, v108, v109
 v_add_f32 v109, v110, v111
 v_add_f32 v112, v112, v113
 v_add_f32 v113, v114, v115
 s_nop 0
 v_permlane32_swap_b32 v108, v112
 v_permlane32_swap_b32 v109, v113
 v_add_f32 v108, v108, v112
 v_add_f32 v109, v109, v113
 v_mov_b32 v110, v108
 v_mov_b32 v111, v109
 s_nop 0
 v_permlane16_swap_b32 v108, v110
 v_permlane16_swap_b32 v109, v111
 v_add_f32 v108, v108, v110
 v_add_f32 v109, v109, v111
 v_and_b32 v1, 15, v0
 v_lshlrev_b32 v1, 3, v1
 v_lshrrev_b32 v2, 5, v0
 v_lshl_add_u32 v1, v2, 11, v1
 v_bfe_u32 v2, v0, 4, 1
 v_lshl_add_u32 v1, v2, 30, v1
 s_lshl_b32 s18, s15, 11
 s_lshl_b32 s19, s13, 7
 s_add_u32 s18, s18, s19
 buffer_store_dwordx2 v[108:109], v1, s[48:51], s18 offen sc1
 v_cvt_pk_bf16_f32 v52, v4, v5
 v_cvt_pk_bf16_f32 v53, v6, v7
 v_cvt_pk_bf16_f32 v54, v12, v13
 v_cvt_pk_bf16_f32 v55, v14, v15
 v_accvgpr_write_b32 a236, v52
 v_accvgpr_write_b32 a237, v53
 v_accvgpr_write_b32 a238, v54
 v_accvgpr_write_b32 a239, v55
 v_cvt_pk_bf16_f32 v56, v20, v21
 v_cvt_pk_bf16_f32 v57, v22, v23
 v_cvt_pk_bf16_f32 v58, v28, v29
 v_cvt_pk_bf16_f32 v59, v30, v31
 v_accvgpr_write_b32 a240, v56
 v_accvgpr_write_b32 a241, v57
 v_accvgpr_write_b32 a242, v58
 v_accvgpr_write_b32 a243, v59
 v_cvt_pk_bf16_f32 v60, v8, v9
 v_cvt_pk_bf16_f32 v61, v10, v11
 v_cvt_pk_bf16_f32 v62, v16, v17
 v_cvt_pk_bf16_f32 v63, v18, v19
 v_accvgpr_write_b32 a244, v60
 v_accvgpr_write_b32 a245, v61
 v_accvgpr_write_b32 a246, v62
 v_accvgpr_write_b32 a247, v63
 v_cvt_pk_bf16_f32 v64, v24, v25
 v_cvt_pk_bf16_f32 v65, v26, v27
 v_cvt_pk_bf16_f32 v66, v32, v33
 v_cvt_pk_bf16_f32 v67, v34, v35
 v_accvgpr_write_b32 a248, v64
 v_accvgpr_write_b32 a249, v65
 v_accvgpr_write_b32 a250, v66
 v_accvgpr_write_b32 a251, v67
 s_lshr_b32 s16, s15, 3
 s_lshl_b32 s16, s16, 12
 s_lshl_b32 s17, s13, 7
 s_add_u32 s16, s16, s17
 s_add_u32 s16, s16, 65536
 v_mov_b32 v248, s16
 s_lshr_b32 s16, s94, 3
 s_and_b32 s16, s16, -2
 s_lshl_b32 s16, s16, 12
 s_add_u32 s16, s16, 65536
 v_and_b32 v1, 15, v0
 v_lshl_add_u32 v2, v1, 7, s16
 v_lshrrev_b32 v3, 5, v0
 v_lshl_add_u32 v2, v3, 12, v2
 s_mul_i32 s43, s95, 7
 v_bfe_u32 v3, v0, 2, 1
 v_mul_u32_u24 v3, 6, v3
 v_add_u32 v3, s43, v3
 v_lshrrev_b32 v3, 3, v3
 v_bfe_u32 v4, v0, 3, 1
 v_mul_u32_u24 v4, 28, v4
 v_add_u32 v3, v3, v4
 v_and_b32 v4, 3, v0
 v_lshl_add_u32 v3, v3, 2, v4
 v_lshlrev_b32 v3, 7, v3
 v_add_u32 v3, 163840, v3
 v_and_b32 v4, 16, v0
 v_cmp_eq_u32 vcc, 0, v4
 s_nop 1
 v_cndmask_b32 v249, v3, v2, vcc
 s_lshl_b32 s16, s94, 15
 v_lshl_add_u32 v231, v0, 4, s16
 v_add_u32 v232, 32768, v231
 v_add_u32 v233, 65536, v231
 v_add_u32 v234, 98304, v231
 v_lshrrev_b32 v2, 2, v0
 v_mul_u32_u24 v2, 224, v2
 v_and_b32 v3, 3, v0
 v_lshl_add_u32 v235, v3, 3, v2
 v_add_u32 v236, 57344, v235
 v_add_u32 v237, 131072, v235
 v_lshrrev_b32 v1, 4, v0
 v_and_b32 v2, 15, v0
 v_lshlrev_b32 v2, 3, v2
 v_lshl_add_u32 v246, v1, 9, v2
 s_mov_b32 s40, 1376256
 s_add_u32 m0, s96, 57344
 s_mov_b32 s41, 0
 s_add_u32 s24, s8, 0x1000000
 s_addc_u32 s25, s9, 0
 s_mov_b32 s26, 0x400000
 s_mov_b32 s27, 0x00020000
 s_add_u32 s32, s8, 0x200000
 s_addc_u32 s33, s9, 0
 s_mov_b32 s34, 0x40000
 s_mov_b32 s35, 0x00020000
 s_add_u32 s36, s8, 0x100000
 s_addc_u32 s37, s9, 0
 s_mov_b32 s38, 0x38000
 s_mov_b32 s39, 0x00020000
 s_lshl_b32 s42, s94, 11
 s_and_b32 s19, s95, 1
 s_add_u32 s44, s43, s19
 s_lshl_b32 s45, s44, 10
 s_cmp_eq_u32 s19, 0
 s_cselect_b32 s46, 6, 0
 s_add_u32 s46, s46, s43
 s_lshl_b32 s47, s46, 10
 s_waitcnt vmcnt(0)
 s_barrier
 s_cmp_lg_u32 s3, 0
 s_cbranch_scc1 m_kernel_pub7
 v_mov_b32 v250, s59
 s_mov_b64 exec, 1
 buffer_store_dword v250, v248, s[28:31], 0 offen sc1
 s_mov_b64 exec, -1
m_kernel_pub7:
 ds_read_b64_tr_b16 a[0:1], v237 offset:0
 ds_read_b64_tr_b16 a[2:3], v237 offset:3584
 ds_read_b64_tr_b16 a[4:5], v237 offset:32
 ds_read_b64_tr_b16 a[6:7], v237 offset:3616
 ds_read_b64_tr_b16 a[8:9], v237 offset:64
 ds_read_b64_tr_b16 a[10:11], v237 offset:3648
 ds_read_b64_tr_b16 a[12:13], v237 offset:96
 ds_read_b64_tr_b16 a[14:15], v237 offset:3680
 ds_read_b64_tr_b16 a[16:17], v237 offset:128
 ds_read_b64_tr_b16 a[18:19], v237 offset:3712
 ds_read_b64_tr_b16 a[20:21], v237 offset:160
 ds_read_b64_tr_b16 a[22:23], v237 offset:3744
 ds_read_b64_tr_b16 a[24:25], v237 offset:192
 ds_read_b64_tr_b16 a[26:27], v237 offset:3776
 s_mov_b32 s16, 0x8000
 s_cmp_lg_u32 s3, 1
 s_cbranch_scc1 m_kernel_poll8x
m_kernel_poll8:
 buffer_load_dword v250, v249, s[28:31], 0 offen sc1
 s_sub_u32 s16, s16, 1
 s_waitcnt vmcnt(0)
 v_cmp_ne_u32 vcc, s59, v250
 s_nop 0
 s_cselect_b64 vcc, 0, vcc
 s_cbranch_vccnz m_kernel_poll8
m_kernel_poll8x:
 s_barrier
 buffer_load_dwordx4 a[56:59], v231, s[24:27], s41 offen sc1
 buffer_load_dwordx4 a[60:63], v232, s[24:27], s41 offen sc1
 buffer_load_dwordx4 a[64:67], v233, s[24:27], s41 offen sc1
 buffer_load_dwordx4 a[68:71], v234, s[24:27], s41 offen sc1
 buffer_load_dwordx4 a[72:75], v231, s[24:27], s41 offen offset:1024 sc1
 buffer_load_dwordx4 a[76:79], v232, s[24:27], s41 offen offset:1024 sc1
 buffer_load_dwordx4 a[80:83], v233, s[24:27], s41 offen offset:1024 sc1
 buffer_load_dwordx4 a[84:87], v234, s[24:27], s41 offen offset:1024 sc1
 buffer_load_dwordx4 a[88:91], v231, s[24:27], s41 offen offset:2048 sc1
 buffer_load_dwordx4 a[92:95], v232, s[24:27], s41 offen offset:2048 sc1
 buffer_load_dwordx4 a[96:99], v233, s[24:27], s41 offen offset:2048 sc1
 buffer_load_dwordx4 a[100:103], v234, s[24:27], s41 offen offset:2048 sc1
 buffer_load_dwordx4 a[104:107], v231, s[24:27], s41 offen offset:3072 sc1
 buffer_load_dwordx4 a[108:111], v232, s[24:27], s41 offen offset:3072 sc1
 buffer_load_dwordx4 a[112:115], v233, s[24:27], s41 offen offset:3072 sc1
 buffer_load_dwordx4 a[116:119], v234, s[24:27], s41 offen offset:3072 sc1
 s_add_u32 s41, s41, 4096
 buffer_load_dwordx4 a[120:123], v231, s[24:27], s41 offen sc1
 buffer_load_dwordx4 a[124:127], v232, s[24:27], s41 offen sc1
 buffer_load_dwordx4 a[128:131], v233, s[24:27], s41 offen sc1
 buffer_load_dwordx4 a[132:135], v234, s[24:27], s41 offen sc1
 buffer_load_dwordx4 a[136:139], v231, s[24:27], s41 offen offset:1024 sc1
 buffer_load_dwordx4 a[140:143], v232, s[24:27], s41 offen offset:1024 sc1
 buffer_load_dwordx4 a[144:147], v233, s[24:27], s41 offen offset:1024 sc1
 buffer_load_dwordx4 a[148:151], v234, s[24:27], s41 offen offset:1024 sc1
 s_waitcnt vmcnt(23) lgkmcnt(12)
 v_mfma_f32_16x16x32_bf16 v[0:3], a[0:3], a[56:59], 0
 ds_read_b64_tr_b16 a[28:29], v237 offset:14336
 s_waitcnt vmcnt(22)
 v_mfma_f32_16x16x32_bf16 v[4:7], a[0:3], a[60:63], 0
 buffer_load_dwordx4 v224, s[60:63], s40 offen lds
 s_waitcnt vmcnt(22)
 v_mfma_f32_16x16x32_bf16 v[8:11], a[0:3], a[64:67], 0
 ds_read_b64_tr_b16 a[30:31], v237 offset:17920
 s_waitcnt vmcnt(21)
 v_mfma_f32_16x16x32_bf16 v[12:15], a[0:3], a[68:71], 0
 s_waitcnt lgkmcnt(12)
 v_mfma_f32_16x16x32_bf16 v[28:31], a[4:7], a[68:71], 0
 ds_read_b64_tr_b16 a[32:33], v237 offset:14368
 v_mfma_f32_16x16x32_bf16 v[24:27], a[4:7], a[64:67], 0
 buffer_load_dwordx4 v225, s[60:63], s40 offen offset:1024 lds
 v_mfma_f32_16x16x32_bf16 v[20:23], a[4:7], a[60:63], 0
 ds_read_b64_tr_b16 a[34:35], v237 offset:17952
 v_mfma_f32_16x16x32_bf16 v[16:19], a[4:7], a[56:59], 0
 s_waitcnt lgkmcnt(12)
 v_mfma_f32_16x16x32_bf16 v[32:35], a[8:11], a[56:59], 0
 ds_read_b64_tr_b16 a[36:37], v237 offset:14400
 v_mfma_f32_16x16x32_bf16 v[36:39], a[8:11], a[60:63], 0
 buffer_load_dwordx4 v226, s[60:63], s40 offen offset:2048 lds
 v_mfma_f32_16x16x32_bf16 v[40:43], a[8:11], a[64:67], 0
 ds_read_b64_tr_b16 a[38:39], v237 offset:17984
 v_mfma_f32_16x16x32_bf16 v[44:47], a[8:11], a[68:71], 0
 s_waitcnt lgkmcnt(12)
 v_mfma_f32_16x16x32_bf16 v[60:63], a[12:15], a[68:71], 0
 ds_read_b64_tr_b16 a[40:41], v237 offset:14432
 v_mfma_f32_16x16x32_bf16 v[56:59], a[12:15], a[64:67], 0
 buffer_load_dwordx4 v227, s[60:63], s40 offen offset:3072 lds
 s_add_u32 m0, s96, 61440
 v_mfma_f32_16x16x32_bf16 v[52:55], a[12:15], a[60:63], 0
 ds_read_b64_tr_b16 a[42:43], v237 offset:18016
 v_mfma_f32_16x16x32_bf16 v[48:51], a[12:15], a[56:59], 0
 s_waitcnt lgkmcnt(12)
 v_mfma_f32_16x16x32_bf16 v[64:67], a[16:19], a[56:59], 0
 ds_read_b64_tr_b16 a[44:45], v237 offset:14464
 v_mfma_f32_16x16x32_bf16 v[68:71], a[16:19], a[60:63], 0
 buffer_load_dwordx4 v228, s[60:63], s40 offen lds
 v_mfma_f32_16x16x32_bf16 v[72:75], a[16:19], a[64:67], 0
 ds_read_b64_tr_b16 a[46:47], v237 offset:18048
 v_mfma_f32_16x16x32_bf16 v[76:79], a[16:19], a[68:71], 0
 s_waitcnt lgkmcnt(12)
 v_mfma_f32_16x16x32_bf16 v[92:95], a[20:23], a[68:71], 0
 ds_read_b64_tr_b16 a[48:49], v237 offset:14496
 v_mfma_f32_16x16x32_bf16 v[88:91], a[20:23], a[64:67], 0
 buffer_load_dwordx4 v229, s[60:63], s40 offen offset:1024 lds
 v_mfma_f32_16x16x32_bf16 v[84:87], a[20:23], a[60:63], 0
 ds_read_b64_tr_b16 a[50:51], v237 offset:18080
 v_mfma_f32_16x16x32_bf16 v[80:83], a[20:23], a[56:59], 0
 s_waitcnt lgkmcnt(12)
 v_mfma_f32_16x16x32_bf16 v[96:99], a[24:27], a[56:59], 0
 ds_read_b64_tr_b16 a[52:53], v237 offset:14528
 v_mfma_f32_16x16x32_bf16 v[100:103], a[24:27], a[60:63], 0
 v_mfma_f32_16x16x32_bf16 v[104:107], a[24:27], a[64:67], 0
 ds_read_b64_tr_b16 a[54:55], v237 offset:18112
 v_mfma_f32_16x16x32_bf16 v[108:111], a[24:27], a[68:71], 0
 s_waitcnt lgkmcnt(12)
 v_mfma_f32_16x16x32_bf16 v[112:115], a[28:31], a[56:59], 0
 ds_read_b64_tr_b16 a[0:1], v237 offset:7168
 v_mfma_f32_16x16x32_bf16 v[116:119], a[28:31], a[60:63], 0
 buffer_load_dwordx4 v230, s[60:63], s40 offen offset:2048 lds
 s_add_u32 s40, s40, 458752
 s_add_u32 m0, s96, 86016
 v_mfma_f32_16x16x32_bf16 v[120:123], a[28:31], a[64:67], 0
 ds_read_b64_tr_b16 a[2:3], v237 offset:10752
 v_mfma_f32_16x16x32_bf16 v[124:127], a[28:31], a[68:71], 0
 s_waitcnt lgkmcnt(12)
 v_mfma_f32_16x16x32_bf16 v[140:143], a[32:35], a[68:71], 0
 ds_read_b64_tr_b16 a[4:5], v237 offset:7200
 v_mfma_f32_16x16x32_bf16 v[136:139], a[32:35], a[64:67], 0
 buffer_load_dwordx4 a[152:155], v231, s[24:27], s41 offen offset:2048 sc1
 v_mfma_f32_16x16x32_bf16 v[132:135], a[32:35], a[60:63], 0
 ds_read_b64_tr_b16 a[6:7], v237 offset:10784
 v_mfma_f32_16x16x32_bf16 v[128:131], a[32:35], a[56:59], 0
 s_waitcnt lgkmcnt(12)
 v_mfma_f32_16x16x32_bf16 v[144:147], a[36:39], a[56:59], 0
 ds_read_b64_tr_b16 a[8:9], v237 offset:7232
 v_mfma_f32_16x16x32_bf16 v[148:151], a[36:39], a[60:63], 0
 buffer_load_dwordx4 a[156:159], v232, s[24:27], s41 offen offset:2048 sc1
 v_mfma_f32_16x16x32_bf16 v[152:155], a[36:39], a[64:67], 0
 ds_read_b64_tr_b16 a[10:11], v237 offset:10816
 v_mfma_f32_16x16x32_bf16 v[156:159], a[36:39], a[68:71], 0
 s_waitcnt lgkmcnt(12)
 v_mfma_f32_16x16x32_bf16 v[172:175], a[40:43], a[68:71], 0
 ds_read_b64_tr_b16 a[12:13], v237 offset:7264
 v_mfma_f32_16x16x32_bf16 v[168:171], a[40:43], a[64:67], 0
 buffer_load_dwordx4 a[160:163], v233, s[24:27], s41 offen offset:2048 sc1
 v_mfma_f32_16x16x32_bf16 v[164:167], a[40:43], a[60:63], 0
 ds_read_b64_tr_b16 a[14:15], v237 offset:10848
 v_mfma_f32_16x16x32_bf16 v[160:163], a[40:43], a[56:59], 0
 s_waitcnt lgkmcnt(12)
 v_mfma_f32_16x16x32_bf16 v[176:179], a[44:47], a[56:59], 0
 ds_read_b64_tr_b16 a[16:17], v237 offset:7296
 v_mfma_f32_16x16x32_bf16 v[180:183], a[44:47], a[60:63], 0
 buffer_load_dwordx4 a[164:167], v234, s[24:27], s41 offen offset:2048 sc1
 v_mfma_f32_16x16x32_bf16 v[184:187], a[44:47], a[64:67], 0
 ds_read_b64_tr_b16 a[18:19], v237 offset:10880
 v_mfma_f32_16x16x32_bf16 v[188:191], a[44:47], a[68:71], 0
 s_waitcnt lgkmcnt(12)
 v_mfma_f32_16x16x32_bf16 v[204:207], a[48:51], a[68:71], 0
 ds_read_b64_tr_b16 a[20:21], v237 offset:7328
 v_mfma_f32_16x16x32_bf16 v[200:203], a[48:51], a[64:67], 0
 buffer_load_dwordx4 a[168:171], v231, s[24:27], s41 offen offset:3072 sc1
 v_mfma_f32_16x16x32_bf16 v[196:199], a[48:51], a[60:63], 0
 ds_read_b64_tr_b16 a[22:23], v237 offset:10912
 v_mfma_f32_16x16x32_bf16 v[192:195], a[48:51], a[56:59], 0
 s_waitcnt lgkmcnt(12)
 v_mfma_f32_16x16x32_bf16 v[208:211], a[52:55], a[56:59], 0
 ds_read_b64_tr_b16 a[24:25], v237 offset:7360
 v_mfma_f32_16x16x32_bf16 v[212:215], a[52:55], a[60:63], 0
 v_mfma_f32_16x16x32_bf16 v[216:219], a[52:55], a[64:67], 0
 ds_read_b64_tr_b16 a[26:27], v237 offset:10944
 v_mfma_f32_16x16x32_bf16 v[220:223], a[52:55], a[68:71], 0
 s_waitcnt vmcnt(31) lgkmcnt(12)
 v_mfma_f32_16x16x32_bf16 v[0:3], a[0:3], a[72:75], v[0:3]
 ds_read_b64_tr_b16 a[28:29], v237 offset:21504
 s_waitcnt vmcnt(30)
 v_mfma_f32_16x16x32_bf16 v[4:7], a[0:3], a[76:79], v[4:7]
 buffer_load_dwordx4 a[172:175], v232, s[24:27], s41 offen offset:3072 sc1
 s_waitcnt vmcnt(30)
 v_mfma_f32_16x16x32_bf16 v[8:11], a[0:3], a[80:83], v[8:11]
 ds_read_b64_tr_b16 a[30:31], v237 offset:25088
 s_waitcnt vmcnt(29)
 v_mfma_f32_16x16x32_bf16 v[12:15], a[0:3], a[84:87], v[12:15]
 buffer_load_dwordx2 v[238:239], v246, s[32:35], s42 offen offset:0 sc1
 s_waitcnt lgkmcnt(12)
 v_mfma_f32_16x16x32_bf16 v[28:31], a[4:7], a[84:87], v[28:31]
 ds_read_b64_tr_b16 a[32:33], v237 offset:21536
 v_mfma_f32_16x16x32_bf16 v[24:27], a[4:7], a[80:83], v[24:27]
 buffer_load_dwordx4 a[176:179], v233, s[24:27], s41 offen offset:3072 sc1
 buffer_load_dwordx2 v[240:241], v246, s[32:35], s42 offen offset:128 sc1
 v_mfma_f32_16x16x32_bf16 v[20:23], a[4:7], a[76:79], v[20:23]
 ds_read_b64_tr_b16 a[34:35], v237 offset:25120
 v_mfma_f32_16x16x32_bf16 v[16:19], a[4:7], a[72:75], v[16:19]
 buffer_load_dwordx2 v[242:243], v246, s[32:35], s42 offen offset:256 sc1
 s_waitcnt lgkmcnt(12)
 v_mfma_f32_16x16x32_bf16 v[32:35], a[8:11], a[72:75], v[32:35]
 ds_read_b64_tr_b16 a[36:37], v237 offset:21568
 v_mfma_f32_16x16x32_bf16 v[36:39], a[8:11], a[76:79], v[36:39]
 buffer_load_dwordx4 a[180:183], v234, s[24:27], s41 offen offset:3072 sc1
 s_add_u32 s41, s41, 4096
 buffer_load_dwordx2 v[244:245], v246, s[32:35], s42 offen offset:384 sc1
 v_mfma_f32_16x16x32_bf16 v[40:43], a[8:11], a[80:83], v[40:43]
 ds_read_b64_tr_b16 a[38:39], v237 offset:25152
 v_mfma_f32_16x16x32_bf16 v[44:47], a[8:11], a[84:87], v[44:47]
 s_add_u32 s42, s42, 2048
 s_waitcnt lgkmcnt(12)
 v_mfma_f32_16x16x32_bf16 v[60:63], a[12:15], a[84:87], v[60:63]
 ds_read_b64_tr_b16 a[40:41], v237 offset:21600
 v_mfma_f32_16x16x32_bf16 v[56:59], a[12:15], a[80:83], v[56:59]
 buffer_load_dwordx4 v224, s[60:63], s40 offen lds
 v_mfma_f32_16x16x32_bf16 v[52:55], a[12:15], a[76:79], v[52:55]
 ds_read_b64_tr_b16 a[42:43], v237 offset:25184
 v_mfma_f32_16x16x32_bf16 v[48:51], a[12:15], a[72:75], v[48:51]
 s_waitcnt lgkmcnt(12)
 v_mfma_f32_16x16x32_bf16 v[64:67], a[16:19], a[72:75], v[64:67]
 ds_read_b64_tr_b16 a[44:45], v237 offset:21632
 v_mfma_f32_16x16x32_bf16 v[68:71], a[16:19], a[76:79], v[68:71]
 buffer_load_dwordx4 v225, s[60:63], s40 offen offset:1024 lds
 v_mfma_f32_16x16x32_bf16 v[72:75], a[16:19], a[80:83], v[72:75]
 ds_read_b64_tr_b16 a[46:47], v237 offset:25216
 v_mfma_f32_16x16x32_bf16 v[76:79], a[16:19], a[84:87], v[76:79]
 s_waitcnt lgkmcnt(12)
 v_mfma_f32_16x16x32_bf16 v[92:95], a[20:23], a[84:87], v[92:95]
 ds_read_b64_tr_b16 a[48:49], v237 offset:21664
 v_mfma_f32_16x16x32_bf16 v[88:91], a[20:23], a[80:83], v[88:91]
 buffer_load_dwordx4 v226, s[60:63], s40 offen offset:2048 lds
 v_mfma_f32_16x16x32_bf16 v[84:87], a[20:23], a[76:79], v[84:87]
 ds_read_b64_tr_b16 a[50:51], v237 offset:25248
 v_mfma_f32_16x16x32_bf16 v[80:83], a[20:23], a[72:75], v[80:83]
 s_waitcnt lgkmcnt(12)
 v_mfma_f32_16x16x32_bf16 v[96:99], a[24:27], a[72:75], v[96:99]
 ds_read_b64_tr_b16 a[52:53], v237 offset:21696
 v_mfma_f32_16x16x32_bf16 v[100:103], a[24:27], a[76:79], v[100:103]
 v_mfma_f32_16x16x32_bf16 v[104:107], a[24:27], a[80:83], v[104:107]
 ds_read_b64_tr_b16 a[54:55], v237 offset:25280
 v_mfma_f32_16x16x32_bf16 v[108:111], a[24:27], a[84:87], v[108:111]
 s_waitcnt lgkmcnt(0)
 s_barrier
 v_mfma_f32_16x16x32_bf16 v[112:115], a[28:31], a[72:75], v[112:115]
 ds_read_b64_tr_b16 a[0:1], v235 offset:0
 v_mfma_f32_16x16x32_bf16 v[116:119], a[28:31], a[76:79], v[116:119]
 buffer_load_dwordx4 v227, s[60:63], s40 offen offset:3072 lds
 s_add_u32 m0, s96, 90112
 v_mfma_f32_16x16x32_bf16 v[120:123], a[28:31], a[80:83], v[120:123]
 ds_read_b64_tr_b16 a[2:3], v235 offset:3584
 v_mfma_f32_16x16x32_bf16 v[124:127], a[28:31], a[84:87], v[124:127]
 v_mfma_f32_16x16x32_bf16 v[140:143], a[32:35], a[84:87], v[140:143]
 ds_read_b64_tr_b16 a[4:5], v235 offset:32
 v_mfma_f32_16x16x32_bf16 v[136:139], a[32:35], a[80:83], v[136:139]
 buffer_load_dwordx4 v228, s[60:63], s40 offen lds
 v_mfma_f32_16x16x32_bf16 v[132:135], a[32:35], a[76:79], v[132:135]
 ds_read_b64_tr_b16 a[6:7], v235 offset:3616
 v_mfma_f32_16x16x32_bf16 v[128:131], a[32:35], a[72:75], v[128:131]
 v_mfma_f32_16x16x32_bf16 v[144:147], a[36:39], a[72:75], v[144:147]
 ds_read_b64_tr_b16 a[8:9], v235 offset:64
 v_mfma_f32_16x16x32_bf16 v[148:151], a[36:39], a[76:79], v[148:151]
 buffer_load_dwordx4 v229, s[60:63], s40 offen offset:1024 lds
 v_mfma_f32_16x16x32_bf16 v[152:155], a[36:39], a[80:83], v[152:155]
 ds_read_b64_tr_b16 a[10:11], v235 offset:3648
 v_mfma_f32_16x16x32_bf16 v[156:159], a[36:39], a[84:87], v[156:159]
 v_mfma_f32_16x16x32_bf16 v[172:175], a[40:43], a[84:87], v[172:175]
 ds_read_b64_tr_b16 a[12:13], v235 offset:96
 v_mfma_f32_16x16x32_bf16 v[168:171], a[40:43], a[80:83], v[168:171]
 buffer_load_dwordx4 v230, s[60:63], s40 offen offset:2048 lds
 s_add_u32 s40, s40, 458752
 s_add_u32 m0, s96, 131072
 v_mfma_f32_16x16x32_bf16 v[164:167], a[40:43], a[76:79], v[164:167]
 ds_read_b64_tr_b16 a[14:15], v235 offset:3680
 v_mfma_f32_16x16x32_bf16 v[160:163], a[40:43], a[72:75], v[160:163]
 v_mfma_f32_16x16x32_bf16 v[176:179], a[44:47], a[72:75], v[176:179]
 ds_read_b64_tr_b16 a[16:17], v235 offset:128
 v_mfma_f32_16x16x32_bf16 v[180:183], a[44:47], a[76:79], v[180:183]
 buffer_load_dwordx4 a[56:59], v231, s[24:27], s41 offen sc1
 v_mfma_f32_16x16x32_bf16 v[184:187], a[44:47], a[80:83], v[184:187]
 ds_read_b64_tr_b16 a[18:19], v235 offset:3712
 v_mfma_f32_16x16x32_bf16 v[188:191], a[44:47], a[84:87], v[188:191]
 v_mfma_f32_16x16x32_bf16 v[204:207], a[48:51], a[84:87], v[204:207]
 ds_read_b64_tr_b16 a[20:21], v235 offset:160
 v_mfma_f32_16x16x32_bf16 v[200:203], a[48:51], a[80:83], v[200:203]
 buffer_load_dwordx4 a[60:63], v232, s[24:27], s41 offen sc1
 v_mfma_f32_16x16x32_bf16 v[196:199], a[48:51], a[76:79], v[196:199]
 ds_read_b64_tr_b16 a[22:23], v235 offset:3744
 v_mfma_f32_16x16x32_bf16 v[192:195], a[48:51], a[72:75], v[192:195]
 v_mfma_f32_16x16x32_bf16 v[208:211], a[52:55], a[72:75], v[208:211]
 ds_read_b64_tr_b16 a[24:25], v235 offset:192
 v_mfma_f32_16x16x32_bf16 v[212:215], a[52:55], a[76:79], v[212:215]
 v_mfma_f32_16x16x32_bf16 v[216:219], a[52:55], a[80:83], v[216:219]
 ds_read_b64_tr_b16 a[26:27], v235 offset:3776
 v_mfma_f32_16x16x32_bf16 v[220:223], a[52:55], a[84:87], v[220:223]
 s_waitcnt vmcnt(43) lgkmcnt(12)
 v_mfma_f32_16x16x32_bf16 v[0:3], a[0:3], a[88:91], v[0:3]
 ds_read_b64_tr_b16 a[28:29], v235 offset:14336
 s_waitcnt vmcnt(42)
 v_mfma_f32_16x16x32_bf16 v[4:7], a[0:3], a[92:95], v[4:7]
 buffer_load_dwordx4 a[64:67], v233, s[24:27], s41 offen sc1
 s_waitcnt vmcnt(42)
 v_mfma_f32_16x16x32_bf16 v[8:11], a[0:3], a[96:99], v[8:11]
 ds_read_b64_tr_b16 a[30:31], v235 offset:17920
 s_waitcnt vmcnt(41)
 v_mfma_f32_16x16x32_bf16 v[12:15], a[0:3], a[100:103], v[12:15]
 s_waitcnt lgkmcnt(12)
 v_mfma_f32_16x16x32_bf16 v[28:31], a[4:7], a[100:103], v[28:31]
 ds_read_b64_tr_b16 a[32:33], v235 offset:14368
 v_mfma_f32_16x16x32_bf16 v[24:27], a[4:7], a[96:99], v[24:27]
 buffer_load_dwordx4 a[68:71], v234, s[24:27], s41 offen sc1
 v_mfma_f32_16x16x32_bf16 v[20:23], a[4:7], a[92:95], v[20:23]
 ds_read_b64_tr_b16 a[34:35], v235 offset:17952
 v_mfma_f32_16x16x32_bf16 v[16:19], a[4:7], a[88:91], v[16:19]
 s_waitcnt lgkmcnt(12)
 v_mfma_f32_16x16x32_bf16 v[32:35], a[8:11], a[88:91], v[32:35]
 ds_read_b64_tr_b16 a[36:37], v235 offset:14400
 v_mfma_f32_16x16x32_bf16 v[36:39], a[8:11], a[92:95], v[36:39]
 buffer_load_dwordx4 a[72:75], v231, s[24:27], s41 offen offset:1024 sc1
 v_mfma_f32_16x16x32_bf16 v[40:43], a[8:11], a[96:99], v[40:43]
 ds_read_b64_tr_b16 a[38:39], v235 offset:17984
 v_mfma_f32_16x16x32_bf16 v[44:47], a[8:11], a[100:103], v[44:47]
 s_waitcnt lgkmcnt(12)
 v_mfma_f32_16x16x32_bf16 v[60:63], a[12:15], a[100:103], v[60:63]
 ds_read_b64_tr_b16 a[40:41], v235 offset:14432
 v_mfma_f32_16x16x32_bf16 v[56:59], a[12:15], a[96:99], v[56:59]
 buffer_load_dwordx4 a[76:79], v232, s[24:27], s41 offen offset:1024 sc1
 v_mfma_f32_16x16x32_bf16 v[52:55], a[12:15], a[92:95], v[52:55]
 ds_read_b64_tr_b16 a[42:43], v235 offset:18016
 v_mfma_f32_16x16x32_bf16 v[48:51], a[12:15], a[88:91], v[48:51]
 s_waitcnt lgkmcnt(12)
 v_mfma_f32_16x16x32_bf16 v[64:67], a[16:19], a[88:91], v[64:67]
 ds_read_b64_tr_b16 a[44:45], v235 offset:14464
 v_mfma_f32_16x16x32_bf16 v[68:71], a[16:19], a[92:95], v[68:71]
 buffer_load_dwordx4 a[80:83], v233, s[24:27], s41 offen offset:1024 sc1
 v_mfma_f32_16x16x32_bf16 v[72:75], a[16:19], a[96:99], v[72:75]
 ds_read_b64_tr_b16 a[46:47], v235 offset:18048
 v_mfma_f32_16x16x32_bf16 v[76:79], a[16:19], a[100:103], v[76:79]
 s_waitcnt lgkmcnt(12)
 v_mfma_f32_16x16x32_bf16 v[92:95], a[20:23], a[100:103], v[92:95]
 ds_read_b64_tr_b16 a[48:49], v235 offset:14496
 v_mfma_f32_16x16x32_bf16 v[88:91], a[20:23], a[96:99], v[88:91]
 buffer_load_dwordx4 a[84:87], v234, s[24:27], s41 offen offset:1024 sc1
 v_mfma_f32_16x16x32_bf16 v[84:87], a[20:23], a[92:95], v[84:87]
 ds_read_b64_tr_b16 a[50:51], v235 offset:18080
 v_mfma_f32_16x16x32_bf16 v[80:83], a[20:23], a[88:91], v[80:83]
 s_waitcnt lgkmcnt(12)
 v_mfma_f32_16x16x32_bf16 v[96:99], a[24:27], a[88:91], v[96:99]
 ds_read_b64_tr_b16 a[52:53], v235 offset:14528
 v_mfma_f32_16x16x32_bf16 v[100:103], a[24:27], a[92:95], v[100:103]
 v_mfma_f32_16x16x32_bf16 v[104:107], a[24:27], a[96:99], v[104:107]
 ds_read_b64_tr_b16 a[54:55], v235 offset:18112
 v_mfma_f32_16x16x32_bf16 v[108:111], a[24:27], a[100:103], v[108:111]
 s_waitcnt lgkmcnt(12)
 v_mfma_f32_16x16x32_bf16 v[112:115], a[28:31], a[88:91], v[112:115]
 ds_read_b64_tr_b16 a[0:1], v235 offset:7168
 v_mfma_f32_16x16x32_bf16 v[116:119], a[28:31], a[92:95], v[116:119]
 buffer_load_dwordx4 v224, s[60:63], s40 offen lds
 v_mfma_f32_16x16x32_bf16 v[120:123], a[28:31], a[96:99], v[120:123]
 ds_read_b64_tr_b16 a[2:3], v235 offset:10752
 v_mfma_f32_16x16x32_bf16 v[124:127], a[28:31], a[100:103], v[124:127]
 s_waitcnt lgkmcnt(12)
 v_mfma_f32_16x16x32_bf16 v[140:143], a[32:35], a[100:103], v[140:143]
 ds_read_b64_tr_b16 a[4:5], v235 offset:7200
 v_mfma_f32_16x16x32_bf16 v[136:139], a[32:35], a[96:99], v[136:139]
 buffer_load_dwordx4 v225, s[60:63], s40 offen offset:1024 lds
 v_mfma_f32_16x16x32_bf16 v[132:135], a[32:35], a[92:95], v[132:135]
 ds_read_b64_tr_b16 a[6:7], v235 offset:10784
 v_mfma_f32_16x16x32_bf16 v[128:131], a[32:35], a[88:91], v[128:131]
 s_waitcnt lgkmcnt(12)
 v_mfma_f32_16x16x32_bf16 v[144:147], a[36:39], a[88:91], v[144:147]
 ds_read_b64_tr_b16 a[8:9], v235 offset:7232
 v_mfma_f32_16x16x32_bf16 v[148:151], a[36:39], a[92:95], v[148:151]
 buffer_load_dwordx4 v226, s[60:63], s40 offen offset:2048 lds
 v_mfma_f32_16x16x32_bf16 v[152:155], a[36:39], a[96:99], v[152:155]
 ds_read_b64_tr_b16 a[10:11], v235 offset:10816
 v_mfma_f32_16x16x32_bf16 v[156:159], a[36:39], a[100:103], v[156:159]
 s_waitcnt lgkmcnt(12)
 v_mfma_f32_16x16x32_bf16 v[172:175], a[40:43], a[100:103], v[172:175]
 ds_read_b64_tr_b16 a[12:13], v235 offset:7264
 v_mfma_f32_16x16x32_bf16 v[168:171], a[40:43], a[96:99], v[168:171]
 buffer_load_dwordx4 v227, s[60:63], s40 offen offset:3072 lds
 s_add_u32 m0, s96, 135168
 v_mfma_f32_16x16x32_bf16 v[164:167], a[40:43], a[92:95], v[164:167]
 ds_read_b64_tr_b16 a[14:15], v235 offset:10848
 v_mfma_f32_16x16x32_bf16 v[160:163], a[40:43], a[88:91], v[160:163]
 s_waitcnt lgkmcnt(12)
 v_mfma_f32_16x16x32_bf16 v[176:179], a[44:47], a[88:91], v[176:179]
 ds_read_b64_tr_b16 a[16:17], v235 offset:7296
 v_mfma_f32_16x16x32_bf16 v[180:183], a[44:47], a[92:95], v[180:183]
 buffer_load_dwordx4 v228, s[60:63], s40 offen lds
 v_mfma_f32_16x16x32_bf16 v[184:187], a[44:47], a[96:99], v[184:187]
 ds_read_b64_tr_b16 a[18:19], v235 offset:10880
 v_mfma_f32_16x16x32_bf16 v[188:191], a[44:47], a[100:103], v[188:191]
 s_waitcnt lgkmcnt(12)
 v_mfma_f32_16x16x32_bf16 v[204:207], a[48:51], a[100:103], v[204:207]
 ds_read_b64_tr_b16 a[20:21], v235 offset:7328
 v_mfma_f32_16x16x32_bf16 v[200:203], a[48:51], a[96:99], v[200:203]
 buffer_load_dwordx4 v229, s[60:63], s40 offen offset:1024 lds
 v_mfma_f32_16x16x32_bf16 v[196:199], a[48:51], a[92:95], v[196:199]
 ds_read_b64_tr_b16 a[22:23], v235 offset:10912
 v_mfma_f32_16x16x32_bf16 v[192:195], a[48:51], a[88:91], v[192:195]
 s_waitcnt lgkmcnt(12)
 v_mfma_f32_16x16x32_bf16 v[208:211], a[52:55], a[88:91], v[208:211]
 ds_read_b64_tr_b16 a[24:25], v235 offset:7360
 v_mfma_f32_16x16x32_bf16 v[212:215], a[52:55], a[92:95], v[212:215]
 v_mfma_f32_16x16x32_bf16 v[216:219], a[52:55], a[96:99], v[216:219]
 ds_read_b64_tr_b16 a[26:27], v235 offset:10944
 v_mfma_f32_16x16x32_bf16 v[220:223], a[52:55], a[100:103], v[220:223]
 s_waitcnt vmcnt(51) lgkmcnt(12)
 v_mfma_f32_16x16x32_bf16 v[0:3], a[0:3], a[104:107], v[0:3]
 ds_read_b64_tr_b16 a[28:29], v235 offset:21504
 s_waitcnt vmcnt(50)
 v_mfma_f32_16x16x32_bf16 v[4:7], a[0:3], a[108:111], v[4:7]
 buffer_load_dwordx4 v230, s[60:63], s40 offen offset:2048 lds
 s_add_u32 s40, s40, 458752
 s_add_u32 m0, s96, 0
 s_waitcnt vmcnt(50)
 v_mfma_f32_16x16x32_bf16 v[8:11], a[0:3], a[112:115], v[8:11]
 ds_read_b64_tr_b16 a[30:31], v235 offset:25088
 s_waitcnt vmcnt(49)
 v_mfma_f32_16x16x32_bf16 v[12:15], a[0:3], a[116:119], v[12:15]
 s_waitcnt lgkmcnt(12)
 v_mfma_f32_16x16x32_bf16 v[28:31], a[4:7], a[116:119], v[28:31]
 ds_read_b64_tr_b16 a[32:33], v235 offset:21536
 v_mfma_f32_16x16x32_bf16 v[24:27], a[4:7], a[112:115], v[24:27]
 buffer_load_dwordx4 a[88:91], v231, s[24:27], s41 offen offset:2048 sc1
 v_mfma_f32_16x16x32_bf16 v[20:23], a[4:7], a[108:111], v[20:23]
 ds_read_b64_tr_b16 a[34:35], v235 offset:25120
 v_mfma_f32_16x16x32_bf16 v[16:19], a[4:7], a[104:107], v[16:19]
 s_waitcnt lgkmcnt(12)
 v_mfma_f32_16x16x32_bf16 v[32:35], a[8:11], a[104:107], v[32:35]
 ds_read_b64_tr_b16 a[36:37], v235 offset:21568
 v_mfma_f32_16x16x32_bf16 v[36:39], a[8:11], a[108:111], v[36:39]
 buffer_load_dwordx4 a[92:95], v232, s[24:27], s41 offen offset:2048 sc1
 v_mfma_f32_16x16x32_bf16 v[40:43], a[8:11], a[112:115], v[40:43]
 ds_read_b64_tr_b16 a[38:39], v235 offset:25152
 v_mfma_f32_16x16x32_bf16 v[44:47], a[8:11], a[116:119], v[44:47]
 s_waitcnt lgkmcnt(12)
 v_mfma_f32_16x16x32_bf16 v[60:63], a[12:15], a[116:119], v[60:63]
 ds_read_b64_tr_b16 a[40:41], v235 offset:21600
 v_mfma_f32_16x16x32_bf16 v[56:59], a[12:15], a[112:115], v[56:59]
 buffer_load_dwordx4 a[96:99], v233, s[24:27], s41 offen offset:2048 sc1
 v_mfma_f32_16x16x32_bf16 v[52:55], a[12:15], a[108:111], v[52:55]
 ds_read_b64_tr_b16 a[42:43], v235 offset:25184
 v_mfma_f32_16x16x32_bf16 v[48:51], a[12:15], a[104:107], v[48:51]
 s_waitcnt lgkmcnt(12)
 v_mfma_f32_16x16x32_bf16 v[64:67], a[16:19], a[104:107], v[64:67]
 ds_read_b64_tr_b16 a[44:45], v235 offset:21632
 v_mfma_f32_16x16x32_bf16 v[68:71], a[16:19], a[108:111], v[68:71]
 buffer_load_dwordx4 a[100:103], v234, s[24:27], s41 offen offset:2048 sc1
 v_mfma_f32_16x16x32_bf16 v[72:75], a[16:19], a[112:115], v[72:75]
 ds_read_b64_tr_b16 a[46:47], v235 offset:25216
 v_mfma_f32_16x16x32_bf16 v[76:79], a[16:19], a[116:119], v[76:79]
 s_waitcnt lgkmcnt(12)
 v_mfma_f32_16x16x32_bf16 v[92:95], a[20:23], a[116:119], v[92:95]
 ds_read_b64_tr_b16 a[48:49], v235 offset:21664
 v_mfma_f32_16x16x32_bf16 v[88:91], a[20:23], a[112:115], v[88:91]
 v_mfma_f32_16x16x32_bf16 v[84:87], a[20:23], a[108:111], v[84:87]
 ds_read_b64_tr_b16 a[50:51], v235 offset:25248
 v_mfma_f32_16x16x32_bf16 v[80:83], a[20:23], a[104:107], v[80:83]
 s_waitcnt lgkmcnt(12)
 v_mfma_f32_16x16x32_bf16 v[96:99], a[24:27], a[104:107], v[96:99]
 ds_read_b64_tr_b16 a[52:53], v235 offset:21696
 v_mfma_f32_16x16x32_bf16 v[100:103], a[24:27], a[108:111], v[100:103]
 v_mfma_f32_16x16x32_bf16 v[104:107], a[24:27], a[112:115], v[104:107]
 ds_read_b64_tr_b16 a[54:55], v235 offset:25280
 v_mfma_f32_16x16x32_bf16 v[108:111], a[24:27], a[116:119], v[108:111]
 s_waitcnt lgkmcnt(0)
 s_barrier
 v_mfma_f32_16x16x32_bf16 v[112:115], a[28:31], a[104:107], v[112:115]
 ds_read_b64_tr_b16 a[0:1], v235 offset:28672
 v_mfma_f32_16x16x32_bf16 v[116:119], a[28:31], a[108:111], v[116:119]
 v_mfma_f32_16x16x32_bf16 v[120:123], a[28:31], a[112:115], v[120:123]
 ds_read_b64_tr_b16 a[2:3], v235 offset:32256
 v_mfma_f32_16x16x32_bf16 v[124:127], a[28:31], a[116:119], v[124:127]
 v_mfma_f32_16x16x32_bf16 v[140:143], a[32:35], a[116:119], v[140:143]
 ds_read_b64_tr_b16 a[4:5], v235 offset:28704
 v_mfma_f32_16x16x32_bf16 v[136:139], a[32:35], a[112:115], v[136:139]
 v_mfma_f32_16x16x32_bf16 v[132:135], a[32:35], a[108:111], v[132:135]
 ds_read_b64_tr_b16 a[6:7], v235 offset:32288
 v_mfma_f32_16x16x32_bf16 v[128:131], a[32:35], a[104:107], v[128:131]
 v_mfma_f32_16x16x32_bf16 v[144:147], a[36:39], a[104:107], v[144:147]
 ds_read_b64_tr_b16 a[8:9], v235 offset:28736
 v_mfma_f32_16x16x32_bf16 v[148:151], a[36:39], a[108:111], v[148:151]
 v_mfma_f32_16x16x32_bf16 v[152:155], a[36:39], a[112:115], v[152:155]
 ds_read_b64_tr_b16 a[10:11], v235 offset:32320
 v_mfma_f32_16x16x32_bf16 v[156:159], a[36:39], a[116:119], v[156:159]
 v_mfma_f32_16x16x32_bf16 v[172:175], a[40:43], a[116:119], v[172:175]
 ds_read_b64_tr_b16 a[12:13], v235 offset:28768
 v_mfma_f32_16x16x32_bf16 v[168:171], a[40:43], a[112:115], v[168:171]
 v_mfma_f32_16x16x32_bf16 v[164:167], a[40:43], a[108:111], v[164:167]
 ds_read_b64_tr_b16 a[14:15], v235 offset:32352
 v_mfma_f32_16x16x32_bf16 v[160:163], a[40:43], a[104:107], v[160:163]
 v_mfma_f32_16x16x32_bf16 v[176:179], a[44:47], a[104:107], v[176:179]
 ds_read_b64_tr_b16 a[16:17], v235 offset:28800
 v_mfma_f32_16x16x32_bf16 v[180:183], a[44:47], a[108:111], v[180:183]
 v_mfma_f32_16x16x32_bf16 v[184:187], a[44:47], a[112:115], v[184:187]
 ds_read_b64_tr_b16 a[18:19], v235 offset:32384
 v_mfma_f32_16x16x32_bf16 v[188:191], a[44:47], a[116:119], v[188:191]
 v_mfma_f32_16x16x32_bf16 v[204:207], a[48:51], a[116:119], v[204:207]
 ds_read_b64_tr_b16 a[20:21], v235 offset:28832
 v_mfma_f32_16x16x32_bf16 v[200:203], a[48:51], a[112:115], v[200:203]
 v_mfma_f32_16x16x32_bf16 v[196:199], a[48:51], a[108:111], v[196:199]
 ds_read_b64_tr_b16 a[22:23], v235 offset:32416
 v_mfma_f32_16x16x32_bf16 v[192:195], a[48:51], a[104:107], v[192:195]
 v_mfma_f32_16x16x32_bf16 v[208:211], a[52:55], a[104:107], v[208:211]
 ds_read_b64_tr_b16 a[24:25], v235 offset:28864
 v_mfma_f32_16x16x32_bf16 v[212:215], a[52:55], a[108:111], v[212:215]
 v_mfma_f32_16x16x32_bf16 v[216:219], a[52:55], a[112:115], v[216:219]
 ds_read_b64_tr_b16 a[26:27], v235 offset:32448
 v_mfma_f32_16x16x32_bf16 v[220:223], a[52:55], a[116:119], v[220:223]
 s_waitcnt vmcnt(52) lgkmcnt(12)
 v_mfma_f32_16x16x32_bf16 v[0:3], a[0:3], a[120:123], v[0:3]
 ds_read_b64_tr_b16 a[28:29], v235 offset:43008
 s_waitcnt vmcnt(51)
 v_mfma_f32_16x16x32_bf16 v[4:7], a[0:3], a[124:127], v[4:7]
 buffer_load_dwordx4 a[104:107], v231, s[24:27], s41 offen offset:3072 sc1
 s_waitcnt vmcnt(51)
 v_mfma_f32_16x16x32_bf16 v[8:11], a[0:3], a[128:131], v[8:11]
 ds_read_b64_tr_b16 a[30:31], v235 offset:46592
 s_waitcnt vmcnt(50)
 v_mfma_f32_16x16x32_bf16 v[12:15], a[0:3], a[132:135], v[12:15]
 s_waitcnt lgkmcnt(12)
 v_mfma_f32_16x16x32_bf16 v[28:31], a[4:7], a[132:135], v[28:31]
 ds_read_b64_tr_b16 a[32:33], v235 offset:43040
 v_mfma_f32_16x16x32_bf16 v[24:27], a[4:7], a[128:131], v[24:27]
 buffer_load_dwordx4 a[108:111], v232, s[24:27], s41 offen offset:3072 sc1
 v_mfma_f32_16x16x32_bf16 v[20:23], a[4:7], a[124:127], v[20:23]
 ds_read_b64_tr_b16 a[34:35], v235 offset:46624
 v_mfma_f32_16x16x32_bf16 v[16:19], a[4:7], a[120:123], v[16:19]
 s_waitcnt lgkmcnt(12)
 v_mfma_f32_16x16x32_bf16 v[32:35], a[8:11], a[120:123], v[32:35]
 ds_read_b64_tr_b16 a[36:37], v235 offset:43072
 v_mfma_f32_16x16x32_bf16 v[36:39], a[8:11], a[124:127], v[36:39]
 buffer_load_dwordx4 a[112:115], v233, s[24:27], s41 offen offset:3072 sc1
 v_mfma_f32_16x16x32_bf16 v[40:43], a[8:11], a[128:131], v[40:43]
 ds_read_b64_tr_b16 a[38:39], v235 offset:46656
 v_mfma_f32_16x16x32_bf16 v[44:47], a[8:11], a[132:135], v[44:47]
 s_waitcnt lgkmcnt(12)
 v_mfma_f32_16x16x32_bf16 v[60:63], a[12:15], a[132:135], v[60:63]
 ds_read_b64_tr_b16 a[40:41], v235 offset:43104
 v_mfma_f32_16x16x32_bf16 v[56:59], a[12:15], a[128:131], v[56:59]
 buffer_load_dwordx4 a[116:119], v234, s[24:27], s41 offen offset:3072 sc1
 s_add_u32 s41, s41, 4096
 v_mfma_f32_16x16x32_bf16 v[52:55], a[12:15], a[124:127], v[52:55]
 ds_read_b64_tr_b16 a[42:43], v235 offset:46688
 v_mfma_f32_16x16x32_bf16 v[48:51], a[12:15], a[120:123], v[48:51]
 s_waitcnt lgkmcnt(12)
 v_mfma_f32_16x16x32_bf16 v[64:67], a[16:19], a[120:123], v[64:67]
 ds_read_b64_tr_b16 a[44:45], v235 offset:43136
 v_mfma_f32_16x16x32_bf16 v[68:71], a[16:19], a[124:127], v[68:71]
 buffer_load_dwordx4 v224, s[60:63], s40 offen lds
 v_mfma_f32_16x16x32_bf16 v[72:75], a[16:19], a[128:131], v[72:75]
 ds_read_b64_tr_b16 a[46:47], v235 offset:46720
 v_mfma_f32_16x16x32_bf16 v[76:79], a[16:19], a[132:135], v[76:79]
 s_waitcnt lgkmcnt(12)
 v_mfma_f32_16x16x32_bf16 v[92:95], a[20:23], a[132:135], v[92:95]
 ds_read_b64_tr_b16 a[48:49], v235 offset:43168
 v_mfma_f32_16x16x32_bf16 v[88:91], a[20:23], a[128:131], v[88:91]
 buffer_load_dwordx4 v225, s[60:63], s40 offen offset:1024 lds
 v_mfma_f32_16x16x32_bf16 v[84:87], a[20:23], a[124:127], v[84:87]
 ds_read_b64_tr_b16 a[50:51], v235 offset:46752
 v_mfma_f32_16x16x32_bf16 v[80:83], a[20:23], a[120:123], v[80:83]
 s_waitcnt lgkmcnt(12)
 v_mfma_f32_16x16x32_bf16 v[96:99], a[24:27], a[120:123], v[96:99]
 ds_read_b64_tr_b16 a[52:53], v235 offset:43200
 v_mfma_f32_16x16x32_bf16 v[100:103], a[24:27], a[124:127], v[100:103]
 v_mfma_f32_16x16x32_bf16 v[104:107], a[24:27], a[128:131], v[104:107]
 ds_read_b64_tr_b16 a[54:55], v235 offset:46784
 v_mfma_f32_16x16x32_bf16 v[108:111], a[24:27], a[132:135], v[108:111]
 s_waitcnt lgkmcnt(12)
 v_mfma_f32_16x16x32_bf16 v[112:115], a[28:31], a[120:123], v[112:115]
 ds_read_b64_tr_b16 a[0:1], v235 offset:35840
 v_mfma_f32_16x16x32_bf16 v[116:119], a[28:31], a[124:127], v[116:119]
 buffer_load_dwordx4 v226, s[60:63], s40 offen offset:2048 lds
 v_mfma_f32_16x16x32_bf16 v[120:123], a[28:31], a[128:131], v[120:123]
 ds_read_b64_tr_b16 a[2:3], v235 offset:39424
 v_mfma_f32_16x16x32_bf16 v[124:127], a[28:31], a[132:135], v[124:127]
 s_waitcnt vmcnt(36)
 v_add_f32 v238, v238, v240
 s_waitcnt lgkmcnt(12)
 v_mfma_f32_16x16x32_bf16 v[140:143], a[32:35], a[132:135], v[140:143]
 ds_read_b64_tr_b16 a[4:5], v235 offset:35872
 v_mfma_f32_16x16x32_bf16 v[136:139], a[32:35], a[128:131], v[136:139]
 buffer_load_dwordx4 v227, s[60:63], s40 offen offset:3072 lds
 s_add_u32 m0, s96, 4096
 v_add_f32 v239, v239, v241
 v_mfma_f32_16x16x32_bf16 v[132:135], a[32:35], a[124:127], v[132:135]
 ds_read_b64_tr_b16 a[6:7], v235 offset:39456
 v_mfma_f32_16x16x32_bf16 v[128:131], a[32:35], a[120:123], v[128:131]
 s_waitcnt vmcnt(34)
 v_add_f32 v242, v242, v244
 s_waitcnt lgkmcnt(12)
 v_mfma_f32_16x16x32_bf16 v[144:147], a[36:39], a[120:123], v[144:147]
 ds_read_b64_tr_b16 a[8:9], v235 offset:35904
 v_mfma_f32_16x16x32_bf16 v[148:151], a[36:39], a[124:127], v[148:151]
 buffer_load_dwordx4 v228, s[60:63], s40 offen lds
 v_add_f32 v243, v243, v245
 v_mfma_f32_16x16x32_bf16 v[152:155], a[36:39], a[128:131], v[152:155]
 ds_read_b64_tr_b16 a[10:11], v235 offset:39488
 v_mfma_f32_16x16x32_bf16 v[156:159], a[36:39], a[132:135], v[156:159]
 v_add_f32 v238, v238, v242
 s_waitcnt lgkmcnt(12)
 v_mfma_f32_16x16x32_bf16 v[172:175], a[40:43], a[132:135], v[172:175]
 ds_read_b64_tr_b16 a[12:13], v235 offset:35936
 v_mfma_f32_16x16x32_bf16 v[168:171], a[40:43], a[128:131], v[168:171]
 buffer_load_dwordx4 v229, s[60:63], s40 offen offset:1024 lds
 v_add_f32 v239, v239, v243
 v_mfma_f32_16x16x32_bf16 v[164:167], a[40:43], a[124:127], v[164:167]
 ds_read_b64_tr_b16 a[14:15], v235 offset:39520
 v_mfma_f32_16x16x32_bf16 v[160:163], a[40:43], a[120:123], v[160:163]
 v_mov_b32 v240, v238
 s_waitcnt lgkmcnt(12)
 v_mfma_f32_16x16x32_bf16 v[176:179], a[44:47], a[120:123], v[176:179]
 ds_read_b64_tr_b16 a[16:17], v235 offset:35968
 v_mfma_f32_16x16x32_bf16 v[180:183], a[44:47], a[124:127], v[180:183]
 buffer_load_dwordx4 v230, s[60:63], s40 offen offset:2048 lds
 s_add_u32 s40, s40, 458752
 s_add_u32 m0, s96, 28672
 v_mov_b32 v241, v239
 v_mfma_f32_16x16x32_bf16 v[184:187], a[44:47], a[128:131], v[184:187]
 ds_read_b64_tr_b16 a[18:19], v235 offset:39552
 v_mfma_f32_16x16x32_bf16 v[188:191], a[44:47], a[132:135], v[188:191]
 v_permlane32_swap_b32 v238, v240
 s_waitcnt lgkmcnt(12)
 v_mfma_f32_16x16x32_bf16 v[204:207], a[48:51], a[132:135], v[204:207]
 ds_read_b64_tr_b16 a[20:21], v235 offset:36000
 v_mfma_f32_16x16x32_bf16 v[200:203], a[48:51], a[128:131], v[200:203]
 v_permlane32_swap_b32 v239, v241
 v_mfma_f32_16x16x32_bf16 v[196:199], a[48:51], a[124:127], v[196:199]
 ds_read_b64_tr_b16 a[22:23], v235 offset:39584
 v_mfma_f32_16x16x32_bf16 v[192:195], a[48:51], a[120:123], v[192:195]
 v_add_f32 v238, v238, v240
 s_waitcnt lgkmcnt(12)
 v_mfma_f32_16x16x32_bf16 v[208:211], a[52:55], a[120:123], v[208:211]
 ds_read_b64_tr_b16 a[24:25], v235 offset:36032
 v_mfma_f32_16x16x32_bf16 v[212:215], a[52:55], a[124:127], v[212:215]
 v_mfma_f32_16x16x32_bf16 v[216:219], a[52:55], a[128:131], v[216:219]
 ds_read_b64_tr_b16 a[26:27], v235 offset:39616
 v_mfma_f32_16x16x32_bf16 v[220:223], a[52:55], a[132:135], v[220:223]
 s_waitcnt lgkmcnt(12)
 v_mfma_f32_16x16x32_bf16 v[0:3], a[0:3], a[136:139], v[0:3]
 ds_read_b64_tr_b16 a[28:29], v235 offset:50176
 v_mfma_f32_16x16x32_bf16 v[4:7], a[0:3], a[140:143], v[4:7]
 buffer_load_dwordx4 a[120:123], v231, s[24:27], s41 offen sc1
 v_mfma_f32_16x16x32_bf16 v[8:11], a[0:3], a[144:147], v[8:11]
 ds_read_b64_tr_b16 a[30:31], v235 offset:53760
 v_mfma_f32_16x16x32_bf16 v[12:15], a[0:3], a[148:151], v[12:15]
 v_add_f32 v239, v239, v241
 s_waitcnt lgkmcnt(12)
 v_mfma_f32_16x16x32_bf16 v[28:31], a[4:7], a[148:151], v[28:31]
 ds_read_b64_tr_b16 a[32:33], v235 offset:50208
 v_mfma_f32_16x16x32_bf16 v[24:27], a[4:7], a[144:147], v[24:27]
 v_mov_b32 v240, v238
 v_mfma_f32_16x16x32_bf16 v[20:23], a[4:7], a[140:143], v[20:23]
 ds_read_b64_tr_b16 a[34:35], v235 offset:53792
 v_mfma_f32_16x16x32_bf16 v[16:19], a[4:7], a[136:139], v[16:19]
 buffer_load_dwordx4 a[124:127], v232, s[24:27], s41 offen sc1
 v_mov_b32 v241, v239
 s_waitcnt lgkmcnt(12)
 v_mfma_f32_16x16x32_bf16 v[32:35], a[8:11], a[136:139], v[32:35]
 ds_read_b64_tr_b16 a[36:37], v235 offset:50240
 v_mfma_f32_16x16x32_bf16 v[36:39], a[8:11], a[140:143], v[36:39]
 v_permlane16_swap_b32 v238, v240
 v_mfma_f32_16x16x32_bf16 v[40:43], a[8:11], a[144:147], v[40:43]
 ds_read_b64_tr_b16 a[38:39], v235 offset:53824
 v_mfma_f32_16x16x32_bf16 v[44:47], a[8:11], a[148:151], v[44:47]
 v_permlane16_swap_b32 v239, v241
 s_waitcnt lgkmcnt(12)
 v_mfma_f32_16x16x32_bf16 v[60:63], a[12:15], a[148:151], v[60:63]
 ds_read_b64_tr_b16 a[40:41], v235 offset:50272
 v_mfma_f32_16x16x32_bf16 v[56:59], a[12:15], a[144:147], v[56:59]
 buffer_load_dwordx4 a[128:131], v233, s[24:27], s41 offen sc1
 v_add_f32 v238, v238, v240
 v_mfma_f32_16x16x32_bf16 v[52:55], a[12:15], a[140:143], v[52:55]
 ds_read_b64_tr_b16 a[42:43], v235 offset:53856
 v_mfma_f32_16x16x32_bf16 v[48:51], a[12:15], a[136:139], v[48:51]
 v_add_f32 v239, v239, v241
 s_waitcnt lgkmcnt(12)
 v_mfma_f32_16x16x32_bf16 v[64:67], a[16:19], a[136:139], v[64:67]
 ds_read_b64_tr_b16 a[44:45], v235 offset:50304
 v_mfma_f32_16x16x32_bf16 v[68:71], a[16:19], a[140:143], v[68:71]
 v_mul_f32 v238, 0xba800000, v238
 v_mfma_f32_16x16x32_bf16 v[72:75], a[16:19], a[144:147], v[72:75]
 ds_read_b64_tr_b16 a[46:47], v235 offset:53888
 v_mfma_f32_16x16x32_bf16 v[76:79], a[16:19], a[148:151], v[76:79]
 buffer_load_dwordx4 a[132:135], v234, s[24:27], s41 offen sc1
 v_mul_f32 v239, 0x3a800000, v239
 s_waitcnt lgkmcnt(12)
 v_mfma_f32_16x16x32_bf16 v[92:95], a[20:23], a[148:151], v[92:95]
 ds_read_b64_tr_b16 a[48:49], v235 offset:50336
 v_mfma_f32_16x16x32_bf16 v[88:91], a[20:23], a[144:147], v[88:91]
 v_fma_f32 v239, -v238, v238, v239
 v_mfma_f32_16x16x32_bf16 v[84:87], a[20:23], a[140:143], v[84:87]
 ds_read_b64_tr_b16 a[50:51], v235 offset:53920
 v_mfma_f32_16x16x32_bf16 v[80:83], a[20:23], a[136:139], v[80:83]
 v_max_f32 v239, 0, v239
 s_waitcnt lgkmcnt(12)
 v_mfma_f32_16x16x32_bf16 v[96:99], a[24:27], a[136:139], v[96:99]
 ds_read_b64_tr_b16 a[52:53], v235 offset:50368
 v_mfma_f32_16x16x32_bf16 v[100:103], a[24:27], a[140:143], v[100:103]
 v_mfma_f32_16x16x32_bf16 v[104:107], a[24:27], a[144:147], v[104:107]
 ds_read_b64_tr_b16 a[54:55], v235 offset:53952
 v_mfma_f32_16x16x32_bf16 v[108:111], a[24:27], a[148:151], v[108:111]
 s_waitcnt lgkmcnt(0)
 s_barrier
 v_mfma_f32_16x16x32_bf16 v[112:115], a[28:31], a[136:139], v[112:115]
 ds_read_b64_tr_b16 a[0:1], v236 offset:0
 v_mfma_f32_16x16x32_bf16 v[116:119], a[28:31], a[140:143], v[116:119]
 v_mfma_f32_16x16x32_bf16 v[120:123], a[28:31], a[144:147], v[120:123]
 ds_read_b64_tr_b16 a[2:3], v236 offset:3584
 v_mfma_f32_16x16x32_bf16 v[124:127], a[28:31], a[148:151], v[124:127]
 v_add_f32 v239, 0x3727c5ac, v239
 v_mfma_f32_16x16x32_bf16 v[140:143], a[32:35], a[148:151], v[140:143]
 ds_read_b64_tr_b16 a[4:5], v236 offset:32
 v_mfma_f32_16x16x32_bf16 v[136:139], a[32:35], a[144:147], v[136:139]
 v_sqrt_f32 v252, v239
 v_mfma_f32_16x16x32_bf16 v[132:135], a[32:35], a[140:143], v[132:135]
 ds_read_b64_tr_b16 a[6:7], v236 offset:3616
 v_mfma_f32_16x16x32_bf16 v[128:131], a[32:35], a[136:139], v[128:131]
 v_rsq_f32 v248, v239
 v_mfma_f32_16x16x32_bf16 v[144:147], a[36:39], a[136:139], v[144:147]
 ds_read_b64_tr_b16 a[8:9], v236 offset:64
 v_mfma_f32_16x16x32_bf16 v[148:151], a[36:39], a[140:143], v[148:151]
 v_cvt_pk_bf16_f32 v240, v238, v252
 v_mfma_f32_16x16x32_bf16 v[152:155], a[36:39], a[144:147], v[152:155]
 ds_read_b64_tr_b16 a[10:11], v236 offset:3648
 v_mfma_f32_16x16x32_bf16 v[156:159], a[36:39], a[148:151], v[156:159]
 v_mul_f32 v248, 0xbfb8aa3b, v248
 v_mfma_f32_16x16x32_bf16 v[172:175], a[40:43], a[148:151], v[172:175]
 ds_read_b64_tr_b16 a[12:13], v236 offset:96
 v_mfma_f32_16x16x32_bf16 v[168:171], a[40:43], a[144:147], v[168:171]
 v_and_b32 v241, 0xffff0000, v240
 v_mfma_f32_16x16x32_bf16 v[164:167], a[40:43], a[140:143], v[164:167]
 ds_read_b64_tr_b16 a[14:15], v236 offset:3680
 v_mfma_f32_16x16x32_bf16 v[160:163], a[40:43], a[136:139], v[160:163]
 v_sub_f32 v242, v252, v241
 v_mfma_f32_16x16x32_bf16 v[176:179], a[44:47], a[136:139], v[176:179]
 ds_read_b64_tr_b16 a[16:17], v236 offset:128
 v_mfma_f32_16x16x32_bf16 v[180:183], a[44:47], a[140:143], v[180:183]
 v_cvt_pk_bf16_f32 v241, v241, v242
 v_mfma_f32_16x16x32_bf16 v[184:187], a[44:47], a[144:147], v[184:187]
 ds_read_b64_tr_b16 a[18:19], v236 offset:3712
 v_mfma_f32_16x16x32_bf16 v[188:191], a[44:47], a[148:151], v[188:191]
 v_accvgpr_write_b32 a184, v240
 v_mfma_f32_16x16x32_bf16 v[204:207], a[48:51], a[148:151], v[204:207]
 ds_read_b64_tr_b16 a[20:21], v236 offset:160
 v_mfma_f32_16x16x32_bf16 v[200:203], a[48:51], a[144:147], v[200:203]
 v_accvgpr_write_b32 a185, v241
 v_mfma_f32_16x16x32_bf16 v[196:199], a[48:51], a[140:143], v[196:199]
 ds_read_b64_tr_b16 a[22:23], v236 offset:3744
 v_mfma_f32_16x16x32_bf16 v[192:195], a[48:51], a[136:139], v[192:195]
 v_mfma_f32_16x16x32_bf16 v[208:211], a[52:55], a[136:139], v[208:211]
 ds_read_b64_tr_b16 a[24:25], v236 offset:192
 v_mfma_f32_16x16x32_bf16 v[212:215], a[52:55], a[140:143], v[212:215]
 v_mfma_f32_16x16x32_bf16 v[216:219], a[52:55], a[144:147], v[216:219]
 ds_read_b64_tr_b16 a[26:27], v236 offset:3776
 v_mfma_f32_16x16x32_bf16 v[220:223], a[52:55], a[148:151], v[220:223]
 s_waitcnt lgkmcnt(12)
 v_mfma_f32_16x16x32_bf16 v[0:3], a[0:3], a[152:155], v[0:3]
 ds_read_b64_tr_b16 a[28:29], v236 offset:14336
 v_mfma_f32_16x16x32_bf16 v[4:7], a[0:3], a[156:159], v[4:7]
 buffer_load_dwordx4 a[136:139], v231, s[24:27], s41 offen offset:1024 sc1
 v_mfma_f32_16x16x32_bf16 v[8:11], a[0:3], a[160:163], v[8:11]
 ds_read_b64_tr_b16 a[30:31], v236 offset:17920
 v_mfma_f32_16x16x32_bf16 v[12:15], a[0:3], a[164:167], v[12:15]
 buffer_load_dwordx2 v[238:239], v246, s[32:35], s42 offen offset:0 sc1
 s_waitcnt lgkmcnt(12)
 v_mfma_f32_16x16x32_bf16 v[28:31], a[4:7], a[164:167], v[28:31]
 ds_read_b64_tr_b16 a[32:33], v236 offset:14368
 v_mfma_f32_16x16x32_bf16 v[24:27], a[4:7], a[160:163], v[24:27]
 buffer_load_dwordx4 a[140:143], v232, s[24:27], s41 offen offset:1024 sc1
 buffer_load_dwordx2 v[240:241], v246, s[32:35], s42 offen offset:128 sc1
 v_mfma_f32_16x16x32_bf16 v[20:23], a[4:7], a[156:159], v[20:23]
 ds_read_b64_tr_b16 a[34:35], v236 offset:17952
 v_mfma_f32_16x16x32_bf16 v[16:19], a[4:7], a[152:155], v[16:19]
 buffer_load_dwordx2 v[242:243], v246, s[32:35], s42 offen offset:256 sc1
 s_waitcnt lgkmcnt(12)
 v_mfma_f32_16x16x32_bf16 v[32:35], a[8:11], a[152:155], v[32:35]
 ds_read_b64_tr_b16 a[36:37], v236 offset:14400
 v_mfma_f32_16x16x32_bf16 v[36:39], a[8:11], a[156:159], v[36:39]
 buffer_load_dwordx4 a[144:147], v233, s[24:27], s41 offen offset:1024 sc1
 buffer_load_dwordx2 v[244:245], v246, s[32:35], s42 offen offset:384 sc1
 v_mfma_f32_16x16x32_bf16 v[40:43], a[8:11], a[160:163], v[40:43]
 ds_read_b64_tr_b16 a[38:39], v236 offset:17984
 v_mfma_f32_16x16x32_bf16 v[44:47], a[8:11], a[164:167], v[44:47]
 s_add_u32 s42, s42, 2048
 s_waitcnt lgkmcnt(12)
 v_mfma_f32_16x16x32_bf16 v[60:63], a[12:15], a[164:167], v[60:63]
 ds_read_b64_tr_b16 a[40:41], v236 offset:14432
 v_mfma_f32_16x16x32_bf16 v[56:59], a[12:15], a[160:163], v[56:59]
 buffer_load_dwordx4 a[148:151], v234, s[24:27], s41 offen offset:1024 sc1
 v_mfma_f32_16x16x32_bf16 v[52:55], a[12:15], a[156:159], v[52:55]
 ds_read_b64_tr_b16 a[42:43], v236 offset:18016
 v_mfma_f32_16x16x32_bf16 v[48:51], a[12:15], a[152:155], v[48:51]
 s_waitcnt lgkmcnt(12)
 v_mfma_f32_16x16x32_bf16 v[64:67], a[16:19], a[152:155], v[64:67]
 ds_read_b64_tr_b16 a[44:45], v236 offset:14464
 v_mfma_f32_16x16x32_bf16 v[68:71], a[16:19], a[156:159], v[68:71]
 buffer_load_dwordx4 v224, s[60:63], s40 offen lds
 v_mfma_f32_16x16x32_bf16 v[72:75], a[16:19], a[160:163], v[72:75]
 ds_read_b64_tr_b16 a[46:47], v236 offset:18048
 v_mfma_f32_16x16x32_bf16 v[76:79], a[16:19], a[164:167], v[76:79]
 s_waitcnt lgkmcnt(12)
 v_mfma_f32_16x16x32_bf16 v[92:95], a[20:23], a[164:167], v[92:95]
 ds_read_b64_tr_b16 a[48:49], v236 offset:14496
 v_mfma_f32_16x16x32_bf16 v[88:91], a[20:23], a[160:163], v[88:91]
 buffer_load_dwordx4 v225, s[60:63], s40 offen offset:1024 lds
 v_mfma_f32_16x16x32_bf16 v[84:87], a[20:23], a[156:159], v[84:87]
 ds_read_b64_tr_b16 a[50:51], v236 offset:18080
 v_mfma_f32_16x16x32_bf16 v[80:83], a[20:23], a[152:155], v[80:83]
 s_waitcnt lgkmcnt(12)
 v_mfma_f32_16x16x32_bf16 v[96:99], a[24:27], a[152:155], v[96:99]
 ds_read_b64_tr_b16 a[52:53], v236 offset:14528
 v_mfma_f32_16x16x32_bf16 v[100:103], a[24:27], a[156:159], v[100:103]
 v_mfma_f32_16x16x32_bf16 v[104:107], a[24:27], a[160:163], v[104:107]
 ds_read_b64_tr_b16 a[54:55], v236 offset:18112
 v_mfma_f32_16x16x32_bf16 v[108:111], a[24:27], a[164:167], v[108:111]
 s_waitcnt lgkmcnt(12)
 v_mfma_f32_16x16x32_bf16 v[112:115], a[28:31], a[152:155], v[112:115]
 ds_read_b64_tr_b16 a[0:1], v236 offset:7168
 v_mfma_f32_16x16x32_bf16 v[116:119], a[28:31], a[156:159], v[116:119]
 buffer_load_dwordx4 v226, s[60:63], s40 offen offset:2048 lds
 v_mfma_f32_16x16x32_bf16 v[120:123], a[28:31], a[160:163], v[120:123]
 ds_read_b64_tr_b16 a[2:3], v236 offset:10752
 v_mfma_f32_16x16x32_bf16 v[124:127], a[28:31], a[164:167], v[124:127]
 s_waitcnt lgkmcnt(12)
 v_mfma_f32_16x16x32_bf16 v[140:143], a[32:35], a[164:167], v[140:143]
 ds_read_b64_tr_b16 a[4:5], v236 offset:7200
 v_mfma_f32_16x16x32_bf16 v[136:139], a[32:35], a[160:163], v[136:139]
 buffer_load_dwordx4 v227, s[60:63], s40 offen offset:3072 lds
 s_add_u32 m0, s96, 32768
 v_mfma_f32_16x16x32_bf16 v[132:135], a[32:35], a[156:159], v[132:135]
 ds_read_b64_tr_b16 a[6:7], v236 offset:10784
 v_mfma_f32_16x16x32_bf16 v[128:131], a[32:35], a[152:155], v[128:131]
 s_waitcnt lgkmcnt(12)
 v_mfma_f32_16x16x32_bf16 v[144:147], a[36:39], a[152:155], v[144:147]
 ds_read_b64_tr_b16 a[8:9], v236 offset:7232
 v_mfma_f32_16x16x32_bf16 v[148:151], a[36:39], a[156:159], v[148:151]
 buffer_load_dwordx4 v228, s[60:63], s40 offen lds
 v_mfma_f32_16x16x32_bf16 v[152:155], a[36:39], a[160:163], v[152:155]
 ds_read_b64_tr_b16 a[10:11], v236 offset:10816
 v_mfma_f32_16x16x32_bf16 v[156:159], a[36:39], a[164:167], v[156:159]
 s_waitcnt lgkmcnt(12)
 v_mfma_f32_16x16x32_bf16 v[172:175], a[40:43], a[164:167], v[172:175]
 ds_read_b64_tr_b16 a[12:13], v236 offset:7264
 v_mfma_f32_16x16x32_bf16 v[168:171], a[40:43], a[160:163], v[168:171]
 buffer_load_dwordx4 v229, s[60:63], s40 offen offset:1024 lds
 v_mfma_f32_16x16x32_bf16 v[164:167], a[40:43], a[156:159], v[164:167]
 ds_read_b64_tr_b16 a[14:15], v236 offset:10848
 v_mfma_f32_16x16x32_bf16 v[160:163], a[40:43], a[152:155], v[160:163]
 s_waitcnt lgkmcnt(12)
 v_mfma_f32_16x16x32_bf16 v[176:179], a[44:47], a[152:155], v[176:179]
 ds_read_b64_tr_b16 a[16:17], v236 offset:7296
 v_mfma_f32_16x16x32_bf16 v[180:183], a[44:47], a[156:159], v[180:183]
 buffer_load_dwordx4 v230, s[60:63], s40 offen offset:2048 lds
 s_add_u32 s40, s40, 458752
 s_add_u32 m0, s96, 57344
 v_mfma_f32_16x16x32_bf16 v[184:187], a[44:47], a[160:163], v[184:187]
 ds_read_b64_tr_b16 a[18:19], v236 offset:10880
 v_mfma_f32_16x16x32_bf16 v[188:191], a[44:47], a[164:167], v[188:191]
 s_waitcnt lgkmcnt(12)
 v_mfma_f32_16x16x32_bf16 v[204:207], a[48:51], a[164:167], v[204:207]
 ds_read_b64_tr_b16 a[20:21], v236 offset:7328
 v_mfma_f32_16x16x32_bf16 v[200:203], a[48:51], a[160:163], v[200:203]
 v_mfma_f32_16x16x32_bf16 v[196:199], a[48:51], a[156:159], v[196:199]
 ds_read_b64_tr_b16 a[22:23], v236 offset:10912
 v_mfma_f32_16x16x32_bf16 v[192:195], a[48:51], a[152:155], v[192:195]
 s_waitcnt lgkmcnt(12)
 v_mfma_f32_16x16x32_bf16 v[208:211], a[52:55], a[152:155], v[208:211]
 ds_read_b64_tr_b16 a[24:25], v236 offset:7360
 v_mfma_f32_16x16x32_bf16 v[212:215], a[52:55], a[156:159], v[212:215]
 v_mfma_f32_16x16x32_bf16 v[216:219], a[52:55], a[160:163], v[216:219]
 ds_read_b64_tr_b16 a[26:27], v236 offset:10944
 v_mfma_f32_16x16x32_bf16 v[220:223], a[52:55], a[164:167], v[220:223]
 s_waitcnt lgkmcnt(12)
 v_mfma_f32_16x16x32_bf16 v[0:3], a[0:3], a[168:171], v[0:3]
 ds_read_b64_tr_b16 a[28:29], v236 offset:21504
 v_mfma_f32_16x16x32_bf16 v[4:7], a[0:3], a[172:175], v[4:7]
 buffer_load_dwordx4 a[152:155], v231, s[24:27], s41 offen offset:2048 sc1
 v_mfma_f32_16x16x32_bf16 v[8:11], a[0:3], a[176:179], v[8:11]
 ds_read_b64_tr_b16 a[30:31], v236 offset:25088
 v_mfma_f32_16x16x32_bf16 v[12:15], a[0:3], a[180:183], v[12:15]
 s_waitcnt lgkmcnt(12)
 v_mfma_f32_16x16x32_bf16 v[28:31], a[4:7], a[180:183], v[28:31]
 ds_read_b64_tr_b16 a[32:33], v236 offset:21536
 v_mfma_f32_16x16x32_bf16 v[24:27], a[4:7], a[176:179], v[24:27]
 v_mfma_f32_16x16x32_bf16 v[20:23], a[4:7], a[172:175], v[20:23]
 ds_read_b64_tr_b16 a[34:35], v236 offset:25120
 v_mfma_f32_16x16x32_bf16 v[16:19], a[4:7], a[168:171], v[16:19]
 buffer_load_dwordx4 a[156:159], v232, s[24:27], s41 offen offset:2048 sc1
 s_waitcnt lgkmcnt(12)
 v_mfma_f32_16x16x32_bf16 v[32:35], a[8:11], a[168:171], v[32:35]
 ds_read_b64_tr_b16 a[36:37], v236 offset:21568
 v_mfma_f32_16x16x32_bf16 v[36:39], a[8:11], a[172:175], v[36:39]
 v_mfma_f32_16x16x32_bf16 v[40:43], a[8:11], a[176:179], v[40:43]
 ds_read_b64_tr_b16 a[38:39], v236 offset:25152
 v_mfma_f32_16x16x32_bf16 v[44:47], a[8:11], a[180:183], v[44:47]
 s_waitcnt lgkmcnt(12)
 v_mfma_f32_16x16x32_bf16 v[60:63], a[12:15], a[180:183], v[60:63]
 ds_read_b64_tr_b16 a[40:41], v236 offset:21600
 v_mfma_f32_16x16x32_bf16 v[56:59], a[12:15], a[176:179], v[56:59]
 buffer_load_dwordx4 a[160:163], v233, s[24:27], s41 offen offset:2048 sc1
 v_mfma_f32_16x16x32_bf16 v[52:55], a[12:15], a[172:175], v[52:55]
 ds_read_b64_tr_b16 a[42:43], v236 offset:25184
 v_mfma_f32_16x16x32_bf16 v[48:51], a[12:15], a[168:171], v[48:51]
 s_waitcnt lgkmcnt(12)
 v_mfma_f32_16x16x32_bf16 v[64:67], a[16:19], a[168:171], v[64:67]
 ds_read_b64_tr_b16 a[44:45], v236 offset:21632
 v_mfma_f32_16x16x32_bf16 v[68:71], a[16:19], a[172:175], v[68:71]
 v_mfma_f32_16x16x32_bf16 v[72:75], a[16:19], a[176:179], v[72:75]
 ds_read_b64_tr_b16 a[46:47], v236 offset:25216
 v_mfma_f32_16x16x32_bf16 v[76:79], a[16:19], a[180:183], v[76:79]
 buffer_load_dwordx4 a[164:167], v234, s[24:27], s41 offen offset:2048 sc1
 s_waitcnt lgkmcnt(12)
 v_mfma_f32_16x16x32_bf16 v[92:95], a[20:23], a[180:183], v[92:95]
 ds_read_b64_tr_b16 a[48:49], v236 offset:21664
 v_mfma_f32_16x16x32_bf16 v[88:91], a[20:23], a[176:179], v[88:91]
 v_mfma_f32_16x16x32_bf16 v[84:87], a[20:23], a[172:175], v[84:87]
 ds_read_b64_tr_b16 a[50:51], v236 offset:25248
 v_mfma_f32_16x16x32_bf16 v[80:83], a[20:23], a[168:171], v[80:83]
 s_waitcnt lgkmcnt(12)
 v_mfma_f32_16x16x32_bf16 v[96:99], a[24:27], a[168:171], v[96:99]
 ds_read_b64_tr_b16 a[52:53], v236 offset:21696
 v_mfma_f32_16x16x32_bf16 v[100:103], a[24:27], a[172:175], v[100:103]
 v_mfma_f32_16x16x32_bf16 v[104:107], a[24:27], a[176:179], v[104:107]
 ds_read_b64_tr_b16 a[54:55], v236 offset:25280
 v_mfma_f32_16x16x32_bf16 v[108:111], a[24:27], a[180:183], v[108:111]
 s_waitcnt lgkmcnt(0)
 s_waitcnt vmcnt(53)
 s_barrier
 v_mfma_f32_16x16x32_bf16 v[112:115], a[28:31], a[168:171], v[112:115]
 ds_read_b64_tr_b16 a[0:1], v236 offset:28672
 v_mfma_f32_16x16x32_bf16 v[116:119], a[28:31], a[172:175], v[116:119]
 v_mfma_f32_16x16x32_bf16 v[120:123], a[28:31], a[176:179], v[120:123]
 ds_read_b64_tr_b16 a[2:3], v236 offset:32256
 v_mfma_f32_16x16x32_bf16 v[124:127], a[28:31], a[180:183], v[124:127]
 v_mfma_f32_16x16x32_bf16 v[140:143], a[32:35], a[180:183], v[140:143]
 ds_read_b64_tr_b16 a[4:5], v236 offset:28704
 v_mfma_f32_16x16x32_bf16 v[136:139], a[32:35], a[176:179], v[136:139]
 v_mfma_f32_16x16x32_bf16 v[132:135], a[32:35], a[172:175], v[132:135]
 ds_read_b64_tr_b16 a[6:7], v236 offset:32288
 v_mfma_f32_16x16x32_bf16 v[128:131], a[32:35], a[168:171], v[128:131]
 v_mfma_f32_16x16x32_bf16 v[144:147], a[36:39], a[168:171], v[144:147]
 ds_read_b64_tr_b16 a[8:9], v236 offset:28736
 v_mfma_f32_16x16x32_bf16 v[148:151], a[36:39], a[172:175], v[148:151]
 v_mfma_f32_16x16x32_bf16 v[152:155], a[36:39], a[176:179], v[152:155]
 ds_read_b64_tr_b16 a[10:11], v236 offset:32320
 v_mfma_f32_16x16x32_bf16 v[156:159], a[36:39], a[180:183], v[156:159]
 v_mfma_f32_16x16x32_bf16 v[172:175], a[40:43], a[180:183], v[172:175]
 ds_read_b64_tr_b16 a[12:13], v236 offset:28768
 v_mfma_f32_16x16x32_bf16 v[168:171], a[40:43], a[176:179], v[168:171]
 v_mfma_f32_16x16x32_bf16 v[164:167], a[40:43], a[172:175], v[164:167]
 ds_read_b64_tr_b16 a[14:15], v236 offset:32352
 v_mfma_f32_16x16x32_bf16 v[160:163], a[40:43], a[168:171], v[160:163]
 v_mfma_f32_16x16x32_bf16 v[176:179], a[44:47], a[168:171], v[176:179]
 ds_read_b64_tr_b16 a[16:17], v236 offset:28800
 v_mfma_f32_16x16x32_bf16 v[180:183], a[44:47], a[172:175], v[180:183]
 v_mfma_f32_16x16x32_bf16 v[184:187], a[44:47], a[176:179], v[184:187]
 ds_read_b64_tr_b16 a[18:19], v236 offset:32384
 v_mfma_f32_16x16x32_bf16 v[188:191], a[44:47], a[180:183], v[188:191]
 v_mfma_f32_16x16x32_bf16 v[204:207], a[48:51], a[180:183], v[204:207]
 ds_read_b64_tr_b16 a[20:21], v236 offset:28832
 v_mfma_f32_16x16x32_bf16 v[200:203], a[48:51], a[176:179], v[200:203]
 v_mfma_f32_16x16x32_bf16 v[196:199], a[48:51], a[172:175], v[196:199]
 ds_read_b64_tr_b16 a[22:23], v236 offset:32416
 v_mfma_f32_16x16x32_bf16 v[192:195], a[48:51], a[168:171], v[192:195]
 v_mfma_f32_16x16x32_bf16 v[208:211], a[52:55], a[168:171], v[208:211]
 ds_read_b64_tr_b16 a[24:25], v236 offset:28864
 v_mfma_f32_16x16x32_bf16 v[212:215], a[52:55], a[172:175], v[212:215]
 v_mfma_f32_16x16x32_bf16 v[216:219], a[52:55], a[176:179], v[216:219]
 ds_read_b64_tr_b16 a[26:27], v236 offset:32448
 v_mfma_f32_16x16x32_bf16 v[220:223], a[52:55], a[180:183], v[220:223]
 s_waitcnt vmcnt(52) lgkmcnt(12)
 v_mfma_f32_16x16x32_bf16 v[0:3], a[0:3], a[56:59], v[0:3]
 ds_read_b64_tr_b16 a[28:29], v236 offset:43008
 s_waitcnt vmcnt(51)
 v_mfma_f32_16x16x32_bf16 v[4:7], a[0:3], a[60:63], v[4:7]
 buffer_load_dwordx4 a[168:171], v231, s[24:27], s41 offen offset:3072 sc1
 s_waitcnt vmcnt(51)
 v_mfma_f32_16x16x32_bf16 v[8:11], a[0:3], a[64:67], v[8:11]
 ds_read_b64_tr_b16 a[30:31], v236 offset:46592
 s_waitcnt vmcnt(50)
 v_mfma_f32_16x16x32_bf16 v[12:15], a[0:3], a[68:71], v[12:15]
 s_waitcnt lgkmcnt(12)
 v_mfma_f32_16x16x32_bf16 v[28:31], a[4:7], a[68:71], v[28:31]
 ds_read_b64_tr_b16 a[32:33], v236 offset:43040
 v_mfma_f32_16x16x32_bf16 v[24:27], a[4:7], a[64:67], v[24:27]
 buffer_load_dwordx4 a[172:175], v232, s[24:27], s41 offen offset:3072 sc1
 v_mfma_f32_16x16x32_bf16 v[20:23], a[4:7], a[60:63], v[20:23]
 ds_read_b64_tr_b16 a[34:35], v236 offset:46624
 v_mfma_f32_16x16x32_bf16 v[16:19], a[4:7], a[56:59], v[16:19]
 s_waitcnt lgkmcnt(12)
 v_mfma_f32_16x16x32_bf16 v[32:35], a[8:11], a[56:59], v[32:35]
 ds_read_b64_tr_b16 a[36:37], v236 offset:43072
 v_mfma_f32_16x16x32_bf16 v[36:39], a[8:11], a[60:63], v[36:39]
 buffer_load_dwordx4 a[176:179], v233, s[24:27], s41 offen offset:3072 sc1
 v_mfma_f32_16x16x32_bf16 v[40:43], a[8:11], a[64:67], v[40:43]
 ds_read_b64_tr_b16 a[38:39], v236 offset:46656
 v_mfma_f32_16x16x32_bf16 v[44:47], a[8:11], a[68:71], v[44:47]
 s_waitcnt lgkmcnt(12)
 v_mfma_f32_16x16x32_bf16 v[60:63], a[12:15], a[68:71], v[60:63]
 ds_read_b64_tr_b16 a[40:41], v236 offset:43104
 v_mfma_f32_16x16x32_bf16 v[56:59], a[12:15], a[64:67], v[56:59]
 buffer_load_dwordx4 a[180:183], v234, s[24:27], s41 offen offset:3072 sc1
 s_add_u32 s41, s41, 4096
 v_mfma_f32_16x16x32_bf16 v[52:55], a[12:15], a[60:63], v[52:55]
 ds_read_b64_tr_b16 a[42:43], v236 offset:46688
 v_mfma_f32_16x16x32_bf16 v[48:51], a[12:15], a[56:59], v[48:51]
 s_waitcnt lgkmcnt(12)
 v_mfma_f32_16x16x32_bf16 v[64:67], a[16:19], a[56:59], v[64:67]
 ds_read_b64_tr_b16 a[44:45], v236 offset:43136
 v_mfma_f32_16x16x32_bf16 v[68:71], a[16:19], a[60:63], v[68:71]
 buffer_load_dwordx4 v224, s[60:63], s40 offen lds
 v_mfma_f32_16x16x32_bf16 v[72:75], a[16:19], a[64:67], v[72:75]
 ds_read_b64_tr_b16 a[46:47], v236 offset:46720
 v_mfma_f32_16x16x32_bf16 v[76:79], a[16:19], a[68:71], v[76:79]
 s_waitcnt lgkmcnt(12)
 v_mfma_f32_16x16x32_bf16 v[92:95], a[20:23], a[68:71], v[92:95]
 ds_read_b64_tr_b16 a[48:49], v236 offset:43168
 v_mfma_f32_16x16x32_bf16 v[88:91], a[20:23], a[64:67], v[88:91]
 buffer_load_dwordx4 v225, s[60:63], s40 offen offset:1024 lds
 v_mfma_f32_16x16x32_bf16 v[84:87], a[20:23], a[60:63], v[84:87]
 ds_read_b64_tr_b16 a[50:51], v236 offset:46752
 v_mfma_f32_16x16x32_bf16 v[80:83], a[20:23], a[56:59], v[80:83]
 s_waitcnt lgkmcnt(12)
 v_mfma_f32_16x16x32_bf16 v[96:99], a[24:27], a[56:59], v[96:99]
 ds_read_b64_tr_b16 a[52:53], v236 offset:43200
 v_mfma_f32_16x16x32_bf16 v[100:103], a[24:27], a[60:63], v[100:103]
 v_mfma_f32_16x16x32_bf16 v[104:107], a[24:27], a[64:67], v[104:107]
 ds_read_b64_tr_b16 a[54:55], v236 offset:46784
 v_mfma_f32_16x16x32_bf16 v[108:111], a[24:27], a[68:71], v[108:111]
 s_waitcnt lgkmcnt(12)
 v_mfma_f32_16x16x32_bf16 v[112:115], a[28:31], a[56:59], v[112:115]
 ds_read_b64_tr_b16 a[0:1], v236 offset:35840
 v_mfma_f32_16x16x32_bf16 v[116:119], a[28:31], a[60:63], v[116:119]
 buffer_load_dwordx4 v226, s[60:63], s40 offen offset:2048 lds
 v_mfma_f32_16x16x32_bf16 v[120:123], a[28:31], a[64:67], v[120:123]
 ds_read_b64_tr_b16 a[2:3], v236 offset:39424
 v_mfma_f32_16x16x32_bf16 v[124:127], a[28:31], a[68:71], v[124:127]
 s_waitcnt lgkmcnt(12)
 v_mfma_f32_16x16x32_bf16 v[140:143], a[32:35], a[68:71], v[140:143]
 ds_read_b64_tr_b16 a[4:5], v236 offset:35872
 v_mfma_f32_16x16x32_bf16 v[136:139], a[32:35], a[64:67], v[136:139]
 buffer_load_dwordx4 v227, s[60:63], s40 offen offset:3072 lds
 s_add_u32 m0, s96, 61440
 v_mfma_f32_16x16x32_bf16 v[132:135], a[32:35], a[60:63], v[132:135]
 ds_read_b64_tr_b16 a[6:7], v236 offset:39456
 v_mfma_f32_16x16x32_bf16 v[128:131], a[32:35], a[56:59], v[128:131]
 s_waitcnt lgkmcnt(12)
 v_mfma_f32_16x16x32_bf16 v[144:147], a[36:39], a[56:59], v[144:147]
 ds_read_b64_tr_b16 a[8:9], v236 offset:35904
 v_mfma_f32_16x16x32_bf16 v[148:151], a[36:39], a[60:63], v[148:151]
 buffer_load_dwordx4 v228, s[60:63], s40 offen lds
 v_mfma_f32_16x16x32_bf16 v[152:155], a[36:39], a[64:67], v[152:155]
 ds_read_b64_tr_b16 a[10:11], v236 offset:39488
 v_mfma_f32_16x16x32_bf16 v[156:159], a[36:39], a[68:71], v[156:159]
 s_waitcnt lgkmcnt(12)
 v_mfma_f32_16x16x32_bf16 v[172:175], a[40:43], a[68:71], v[172:175]
 ds_read_b64_tr_b16 a[12:13], v236 offset:35936
 v_mfma_f32_16x16x32_bf16 v[168:171], a[40:43], a[64:67], v[168:171]
 buffer_load_dwordx4 v229, s[60:63], s40 offen offset:1024 lds
 v_mfma_f32_16x16x32_bf16 v[164:167], a[40:43], a[60:63], v[164:167]
 ds_read_b64_tr_b16 a[14:15], v236 offset:39520
 v_mfma_f32_16x16x32_bf16 v[160:163], a[40:43], a[56:59], v[160:163]
 s_waitcnt lgkmcnt(12)
 v_mfma_f32_16x16x32_bf16 v[176:179], a[44:47], a[56:59], v[176:179]
 ds_read_b64_tr_b16 a[16:17], v236 offset:35968
 v_mfma_f32_16x16x32_bf16 v[180:183], a[44:47], a[60:63], v[180:183]
 buffer_load_dwordx4 v230, s[60:63], s40 offen offset:2048 lds
 s_add_u32 s40, s40, 458752
 s_add_u32 m0, s96, 86016
 v_mfma_f32_16x16x32_bf16 v[184:187], a[44:47], a[64:67], v[184:187]
 ds_read_b64_tr_b16 a[18:19], v236 offset:39552
 v_mfma_f32_16x16x32_bf16 v[188:191], a[44:47], a[68:71], v[188:191]
 s_waitcnt lgkmcnt(12)
 v_mfma_f32_16x16x32_bf16 v[204:207], a[48:51], a[68:71], v[204:207]
 ds_read_b64_tr_b16 a[20:21], v236 offset:36000
 v_mfma_f32_16x16x32_bf16 v[200:203], a[48:51], a[64:67], v[200:203]
 v_mfma_f32_16x16x32_bf16 v[196:199], a[48:51], a[60:63], v[196:199]
 ds_read_b64_tr_b16 a[22:23], v236 offset:39584
 v_mfma_f32_16x16x32_bf16 v[192:195], a[48:51], a[56:59], v[192:195]
 s_waitcnt lgkmcnt(12)
 v_mfma_f32_16x16x32_bf16 v[208:211], a[52:55], a[56:59], v[208:211]
 ds_read_b64_tr_b16 a[24:25], v236 offset:36032
 v_mfma_f32_16x16x32_bf16 v[212:215], a[52:55], a[60:63], v[212:215]
 v_mfma_f32_16x16x32_bf16 v[216:219], a[52:55], a[64:67], v[216:219]
 ds_read_b64_tr_b16 a[26:27], v236 offset:39616
 v_mfma_f32_16x16x32_bf16 v[220:223], a[52:55], a[68:71], v[220:223]
 s_waitcnt vmcnt(59) lgkmcnt(12)
 v_mfma_f32_16x16x32_bf16 v[0:3], a[0:3], a[72:75], v[0:3]
 ds_read_b64_tr_b16 a[28:29], v236 offset:50176
 s_waitcnt vmcnt(58)
 v_mfma_f32_16x16x32_bf16 v[4:7], a[0:3], a[76:79], v[4:7]
 buffer_load_dwordx4 a[56:59], v231, s[24:27], s41 offen sc1
 s_waitcnt vmcnt(58)
 v_mfma_f32_16x16x32_bf16 v[8:11], a[0:3], a[80:83], v[8:11]
 ds_read_b64_tr_b16 a[30:31], v236 offset:53760
 s_waitcnt vmcnt(57)
 v_mfma_f32_16x16x32_bf16 v[12:15], a[0:3], a[84:87], v[12:15]
 s_waitcnt lgkmcnt(12)
 v_mfma_f32_16x16x32_bf16 v[28:31], a[4:7], a[84:87], v[28:31]
 ds_read_b64_tr_b16 a[32:33], v236 offset:50208
 v_mfma_f32_16x16x32_bf16 v[24:27], a[4:7], a[80:83], v[24:27]
 v_mfma_f32_16x16x32_bf16 v[20:23], a[4:7], a[76:79], v[20:23]
 ds_read_b64_tr_b16 a[34:35], v236 offset:53792
 v_mfma_f32_16x16x32_bf16 v[16:19], a[4:7], a[72:75], v[16:19]
 buffer_load_dwordx4 a[60:63], v232, s[24:27], s41 offen sc1
 s_waitcnt lgkmcnt(12)
 v_mfma_f32_16x16x32_bf16 v[32:35], a[8:11], a[72:75], v[32:35]
 ds_read_b64_tr_b16 a[36:37], v236 offset:50240
 v_mfma_f32_16x16x32_bf16 v[36:39], a[8:11], a[76:79], v[36:39]
 v_mfma_f32_16x16x32_bf16 v[40:43], a[8:11], a[80:83], v[40:43]
 ds_read_b64_tr_b16 a[38:39], v236 offset:53824
 v_mfma_f32_16x16x32_bf16 v[44:47], a[8:11], a[84:87], v[44:47]
 s_waitcnt lgkmcnt(12)
 v_mfma_f32_16x16x32_bf16 v[60:63], a[12:15], a[84:87], v[60:63]
 ds_read_b64_tr_b16 a[40:41], v236 offset:50272
 v_mfma_f32_16x16x32_bf16 v[56:59], a[12:15], a[80:83], v[56:59]
 buffer_load_dwordx4 a[64:67], v233, s[24:27], s41 offen sc1
 v_mfma_f32_16x16x32_bf16 v[52:55], a[12:15], a[76:79], v[52:55]
 ds_read_b64_tr_b16 a[42:43], v236 offset:53856
 v_mfma_f32_16x16x32_bf16 v[48:51], a[12:15], a[72:75], v[48:51]
 s_waitcnt lgkmcnt(12)
 v_mfma_f32_16x16x32_bf16 v[64:67], a[16:19], a[72:75], v[64:67]
 ds_read_b64_tr_b16 a[44:45], v236 offset:50304
 v_mfma_f32_16x16x32_bf16 v[68:71], a[16:19], a[76:79], v[68:71]
 v_mfma_f32_16x16x32_bf16 v[72:75], a[16:19], a[80:83], v[72:75]
 ds_read_b64_tr_b16 a[46:47], v236 offset:53888
 v_mfma_f32_16x16x32_bf16 v[76:79], a[16:19], a[84:87], v[76:79]
 buffer_load_dwordx4 a[68:71], v234, s[24:27], s41 offen sc1
 s_waitcnt lgkmcnt(12)
 v_mfma_f32_16x16x32_bf16 v[92:95], a[20:23], a[84:87], v[92:95]
 ds_read_b64_tr_b16 a[48:49], v236 offset:50336
 v_mfma_f32_16x16x32_bf16 v[88:91], a[20:23], a[80:83], v[88:91]
 v_mfma_f32_16x16x32_bf16 v[84:87], a[20:23], a[76:79], v[84:87]
 ds_read_b64_tr_b16 a[50:51], v236 offset:53920
 v_mfma_f32_16x16x32_bf16 v[80:83], a[20:23], a[72:75], v[80:83]
 s_waitcnt lgkmcnt(12)
 v_mfma_f32_16x16x32_bf16 v[96:99], a[24:27], a[72:75], v[96:99]
 ds_read_b64_tr_b16 a[52:53], v236 offset:50368
 v_mfma_f32_16x16x32_bf16 v[100:103], a[24:27], a[76:79], v[100:103]
 v_mfma_f32_16x16x32_bf16 v[104:107], a[24:27], a[80:83], v[104:107]
 ds_read_b64_tr_b16 a[54:55], v236 offset:53952
 v_mfma_f32_16x16x32_bf16 v[108:111], a[24:27], a[84:87], v[108:111]
 s_waitcnt lgkmcnt(0)
 s_waitcnt vmcnt(53)
 s_barrier
 v_mfma_f32_16x16x32_bf16 v[112:115], a[28:31], a[72:75], v[112:115]
 ds_read_b64_tr_b16 a[0:1], v237 offset:0
 v_mfma_f32_16x16x32_bf16 v[116:119], a[28:31], a[76:79], v[116:119]
 v_mfma_f32_16x16x32_bf16 v[120:123], a[28:31], a[80:83], v[120:123]
 ds_read_b64_tr_b16 a[2:3], v237 offset:3584
 v_mfma_f32_16x16x32_bf16 v[124:127], a[28:31], a[84:87], v[124:127]
 s_waitcnt vmcnt(30)
 v_add_f32 v238, v238, v240
 v_mfma_f32_16x16x32_bf16 v[140:143], a[32:35], a[84:87], v[140:143]
 ds_read_b64_tr_b16 a[4:5], v237 offset:32
 v_mfma_f32_16x16x32_bf16 v[136:139], a[32:35], a[80:83], v[136:139]
 v_add_f32 v239, v239, v241
 v_mfma_f32_16x16x32_bf16 v[132:135], a[32:35], a[76:79], v[132:135]
 ds_read_b64_tr_b16 a[6:7], v237 offset:3616
 v_mfma_f32_16x16x32_bf16 v[128:131], a[32:35], a[72:75], v[128:131]
 s_waitcnt vmcnt(27)
 v_add_f32 v242, v242, v244
 v_mfma_f32_16x16x32_bf16 v[144:147], a[36:39], a[72:75], v[144:147]
 ds_read_b64_tr_b16 a[8:9], v237 offset:64
 v_mfma_f32_16x16x32_bf16 v[148:151], a[36:39], a[76:79], v[148:151]
 v_add_f32 v243, v243, v245
 v_mfma_f32_16x16x32_bf16 v[152:155], a[36:39], a[80:83], v[152:155]
 ds_read_b64_tr_b16 a[10:11], v237 offset:3648
 v_mfma_f32_16x16x32_bf16 v[156:159], a[36:39], a[84:87], v[156:159]
 v_add_f32 v238, v238, v242
 v_mfma_f32_16x16x32_bf16 v[172:175], a[40:43], a[84:87], v[172:175]
 ds_read_b64_tr_b16 a[12:13], v237 offset:96
 v_mfma_f32_16x16x32_bf16 v[168:171], a[40:43], a[80:83], v[168:171]
 v_add_f32 v239, v239, v243
 v_mfma_f32_16x16x32_bf16 v[164:167], a[40:43], a[76:79], v[164:167]
 ds_read_b64_tr_b16 a[14:15], v237 offset:3680
 v_mfma_f32_16x16x32_bf16 v[160:163], a[40:43], a[72:75], v[160:163]
 v_mov_b32 v240, v238
 v_mfma_f32_16x16x32_bf16 v[176:179], a[44:47], a[72:75], v[176:179]
 ds_read_b64_tr_b16 a[16:17], v237 offset:128
 v_mfma_f32_16x16x32_bf16 v[180:183], a[44:47], a[76:79], v[180:183]
 v_mov_b32 v241, v239
 v_mfma_f32_16x16x32_bf16 v[184:187], a[44:47], a[80:83], v[184:187]
 ds_read_b64_tr_b16 a[18:19], v237 offset:3712
 v_mfma_f32_16x16x32_bf16 v[188:191], a[44:47], a[84:87], v[188:191]
 v_permlane32_swap_b32 v238, v240
 v_mfma_f32_16x16x32_bf16 v[204:207], a[48:51], a[84:87], v[204:207]
 ds_read_b64_tr_b16 a[20:21], v237 offset:160
 v_mfma_f32_16x16x32_bf16 v[200:203], a[48:51], a[80:83], v[200:203]
 v_permlane32_swap_b32 v239, v241
 v_mfma_f32_16x16x32_bf16 v[196:199], a[48:51], a[76:79], v[196:199]
 ds_read_b64_tr_b16 a[22:23], v237 offset:3744
 v_mfma_f32_16x16x32_bf16 v[192:195], a[48:51], a[72:75], v[192:195]
 v_add_f32 v238, v238, v240
 v_mfma_f32_16x16x32_bf16 v[208:211], a[52:55], a[72:75], v[208:211]
 ds_read_b64_tr_b16 a[24:25], v237 offset:192
 v_mfma_f32_16x16x32_bf16 v[212:215], a[52:55], a[76:79], v[212:215]
 v_mfma_f32_16x16x32_bf16 v[216:219], a[52:55], a[80:83], v[216:219]
 ds_read_b64_tr_b16 a[26:27], v237 offset:3776
 v_mfma_f32_16x16x32_bf16 v[220:223], a[52:55], a[84:87], v[220:223]
 s_waitcnt lgkmcnt(12)
 v_mfma_f32_16x16x32_bf16 v[0:3], a[0:3], a[88:91], v[0:3]
 ds_read_b64_tr_b16 a[28:29], v237 offset:14336
 v_mfma_f32_16x16x32_bf16 v[4:7], a[0:3], a[92:95], v[4:7]
 buffer_load_dwordx4 a[72:75], v231, s[24:27], s41 offen offset:1024 sc1
 v_mfma_f32_16x16x32_bf16 v[8:11], a[0:3], a[96:99], v[8:11]
 ds_read_b64_tr_b16 a[30:31], v237 offset:17920
 v_mfma_f32_16x16x32_bf16 v[12:15], a[0:3], a[100:103], v[12:15]
 v_add_f32 v239, v239, v241
 s_waitcnt lgkmcnt(12)
 v_mfma_f32_16x16x32_bf16 v[28:31], a[4:7], a[100:103], v[28:31]
 ds_read_b64_tr_b16 a[32:33], v237 offset:14368
 v_mfma_f32_16x16x32_bf16 v[24:27], a[4:7], a[96:99], v[24:27]
 buffer_load_dwordx4 a[76:79], v232, s[24:27], s41 offen offset:1024 sc1
 v_mov_b32 v240, v238
 v_mfma_f32_16x16x32_bf16 v[20:23], a[4:7], a[92:95], v[20:23]
 ds_read_b64_tr_b16 a[34:35], v237 offset:17952
 v_mfma_f32_16x16x32_bf16 v[16:19], a[4:7], a[88:91], v[16:19]
 v_mov_b32 v241, v239
 s_waitcnt lgkmcnt(12)
 v_mfma_f32_16x16x32_bf16 v[32:35], a[8:11], a[88:91], v[32:35]
 ds_read_b64_tr_b16 a[36:37], v237 offset:14400
 v_mfma_f32_16x16x32_bf16 v[36:39], a[8:11], a[92:95], v[36:39]
 buffer_load_dwordx4 a[80:83], v233, s[24:27], s41 offen offset:1024 sc1
 v_permlane16_swap_b32 v238, v240
 v_mfma_f32_16x16x32_bf16 v[40:43], a[8:11], a[96:99], v[40:43]
 ds_read_b64_tr_b16 a[38:39], v237 offset:17984
 v_mfma_f32_16x16x32_bf16 v[44:47], a[8:11], a[100:103], v[44:47]
 v_permlane16_swap_b32 v239, v241
 s_waitcnt lgkmcnt(12)
 v_mfma_f32_16x16x32_bf16 v[60:63], a[12:15], a[100:103], v[60:63]
 ds_read_b64_tr_b16 a[40:41], v237 offset:14432
 v_mfma_f32_16x16x32_bf16 v[56:59], a[12:15], a[96:99], v[56:59]
 buffer_load_dwordx4 a[84:87], v234, s[24:27], s41 offen offset:1024 sc1
 v_add_f32 v238, v238, v240
 v_mfma_f32_16x16x32_bf16 v[52:55], a[12:15], a[92:95], v[52:55]
 ds_read_b64_tr_b16 a[42:43], v237 offset:18016
 v_mfma_f32_16x16x32_bf16 v[48:51], a[12:15], a[88:91], v[48:51]
 v_add_f32 v239, v239, v241
 s_waitcnt lgkmcnt(12)
 v_mfma_f32_16x16x32_bf16 v[64:67], a[16:19], a[88:91], v[64:67]
 ds_read_b64_tr_b16 a[44:45], v237 offset:14464
 v_mfma_f32_16x16x32_bf16 v[68:71], a[16:19], a[92:95], v[68:71]
 buffer_load_dwordx4 v224, s[60:63], s40 offen lds
 v_mul_f32 v238, 0xba800000, v238
 v_mfma_f32_16x16x32_bf16 v[72:75], a[16:19], a[96:99], v[72:75]
 ds_read_b64_tr_b16 a[46:47], v237 offset:18048
 v_mfma_f32_16x16x32_bf16 v[76:79], a[16:19], a[100:103], v[76:79]
 v_mul_f32 v239, 0x3a800000, v239
 s_waitcnt lgkmcnt(12)
 v_mfma_f32_16x16x32_bf16 v[92:95], a[20:23], a[100:103], v[92:95]
 ds_read_b64_tr_b16 a[48:49], v237 offset:14496
 v_mfma_f32_16x16x32_bf16 v[88:91], a[20:23], a[96:99], v[88:91]
 buffer_load_dwordx4 v225, s[60:63], s40 offen offset:1024 lds
 v_fma_f32 v239, -v238, v238, v239
 v_mfma_f32_16x16x32_bf16 v[84:87], a[20:23], a[92:95], v[84:87]
 ds_read_b64_tr_b16 a[50:51], v237 offset:18080
 v_mfma_f32_16x16x32_bf16 v[80:83], a[20:23], a[88:91], v[80:83]
 v_max_f32 v239, 0, v239
 s_waitcnt lgkmcnt(12)
 v_mfma_f32_16x16x32_bf16 v[96:99], a[24:27], a[88:91], v[96:99]
 ds_read_b64_tr_b16 a[52:53], v237 offset:14528
 v_mfma_f32_16x16x32_bf16 v[100:103], a[24:27], a[92:95], v[100:103]
 v_mfma_f32_16x16x32_bf16 v[104:107], a[24:27], a[96:99], v[104:107]
 ds_read_b64_tr_b16 a[54:55], v237 offset:18112
 v_mfma_f32_16x16x32_bf16 v[108:111], a[24:27], a[100:103], v[108:111]
 s_waitcnt lgkmcnt(12)
 v_mfma_f32_16x16x32_bf16 v[112:115], a[28:31], a[88:91], v[112:115]
 ds_read_b64_tr_b16 a[0:1], v237 offset:7168
 v_mfma_f32_16x16x32_bf16 v[116:119], a[28:31], a[92:95], v[116:119]
 buffer_load_dwordx4 v226, s[60:63], s40 offen offset:2048 lds
 v_mfma_f32_16x16x32_bf16 v[120:123], a[28:31], a[96:99], v[120:123]
 ds_read_b64_tr_b16 a[2:3], v237 offset:10752
 v_mfma_f32_16x16x32_bf16 v[124:127], a[28:31], a[100:103], v[124:127]
 v_add_f32 v239, 0x3727c5ac, v239
 s_waitcnt lgkmcnt(12)
 v_mfma_f32_16x16x32_bf16 v[140:143], a[32:35], a[100:103], v[140:143]
 ds_read_b64_tr_b16 a[4:5], v237 offset:7200
 v_mfma_f32_16x16x32_bf16 v[136:139], a[32:35], a[96:99], v[136:139]
 buffer_load_dwordx4 v227, s[60:63], s40 offen offset:3072 lds
 s_add_u32 m0, s96, 90112
 v_sqrt_f32 v253, v239
 v_mfma_f32_16x16x32_bf16 v[132:135], a[32:35], a[92:95], v[132:135]
 ds_read_b64_tr_b16 a[6:7], v237 offset:10784
 v_mfma_f32_16x16x32_bf16 v[128:131], a[32:35], a[88:91], v[128:131]
 v_rsq_f32 v249, v239
 s_waitcnt lgkmcnt(12)
 v_mfma_f32_16x16x32_bf16 v[144:147], a[36:39], a[88:91], v[144:147]
 ds_read_b64_tr_b16 a[8:9], v237 offset:7232
 v_mfma_f32_16x16x32_bf16 v[148:151], a[36:39], a[92:95], v[148:151]
 buffer_load_dwordx4 v228, s[60:63], s40 offen lds
 v_cvt_pk_bf16_f32 v240, v238, v253
 v_mfma_f32_16x16x32_bf16 v[152:155], a[36:39], a[96:99], v[152:155]
 ds_read_b64_tr_b16 a[10:11], v237 offset:10816
 v_mfma_f32_16x16x32_bf16 v[156:159], a[36:39], a[100:103], v[156:159]
 v_mul_f32 v249, 0xbfb8aa3b, v249
 s_waitcnt lgkmcnt(12)
 v_mfma_f32_16x16x32_bf16 v[172:175], a[40:43], a[100:103], v[172:175]
 ds_read_b64_tr_b16 a[12:13], v237 offset:7264
 v_mfma_f32_16x16x32_bf16 v[168:171], a[40:43], a[96:99], v[168:171]
 buffer_load_dwordx4 v229, s[60:63], s40 offen offset:1024 lds
 v_and_b32 v241, 0xffff0000, v240
 v_mfma_f32_16x16x32_bf16 v[164:167], a[40:43], a[92:95], v[164:167]
 ds_read_b64_tr_b16 a[14:15], v237 offset:10848
 v_mfma_f32_16x16x32_bf16 v[160:163], a[40:43], a[88:91], v[160:163]
 v_sub_f32 v242, v253, v241
 s_waitcnt lgkmcnt(12)
 v_mfma_f32_16x16x32_bf16 v[176:179], a[44:47], a[88:91], v[176:179]
 ds_read_b64_tr_b16 a[16:17], v237 offset:7296
 v_mfma_f32_16x16x32_bf16 v[180:183], a[44:47], a[92:95], v[180:183]
 buffer_load_dwordx4 v230, s[60:63], s40 offen offset:2048 lds
 s_add_u32 s40, s40, 458752
 s_add_u32 m0, s96, 131072
 v_cvt_pk_bf16_f32 v241, v241, v242
 v_mfma_f32_16x16x32_bf16 v[184:187], a[44:47], a[96:99], v[184:187]
 ds_read_b64_tr_b16 a[18:19], v237 offset:10880
 v_mfma_f32_16x16x32_bf16 v[188:191], a[44:47], a[100:103], v[188:191]
 v_accvgpr_write_b32 a186, v240
 s_waitcnt lgkmcnt(12)
 v_mfma_f32_16x16x32_bf16 v[204:207], a[48:51], a[100:103], v[204:207]
 ds_read_b64_tr_b16 a[20:21], v237 offset:7328
 v_mfma_f32_16x16x32_bf16 v[200:203], a[48:51], a[96:99], v[200:203]
 v_accvgpr_write_b32 a187, v241
 v_mfma_f32_16x16x32_bf16 v[196:199], a[48:51], a[92:95], v[196:199]
 ds_read_b64_tr_b16 a[22:23], v237 offset:10912
 v_mfma_f32_16x16x32_bf16 v[192:195], a[48:51], a[88:91], v[192:195]
 s_waitcnt lgkmcnt(12)
 v_mfma_f32_16x16x32_bf16 v[208:211], a[52:55], a[88:91], v[208:211]
 ds_read_b64_tr_b16 a[24:25], v237 offset:7360
 v_mfma_f32_16x16x32_bf16 v[212:215], a[52:55], a[92:95], v[212:215]
 v_mfma_f32_16x16x32_bf16 v[216:219], a[52:55], a[96:99], v[216:219]
 ds_read_b64_tr_b16 a[26:27], v237 offset:10944
 v_mfma_f32_16x16x32_bf16 v[220:223], a[52:55], a[100:103], v[220:223]
 s_waitcnt lgkmcnt(12)
 v_mfma_f32_16x16x32_bf16 v[0:3], a[0:3], a[104:107], v[0:3]
 ds_read_b64_tr_b16 a[28:29], v237 offset:21504
 v_mfma_f32_16x16x32_bf16 v[4:7], a[0:3], a[108:111], v[4:7]
 buffer_load_dwordx4 a[88:91], v231, s[24:27], s41 offen offset:2048 sc1
 v_mfma_f32_16x16x32_bf16 v[8:11], a[0:3], a[112:115], v[8:11]
 ds_read_b64_tr_b16 a[30:31], v237 offset:25088
 v_mfma_f32_16x16x32_bf16 v[12:15], a[0:3], a[116:119], v[12:15]
 buffer_load_dwordx2 v[238:239], v246, s[32:35], s42 offen offset:0 sc1
 s_waitcnt lgkmcnt(12)
 v_mfma_f32_16x16x32_bf16 v[28:31], a[4:7], a[116:119], v[28:31]
 ds_read_b64_tr_b16 a[32:33], v237 offset:21536
 v_mfma_f32_16x16x32_bf16 v[24:27], a[4:7], a[112:115], v[24:27]
 buffer_load_dwordx2 v[240:241], v246, s[32:35], s42 offen offset:128 sc1
 v_mfma_f32_16x16x32_bf16 v[20:23], a[4:7], a[108:111], v[20:23]
 ds_read_b64_tr_b16 a[34:35], v237 offset:25120
 v_mfma_f32_16x16x32_bf16 v[16:19], a[4:7], a[104:107], v[16:19]
 buffer_load_dwordx4 a[92:95], v232, s[24:27], s41 offen offset:2048 sc1
 buffer_load_dwordx2 v[242:243], v246, s[32:35], s42 offen offset:256 sc1
 s_waitcnt lgkmcnt(12)
 v_mfma_f32_16x16x32_bf16 v[32:35], a[8:11], a[104:107], v[32:35]
 ds_read_b64_tr_b16 a[36:37], v237 offset:21568
 v_mfma_f32_16x16x32_bf16 v[36:39], a[8:11], a[108:111], v[36:39]
 buffer_load_dwordx2 v[244:245], v246, s[32:35], s42 offen offset:384 sc1
 v_mfma_f32_16x16x32_bf16 v[40:43], a[8:11], a[112:115], v[40:43]
 ds_read_b64_tr_b16 a[38:39], v237 offset:25152
 v_mfma_f32_16x16x32_bf16 v[44:47], a[8:11], a[116:119], v[44:47]
 s_add_u32 s42, s42, 2048
 s_waitcnt lgkmcnt(12)
 v_mfma_f32_16x16x32_bf16 v[60:63], a[12:15], a[116:119], v[60:63]
 ds_read_b64_tr_b16 a[40:41], v237 offset:21600
 v_mfma_f32_16x16x32_bf16 v[56:59], a[12:15], a[112:115], v[56:59]
 buffer_load_dwordx4 a[96:99], v233, s[24:27], s41 offen offset:2048 sc1
 v_mfma_f32_16x16x32_bf16 v[52:55], a[12:15], a[108:111], v[52:55]
 ds_read_b64_tr_b16 a[42:43], v237 offset:25184
 v_mfma_f32_16x16x32_bf16 v[48:51], a[12:15], a[104:107], v[48:51]
 s_waitcnt lgkmcnt(12)
 v_mfma_f32_16x16x32_bf16 v[64:67], a[16:19], a[104:107], v[64:67]
 ds_read_b64_tr_b16 a[44:45], v237 offset:21632
 v_mfma_f32_16x16x32_bf16 v[68:71], a[16:19], a[108:111], v[68:71]
 v_mfma_f32_16x16x32_bf16 v[72:75], a[16:19], a[112:115], v[72:75]
 ds_read_b64_tr_b16 a[46:47], v237 offset:25216
 v_mfma_f32_16x16x32_bf16 v[76:79], a[16:19], a[116:119], v[76:79]
 buffer_load_dwordx4 a[100:103], v234, s[24:27], s41 offen offset:2048 sc1
 s_waitcnt lgkmcnt(12)
 v_mfma_f32_16x16x32_bf16 v[92:95], a[20:23], a[116:119], v[92:95]
 ds_read_b64_tr_b16 a[48:49], v237 offset:21664
 v_mfma_f32_16x16x32_bf16 v[88:91], a[20:23], a[112:115], v[88:91]
 v_mfma_f32_16x16x32_bf16 v[84:87], a[20:23], a[108:111], v[84:87]
 ds_read_b64_tr_b16 a[50:51], v237 offset:25248
 v_mfma_f32_16x16x32_bf16 v[80:83], a[20:23], a[104:107], v[80:83]
 s_waitcnt lgkmcnt(12)
 v_mfma_f32_16x16x32_bf16 v[96:99], a[24:27], a[104:107], v[96:99]
 ds_read_b64_tr_b16 a[52:53], v237 offset:21696
 v_mfma_f32_16x16x32_bf16 v[100:103], a[24:27], a[108:111], v[100:103]
 v_mfma_f32_16x16x32_bf16 v[104:107], a[24:27], a[112:115], v[104:107]
 ds_read_b64_tr_b16 a[54:55], v237 offset:25280
 v_mfma_f32_16x16x32_bf16 v[108:111], a[24:27], a[116:119], v[108:111]
 s_waitcnt lgkmcnt(0)
 s_barrier
 v_mfma_f32_16x16x32_bf16 v[112:115], a[28:31], a[104:107], v[112:115]
 ds_read_b64_tr_b16 a[0:1], v235 offset:0
 v_mfma_f32_16x16x32_bf16 v[116:119], a[28:31], a[108:111], v[116:119]
 v_mfma_f32_16x16x32_bf16 v[120:123], a[28:31], a[112:115], v[120:123]
 ds_read_b64_tr_b16 a[2:3], v235 offset:3584
 v_mfma_f32_16x16x32_bf16 v[124:127], a[28:31], a[116:119], v[124:127]
 v_mfma_f32_16x16x32_bf16 v[140:143], a[32:35], a[116:119], v[140:143]
 ds_read_b64_tr_b16 a[4:5], v235 offset:32
 v_mfma_f32_16x16x32_bf16 v[136:139], a[32:35], a[112:115], v[136:139]
 v_mfma_f32_16x16x32_bf16 v[132:135], a[32:35], a[108:111], v[132:135]
 ds_read_b64_tr_b16 a[6:7], v235 offset:3616
 v_mfma_f32_16x16x32_bf16 v[128:131], a[32:35], a[104:107], v[128:131]
 v_mfma_f32_16x16x32_bf16 v[144:147], a[36:39], a[104:107], v[144:147]
 ds_read_b64_tr_b16 a[8:9], v235 offset:64
 v_mfma_f32_16x16x32_bf16 v[148:151], a[36:39], a[108:111], v[148:151]
 v_mfma_f32_16x16x32_bf16 v[152:155], a[36:39], a[112:115], v[152:155]
 ds_read_b64_tr_b16 a[10:11], v235 offset:3648
 v_mfma_f32_16x16x32_bf16 v[156:159], a[36:39], a[116:119], v[156:159]
 v_mfma_f32_16x16x32_bf16 v[172:175], a[40:43], a[116:119], v[172:175]
 ds_read_b64_tr_b16 a[12:13], v235 offset:96
 v_mfma_f32_16x16x32_bf16 v[168:171], a[40:43], a[112:115], v[168:171]
 v_mfma_f32_16x16x32_bf16 v[164:167], a[40:43], a[108:111], v[164:167]
 ds_read_b64_tr_b16 a[14:15], v235 offset:3680
 v_mfma_f32_16x16x32_bf16 v[160:163], a[40:43], a[104:107], v[160:163]
 v_mfma_f32_16x16x32_bf16 v[176:179], a[44:47], a[104:107], v[176:179]
 ds_read_b64_tr_b16 a[16:17], v235 offset:128
 v_mfma_f32_16x16x32_bf16 v[180:183], a[44:47], a[108:111], v[180:183]
 v_mfma_f32_16x16x32_bf16 v[184:187], a[44:47], a[112:115], v[184:187]
 ds_read_b64_tr_b16 a[18:19], v235 offset:3712
 v_mfma_f32_16x16x32_bf16 v[188:191], a[44:47], a[116:119], v[188:191]
 v_mfma_f32_16x16x32_bf16 v[204:207], a[48:51], a[116:119], v[204:207]
 ds_read_b64_tr_b16 a[20:21], v235 offset:160
 v_mfma_f32_16x16x32_bf16 v[200:203], a[48:51], a[112:115], v[200:203]
 v_mfma_f32_16x16x32_bf16 v[196:199], a[48:51], a[108:111], v[196:199]
 ds_read_b64_tr_b16 a[22:23], v235 offset:3744
 v_mfma_f32_16x16x32_bf16 v[192:195], a[48:51], a[104:107], v[192:195]
 v_mfma_f32_16x16x32_bf16 v[208:211], a[52:55], a[104:107], v[208:211]
 ds_read_b64_tr_b16 a[24:25], v235 offset:192
 v_mfma_f32_16x16x32_bf16 v[212:215], a[52:55], a[108:111], v[212:215]
 v_mfma_f32_16x16x32_bf16 v[216:219], a[52:55], a[112:115], v[216:219]
 ds_read_b64_tr_b16 a[26:27], v235 offset:3776
 v_mfma_f32_16x16x32_bf16 v[220:223], a[52:55], a[116:119], v[220:223]
 s_waitcnt lgkmcnt(12)
 v_mfma_f32_16x16x32_bf16 v[0:3], a[0:3], a[120:123], v[0:3]
 ds_read_b64_tr_b16 a[28:29], v235 offset:14336
 v_mfma_f32_16x16x32_bf16 v[4:7], a[0:3], a[124:127], v[4:7]
 buffer_load_dwordx4 a[104:107], v231, s[24:27], s41 offen offset:3072 sc1
 v_mfma_f32_16x16x32_bf16 v[8:11], a[0:3], a[128:131], v[8:11]
 ds_read_b64_tr_b16 a[30:31], v235 offset:17920
 v_mfma_f32_16x16x32_bf16 v[12:15], a[0:3], a[132:135], v[12:15]
 s_waitcnt lgkmcnt(12)
 v_mfma_f32_16x16x32_bf16 v[28:31], a[4:7], a[132:135], v[28:31]
 ds_read_b64_tr_b16 a[32:33], v235 offset:14368
 v_mfma_f32_16x16x32_bf16 v[24:27], a[4:7], a[128:131], v[24:27]
 buffer_load_dwordx4 a[108:111], v232, s[24:27], s41 offen offset:3072 sc1
 v_mfma_f32_16x16x32_bf16 v[20:23], a[4:7], a[124:127], v[20:23]
 ds_read_b64_tr_b16 a[34:35], v235 offset:17952
 v_mfma_f32_16x16x32_bf16 v[16:19], a[4:7], a[120:123], v[16:19]
 s_waitcnt lgkmcnt(12)
 v_mfma_f32_16x16x32_bf16 v[32:35], a[8:11], a[120:123], v[32:35]
 ds_read_b64_tr_b16 a[36:37], v235 offset:14400
 v_mfma_f32_16x16x32_bf16 v[36:39], a[8:11], a[124:127], v[36:39]
 buffer_load_dwordx4 a[112:115], v233, s[24:27], s41 offen offset:3072 sc1
 v_mfma_f32_16x16x32_bf16 v[40:43], a[8:11], a[128:131], v[40:43]
 ds_read_b64_tr_b16 a[38:39], v235 offset:17984
 v_mfma_f32_16x16x32_bf16 v[44:47], a[8:11], a[132:135], v[44:47]
 s_waitcnt lgkmcnt(12)
 v_mfma_f32_16x16x32_bf16 v[60:63], a[12:15], a[132:135], v[60:63]
 ds_read_b64_tr_b16 a[40:41], v235 offset:14432
 v_mfma_f32_16x16x32_bf16 v[56:59], a[12:15], a[128:131], v[56:59]
 buffer_load_dwordx4 a[116:119], v234, s[24:27], s41 offen offset:3072 sc1
 s_add_u32 s41, s41, 4096
 v_mfma_f32_16x16x32_bf16 v[52:55], a[12:15], a[124:127], v[52:55]
 ds_read_b64_tr_b16 a[42:43], v235 offset:18016
 v_mfma_f32_16x16x32_bf16 v[48:51], a[12:15], a[120:123], v[48:51]
 s_waitcnt lgkmcnt(12)
 v_mfma_f32_16x16x32_bf16 v[64:67], a[16:19], a[120:123], v[64:67]
 ds_read_b64_tr_b16 a[44:45], v235 offset:14464
 v_mfma_f32_16x16x32_bf16 v[68:71], a[16:19], a[124:127], v[68:71]
 buffer_load_dwordx4 v224, s[60:63], s40 offen lds
 v_mfma_f32_16x16x32_bf16 v[72:75], a[16:19], a[128:131], v[72:75]
 ds_read_b64_tr_b16 a[46:47], v235 offset:18048
 v_mfma_f32_16x16x32_bf16 v[76:79], a[16:19], a[132:135], v[76:79]
 s_waitcnt lgkmcnt(12)
 v_mfma_f32_16x16x32_bf16 v[92:95], a[20:23], a[132:135], v[92:95]
 ds_read_b64_tr_b16 a[48:49], v235 offset:14496
 v_mfma_f32_16x16x32_bf16 v[88:91], a[20:23], a[128:131], v[88:91]
 buffer_load_dwordx4 v225, s[60:63], s40 offen offset:1024 lds
 v_mfma_f32_16x16x32_bf16 v[84:87], a[20:23], a[124:127], v[84:87]
 ds_read_b64_tr_b16 a[50:51], v235 offset:18080
 v_mfma_f32_16x16x32_bf16 v[80:83], a[20:23], a[120:123], v[80:83]
 s_waitcnt lgkmcnt(12)
 v_mfma_f32_16x16x32_bf16 v[96:99], a[24:27], a[120:123], v[96:99]
 ds_read_b64_tr_b16 a[52:53], v235 offset:14528
 v_mfma_f32_16x16x32_bf16 v[100:103], a[24:27], a[124:127], v[100:103]
 v_mfma_f32_16x16x32_bf16 v[104:107], a[24:27], a[128:131], v[104:107]
 ds_read_b64_tr_b16 a[54:55], v235 offset:18112
 v_mfma_f32_16x16x32_bf16 v[108:111], a[24:27], a[132:135], v[108:111]
 s_waitcnt lgkmcnt(12)
 v_mfma_f32_16x16x32_bf16 v[112:115], a[28:31], a[120:123], v[112:115]
 ds_read_b64_tr_b16 a[0:1], v235 offset:7168
 v_mfma_f32_16x16x32_bf16 v[116:119], a[28:31], a[124:127], v[116:119]
 buffer_load_dwordx4 v226, s[60:63], s40 offen offset:2048 lds
 v_mfma_f32_16x16x32_bf16 v[120:123], a[28:31], a[128:131], v[120:123]
 ds_read_b64_tr_b16 a[2:3], v235 offset:10752
 v_mfma_f32_16x16x32_bf16 v[124:127], a[28:31], a[132:135], v[124:127]
 s_waitcnt lgkmcnt(12)
 v_mfma_f32_16x16x32_bf16 v[140:143], a[32:35], a[132:135], v[140:143]
 ds_read_b64_tr_b16 a[4:5], v235 offset:7200
 v_mfma_f32_16x16x32_bf16 v[136:139], a[32:35], a[128:131], v[136:139]
 buffer_load_dwordx4 v227, s[60:63], s40 offen offset:3072 lds
 s_add_u32 m0, s96, 135168
 v_mfma_f32_16x16x32_bf16 v[132:135], a[32:35], a[124:127], v[132:135]
 ds_read_b64_tr_b16 a[6:7], v235 offset:10784
 v_mfma_f32_16x16x32_bf16 v[128:131], a[32:35], a[120:123], v[128:131]
 s_waitcnt lgkmcnt(12)
 v_mfma_f32_16x16x32_bf16 v[144:147], a[36:39], a[120:123], v[144:147]
 ds_read_b64_tr_b16 a[8:9], v235 offset:7232
 v_mfma_f32_16x16x32_bf16 v[148:151], a[36:39], a[124:127], v[148:151]
 buffer_load_dwordx4 v228, s[60:63], s40 offen lds
 v_mfma_f32_16x16x32_bf16 v[152:155], a[36:39], a[128:131], v[152:155]
 ds_read_b64_tr_b16 a[10:11], v235 offset:10816
 v_mfma_f32_16x16x32_bf16 v[156:159], a[36:39], a[132:135], v[156:159]
 s_waitcnt lgkmcnt(12)
 v_mfma_f32_16x16x32_bf16 v[172:175], a[40:43], a[132:135], v[172:175]
 ds_read_b64_tr_b16 a[12:13], v235 offset:7264
 v_mfma_f32_16x16x32_bf16 v[168:171], a[40:43], a[128:131], v[168:171]
 buffer_load_dwordx4 v229, s[60:63], s40 offen offset:1024 lds
 v_mfma_f32_16x16x32_bf16 v[164:167], a[40:43], a[124:127], v[164:167]
 ds_read_b64_tr_b16 a[14:15], v235 offset:10848
 v_mfma_f32_16x16x32_bf16 v[160:163], a[40:43], a[120:123], v[160:163]
 s_waitcnt lgkmcnt(12)
 v_mfma_f32_16x16x32_bf16 v[176:179], a[44:47], a[120:123], v[176:179]
 ds_read_b64_tr_b16 a[16:17], v235 offset:7296
 v_mfma_f32_16x16x32_bf16 v[180:183], a[44:47], a[124:127], v[180:183]
 buffer_load_dwordx4 v230, s[60:63], s40 offen offset:2048 lds
 s_add_u32 s40, s40, 458752
 s_add_u32 m0, s96, 0
 v_mfma_f32_16x16x32_bf16 v[184:187], a[44:47], a[128:131], v[184:187]
 ds_read_b64_tr_b16 a[18:19], v235 offset:10880
 v_mfma_f32_16x16x32_bf16 v[188:191], a[44:47], a[132:135], v[188:191]
 s_waitcnt lgkmcnt(12)
 v_mfma_f32_16x16x32_bf16 v[204:207], a[48:51], a[132:135], v[204:207]
 ds_read_b64_tr_b16 a[20:21], v235 offset:7328
 v_mfma_f32_16x16x32_bf16 v[200:203], a[48:51], a[128:131], v[200:203]
 v_mfma_f32_16x16x32_bf16 v[196:199], a[48:51], a[124:127], v[196:199]
 ds_read_b64_tr_b16 a[22:23], v235 offset:10912
 v_mfma_f32_16x16x32_bf16 v[192:195], a[48:51], a[120:123], v[192:195]
 s_waitcnt lgkmcnt(12)
 v_mfma_f32_16x16x32_bf16 v[208:211], a[52:55], a[120:123], v[208:211]
 ds_read_b64_tr_b16 a[24:25], v235 offset:7360
 v_mfma_f32_16x16x32_bf16 v[212:215], a[52:55], a[124:127], v[212:215]
 v_mfma_f32_16x16x32_bf16 v[216:219], a[52:55], a[128:131], v[216:219]
 ds_read_b64_tr_b16 a[26:27], v235 offset:10944
 v_mfma_f32_16x16x32_bf16 v[220:223], a[52:55], a[132:135], v[220:223]
 s_waitcnt lgkmcnt(12)
 v_mfma_f32_16x16x32_bf16 v[0:3], a[0:3], a[136:139], v[0:3]
 ds_read_b64_tr_b16 a[28:29], v235 offset:21504
 v_mfma_f32_16x16x32_bf16 v[4:7], a[0:3], a[140:143], v[4:7]
 buffer_load_dwordx4 a[120:123], v231, s[24:27], s41 offen sc1
 v_mfma_f32_16x16x32_bf16 v[8:11], a[0:3], a[144:147], v[8:11]
 ds_read_b64_tr_b16 a[30:31], v235 offset:25088
 s_waitcnt vmcnt(57)
 v_mfma_f32_16x16x32_bf16 v[12:15], a[0:3], a[148:151], v[12:15]
 s_waitcnt lgkmcnt(12)
 v_mfma_f32_16x16x32_bf16 v[28:31], a[4:7], a[148:151], v[28:31]
 ds_read_b64_tr_b16 a[32:33], v235 offset:21536
 v_mfma_f32_16x16x32_bf16 v[24:27], a[4:7], a[144:147], v[24:27]
 v_mfma_f32_16x16x32_bf16 v[20:23], a[4:7], a[140:143], v[20:23]
 ds_read_b64_tr_b16 a[34:35], v235 offset:25120
 v_mfma_f32_16x16x32_bf16 v[16:19], a[4:7], a[136:139], v[16:19]
 buffer_load_dwordx4 a[124:127], v232, s[24:27], s41 offen sc1
 s_waitcnt lgkmcnt(12)
 v_mfma_f32_16x16x32_bf16 v[32:35], a[8:11], a[136:139], v[32:35]
 ds_read_b64_tr_b16 a[36:37], v235 offset:21568
 v_mfma_f32_16x16x32_bf16 v[36:39], a[8:11], a[140:143], v[36:39]
 v_mfma_f32_16x16x32_bf16 v[40:43], a[8:11], a[144:147], v[40:43]
 ds_read_b64_tr_b16 a[38:39], v235 offset:25152
 v_mfma_f32_16x16x32_bf16 v[44:47], a[8:11], a[148:151], v[44:47]
 s_waitcnt lgkmcnt(12)
 v_mfma_f32_16x16x32_bf16 v[60:63], a[12:15], a[148:151], v[60:63]
 ds_read_b64_tr_b16 a[40:41], v235 offset:21600
 v_mfma_f32_16x16x32_bf16 v[56:59], a[12:15], a[144:147], v[56:59]
 buffer_load_dwordx4 a[128:131], v233, s[24:27], s41 offen sc1
 v_mfma_f32_16x16x32_bf16 v[52:55], a[12:15], a[140:143], v[52:55]
 ds_read_b64_tr_b16 a[42:43], v235 offset:25184
 v_mfma_f32_16x16x32_bf16 v[48:51], a[12:15], a[136:139], v[48:51]
 s_waitcnt lgkmcnt(12)
 v_mfma_f32_16x16x32_bf16 v[64:67], a[16:19], a[136:139], v[64:67]
 ds_read_b64_tr_b16 a[44:45], v235 offset:21632
 v_mfma_f32_16x16x32_bf16 v[68:71], a[16:19], a[140:143], v[68:71]
 v_mfma_f32_16x16x32_bf16 v[72:75], a[16:19], a[144:147], v[72:75]
 ds_read_b64_tr_b16 a[46:47], v235 offset:25216
 v_mfma_f32_16x16x32_bf16 v[76:79], a[16:19], a[148:151], v[76:79]
 buffer_load_dwordx4 a[132:135], v234, s[24:27], s41 offen sc1
 s_waitcnt lgkmcnt(12)
 v_mfma_f32_16x16x32_bf16 v[92:95], a[20:23], a[148:151], v[92:95]
 ds_read_b64_tr_b16 a[48:49], v235 offset:21664
 v_mfma_f32_16x16x32_bf16 v[88:91], a[20:23], a[144:147], v[88:91]
 v_mfma_f32_16x16x32_bf16 v[84:87], a[20:23], a[140:143], v[84:87]
 ds_read_b64_tr_b16 a[50:51], v235 offset:25248
 v_mfma_f32_16x16x32_bf16 v[80:83], a[20:23], a[136:139], v[80:83]
 s_waitcnt lgkmcnt(12)
 v_mfma_f32_16x16x32_bf16 v[96:99], a[24:27], a[136:139], v[96:99]
 ds_read_b64_tr_b16 a[52:53], v235 offset:21696
 v_mfma_f32_16x16x32_bf16 v[100:103], a[24:27], a[140:143], v[100:103]
 v_mfma_f32_16x16x32_bf16 v[104:107], a[24:27], a[144:147], v[104:107]
 ds_read_b64_tr_b16 a[54:55], v235 offset:25280
 v_mfma_f32_16x16x32_bf16 v[108:111], a[24:27], a[148:151], v[108:111]
 s_waitcnt lgkmcnt(0)
 s_waitcnt vmcnt(53)
 s_barrier
 v_mfma_f32_16x16x32_bf16 v[112:115], a[28:31], a[136:139], v[112:115]
 ds_read_b64_tr_b16 a[0:1], v235 offset:28672
 v_mfma_f32_16x16x32_bf16 v[116:119], a[28:31], a[140:143], v[116:119]
 v_mfma_f32_16x16x32_bf16 v[120:123], a[28:31], a[144:147], v[120:123]
 ds_read_b64_tr_b16 a[2:3], v235 offset:32256
 v_mfma_f32_16x16x32_bf16 v[124:127], a[28:31], a[148:151], v[124:127]
 v_mfma_f32_16x16x32_bf16 v[140:143], a[32:35], a[148:151], v[140:143]
 ds_read_b64_tr_b16 a[4:5], v235 offset:28704
 v_mfma_f32_16x16x32_bf16 v[136:139], a[32:35], a[144:147], v[136:139]
 v_mfma_f32_16x16x32_bf16 v[132:135], a[32:35], a[140:143], v[132:135]
 ds_read_b64_tr_b16 a[6:7], v235 offset:32288
 v_mfma_f32_16x16x32_bf16 v[128:131], a[32:35], a[136:139], v[128:131]
 v_mfma_f32_16x16x32_bf16 v[144:147], a[36:39], a[136:139], v[144:147]
 ds_read_b64_tr_b16 a[8:9], v235 offset:28736
 v_mfma_f32_16x16x32_bf16 v[148:151], a[36:39], a[140:143], v[148:151]
 v_mfma_f32_16x16x32_bf16 v[152:155], a[36:39], a[144:147], v[152:155]
 ds_read_b64_tr_b16 a[10:11], v235 offset:32320
 v_mfma_f32_16x16x32_bf16 v[156:159], a[36:39], a[148:151], v[156:159]
 v_mfma_f32_16x16x32_bf16 v[172:175], a[40:43], a[148:151], v[172:175]
 ds_read_b64_tr_b16 a[12:13], v235 offset:28768
 v_mfma_f32_16x16x32_bf16 v[168:171], a[40:43], a[144:147], v[168:171]
 v_mfma_f32_16x16x32_bf16 v[164:167], a[40:43], a[140:143], v[164:167]
 ds_read_b64_tr_b16 a[14:15], v235 offset:32352
 v_mfma_f32_16x16x32_bf16 v[160:163], a[40:43], a[136:139], v[160:163]
 v_mfma_f32_16x16x32_bf16 v[176:179], a[44:47], a[136:139], v[176:179]
 ds_read_b64_tr_b16 a[16:17], v235 offset:28800
 v_mfma_f32_16x16x32_bf16 v[180:183], a[44:47], a[140:143], v[180:183]
 v_mfma_f32_16x16x32_bf16 v[184:187], a[44:47], a[144:147], v[184:187]
 ds_read_b64_tr_b16 a[18:19], v235 offset:32384
 v_mfma_f32_16x16x32_bf16 v[188:191], a[44:47], a[148:151], v[188:191]
 v_mfma_f32_16x16x32_bf16 v[204:207], a[48:51], a[148:151], v[204:207]
 ds_read_b64_tr_b16 a[20:21], v235 offset:28832
 v_mfma_f32_16x16x32_bf16 v[200:203], a[48:51], a[144:147], v[200:203]
 v_mfma_f32_16x16x32_bf16 v[196:199], a[48:51], a[140:143], v[196:199]
 ds_read_b64_tr_b16 a[22:23], v235 offset:32416
 v_mfma_f32_16x16x32_bf16 v[192:195], a[48:51], a[136:139], v[192:195]
 v_mfma_f32_16x16x32_bf16 v[208:211], a[52:55], a[136:139], v[208:211]
 ds_read_b64_tr_b16 a[24:25], v235 offset:28864
 v_mfma_f32_16x16x32_bf16 v[212:215], a[52:55], a[140:143], v[212:215]
 v_mfma_f32_16x16x32_bf16 v[216:219], a[52:55], a[144:147], v[216:219]
 ds_read_b64_tr_b16 a[26:27], v235 offset:32448
 v_mfma_f32_16x16x32_bf16 v[220:223], a[52:55], a[148:151], v[220:223]
 s_waitcnt vmcnt(52) lgkmcnt(12)
 v_mfma_f32_16x16x32_bf16 v[0:3], a[0:3], a[152:155], v[0:3]
 ds_read_b64_tr_b16 a[28:29], v235 offset:43008
 s_waitcnt vmcnt(51)
 v_mfma_f32_16x16x32_bf16 v[4:7], a[0:3], a[156:159], v[4:7]
 buffer_load_dwordx4 a[136:139], v231, s[24:27], s41 offen offset:1024 sc1
 s_waitcnt vmcnt(51)
 v_mfma_f32_16x16x32_bf16 v[8:11], a[0:3], a[160:163], v[8:11]
 ds_read_b64_tr_b16 a[30:31], v235 offset:46592
 s_waitcnt vmcnt(50)
 v_mfma_f32_16x16x32_bf16 v[12:15], a[0:3], a[164:167], v[12:15]
 s_waitcnt lgkmcnt(12)
 v_mfma_f32_16x16x32_bf16 v[28:31], a[4:7], a[164:167], v[28:31]
 ds_read_b64_tr_b16 a[32:33], v235 offset:43040
 v_mfma_f32_16x16x32_bf16 v[24:27], a[4:7], a[160:163], v[24:27]
 buffer_load_dwordx4 a[140:143], v232, s[24:27], s41 offen offset:1024 sc1
 v_mfma_f32_16x16x32_bf16 v[20:23], a[4:7], a[156:159], v[20:23]
 ds_read_b64_tr_b16 a[34:35], v235 offset:46624
 v_mfma_f32_16x16x32_bf16 v[16:19], a[4:7], a[152:155], v[16:19]
 s_waitcnt lgkmcnt(12)
 v_mfma_f32_16x16x32_bf16 v[32:35], a[8:11], a[152:155], v[32:35]
 ds_read_b64_tr_b16 a[36:37], v235 offset:43072
 v_mfma_f32_16x16x32_bf16 v[36:39], a[8:11], a[156:159], v[36:39]
 buffer_load_dwordx4 a[144:147], v233, s[24:27], s41 offen offset:1024 sc1
 v_mfma_f32_16x16x32_bf16 v[40:43], a[8:11], a[160:163], v[40:43]
 ds_read_b64_tr_b16 a[38:39], v235 offset:46656
 v_mfma_f32_16x16x32_bf16 v[44:47], a[8:11], a[164:167], v[44:47]
 s_waitcnt lgkmcnt(12)
 v_mfma_f32_16x16x32_bf16 v[60:63], a[12:15], a[164:167], v[60:63]
 ds_read_b64_tr_b16 a[40:41], v235 offset:43104
 v_mfma_f32_16x16x32_bf16 v[56:59], a[12:15], a[160:163], v[56:59]
 buffer_load_dwordx4 a[148:151], v234, s[24:27], s41 offen offset:1024 sc1
 v_mfma_f32_16x16x32_bf16 v[52:55], a[12:15], a[156:159], v[52:55]
 ds_read_b64_tr_b16 a[42:43], v235 offset:46688
 v_mfma_f32_16x16x32_bf16 v[48:51], a[12:15], a[152:155], v[48:51]
 s_waitcnt lgkmcnt(12)
 v_mfma_f32_16x16x32_bf16 v[64:67], a[16:19], a[152:155], v[64:67]
 ds_read_b64_tr_b16 a[44:45], v235 offset:43136
 v_mfma_f32_16x16x32_bf16 v[68:71], a[16:19], a[156:159], v[68:71]
 buffer_load_dwordx4 v224, s[60:63], s40 offen lds
 v_mfma_f32_16x16x32_bf16 v[72:75], a[16:19], a[160:163], v[72:75]
 ds_read_b64_tr_b16 a[46:47], v235 offset:46720
 v_mfma_f32_16x16x32_bf16 v[76:79], a[16:19], a[164:167], v[76:79]
 s_waitcnt lgkmcnt(12)
 v_mfma_f32_16x16x32_bf16 v[92:95], a[20:23], a[164:167], v[92:95]
 ds_read_b64_tr_b16 a[48:49], v235 offset:43168
 v_mfma_f32_16x16x32_bf16 v[88:91], a[20:23], a[160:163], v[88:91]
 buffer_load_dwordx4 v225, s[60:63], s40 offen offset:1024 lds
 v_mfma_f32_16x16x32_bf16 v[84:87], a[20:23], a[156:159], v[84:87]
 ds_read_b64_tr_b16 a[50:51], v235 offset:46752
 v_mfma_f32_16x16x32_bf16 v[80:83], a[20:23], a[152:155], v[80:83]
 s_waitcnt lgkmcnt(12)
 v_mfma_f32_16x16x32_bf16 v[96:99], a[24:27], a[152:155], v[96:99]
 ds_read_b64_tr_b16 a[52:53], v235 offset:43200
 v_mfma_f32_16x16x32_bf16 v[100:103], a[24:27], a[156:159], v[100:103]
 v_mfma_f32_16x16x32_bf16 v[104:107], a[24:27], a[160:163], v[104:107]
 ds_read_b64_tr_b16 a[54:55], v235 offset:46784
 v_mfma_f32_16x16x32_bf16 v[108:111], a[24:27], a[164:167], v[108:111]
 s_waitcnt lgkmcnt(12)
 v_mfma_f32_16x16x32_bf16 v[112:115], a[28:31], a[152:155], v[112:115]
 ds_read_b64_tr_b16 a[0:1], v235 offset:35840
 v_mfma_f32_16x16x32_bf16 v[116:119], a[28:31], a[156:159], v[116:119]
 buffer_load_dwordx4 v226, s[60:63], s40 offen offset:2048 lds
 v_mfma_f32_16x16x32_bf16 v[120:123], a[28:31], a[160:163], v[120:123]
 ds_read_b64_tr_b16 a[2:3], v235 offset:39424
 v_mfma_f32_16x16x32_bf16 v[124:127], a[28:31], a[164:167], v[124:127]
 s_waitcnt vmcnt(27)
 v_add_f32 v238, v238, v240
 s_waitcnt lgkmcnt(12)
 v_mfma_f32_16x16x32_bf16 v[140:143], a[32:35], a[164:167], v[140:143]
 ds_read_b64_tr_b16 a[4:5], v235 offset:35872
 v_mfma_f32_16x16x32_bf16 v[136:139], a[32:35], a[160:163], v[136:139]
 buffer_load_dwordx4 v227, s[60:63], s40 offen offset:3072 lds
 s_add_u32 m0, s96, 4096
 v_add_f32 v239, v239, v241
 v_mfma_f32_16x16x32_bf16 v[132:135], a[32:35], a[156:159], v[132:135]
 ds_read_b64_tr_b16 a[6:7], v235 offset:39456
 v_mfma_f32_16x16x32_bf16 v[128:131], a[32:35], a[152:155], v[128:131]
 s_waitcnt vmcnt(25)
 v_add_f32 v242, v242, v244
 s_waitcnt lgkmcnt(12)
 v_mfma_f32_16x16x32_bf16 v[144:147], a[36:39], a[152:155], v[144:147]
 ds_read_b64_tr_b16 a[8:9], v235 offset:35904
 v_mfma_f32_16x16x32_bf16 v[148:151], a[36:39], a[156:159], v[148:151]
 buffer_load_dwordx4 v228, s[60:63], s40 offen lds
 v_add_f32 v243, v243, v245
 v_mfma_f32_16x16x32_bf16 v[152:155], a[36:39], a[160:163], v[152:155]
 ds_read_b64_tr_b16 a[10:11], v235 offset:39488
 v_mfma_f32_16x16x32_bf16 v[156:159], a[36:39], a[164:167], v[156:159]
 v_add_f32 v238, v238, v242
 s_waitcnt lgkmcnt(12)
 v_mfma_f32_16x16x32_bf16 v[172:175], a[40:43], a[164:167], v[172:175]
 ds_read_b64_tr_b16 a[12:13], v235 offset:35936
 v_mfma_f32_16x16x32_bf16 v[168:171], a[40:43], a[160:163], v[168:171]
 buffer_load_dwordx4 v229, s[60:63], s40 offen offset:1024 lds
 v_add_f32 v239, v239, v243
 v_mfma_f32_16x16x32_bf16 v[164:167], a[40:43], a[156:159], v[164:167]
 ds_read_b64_tr_b16 a[14:15], v235 offset:39520
 v_mfma_f32_16x16x32_bf16 v[160:163], a[40:43], a[152:155], v[160:163]
 v_mov_b32 v240, v238
 s_waitcnt lgkmcnt(12)
 v_mfma_f32_16x16x32_bf16 v[176:179], a[44:47], a[152:155], v[176:179]
 ds_read_b64_tr_b16 a[16:17], v235 offset:35968
 v_mfma_f32_16x16x32_bf16 v[180:183], a[44:47], a[156:159], v[180:183]
 buffer_load_dwordx4 v230, s[60:63], s40 offen offset:2048 lds
 s_add_u32 s40, s40, 458752
 s_add_u32 m0, s96, 28672
 v_mov_b32 v241, v239
 v_mfma_f32_16x16x32_bf16 v[184:187], a[44:47], a[160:163], v[184:187]
 ds_read_b64_tr_b16 a[18:19], v235 offset:39552
 v_mfma_f32_16x16x32_bf16 v[188:191], a[44:47], a[164:167], v[188:191]
 v_permlane32_swap_b32 v238, v240
 s_waitcnt lgkmcnt(12)
 v_mfma_f32_16x16x32_bf16 v[204:207], a[48:51], a[164:167], v[204:207]
 ds_read_b64_tr_b16 a[20:21], v235 offset:36000
 v_mfma_f32_16x16x32_bf16 v[200:203], a[48:51], a[160:163], v[200:203]
 v_permlane32_swap_b32 v239, v241
 v_mfma_f32_16x16x32_bf16 v[196:199], a[48:51], a[156:159], v[196:199]
 ds_read_b64_tr_b16 a[22:23], v235 offset:39584
 v_mfma_f32_16x16x32_bf16 v[192:195], a[48:51], a[152:155], v[192:195]
 v_add_f32 v238, v238, v240
 s_waitcnt lgkmcnt(12)
 v_mfma_f32_16x16x32_bf16 v[208:211], a[52:55], a[152:155], v[208:211]
 ds_read_b64_tr_b16 a[24:25], v235 offset:36032
 v_mfma_f32_16x16x32_bf16 v[212:215], a[52:55], a[156:159], v[212:215]
 v_mfma_f32_16x16x32_bf16 v[216:219], a[52:55], a[160:163], v[216:219]
 ds_read_b64_tr_b16 a[26:27], v235 offset:39616
 v_mfma_f32_16x16x32_bf16 v[220:223], a[52:55], a[164:167], v[220:223]
 s_waitcnt lgkmcnt(12)
 v_mfma_f32_16x16x32_bf16 v[0:3], a[0:3], a[168:171], v[0:3]
 ds_read_b64_tr_b16 a[28:29], v235 offset:50176
 v_mfma_f32_16x16x32_bf16 v[4:7], a[0:3], a[172:175], v[4:7]
 buffer_load_dwordx4 a[152:155], v231, s[24:27], s41 offen offset:2048 sc1
 v_mfma_f32_16x16x32_bf16 v[8:11], a[0:3], a[176:179], v[8:11]
 ds_read_b64_tr_b16 a[30:31], v235 offset:53760
 v_mfma_f32_16x16x32_bf16 v[12:15], a[0:3], a[180:183], v[12:15]
 v_add_f32 v239, v239, v241
 s_waitcnt lgkmcnt(12)
 v_mfma_f32_16x16x32_bf16 v[28:31], a[4:7], a[180:183], v[28:31]
 ds_read_b64_tr_b16 a[32:33], v235 offset:50208
 v_mfma_f32_16x16x32_bf16 v[24:27], a[4:7], a[176:179], v[24:27]
 v_mov_b32 v240, v238
 v_mfma_f32_16x16x32_bf16 v[20:23], a[4:7], a[172:175], v[20:23]
 ds_read_b64_tr_b16 a[34:35], v235 offset:53792
 v_mfma_f32_16x16x32_bf16 v[16:19], a[4:7], a[168:171], v[16:19]
 buffer_load_dwordx4 a[156:159], v232, s[24:27], s41 offen offset:2048 sc1
 v_mov_b32 v241, v239
 s_waitcnt lgkmcnt(12)
 v_mfma_f32_16x16x32_bf16 v[32:35], a[8:11], a[168:171], v[32:35]
 ds_read_b64_tr_b16 a[36:37], v235 offset:50240
 v_mfma_f32_16x16x32_bf16 v[36:39], a[8:11], a[172:175], v[36:39]
 v_permlane16_swap_b32 v238, v240
 v_mfma_f32_16x16x32_bf16 v[40:43], a[8:11], a[176:179], v[40:43]
 ds_read_b64_tr_b16 a[38:39], v235 offset:53824
 v_mfma_f32_16x16x32_bf16 v[44:47], a[8:11], a[180:183], v[44:47]
 v_permlane16_swap_b32 v239, v241
 s_waitcnt lgkmcnt(12)
 v_mfma_f32_16x16x32_bf16 v[60:63], a[12:15], a[180:183], v[60:63]
 ds_read_b64_tr_b16 a[40:41], v235 offset:50272
 v_mfma_f32_16x16x32_bf16 v[56:59], a[12:15], a[176:179], v[56:59]
 buffer_load_dwordx4 a[160:163], v233, s[24:27], s41 offen offset:2048 sc1
 v_add_f32 v238, v238, v240
 v_mfma_f32_16x16x32_bf16 v[52:55], a[12:15], a[172:175], v[52:55]
 ds_read_b64_tr_b16 a[42:43], v235 offset:53856
 v_mfma_f32_16x16x32_bf16 v[48:51], a[12:15], a[168:171], v[48:51]
 v_add_f32 v239, v239, v241
 s_waitcnt lgkmcnt(12)
 v_mfma_f32_16x16x32_bf16 v[64:67], a[16:19], a[168:171], v[64:67]
 ds_read_b64_tr_b16 a[44:45], v235 offset:50304
 v_mfma_f32_16x16x32_bf16 v[68:71], a[16:19], a[172:175], v[68:71]
 v_mul_f32 v238, 0xba800000, v238
 v_mfma_f32_16x16x32_bf16 v[72:75], a[16:19], a[176:179], v[72:75]
 ds_read_b64_tr_b16 a[46:47], v235 offset:53888
 v_mfma_f32_16x16x32_bf16 v[76:79], a[16:19], a[180:183], v[76:79]
 buffer_load_dwordx4 a[164:167], v234, s[24:27], s41 offen offset:2048 sc1
 v_mul_f32 v239, 0x3a800000, v239
 s_waitcnt lgkmcnt(12)
 v_mfma_f32_16x16x32_bf16 v[92:95], a[20:23], a[180:183], v[92:95]
 ds_read_b64_tr_b16 a[48:49], v235 offset:50336
 v_mfma_f32_16x16x32_bf16 v[88:91], a[20:23], a[176:179], v[88:91]
 v_fma_f32 v239, -v238, v238, v239
 v_mfma_f32_16x16x32_bf16 v[84:87], a[20:23], a[172:175], v[84:87]
 ds_read_b64_tr_b16 a[50:51], v235 offset:53920
 v_mfma_f32_16x16x32_bf16 v[80:83], a[20:23], a[168:171], v[80:83]
 v_max_f32 v239, 0, v239
 s_waitcnt lgkmcnt(12)
 v_mfma_f32_16x16x32_bf16 v[96:99], a[24:27], a[168:171], v[96:99]
 ds_read_b64_tr_b16 a[52:53], v235 offset:50368
 v_mfma_f32_16x16x32_bf16 v[100:103], a[24:27], a[172:175], v[100:103]
 v_mfma_f32_16x16x32_bf16 v[104:107], a[24:27], a[176:179], v[104:107]
 ds_read_b64_tr_b16 a[54:55], v235 offset:53952
 v_mfma_f32_16x16x32_bf16 v[108:111], a[24:27], a[180:183], v[108:111]
 s_waitcnt lgkmcnt(0)
 s_barrier
 v_mfma_f32_16x16x32_bf16 v[112:115], a[28:31], a[168:171], v[112:115]
 ds_read_b64_tr_b16 a[0:1], v236 offset:0
 v_mfma_f32_16x16x32_bf16 v[116:119], a[28:31], a[172:175], v[116:119]
 v_mfma_f32_16x16x32_bf16 v[120:123], a[28:31], a[176:179], v[120:123]
 ds_read_b64_tr_b16 a[2:3], v236 offset:3584
 v_mfma_f32_16x16x32_bf16 v[124:127], a[28:31], a[180:183], v[124:127]
 v_add_f32 v239, 0x3727c5ac, v239
 v_mfma_f32_16x16x32_bf16 v[140:143], a[32:35], a[180:183], v[140:143]
 ds_read_b64_tr_b16 a[4:5], v236 offset:32
 v_mfma_f32_16x16x32_bf16 v[136:139], a[32:35], a[176:179], v[136:139]
 v_sqrt_f32 v254, v239
 v_mfma_f32_16x16x32_bf16 v[132:135], a[32:35], a[172:175], v[132:135]
 ds_read_b64_tr_b16 a[6:7], v236 offset:3616
 v_mfma_f32_16x16x32_bf16 v[128:131], a[32:35], a[168:171], v[128:131]
 v_rsq_f32 v250, v239
 v_mfma_f32_16x16x32_bf16 v[144:147], a[36:39], a[168:171], v[144:147]
 ds_read_b64_tr_b16 a[8:9], v236 offset:64
 v_mfma_f32_16x16x32_bf16 v[148:151], a[36:39], a[172:175], v[148:151]
 v_cvt_pk_bf16_f32 v240, v238, v254
 v_mfma_f32_16x16x32_bf16 v[152:155], a[36:39], a[176:179], v[152:155]
 ds_read_b64_tr_b16 a[10:11], v236 offset:3648
 v_mfma_f32_16x16x32_bf16 v[156:159], a[36:39], a[180:183], v[156:159]
 v_mul_f32 v250, 0xbfb8aa3b, v250
 v_mfma_f32_16x16x32_bf16 v[172:175], a[40:43], a[180:183], v[172:175]
 ds_read_b64_tr_b16 a[12:13], v236 offset:96
 v_mfma_f32_16x16x32_bf16 v[168:171], a[40:43], a[176:179], v[168:171]
 v_and_b32 v241, 0xffff0000, v240
 v_mfma_f32_16x16x32_bf16 v[164:167], a[40:43], a[172:175], v[164:167]
 ds_read_b64_tr_b16 a[14:15], v236 offset:3680
 v_mfma_f32_16x16x32_bf16 v[160:163], a[40:43], a[168:171], v[160:163]
 v_sub_f32 v242, v254, v241
 v_mfma_f32_16x16x32_bf16 v[176:179], a[44:47], a[168:171], v[176:179]
 ds_read_b64_tr_b16 a[16:17], v236 offset:128
 v_mfma_f32_16x16x32_bf16 v[180:183], a[44:47], a[172:175], v[180:183]
 v_cvt_pk_bf16_f32 v241, v241, v242
 v_mfma_f32_16x16x32_bf16 v[184:187], a[44:47], a[176:179], v[184:187]
 ds_read_b64_tr_b16 a[18:19], v236 offset:3712
 v_mfma_f32_16x16x32_bf16 v[188:191], a[44:47], a[180:183], v[188:191]
 v_accvgpr_write_b32 a188, v240
 v_mfma_f32_16x16x32_bf16 v[204:207], a[48:51], a[180:183], v[204:207]
 ds_read_b64_tr_b16 a[20:21], v236 offset:160
 v_mfma_f32_16x16x32_bf16 v[200:203], a[48:51], a[176:179], v[200:203]
 v_accvgpr_write_b32 a189, v241
 v_mfma_f32_16x16x32_bf16 v[196:199], a[48:51], a[172:175], v[196:199]
 ds_read_b64_tr_b16 a[22:23], v236 offset:3744
 v_mfma_f32_16x16x32_bf16 v[192:195], a[48:51], a[168:171], v[192:195]
 v_mfma_f32_16x16x32_bf16 v[208:211], a[52:55], a[168:171], v[208:211]
 ds_read_b64_tr_b16 a[24:25], v236 offset:192
 v_mfma_f32_16x16x32_bf16 v[212:215], a[52:55], a[172:175], v[212:215]
 v_mfma_f32_16x16x32_bf16 v[216:219], a[52:55], a[176:179], v[216:219]
 ds_read_b64_tr_b16 a[26:27], v236 offset:3776
 v_mfma_f32_16x16x32_bf16 v[220:223], a[52:55], a[180:183], v[220:223]
 s_waitcnt lgkmcnt(12)
 v_mfma_f32_16x16x32_bf16 v[0:3], a[0:3], a[56:59], v[0:3]
 ds_read_b64_tr_b16 a[28:29], v236 offset:14336
 v_mfma_f32_16x16x32_bf16 v[4:7], a[0:3], a[60:63], v[4:7]
 buffer_load_dwordx4 a[168:171], v231, s[24:27], s41 offen offset:3072 sc1
 v_mfma_f32_16x16x32_bf16 v[8:11], a[0:3], a[64:67], v[8:11]
 ds_read_b64_tr_b16 a[30:31], v236 offset:17920
 v_mfma_f32_16x16x32_bf16 v[12:15], a[0:3], a[68:71], v[12:15]
 buffer_load_dwordx2 v[238:239], v246, s[32:35], s42 offen offset:0 sc1
 s_waitcnt lgkmcnt(12)
 v_mfma_f32_16x16x32_bf16 v[28:31], a[4:7], a[68:71], v[28:31]
 ds_read_b64_tr_b16 a[32:33], v236 offset:14368
 v_mfma_f32_16x16x32_bf16 v[24:27], a[4:7], a[64:67], v[24:27]
 buffer_load_dwordx4 a[172:175], v232, s[24:27], s41 offen offset:3072 sc1
 buffer_load_dwordx2 v[240:241], v246, s[32:35], s42 offen offset:128 sc1
 v_mfma_f32_16x16x32_bf16 v[20:23], a[4:7], a[60:63], v[20:23]
 ds_read_b64_tr_b16 a[34:35], v236 offset:17952
 v_mfma_f32_16x16x32_bf16 v[16:19], a[4:7], a[56:59], v[16:19]
 buffer_load_dwordx2 v[242:243], v246, s[32:35], s42 offen offset:256 sc1
 s_waitcnt lgkmcnt(12)
 v_mfma_f32_16x16x32_bf16 v[32:35], a[8:11], a[56:59], v[32:35]
 ds_read_b64_tr_b16 a[36:37], v236 offset:14400
 v_mfma_f32_16x16x32_bf16 v[36:39], a[8:11], a[60:63], v[36:39]
 buffer_load_dwordx4 a[176:179], v233, s[24:27], s41 offen offset:3072 sc1
 buffer_load_dwordx2 v[244:245], v246, s[32:35], s42 offen offset:384 sc1
 v_mfma_f32_16x16x32_bf16 v[40:43], a[8:11], a[64:67], v[40:43]
 ds_read_b64_tr_b16 a[38:39], v236 offset:17984
 v_mfma_f32_16x16x32_bf16 v[44:47], a[8:11], a[68:71], v[44:47]
 s_add_u32 s42, s42, 2048
 s_waitcnt lgkmcnt(12)
 v_mfma_f32_16x16x32_bf16 v[60:63], a[12:15], a[68:71], v[60:63]
 ds_read_b64_tr_b16 a[40:41], v236 offset:14432
 v_mfma_f32_16x16x32_bf16 v[56:59], a[12:15], a[64:67], v[56:59]
 buffer_load_dwordx4 a[180:183], v234, s[24:27], s41 offen offset:3072 sc1
 s_add_u32 s41, s41, 4096
 v_mfma_f32_16x16x32_bf16 v[52:55], a[12:15], a[60:63], v[52:55]
 ds_read_b64_tr_b16 a[42:43], v236 offset:18016
 v_mfma_f32_16x16x32_bf16 v[48:51], a[12:15], a[56:59], v[48:51]
 s_waitcnt lgkmcnt(12)
 v_mfma_f32_16x16x32_bf16 v[64:67], a[16:19], a[56:59], v[64:67]
 ds_read_b64_tr_b16 a[44:45], v236 offset:14464
 v_mfma_f32_16x16x32_bf16 v[68:71], a[16:19], a[60:63], v[68:71]
 buffer_load_dwordx4 v224, s[60:63], s40 offen lds
 v_mfma_f32_16x16x32_bf16 v[72:75], a[16:19], a[64:67], v[72:75]
 ds_read_b64_tr_b16 a[46:47], v236 offset:18048
 v_mfma_f32_16x16x32_bf16 v[76:79], a[16:19], a[68:71], v[76:79]
 s_waitcnt lgkmcnt(12)
 v_mfma_f32_16x16x32_bf16 v[92:95], a[20:23], a[68:71], v[92:95]
 ds_read_b64_tr_b16 a[48:49], v236 offset:14496
 v_mfma_f32_16x16x32_bf16 v[88:91], a[20:23], a[64:67], v[88:91]
 buffer_load_dwordx4 v225, s[60:63], s40 offen offset:1024 lds
 v_mfma_f32_16x16x32_bf16 v[84:87], a[20:23], a[60:63], v[84:87]
 ds_read_b64_tr_b16 a[50:51], v236 offset:18080
 v_mfma_f32_16x16x32_bf16 v[80:83], a[20:23], a[56:59], v[80:83]
 s_waitcnt lgkmcnt(12)
 v_mfma_f32_16x16x32_bf16 v[96:99], a[24:27], a[56:59], v[96:99]
 ds_read_b64_tr_b16 a[52:53], v236 offset:14528
 v_mfma_f32_16x16x32_bf16 v[100:103], a[24:27], a[60:63], v[100:103]
 v_mfma_f32_16x16x32_bf16 v[104:107], a[24:27], a[64:67], v[104:107]
 ds_read_b64_tr_b16 a[54:55], v236 offset:18112
 v_mfma_f32_16x16x32_bf16 v[108:111], a[24:27], a[68:71], v[108:111]
 s_waitcnt lgkmcnt(12)
 v_mfma_f32_16x16x32_bf16 v[112:115], a[28:31], a[56:59], v[112:115]
 ds_read_b64_tr_b16 a[0:1], v236 offset:7168
 v_mfma_f32_16x16x32_bf16 v[116:119], a[28:31], a[60:63], v[116:119]
 buffer_load_dwordx4 v226, s[60:63], s40 offen offset:2048 lds
 v_mfma_f32_16x16x32_bf16 v[120:123], a[28:31], a[64:67], v[120:123]
 ds_read_b64_tr_b16 a[2:3], v236 offset:10752
 v_mfma_f32_16x16x32_bf16 v[124:127], a[28:31], a[68:71], v[124:127]
 s_waitcnt lgkmcnt(12)
 v_mfma_f32_16x16x32_bf16 v[140:143], a[32:35], a[68:71], v[140:143]
 ds_read_b64_tr_b16 a[4:5], v236 offset:7200
 v_mfma_f32_16x16x32_bf16 v[136:139], a[32:35], a[64:67], v[136:139]
 buffer_load_dwordx4 v227, s[60:63], s40 offen offset:3072 lds
 s_add_u32 m0, s96, 32768
 v_mfma_f32_16x16x32_bf16 v[132:135], a[32:35], a[60:63], v[132:135]
 ds_read_b64_tr_b16 a[6:7], v236 offset:10784
 v_mfma_f32_16x16x32_bf16 v[128:131], a[32:35], a[56:59], v[128:131]
 s_waitcnt lgkmcnt(12)
 v_mfma_f32_16x16x32_bf16 v[144:147], a[36:39], a[56:59], v[144:147]
 ds_read_b64_tr_b16 a[8:9], v236 offset:7232
 v_mfma_f32_16x16x32_bf16 v[148:151], a[36:39], a[60:63], v[148:151]
 buffer_load_dwordx4 v228, s[60:63], s40 offen lds
 v_mfma_f32_16x16x32_bf16 v[152:155], a[36:39], a[64:67], v[152:155]
 ds_read_b64_tr_b16 a[10:11], v236 offset:10816
 v_mfma_f32_16x16x32_bf16 v[156:159], a[36:39], a[68:71], v[156:159]
 s_waitcnt lgkmcnt(12)
 v_mfma_f32_16x16x32_bf16 v[172:175], a[40:43], a[68:71], v[172:175]
 ds_read_b64_tr_b16 a[12:13], v236 offset:7264
 v_mfma_f32_16x16x32_bf16 v[168:171], a[40:43], a[64:67], v[168:171]
 buffer_load_dwordx4 v229, s[60:63], s40 offen offset:1024 lds
 v_mfma_f32_16x16x32_bf16 v[164:167], a[40:43], a[60:63], v[164:167]
 ds_read_b64_tr_b16 a[14:15], v236 offset:10848
 v_mfma_f32_16x16x32_bf16 v[160:163], a[40:43], a[56:59], v[160:163]
 s_waitcnt lgkmcnt(12)
 v_mfma_f32_16x16x32_bf16 v[176:179], a[44:47], a[56:59], v[176:179]
 ds_read_b64_tr_b16 a[16:17], v236 offset:7296
 v_mfma_f32_16x16x32_bf16 v[180:183], a[44:47], a[60:63], v[180:183]
 buffer_load_dwordx4 v230, s[60:63], s40 offen offset:2048 lds
 s_add_u32 s40, s40, 458752
 s_add_u32 m0, s96, 57344
 v_mfma_f32_16x16x32_bf16 v[184:187], a[44:47], a[64:67], v[184:187]
 ds_read_b64_tr_b16 a[18:19], v236 offset:10880
 v_mfma_f32_16x16x32_bf16 v[188:191], a[44:47], a[68:71], v[188:191]
 s_waitcnt lgkmcnt(12)
 v_mfma_f32_16x16x32_bf16 v[204:207], a[48:51], a[68:71], v[204:207]
 ds_read_b64_tr_b16 a[20:21], v236 offset:7328
 v_mfma_f32_16x16x32_bf16 v[200:203], a[48:51], a[64:67], v[200:203]
 v_mfma_f32_16x16x32_bf16 v[196:199], a[48:51], a[60:63], v[196:199]
 ds_read_b64_tr_b16 a[22:23], v236 offset:10912
 v_mfma_f32_16x16x32_bf16 v[192:195], a[48:51], a[56:59], v[192:195]
 s_waitcnt lgkmcnt(12)
 v_mfma_f32_16x16x32_bf16 v[208:211], a[52:55], a[56:59], v[208:211]
 ds_read_b64_tr_b16 a[24:25], v236 offset:7360
 v_mfma_f32_16x16x32_bf16 v[212:215], a[52:55], a[60:63], v[212:215]
 v_mfma_f32_16x16x32_bf16 v[216:219], a[52:55], a[64:67], v[216:219]
 ds_read_b64_tr_b16 a[26:27], v236 offset:10944
 v_mfma_f32_16x16x32_bf16 v[220:223], a[52:55], a[68:71], v[220:223]
 s_waitcnt lgkmcnt(12)
 v_mfma_f32_16x16x32_bf16 v[0:3], a[0:3], a[72:75], v[0:3]
 ds_read_b64_tr_b16 a[28:29], v236 offset:21504
 v_mfma_f32_16x16x32_bf16 v[4:7], a[0:3], a[76:79], v[4:7]
 buffer_load_dwordx4 a[56:59], v231, s[24:27], s41 offen sc1
 v_mfma_f32_16x16x32_bf16 v[8:11], a[0:3], a[80:83], v[8:11]
 ds_read_b64_tr_b16 a[30:31], v236 offset:25088
 v_mfma_f32_16x16x32_bf16 v[12:15], a[0:3], a[84:87], v[12:15]
 s_waitcnt lgkmcnt(12)
 v_mfma_f32_16x16x32_bf16 v[28:31], a[4:7], a[84:87], v[28:31]
 ds_read_b64_tr_b16 a[32:33], v236 offset:21536
 v_mfma_f32_16x16x32_bf16 v[24:27], a[4:7], a[80:83], v[24:27]
 v_mfma_f32_16x16x32_bf16 v[20:23], a[4:7], a[76:79], v[20:23]
 ds_read_b64_tr_b16 a[34:35], v236 offset:25120
 v_mfma_f32_16x16x32_bf16 v[16:19], a[4:7], a[72:75], v[16:19]
 buffer_load_dwordx4 a[60:63], v232, s[24:27], s41 offen sc1
 s_waitcnt lgkmcnt(12)
 v_mfma_f32_16x16x32_bf16 v[32:35], a[8:11], a[72:75], v[32:35]
 ds_read_b64_tr_b16 a[36:37], v236 offset:21568
 v_mfma_f32_16x16x32_bf16 v[36:39], a[8:11], a[76:79], v[36:39]
 v_mfma_f32_16x16x32_bf16 v[40:43], a[8:11], a[80:83], v[40:43]
 ds_read_b64_tr_b16 a[38:39], v236 offset:25152
 v_mfma_f32_16x16x32_bf16 v[44:47], a[8:11], a[84:87], v[44:47]
 s_waitcnt lgkmcnt(12)
 v_mfma_f32_16x16x32_bf16 v[60:63], a[12:15], a[84:87], v[60:63]
 ds_read_b64_tr_b16 a[40:41], v236 offset:21600
 v_mfma_f32_16x16x32_bf16 v[56:59], a[12:15], a[80:83], v[56:59]
 buffer_load_dwordx4 a[64:67], v233, s[24:27], s41 offen sc1
 v_mfma_f32_16x16x32_bf16 v[52:55], a[12:15], a[76:79], v[52:55]
 ds_read_b64_tr_b16 a[42:43], v236 offset:25184
 v_mfma_f32_16x16x32_bf16 v[48:51], a[12:15], a[72:75], v[48:51]
 s_waitcnt lgkmcnt(12)
 v_mfma_f32_16x16x32_bf16 v[64:67], a[16:19], a[72:75], v[64:67]
 ds_read_b64_tr_b16 a[44:45], v236 offset:21632
 v_mfma_f32_16x16x32_bf16 v[68:71], a[16:19], a[76:79], v[68:71]
 v_mfma_f32_16x16x32_bf16 v[72:75], a[16:19], a[80:83], v[72:75]
 ds_read_b64_tr_b16 a[46:47], v236 offset:25216
 v_mfma_f32_16x16x32_bf16 v[76:79], a[16:19], a[84:87], v[76:79]
 buffer_load_dwordx4 a[68:71], v234, s[24:27], s41 offen sc1
 s_waitcnt lgkmcnt(12)
 v_mfma_f32_16x16x32_bf16 v[92:95], a[20:23], a[84:87], v[92:95]
 ds_read_b64_tr_b16 a[48:49], v236 offset:21664
 v_mfma_f32_16x16x32_bf16 v[88:91], a[20:23], a[80:83], v[88:91]
 v_mfma_f32_16x16x32_bf16 v[84:87], a[20:23], a[76:79], v[84:87]
 ds_read_b64_tr_b16 a[50:51], v236 offset:25248
 v_mfma_f32_16x16x32_bf16 v[80:83], a[20:23], a[72:75], v[80:83]
 s_waitcnt lgkmcnt(12)
 v_mfma_f32_16x16x32_bf16 v[96:99], a[24:27], a[72:75], v[96:99]
 ds_read_b64_tr_b16 a[52:53], v236 offset:21696
 v_mfma_f32_16x16x32_bf16 v[100:103], a[24:27], a[76:79], v[100:103]
 v_mfma_f32_16x16x32_bf16 v[104:107], a[24:27], a[80:83], v[104:107]
 ds_read_b64_tr_b16 a[54:55], v236 offset:25280
 v_mfma_f32_16x16x32_bf16 v[108:111], a[24:27], a[84:87], v[108:111]
 s_waitcnt lgkmcnt(0)
 s_barrier
 v_mfma_f32_16x16x32_bf16 v[112:115], a[28:31], a[72:75], v[112:115]
 ds_read_b64_tr_b16 a[0:1], v236 offset:28672
 v_mfma_f32_16x16x32_bf16 v[116:119], a[28:31], a[76:79], v[116:119]
 v_mfma_f32_16x16x32_bf16 v[120:123], a[28:31], a[80:83], v[120:123]
 ds_read_b64_tr_b16 a[2:3], v236 offset:32256
 v_mfma_f32_16x16x32_bf16 v[124:127], a[28:31], a[84:87], v[124:127]
 v_mfma_f32_16x16x32_bf16 v[140:143], a[32:35], a[84:87], v[140:143]
 ds_read_b64_tr_b16 a[4:5], v236 offset:28704
 v_mfma_f32_16x16x32_bf16 v[136:139], a[32:35], a[80:83], v[136:139]
 v_mfma_f32_16x16x32_bf16 v[132:135], a[32:35], a[76:79], v[132:135]
 ds_read_b64_tr_b16 a[6:7], v236 offset:32288
 v_mfma_f32_16x16x32_bf16 v[128:131], a[32:35], a[72:75], v[128:131]
 v_mfma_f32_16x16x32_bf16 v[144:147], a[36:39], a[72:75], v[144:147]
 ds_read_b64_tr_b16 a[8:9], v236 offset:28736
 v_mfma_f32_16x16x32_bf16 v[148:151], a[36:39], a[76:79], v[148:151]
 v_mfma_f32_16x16x32_bf16 v[152:155], a[36:39], a[80:83], v[152:155]
 ds_read_b64_tr_b16 a[10:11], v236 offset:32320
 v_mfma_f32_16x16x32_bf16 v[156:159], a[36:39], a[84:87], v[156:159]
 v_mfma_f32_16x16x32_bf16 v[172:175], a[40:43], a[84:87], v[172:175]
 ds_read_b64_tr_b16 a[12:13], v236 offset:28768
 v_mfma_f32_16x16x32_bf16 v[168:171], a[40:43], a[80:83], v[168:171]
 v_mfma_f32_16x16x32_bf16 v[164:167], a[40:43], a[76:79], v[164:167]
 ds_read_b64_tr_b16 a[14:15], v236 offset:32352
 v_mfma_f32_16x16x32_bf16 v[160:163], a[40:43], a[72:75], v[160:163]
 v_mfma_f32_16x16x32_bf16 v[176:179], a[44:47], a[72:75], v[176:179]
 ds_read_b64_tr_b16 a[16:17], v236 offset:28800
 v_mfma_f32_16x16x32_bf16 v[180:183], a[44:47], a[76:79], v[180:183]
 v_mfma_f32_16x16x32_bf16 v[184:187], a[44:47], a[80:83], v[184:187]
 ds_read_b64_tr_b16 a[18:19], v236 offset:32384
 v_mfma_f32_16x16x32_bf16 v[188:191], a[44:47], a[84:87], v[188:191]
 v_mfma_f32_16x16x32_bf16 v[204:207], a[48:51], a[84:87], v[204:207]
 ds_read_b64_tr_b16 a[20:21], v236 offset:28832
 v_mfma_f32_16x16x32_bf16 v[200:203], a[48:51], a[80:83], v[200:203]
 v_mfma_f32_16x16x32_bf16 v[196:199], a[48:51], a[76:79], v[196:199]
 ds_read_b64_tr_b16 a[22:23], v236 offset:32416
 v_mfma_f32_16x16x32_bf16 v[192:195], a[48:51], a[72:75], v[192:195]
 v_mfma_f32_16x16x32_bf16 v[208:211], a[52:55], a[72:75], v[208:211]
 ds_read_b64_tr_b16 a[24:25], v236 offset:28864
 v_mfma_f32_16x16x32_bf16 v[212:215], a[52:55], a[76:79], v[212:215]
 v_mfma_f32_16x16x32_bf16 v[216:219], a[52:55], a[80:83], v[216:219]
 ds_read_b64_tr_b16 a[26:27], v236 offset:32448
 v_mfma_f32_16x16x32_bf16 v[220:223], a[52:55], a[84:87], v[220:223]
 s_waitcnt lgkmcnt(12)
 v_mfma_f32_16x16x32_bf16 v[0:3], a[0:3], a[88:91], v[0:3]
 ds_read_b64_tr_b16 a[28:29], v236 offset:43008
 v_mfma_f32_16x16x32_bf16 v[4:7], a[0:3], a[92:95], v[4:7]
 buffer_load_dwordx4 a[72:75], v231, s[24:27], s41 offen offset:1024 sc1
 s_waitcnt vmcnt(51)
 v_mfma_f32_16x16x32_bf16 v[8:11], a[0:3], a[96:99], v[8:11]
 ds_read_b64_tr_b16 a[30:31], v236 offset:46592
 s_waitcnt vmcnt(50)
 v_mfma_f32_16x16x32_bf16 v[12:15], a[0:3], a[100:103], v[12:15]
 s_waitcnt lgkmcnt(12)
 v_mfma_f32_16x16x32_bf16 v[28:31], a[4:7], a[100:103], v[28:31]
 ds_read_b64_tr_b16 a[32:33], v236 offset:43040
 v_mfma_f32_16x16x32_bf16 v[24:27], a[4:7], a[96:99], v[24:27]
 buffer_load_dwordx4 a[76:79], v232, s[24:27], s41 offen offset:1024 sc1
 v_mfma_f32_16x16x32_bf16 v[20:23], a[4:7], a[92:95], v[20:23]
 ds_read_b64_tr_b16 a[34:35], v236 offset:46624
 v_mfma_f32_16x16x32_bf16 v[16:19], a[4:7], a[88:91], v[16:19]
 s_waitcnt lgkmcnt(12)
 v_mfma_f32_16x16x32_bf16 v[32:35], a[8:11], a[88:91], v[32:35]
 ds_read_b64_tr_b16 a[36:37], v236 offset:43072
 v_mfma_f32_16x16x32_bf16 v[36:39], a[8:11], a[92:95], v[36:39]
 buffer_load_dwordx4 a[80:83], v233, s[24:27], s41 offen offset:1024 sc1
 v_mfma_f32_16x16x32_bf16 v[40:43], a[8:11], a[96:99], v[40:43]
 ds_read_b64_tr_b16 a[38:39], v236 offset:46656
 v_mfma_f32_16x16x32_bf16 v[44:47], a[8:11], a[100:103], v[44:47]
 s_waitcnt lgkmcnt(12)
 v_mfma_f32_16x16x32_bf16 v[60:63], a[12:15], a[100:103], v[60:63]
 ds_read_b64_tr_b16 a[40:41], v236 offset:43104
 v_mfma_f32_16x16x32_bf16 v[56:59], a[12:15], a[96:99], v[56:59]
 buffer_load_dwordx4 a[84:87], v234, s[24:27], s41 offen offset:1024 sc1
 v_mfma_f32_16x16x32_bf16 v[52:55], a[12:15], a[92:95], v[52:55]
 ds_read_b64_tr_b16 a[42:43], v236 offset:46688
 v_mfma_f32_16x16x32_bf16 v[48:51], a[12:15], a[88:91], v[48:51]
 s_waitcnt lgkmcnt(12)
 v_mfma_f32_16x16x32_bf16 v[64:67], a[16:19], a[88:91], v[64:67]
 ds_read_b64_tr_b16 a[44:45], v236 offset:43136
 v_mfma_f32_16x16x32_bf16 v[68:71], a[16:19], a[92:95], v[68:71]
 buffer_load_dwordx4 v224, s[60:63], s40 offen lds
 v_mfma_f32_16x16x32_bf16 v[72:75], a[16:19], a[96:99], v[72:75]
 ds_read_b64_tr_b16 a[46:47], v236 offset:46720
 v_mfma_f32_16x16x32_bf16 v[76:79], a[16:19], a[100:103], v[76:79]
 s_waitcnt lgkmcnt(12)
 v_mfma_f32_16x16x32_bf16 v[92:95], a[20:23], a[100:103], v[92:95]
 ds_read_b64_tr_b16 a[48:49], v236 offset:43168
 v_mfma_f32_16x16x32_bf16 v[88:91], a[20:23], a[96:99], v[88:91]
 buffer_load_dwordx4 v225, s[60:63], s40 offen offset:1024 lds
 v_mfma_f32_16x16x32_bf16 v[84:87], a[20:23], a[92:95], v[84:87]
 ds_read_b64_tr_b16 a[50:51], v236 offset:46752
 v_mfma_f32_16x16x32_bf16 v[80:83], a[20:23], a[88:91], v[80:83]
 s_waitcnt lgkmcnt(12)
 v_mfma_f32_16x16x32_bf16 v[96:99], a[24:27], a[88:91], v[96:99]
 ds_read_b64_tr_b16 a[52:53], v236 offset:43200
 v_mfma_f32_16x16x32_bf16 v[100:103], a[24:27], a[92:95], v[100:103]
 v_mfma_f32_16x16x32_bf16 v[104:107], a[24:27], a[96:99], v[104:107]
 ds_read_b64_tr_b16 a[54:55], v236 offset:46784
 v_mfma_f32_16x16x32_bf16 v[108:111], a[24:27], a[100:103], v[108:111]
 s_waitcnt lgkmcnt(12)
 v_mfma_f32_16x16x32_bf16 v[112:115], a[28:31], a[88:91], v[112:115]
 ds_read_b64_tr_b16 a[0:1], v236 offset:35840
 v_mfma_f32_16x16x32_bf16 v[116:119], a[28:31], a[92:95], v[116:119]
 buffer_load_dwordx4 v226, s[60:63], s40 offen offset:2048 lds
 v_mfma_f32_16x16x32_bf16 v[120:123], a[28:31], a[96:99], v[120:123]
 ds_read_b64_tr_b16 a[2:3], v236 offset:39424
 v_mfma_f32_16x16x32_bf16 v[124:127], a[28:31], a[100:103], v[124:127]
 s_waitcnt lgkmcnt(12)
 v_mfma_f32_16x16x32_bf16 v[140:143], a[32:35], a[100:103], v[140:143]
 ds_read_b64_tr_b16 a[4:5], v236 offset:35872
 v_mfma_f32_16x16x32_bf16 v[136:139], a[32:35], a[96:99], v[136:139]
 buffer_load_dwordx4 v227, s[60:63], s40 offen offset:3072 lds
 s_add_u32 m0, s96, 61440
 v_mfma_f32_16x16x32_bf16 v[132:135], a[32:35], a[92:95], v[132:135]
 ds_read_b64_tr_b16 a[6:7], v236 offset:39456
 v_mfma_f32_16x16x32_bf16 v[128:131], a[32:35], a[88:91], v[128:131]
 s_waitcnt lgkmcnt(12)
 v_mfma_f32_16x16x32_bf16 v[144:147], a[36:39], a[88:91], v[144:147]
 ds_read_b64_tr_b16 a[8:9], v236 offset:35904
 v_mfma_f32_16x16x32_bf16 v[148:151], a[36:39], a[92:95], v[148:151]
 buffer_load_dwordx4 v228, s[60:63], s40 offen lds
 v_mfma_f32_16x16x32_bf16 v[152:155], a[36:39], a[96:99], v[152:155]
 ds_read_b64_tr_b16 a[10:11], v236 offset:39488
 v_mfma_f32_16x16x32_bf16 v[156:159], a[36:39], a[100:103], v[156:159]
 s_waitcnt lgkmcnt(12)
 v_mfma_f32_16x16x32_bf16 v[172:175], a[40:43], a[100:103], v[172:175]
 ds_read_b64_tr_b16 a[12:13], v236 offset:35936
 v_mfma_f32_16x16x32_bf16 v[168:171], a[40:43], a[96:99], v[168:171]
 buffer_load_dwordx4 v229, s[60:63], s40 offen offset:1024 lds
 v_mfma_f32_16x16x32_bf16 v[164:167], a[40:43], a[92:95], v[164:167]
 ds_read_b64_tr_b16 a[14:15], v236 offset:39520
 v_mfma_f32_16x16x32_bf16 v[160:163], a[40:43], a[88:91], v[160:163]
 s_waitcnt lgkmcnt(12)
 v_mfma_f32_16x16x32_bf16 v[176:179], a[44:47], a[88:91], v[176:179]
 ds_read_b64_tr_b16 a[16:17], v236 offset:35968
 v_mfma_f32_16x16x32_bf16 v[180:183], a[44:47], a[92:95], v[180:183]
 buffer_load_dwordx4 v230, s[60:63], s40 offen offset:2048 lds
 s_add_u32 s40, s40, 458752
 s_add_u32 m0, s96, 86016
 v_mfma_f32_16x16x32_bf16 v[184:187], a[44:47], a[96:99], v[184:187]
 ds_read_b64_tr_b16 a[18:19], v236 offset:39552
 v_mfma_f32_16x16x32_bf16 v[188:191], a[44:47], a[100:103], v[188:191]
 s_waitcnt lgkmcnt(12)
 v_mfma_f32_16x16x32_bf16 v[204:207], a[48:51], a[100:103], v[204:207]
 ds_read_b64_tr_b16 a[20:21], v236 offset:36000
 v_mfma_f32_16x16x32_bf16 v[200:203], a[48:51], a[96:99], v[200:203]
 v_mfma_f32_16x16x32_bf16 v[196:199], a[48:51], a[92:95], v[196:199]
 ds_read_b64_tr_b16 a[22:23], v236 offset:39584
 v_mfma_f32_16x16x32_bf16 v[192:195], a[48:51], a[88:91], v[192:195]
 s_waitcnt lgkmcnt(12)
 v_mfma_f32_16x16x32_bf16 v[208:211], a[52:55], a[88:91], v[208:211]
 ds_read_b64_tr_b16 a[24:25], v236 offset:36032
 v_mfma_f32_16x16x32_bf16 v[212:215], a[52:55], a[92:95], v[212:215]
 v_mfma_f32_16x16x32_bf16 v[216:219], a[52:55], a[96:99], v[216:219]
 ds_read_b64_tr_b16 a[26:27], v236 offset:39616
 v_mfma_f32_16x16x32_bf16 v[220:223], a[52:55], a[100:103], v[220:223]
 s_waitcnt vmcnt(59) lgkmcnt(12)
 v_mfma_f32_16x16x32_bf16 v[0:3], a[0:3], a[104:107], v[0:3]
 ds_read_b64_tr_b16 a[28:29], v236 offset:50176
 s_waitcnt vmcnt(58)
 v_mfma_f32_16x16x32_bf16 v[4:7], a[0:3], a[108:111], v[4:7]
 buffer_load_dwordx4 a[88:91], v231, s[24:27], s41 offen offset:2048 sc1
 s_waitcnt vmcnt(58)
 v_mfma_f32_16x16x32_bf16 v[8:11], a[0:3], a[112:115], v[8:11]
 ds_read_b64_tr_b16 a[30:31], v236 offset:53760
 s_waitcnt vmcnt(57)
 v_mfma_f32_16x16x32_bf16 v[12:15], a[0:3], a[116:119], v[12:15]
 s_waitcnt lgkmcnt(12)
 v_mfma_f32_16x16x32_bf16 v[28:31], a[4:7], a[116:119], v[28:31]
 ds_read_b64_tr_b16 a[32:33], v236 offset:50208
 v_mfma_f32_16x16x32_bf16 v[24:27], a[4:7], a[112:115], v[24:27]
 v_mfma_f32_16x16x32_bf16 v[20:23], a[4:7], a[108:111], v[20:23]
 ds_read_b64_tr_b16 a[34:35], v236 offset:53792
 v_mfma_f32_16x16x32_bf16 v[16:19], a[4:7], a[104:107], v[16:19]
 buffer_load_dwordx4 a[92:95], v232, s[24:27], s41 offen offset:2048 sc1
 s_waitcnt lgkmcnt(12)
 v_mfma_f32_16x16x32_bf16 v[32:35], a[8:11], a[104:107], v[32:35]
 ds_read_b64_tr_b16 a[36:37], v236 offset:50240
 v_mfma_f32_16x16x32_bf16 v[36:39], a[8:11], a[108:111], v[36:39]
 v_mfma_f32_16x16x32_bf16 v[40:43], a[8:11], a[112:115], v[40:43]
 ds_read_b64_tr_b16 a[38:39], v236 offset:53824
 v_mfma_f32_16x16x32_bf16 v[44:47], a[8:11], a[116:119], v[44:47]
 s_waitcnt lgkmcnt(12)
 v_mfma_f32_16x16x32_bf16 v[60:63], a[12:15], a[116:119], v[60:63]
 ds_read_b64_tr_b16 a[40:41], v236 offset:50272
 v_mfma_f32_16x16x32_bf16 v[56:59], a[12:15], a[112:115], v[56:59]
 buffer_load_dwordx4 a[96:99], v233, s[24:27], s41 offen offset:2048 sc1
 v_mfma_f32_16x16x32_bf16 v[52:55], a[12:15], a[108:111], v[52:55]
 ds_read_b64_tr_b16 a[42:43], v236 offset:53856
 v_mfma_f32_16x16x32_bf16 v[48:51], a[12:15], a[104:107], v[48:51]
 s_waitcnt lgkmcnt(12)
 v_mfma_f32_16x16x32_bf16 v[64:67], a[16:19], a[104:107], v[64:67]
 ds_read_b64_tr_b16 a[44:45], v236 offset:50304
 v_mfma_f32_16x16x32_bf16 v[68:71], a[16:19], a[108:111], v[68:71]
 v_mfma_f32_16x16x32_bf16 v[72:75], a[16:19], a[112:115], v[72:75]
 ds_read_b64_tr_b16 a[46:47], v236 offset:53888
 v_mfma_f32_16x16x32_bf16 v[76:79], a[16:19], a[116:119], v[76:79]
 buffer_load_dwordx4 a[100:103], v234, s[24:27], s41 offen offset:2048 sc1
 s_waitcnt lgkmcnt(12)
 v_mfma_f32_16x16x32_bf16 v[92:95], a[20:23], a[116:119], v[92:95]
 ds_read_b64_tr_b16 a[48:49], v236 offset:50336
 v_mfma_f32_16x16x32_bf16 v[88:91], a[20:23], a[112:115], v[88:91]
 v_mfma_f32_16x16x32_bf16 v[84:87], a[20:23], a[108:111], v[84:87]
 ds_read_b64_tr_b16 a[50:51], v236 offset:53920
 v_mfma_f32_16x16x32_bf16 v[80:83], a[20:23], a[104:107], v[80:83]
 s_waitcnt lgkmcnt(12)
 v_mfma_f32_16x16x32_bf16 v[96:99], a[24:27], a[104:107], v[96:99]
 ds_read_b64_tr_b16 a[52:53], v236 offset:50368
 v_mfma_f32_16x16x32_bf16 v[100:103], a[24:27], a[108:111], v[100:103]
 v_mfma_f32_16x16x32_bf16 v[104:107], a[24:27], a[112:115], v[104:107]
 ds_read_b64_tr_b16 a[54:55], v236 offset:53952
 v_mfma_f32_16x16x32_bf16 v[108:111], a[24:27], a[116:119], v[108:111]
 s_waitcnt lgkmcnt(0)
 s_waitcnt vmcnt(53)
 s_barrier
 v_mfma_f32_16x16x32_bf16 v[112:115], a[28:31], a[104:107], v[112:115]
 ds_read_b64_tr_b16 a[0:1], v237 offset:0
 v_mfma_f32_16x16x32_bf16 v[116:119], a[28:31], a[108:111], v[116:119]
 v_mfma_f32_16x16x32_bf16 v[120:123], a[28:31], a[112:115], v[120:123]
 ds_read_b64_tr_b16 a[2:3], v237 offset:3584
 v_mfma_f32_16x16x32_bf16 v[124:127], a[28:31], a[116:119], v[124:127]
 s_waitcnt vmcnt(30)
 v_add_f32 v238, v238, v240
 v_mfma_f32_16x16x32_bf16 v[140:143], a[32:35], a[116:119], v[140:143]
 ds_read_b64_tr_b16 a[4:5], v237 offset:32
 v_mfma_f32_16x16x32_bf16 v[136:139], a[32:35], a[112:115], v[136:139]
 v_add_f32 v239, v239, v241
 v_mfma_f32_16x16x32_bf16 v[132:135], a[32:35], a[108:111], v[132:135]
 ds_read_b64_tr_b16 a[6:7], v237 offset:3616
 v_mfma_f32_16x16x32_bf16 v[128:131], a[32:35], a[104:107], v[128:131]
 s_waitcnt vmcnt(27)
 v_add_f32 v242, v242, v244
 v_mfma_f32_16x16x32_bf16 v[144:147], a[36:39], a[104:107], v[144:147]
 ds_read_b64_tr_b16 a[8:9], v237 offset:64
 v_mfma_f32_16x16x32_bf16 v[148:151], a[36:39], a[108:111], v[148:151]
 v_add_f32 v243, v243, v245
 v_mfma_f32_16x16x32_bf16 v[152:155], a[36:39], a[112:115], v[152:155]
 ds_read_b64_tr_b16 a[10:11], v237 offset:3648
 v_mfma_f32_16x16x32_bf16 v[156:159], a[36:39], a[116:119], v[156:159]
 v_add_f32 v238, v238, v242
 v_mfma_f32_16x16x32_bf16 v[172:175], a[40:43], a[116:119], v[172:175]
 ds_read_b64_tr_b16 a[12:13], v237 offset:96
 v_mfma_f32_16x16x32_bf16 v[168:171], a[40:43], a[112:115], v[168:171]
 v_add_f32 v239, v239, v243
 v_mfma_f32_16x16x32_bf16 v[164:167], a[40:43], a[108:111], v[164:167]
 ds_read_b64_tr_b16 a[14:15], v237 offset:3680
 v_mfma_f32_16x16x32_bf16 v[160:163], a[40:43], a[104:107], v[160:163]
 v_mov_b32 v240, v238
 v_mfma_f32_16x16x32_bf16 v[176:179], a[44:47], a[104:107], v[176:179]
 ds_read_b64_tr_b16 a[16:17], v237 offset:128
 v_mfma_f32_16x16x32_bf16 v[180:183], a[44:47], a[108:111], v[180:183]
 v_mov_b32 v241, v239
 v_mfma_f32_16x16x32_bf16 v[184:187], a[44:47], a[112:115], v[184:187]
 ds_read_b64_tr_b16 a[18:19], v237 offset:3712
 v_mfma_f32_16x16x32_bf16 v[188:191], a[44:47], a[116:119], v[188:191]
 v_permlane32_swap_b32 v238, v240
 v_mfma_f32_16x16x32_bf16 v[204:207], a[48:51], a[116:119], v[204:207]
 ds_read_b64_tr_b16 a[20:21], v237 offset:160
 v_mfma_f32_16x16x32_bf16 v[200:203], a[48:51], a[112:115], v[200:203]
 v_permlane32_swap_b32 v239, v241
 v_mfma_f32_16x16x32_bf16 v[196:199], a[48:51], a[108:111], v[196:199]
 ds_read_b64_tr_b16 a[22:23], v237 offset:3744
 v_mfma_f32_16x16x32_bf16 v[192:195], a[48:51], a[104:107], v[192:195]
 v_add_f32 v238, v238, v240
 v_mfma_f32_16x16x32_bf16 v[208:211], a[52:55], a[104:107], v[208:211]
 ds_read_b64_tr_b16 a[24:25], v237 offset:192
 v_mfma_f32_16x16x32_bf16 v[212:215], a[52:55], a[108:111], v[212:215]
 v_mfma_f32_16x16x32_bf16 v[216:219], a[52:55], a[112:115], v[216:219]
 ds_read_b64_tr_b16 a[26:27], v237 offset:3776
 v_mfma_f32_16x16x32_bf16 v[220:223], a[52:55], a[116:119], v[220:223]
 s_waitcnt lgkmcnt(12)
 v_mfma_f32_16x16x32_bf16 v[0:3], a[0:3], a[120:123], v[0:3]
 ds_read_b64_tr_b16 a[28:29], v237 offset:14336
 v_mfma_f32_16x16x32_bf16 v[4:7], a[0:3], a[124:127], v[4:7]
 buffer_load_dwordx4 a[104:107], v231, s[24:27], s41 offen offset:3072 sc1
 v_mfma_f32_16x16x32_bf16 v[8:11], a[0:3], a[128:131], v[8:11]
 ds_read_b64_tr_b16 a[30:31], v237 offset:17920
 v_mfma_f32_16x16x32_bf16 v[12:15], a[0:3], a[132:135], v[12:15]
 v_add_f32 v239, v239, v241
 s_waitcnt lgkmcnt(12)
 v_mfma_f32_16x16x32_bf16 v[28:31], a[4:7], a[132:135], v[28:31]
 ds_read_b64_tr_b16 a[32:33], v237 offset:14368
 v_mfma_f32_16x16x32_bf16 v[24:27], a[4:7], a[128:131], v[24:27]
 buffer_load_dwordx4 a[108:111], v232, s[24:27], s41 offen offset:3072 sc1
 v_mov_b32 v240, v238
 v_mfma_f32_16x16x32_bf16 v[20:23], a[4:7], a[124:127], v[20:23]
 ds_read_b64_tr_b16 a[34:35], v237 offset:17952
 v_mfma_f32_16x16x32_bf16 v[16:19], a[4:7], a[120:123], v[16:19]
 v_mov_b32 v241, v239
 s_waitcnt lgkmcnt(12)
 v_mfma_f32_16x16x32_bf16 v[32:35], a[8:11], a[120:123], v[32:35]
 ds_read_b64_tr_b16 a[36:37], v237 offset:14400
 v_mfma_f32_16x16x32_bf16 v[36:39], a[8:11], a[124:127], v[36:39]
 buffer_load_dwordx4 a[112:115], v233, s[24:27], s41 offen offset:3072 sc1
 v_permlane16_swap_b32 v238, v240
 v_mfma_f32_16x16x32_bf16 v[40:43], a[8:11], a[128:131], v[40:43]
 ds_read_b64_tr_b16 a[38:39], v237 offset:17984
 v_mfma_f32_16x16x32_bf16 v[44:47], a[8:11], a[132:135], v[44:47]
 v_permlane16_swap_b32 v239, v241
 s_waitcnt lgkmcnt(12)
 v_mfma_f32_16x16x32_bf16 v[60:63], a[12:15], a[132:135], v[60:63]
 ds_read_b64_tr_b16 a[40:41], v237 offset:14432
 v_mfma_f32_16x16x32_bf16 v[56:59], a[12:15], a[128:131], v[56:59]
 buffer_load_dwordx4 a[116:119], v234, s[24:27], s41 offen offset:3072 sc1
 s_add_u32 s41, s41, 4096
 v_add_f32 v238, v238, v240
 v_mfma_f32_16x16x32_bf16 v[52:55], a[12:15], a[124:127], v[52:55]
 ds_read_b64_tr_b16 a[42:43], v237 offset:18016
 v_mfma_f32_16x16x32_bf16 v[48:51], a[12:15], a[120:123], v[48:51]
 v_add_f32 v239, v239, v241
 s_waitcnt lgkmcnt(12)
 v_mfma_f32_16x16x32_bf16 v[64:67], a[16:19], a[120:123], v[64:67]
 ds_read_b64_tr_b16 a[44:45], v237 offset:14464
 v_mfma_f32_16x16x32_bf16 v[68:71], a[16:19], a[124:127], v[68:71]
 buffer_load_dwordx4 v224, s[60:63], s40 offen lds
 v_mul_f32 v238, 0xba800000, v238
 v_mfma_f32_16x16x32_bf16 v[72:75], a[16:19], a[128:131], v[72:75]
 ds_read_b64_tr_b16 a[46:47], v237 offset:18048
 v_mfma_f32_16x16x32_bf16 v[76:79], a[16:19], a[132:135], v[76:79]
 v_mul_f32 v239, 0x3a800000, v239
 s_waitcnt lgkmcnt(12)
 v_mfma_f32_16x16x32_bf16 v[92:95], a[20:23], a[132:135], v[92:95]
 ds_read_b64_tr_b16 a[48:49], v237 offset:14496
 v_mfma_f32_16x16x32_bf16 v[88:91], a[20:23], a[128:131], v[88:91]
 buffer_load_dwordx4 v225, s[60:63], s40 offen offset:1024 lds
 v_fma_f32 v239, -v238, v238, v239
 v_mfma_f32_16x16x32_bf16 v[84:87], a[20:23], a[124:127], v[84:87]
 ds_read_b64_tr_b16 a[50:51], v237 offset:18080
 v_mfma_f32_16x16x32_bf16 v[80:83], a[20:23], a[120:123], v[80:83]
 v_max_f32 v239, 0, v239
 s_waitcnt lgkmcnt(12)
 v_mfma_f32_16x16x32_bf16 v[96:99], a[24:27], a[120:123], v[96:99]
 ds_read_b64_tr_b16 a[52:53], v237 offset:14528
 v_mfma_f32_16x16x32_bf16 v[100:103], a[24:27], a[124:127], v[100:103]
 v_mfma_f32_16x16x32_bf16 v[104:107], a[24:27], a[128:131], v[104:107]
 ds_read_b64_tr_b16 a[54:55], v237 offset:18112
 v_mfma_f32_16x16x32_bf16 v[108:111], a[24:27], a[132:135], v[108:111]
 s_waitcnt lgkmcnt(12)
 v_mfma_f32_16x16x32_bf16 v[112:115], a[28:31], a[120:123], v[112:115]
 ds_read_b64_tr_b16 a[0:1], v237 offset:7168
 v_mfma_f32_16x16x32_bf16 v[116:119], a[28:31], a[124:127], v[116:119]
 buffer_load_dwordx4 v226, s[60:63], s40 offen offset:2048 lds
 v_mfma_f32_16x16x32_bf16 v[120:123], a[28:31], a[128:131], v[120:123]
 ds_read_b64_tr_b16 a[2:3], v237 offset:10752
 v_mfma_f32_16x16x32_bf16 v[124:127], a[28:31], a[132:135], v[124:127]
 v_add_f32 v239, 0x3727c5ac, v239
 s_waitcnt lgkmcnt(12)
 v_mfma_f32_16x16x32_bf16 v[140:143], a[32:35], a[132:135], v[140:143]
 ds_read_b64_tr_b16 a[4:5], v237 offset:7200
 v_mfma_f32_16x16x32_bf16 v[136:139], a[32:35], a[128:131], v[136:139]
 buffer_load_dwordx4 v227, s[60:63], s40 offen offset:3072 lds
 s_add_u32 m0, s96, 90112
 v_sqrt_f32 v255, v239
 v_mfma_f32_16x16x32_bf16 v[132:135], a[32:35], a[124:127], v[132:135]
 ds_read_b64_tr_b16 a[6:7], v237 offset:10784
 v_mfma_f32_16x16x32_bf16 v[128:131], a[32:35], a[120:123], v[128:131]
 v_rsq_f32 v251, v239
 s_waitcnt lgkmcnt(12)
 v_mfma_f32_16x16x32_bf16 v[144:147], a[36:39], a[120:123], v[144:147]
 ds_read_b64_tr_b16 a[8:9], v237 offset:7232
 v_mfma_f32_16x16x32_bf16 v[148:151], a[36:39], a[124:127], v[148:151]
 buffer_load_dwordx4 v228, s[60:63], s40 offen lds
 v_cvt_pk_bf16_f32 v240, v238, v255
 v_mfma_f32_16x16x32_bf16 v[152:155], a[36:39], a[128:131], v[152:155]
 ds_read_b64_tr_b16 a[10:11], v237 offset:10816
 v_mfma_f32_16x16x32_bf16 v[156:159], a[36:39], a[132:135], v[156:159]
 v_mul_f32 v251, 0xbfb8aa3b, v251
 s_waitcnt lgkmcnt(12)
 v_mfma_f32_16x16x32_bf16 v[172:175], a[40:43], a[132:135], v[172:175]
 ds_read_b64_tr_b16 a[12:13], v237 offset:7264
 v_mfma_f32_16x16x32_bf16 v[168:171], a[40:43], a[128:131], v[168:171]
 buffer_load_dwordx4 v229, s[60:63], s40 offen offset:1024 lds
 v_and_b32 v241, 0xffff0000, v240
 v_mfma_f32_16x16x32_bf16 v[164:167], a[40:43], a[124:127], v[164:167]
 ds_read_b64_tr_b16 a[14:15], v237 offset:10848
 v_mfma_f32_16x16x32_bf16 v[160:163], a[40:43], a[120:123], v[160:163]
 v_sub_f32 v242, v255, v241
 s_waitcnt lgkmcnt(12)
 v_mfma_f32_16x16x32_bf16 v[176:179], a[44:47], a[120:123], v[176:179]
 ds_read_b64_tr_b16 a[16:17], v237 offset:7296
 v_mfma_f32_16x16x32_bf16 v[180:183], a[44:47], a[124:127], v[180:183]
 buffer_load_dwordx4 v230, s[60:63], s40 offen offset:2048 lds
 s_add_u32 s40, s40, 458752
 s_add_u32 m0, s96, 131072
 v_cvt_pk_bf16_f32 v241, v241, v242
 v_mfma_f32_16x16x32_bf16 v[184:187], a[44:47], a[128:131], v[184:187]
 ds_read_b64_tr_b16 a[18:19], v237 offset:10880
 v_mfma_f32_16x16x32_bf16 v[188:191], a[44:47], a[132:135], v[188:191]
 v_accvgpr_write_b32 a190, v240
 s_waitcnt lgkmcnt(12)
 v_mfma_f32_16x16x32_bf16 v[204:207], a[48:51], a[132:135], v[204:207]
 ds_read_b64_tr_b16 a[20:21], v237 offset:7328
 v_mfma_f32_16x16x32_bf16 v[200:203], a[48:51], a[128:131], v[200:203]
 v_accvgpr_write_b32 a191, v241
 v_mfma_f32_16x16x32_bf16 v[196:199], a[48:51], a[124:127], v[196:199]
 ds_read_b64_tr_b16 a[22:23], v237 offset:10912
 v_mfma_f32_16x16x32_bf16 v[192:195], a[48:51], a[120:123], v[192:195]
 s_waitcnt lgkmcnt(12)
 v_mfma_f32_16x16x32_bf16 v[208:211], a[52:55], a[120:123], v[208:211]
 ds_read_b64_tr_b16 a[24:25], v237 offset:7360
 v_mfma_f32_16x16x32_bf16 v[212:215], a[52:55], a[124:127], v[212:215]
 v_mfma_f32_16x16x32_bf16 v[216:219], a[52:55], a[128:131], v[216:219]
 ds_read_b64_tr_b16 a[26:27], v237 offset:10944
 v_mfma_f32_16x16x32_bf16 v[220:223], a[52:55], a[132:135], v[220:223]
 s_waitcnt lgkmcnt(12)
 v_mfma_f32_16x16x32_bf16 v[0:3], a[0:3], a[136:139], v[0:3]
 ds_read_b64_tr_b16 a[28:29], v237 offset:21504
 v_mfma_f32_16x16x32_bf16 v[4:7], a[0:3], a[140:143], v[4:7]
 buffer_load_dwordx4 a[120:123], v231, s[24:27], s41 offen sc1
 v_mfma_f32_16x16x32_bf16 v[8:11], a[0:3], a[144:147], v[8:11]
 ds_read_b64_tr_b16 a[30:31], v237 offset:25088
 v_mfma_f32_16x16x32_bf16 v[12:15], a[0:3], a[148:151], v[12:15]
 v_and_b32 v238, 0x3f0, v231
 s_waitcnt lgkmcnt(12)
 v_mfma_f32_16x16x32_bf16 v[28:31], a[4:7], a[148:151], v[28:31]
 ds_read_b64_tr_b16 a[32:33], v237 offset:21536
 v_mfma_f32_16x16x32_bf16 v[24:27], a[4:7], a[144:147], v[24:27]
 buffer_load_dwordx4 a[192:195], v238, s[36:39], s45 offen offset:0 sc1
 v_mfma_f32_16x16x32_bf16 v[20:23], a[4:7], a[140:143], v[20:23]
 ds_read_b64_tr_b16 a[34:35], v237 offset:25120
 v_mfma_f32_16x16x32_bf16 v[16:19], a[4:7], a[136:139], v[16:19]
 buffer_load_dwordx4 a[124:127], v232, s[24:27], s41 offen sc1
 buffer_load_dwordx4 a[196:199], v238, s[36:39], s45 offen offset:1024 sc1
 s_waitcnt lgkmcnt(12)
 v_mfma_f32_16x16x32_bf16 v[32:35], a[8:11], a[136:139], v[32:35]
 ds_read_b64_tr_b16 a[36:37], v237 offset:21568
 v_mfma_f32_16x16x32_bf16 v[36:39], a[8:11], a[140:143], v[36:39]
 buffer_load_dwordx4 a[200:203], v238, s[36:39], s45 offen offset:2048 sc1
 v_mfma_f32_16x16x32_bf16 v[40:43], a[8:11], a[144:147], v[40:43]
 ds_read_b64_tr_b16 a[38:39], v237 offset:25152
 v_mfma_f32_16x16x32_bf16 v[44:47], a[8:11], a[148:151], v[44:47]
 buffer_load_dwordx4 a[204:207], v238, s[36:39], s45 offen offset:3072 sc1
 s_waitcnt lgkmcnt(12)
 v_mfma_f32_16x16x32_bf16 v[60:63], a[12:15], a[148:151], v[60:63]
 ds_read_b64_tr_b16 a[40:41], v237 offset:21600
 v_mfma_f32_16x16x32_bf16 v[56:59], a[12:15], a[144:147], v[56:59]
 buffer_load_dwordx4 a[128:131], v233, s[24:27], s41 offen sc1
 s_add_u32 s45, s45, 4096
 v_mfma_f32_16x16x32_bf16 v[52:55], a[12:15], a[140:143], v[52:55]
 ds_read_b64_tr_b16 a[42:43], v237 offset:25184
 v_mfma_f32_16x16x32_bf16 v[48:51], a[12:15], a[136:139], v[48:51]
 buffer_load_dwordx4 a[208:211], v238, s[36:39], s45 offen offset:0 sc1
 s_waitcnt lgkmcnt(12)
 v_mfma_f32_16x16x32_bf16 v[64:67], a[16:19], a[136:139], v[64:67]
 ds_read_b64_tr_b16 a[44:45], v237 offset:21632
 v_mfma_f32_16x16x32_bf16 v[68:71], a[16:19], a[140:143], v[68:71]
 buffer_load_dwordx4 a[212:215], v238, s[36:39], s45 offen offset:1024 sc1
 v_mfma_f32_16x16x32_bf16 v[72:75], a[16:19], a[144:147], v[72:75]
 ds_read_b64_tr_b16 a[46:47], v237 offset:25216
 v_mfma_f32_16x16x32_bf16 v[76:79], a[16:19], a[148:151], v[76:79]
 buffer_load_dwordx4 a[132:135], v234, s[24:27], s41 offen sc1
 buffer_load_dwordx4 a[216:219], v238, s[36:39], s47 offen sc1
 s_waitcnt lgkmcnt(12)
 v_mfma_f32_16x16x32_bf16 v[92:95], a[20:23], a[148:151], v[92:95]
 ds_read_b64_tr_b16 a[48:49], v237 offset:21664
 v_mfma_f32_16x16x32_bf16 v[88:91], a[20:23], a[144:147], v[88:91]
 v_mfma_f32_16x16x32_bf16 v[84:87], a[20:23], a[140:143], v[84:87]
 ds_read_b64_tr_b16 a[50:51], v237 offset:25248
 v_mfma_f32_16x16x32_bf16 v[80:83], a[20:23], a[136:139], v[80:83]
 s_waitcnt lgkmcnt(12)
 v_mfma_f32_16x16x32_bf16 v[96:99], a[24:27], a[136:139], v[96:99]
 ds_read_b64_tr_b16 a[52:53], v237 offset:21696
 v_mfma_f32_16x16x32_bf16 v[100:103], a[24:27], a[140:143], v[100:103]
 v_mfma_f32_16x16x32_bf16 v[104:107], a[24:27], a[144:147], v[104:107]
 ds_read_b64_tr_b16 a[54:55], v237 offset:25280
 v_mfma_f32_16x16x32_bf16 v[108:111], a[24:27], a[148:151], v[108:111]
 s_waitcnt lgkmcnt(0)
 s_barrier
 v_mfma_f32_16x16x32_bf16 v[112:115], a[28:31], a[136:139], v[112:115]
 ds_read_b64_tr_b16 a[0:1], v235 offset:0
 v_mfma_f32_16x16x32_bf16 v[116:119], a[28:31], a[140:143], v[116:119]
 v_mfma_f32_16x16x32_bf16 v[120:123], a[28:31], a[144:147], v[120:123]
 ds_read_b64_tr_b16 a[2:3], v235 offset:3584
 v_mfma_f32_16x16x32_bf16 v[124:127], a[28:31], a[148:151], v[124:127]
 v_mfma_f32_16x16x32_bf16 v[140:143], a[32:35], a[148:151], v[140:143]
 ds_read_b64_tr_b16 a[4:5], v235 offset:32
 v_mfma_f32_16x16x32_bf16 v[136:139], a[32:35], a[144:147], v[136:139]
 v_mfma_f32_16x16x32_bf16 v[132:135], a[32:35], a[140:143], v[132:135]
 ds_read_b64_tr_b16 a[6:7], v235 offset:3616
 v_mfma_f32_16x16x32_bf16 v[128:131], a[32:35], a[136:139], v[128:131]
 v_mfma_f32_16x16x32_bf16 v[144:147], a[36:39], a[136:139], v[144:147]
 ds_read_b64_tr_b16 a[8:9], v235 offset:64
 v_mfma_f32_16x16x32_bf16 v[148:151], a[36:39], a[140:143], v[148:151]
 v_mfma_f32_16x16x32_bf16 v[152:155], a[36:39], a[144:147], v[152:155]
 ds_read_b64_tr_b16 a[10:11], v235 offset:3648
 v_mfma_f32_16x16x32_bf16 v[156:159], a[36:39], a[148:151], v[156:159]
 v_mfma_f32_16x16x32_bf16 v[172:175], a[40:43], a[148:151], v[172:175]
 ds_read_b64_tr_b16 a[12:13], v235 offset:96
 v_mfma_f32_16x16x32_bf16 v[168:171], a[40:43], a[144:147], v[168:171]
 v_mfma_f32_16x16x32_bf16 v[164:167], a[40:43], a[140:143], v[164:167]
 ds_read_b64_tr_b16 a[14:15], v235 offset:3680
 v_mfma_f32_16x16x32_bf16 v[160:163], a[40:43], a[136:139], v[160:163]
 v_mfma_f32_16x16x32_bf16 v[176:179], a[44:47], a[136:139], v[176:179]
 ds_read_b64_tr_b16 a[16:17], v235 offset:128
 v_mfma_f32_16x16x32_bf16 v[180:183], a[44:47], a[140:143], v[180:183]
 v_mfma_f32_16x16x32_bf16 v[184:187], a[44:47], a[144:147], v[184:187]
 ds_read_b64_tr_b16 a[18:19], v235 offset:3712
 v_mfma_f32_16x16x32_bf16 v[188:191], a[44:47], a[148:151], v[188:191]
 v_mfma_f32_16x16x32_bf16 v[204:207], a[48:51], a[148:151], v[204:207]
 ds_read_b64_tr_b16 a[20:21], v235 offset:160
 v_mfma_f32_16x16x32_bf16 v[200:203], a[48:51], a[144:147], v[200:203]
 v_mfma_f32_16x16x32_bf16 v[196:199], a[48:51], a[140:143], v[196:199]
 ds_read_b64_tr_b16 a[22:23], v235 offset:3744
 v_mfma_f32_16x16x32_bf16 v[192:195], a[48:51], a[136:139], v[192:195]
 v_mfma_f32_16x16x32_bf16 v[208:211], a[52:55], a[136:139], v[208:211]
 ds_read_b64_tr_b16 a[24:25], v235 offset:192
 v_mfma_f32_16x16x32_bf16 v[212:215], a[52:55], a[140:143], v[212:215]
 v_mfma_f32_16x16x32_bf16 v[216:219], a[52:55], a[144:147], v[216:219]
 ds_read_b64_tr_b16 a[26:27], v235 offset:3776
 v_mfma_f32_16x16x32_bf16 v[220:223], a[52:55], a[148:151], v[220:223]
 s_waitcnt lgkmcnt(12)
 v_mfma_f32_16x16x32_bf16 v[0:3], a[0:3], a[152:155], v[0:3]
 ds_read_b64_tr_b16 a[28:29], v235 offset:14336
 v_mfma_f32_16x16x32_bf16 v[4:7], a[0:3], a[156:159], v[4:7]
 buffer_load_dwordx4 a[136:139], v231, s[24:27], s41 offen offset:1024 sc1
 v_mfma_f32_16x16x32_bf16 v[8:11], a[0:3], a[160:163], v[8:11]
 ds_read_b64_tr_b16 a[30:31], v235 offset:17920
 v_mfma_f32_16x16x32_bf16 v[12:15], a[0:3], a[164:167], v[12:15]
 v_bfe_u32 v245, v231, 4, 6
 s_waitcnt lgkmcnt(12)
 v_mfma_f32_16x16x32_bf16 v[28:31], a[4:7], a[164:167], v[28:31]
 ds_read_b64_tr_b16 a[32:33], v235 offset:14368
 v_mfma_f32_16x16x32_bf16 v[24:27], a[4:7], a[160:163], v[24:27]
 buffer_load_dwordx4 a[140:143], v232, s[24:27], s41 offen offset:1024 sc1
 s_lshr_b32 s11, s2, 3
 v_mfma_f32_16x16x32_bf16 v[20:23], a[4:7], a[156:159], v[20:23]
 ds_read_b64_tr_b16 a[34:35], v235 offset:17952
 v_mfma_f32_16x16x32_bf16 v[16:19], a[4:7], a[152:155], v[16:19]
 v_lshrrev_b32 v247, 1, v245
 s_waitcnt lgkmcnt(12)
 v_mfma_f32_16x16x32_bf16 v[32:35], a[8:11], a[152:155], v[32:35]
 ds_read_b64_tr_b16 a[36:37], v235 offset:14400
 v_mfma_f32_16x16x32_bf16 v[36:39], a[8:11], a[156:159], v[36:39]
 buffer_load_dwordx4 a[144:147], v233, s[24:27], s41 offen offset:1024 sc1
 s_lshr_b32 s16, s11, 3
 v_mfma_f32_16x16x32_bf16 v[40:43], a[8:11], a[160:163], v[40:43]
 ds_read_b64_tr_b16 a[38:39], v235 offset:17984
 v_mfma_f32_16x16x32_bf16 v[44:47], a[8:11], a[164:167], v[44:47]
 s_and_b32 s17, s11, 3
 s_waitcnt lgkmcnt(12)
 v_mfma_f32_16x16x32_bf16 v[60:63], a[12:15], a[164:167], v[60:63]
 ds_read_b64_tr_b16 a[40:41], v235 offset:14432
 v_mfma_f32_16x16x32_bf16 v[56:59], a[12:15], a[160:163], v[56:59]
 buffer_load_dwordx4 a[148:151], v234, s[24:27], s41 offen offset:1024 sc1
 v_mov_b32 v243, v247
 v_mfma_f32_16x16x32_bf16 v[52:55], a[12:15], a[156:159], v[52:55]
 ds_read_b64_tr_b16 a[42:43], v235 offset:18016
 v_mfma_f32_16x16x32_bf16 v[48:51], a[12:15], a[152:155], v[48:51]
 v_mul_u32_u24 v246, 262144, v243
 s_waitcnt lgkmcnt(12)
 v_mfma_f32_16x16x32_bf16 v[64:67], a[16:19], a[152:155], v[64:67]
 ds_read_b64_tr_b16 a[44:45], v235 offset:14464
 v_mfma_f32_16x16x32_bf16 v[68:71], a[16:19], a[156:159], v[68:71]
 buffer_load_dwordx4 v224, s[60:63], s40 offen lds
 v_and_b32 v243, 1, v245
 v_mfma_f32_16x16x32_bf16 v[72:75], a[16:19], a[160:163], v[72:75]
 ds_read_b64_tr_b16 a[46:47], v235 offset:18048
 v_mfma_f32_16x16x32_bf16 v[76:79], a[16:19], a[164:167], v[76:79]
 v_lshl_add_u32 v246, v243, 17, v246
 s_waitcnt lgkmcnt(12)
 v_mfma_f32_16x16x32_bf16 v[92:95], a[20:23], a[164:167], v[92:95]
 ds_read_b64_tr_b16 a[48:49], v235 offset:14496
 v_mfma_f32_16x16x32_bf16 v[88:91], a[20:23], a[160:163], v[88:91]
 buffer_load_dwordx4 v225, s[60:63], s40 offen offset:1024 lds
 v_mov_b32 v243, v245
 v_mfma_f32_16x16x32_bf16 v[84:87], a[20:23], a[156:159], v[84:87]
 ds_read_b64_tr_b16 a[50:51], v235 offset:18080
 v_mfma_f32_16x16x32_bf16 v[80:83], a[20:23], a[152:155], v[80:83]
 v_mul_u32_u24 v247, 4096, v243
 s_waitcnt lgkmcnt(12)
 v_mfma_f32_16x16x32_bf16 v[96:99], a[24:27], a[152:155], v[96:99]
 ds_read_b64_tr_b16 a[52:53], v235 offset:14528
 v_mfma_f32_16x16x32_bf16 v[100:103], a[24:27], a[156:159], v[100:103]
 v_mfma_f32_16x16x32_bf16 v[104:107], a[24:27], a[160:163], v[104:107]
 ds_read_b64_tr_b16 a[54:55], v235 offset:18112
 v_mfma_f32_16x16x32_bf16 v[108:111], a[24:27], a[164:167], v[108:111]
 s_waitcnt lgkmcnt(12)
 v_mfma_f32_16x16x32_bf16 v[112:115], a[28:31], a[152:155], v[112:115]
 ds_read_b64_tr_b16 a[0:1], v235 offset:7168
 v_mfma_f32_16x16x32_bf16 v[116:119], a[28:31], a[156:159], v[116:119]
 buffer_load_dwordx4 v226, s[60:63], s40 offen offset:2048 lds
 v_mfma_f32_16x16x32_bf16 v[120:123], a[28:31], a[160:163], v[120:123]
 ds_read_b64_tr_b16 a[2:3], v235 offset:10752
 v_mfma_f32_16x16x32_bf16 v[124:127], a[28:31], a[164:167], v[124:127]
 s_bfe_u32 s17, s14, 65543
 s_waitcnt lgkmcnt(12)
 v_mfma_f32_16x16x32_bf16 v[140:143], a[32:35], a[164:167], v[140:143]
 ds_read_b64_tr_b16 a[4:5], v235 offset:7200
 v_mfma_f32_16x16x32_bf16 v[136:139], a[32:35], a[160:163], v[136:139]
 buffer_load_dwordx4 v227, s[60:63], s40 offen offset:3072 lds
 s_add_u32 m0, s96, 135168
 s_mul_i32 s18, s17, 3670016
 v_mfma_f32_16x16x32_bf16 v[132:135], a[32:35], a[156:159], v[132:135]
 ds_read_b64_tr_b16 a[6:7], v235 offset:10784
 v_mfma_f32_16x16x32_bf16 v[128:131], a[32:35], a[152:155], v[128:131]
 v_add_u32 v246, s18, v246
 s_waitcnt lgkmcnt(12)
 v_mfma_f32_16x16x32_bf16 v[144:147], a[36:39], a[152:155], v[144:147]
 ds_read_b64_tr_b16 a[8:9], v235 offset:7232
 v_mfma_f32_16x16x32_bf16 v[148:151], a[36:39], a[156:159], v[148:151]
 buffer_load_dwordx4 v228, s[60:63], s40 offen lds
 s_mul_i32 s18, s17, 57344
 v_mfma_f32_16x16x32_bf16 v[152:155], a[36:39], a[160:163], v[152:155]
 ds_read_b64_tr_b16 a[10:11], v235 offset:10816
 v_mfma_f32_16x16x32_bf16 v[156:159], a[36:39], a[164:167], v[156:159]
 v_add_u32 v247, s18, v247
 s_waitcnt lgkmcnt(12)
 v_mfma_f32_16x16x32_bf16 v[172:175], a[40:43], a[164:167], v[172:175]
 ds_read_b64_tr_b16 a[12:13], v235 offset:7264
 v_mfma_f32_16x16x32_bf16 v[168:171], a[40:43], a[160:163], v[168:171]
 buffer_load_dwordx4 v229, s[60:63], s40 offen offset:1024 lds
 s_and_b32 s17, s14, 1792
 v_mfma_f32_16x16x32_bf16 v[164:167], a[40:43], a[156:159], v[164:167]
 ds_read_b64_tr_b16 a[14:15], v235 offset:10848
 v_mfma_f32_16x16x32_bf16 v[160:163], a[40:43], a[152:155], v[160:163]
 s_mov_b32 s52, s100
 s_waitcnt lgkmcnt(12)
 v_mfma_f32_16x16x32_bf16 v[176:179], a[44:47], a[152:155], v[176:179]
 ds_read_b64_tr_b16 a[16:17], v235 offset:7296
 v_mfma_f32_16x16x32_bf16 v[180:183], a[44:47], a[156:159], v[180:183]
 buffer_load_dwordx4 v230, s[60:63], s40 offen offset:2048 lds
 s_add_u32 s40, s40, 458752
 s_add_u32 m0, s96, 0
 s_mov_b32 s53, s101
 v_mfma_f32_16x16x32_bf16 v[184:187], a[44:47], a[160:163], v[184:187]
 ds_read_b64_tr_b16 a[18:19], v235 offset:10880
 v_mfma_f32_16x16x32_bf16 v[188:191], a[44:47], a[164:167], v[188:191]
 s_mov_b32 s54, 0x700000
 s_waitcnt lgkmcnt(12)
 v_mfma_f32_16x16x32_bf16 v[204:207], a[48:51], a[164:167], v[204:207]
 ds_read_b64_tr_b16 a[20:21], v235 offset:7328
 v_mfma_f32_16x16x32_bf16 v[200:203], a[48:51], a[160:163], v[200:203]
 s_mov_b32 s55, 0x00020000
 v_mfma_f32_16x16x32_bf16 v[196:199], a[48:51], a[156:159], v[196:199]
 ds_read_b64_tr_b16 a[22:23], v235 offset:10912
 v_mfma_f32_16x16x32_bf16 v[192:195], a[48:51], a[152:155], v[192:195]
 s_lshl_b32 s18, s3, 15
 s_waitcnt lgkmcnt(12)
 v_mfma_f32_16x16x32_bf16 v[208:211], a[52:55], a[152:155], v[208:211]
 ds_read_b64_tr_b16 a[24:25], v235 offset:7360
 v_mfma_f32_16x16x32_bf16 v[212:215], a[52:55], a[156:159], v[212:215]
 v_mfma_f32_16x16x32_bf16 v[216:219], a[52:55], a[160:163], v[216:219]
 ds_read_b64_tr_b16 a[26:27], v235 offset:10944
 v_mfma_f32_16x16x32_bf16 v[220:223], a[52:55], a[164:167], v[220:223]
 s_waitcnt lgkmcnt(12)
 v_mfma_f32_16x16x32_bf16 v[0:3], a[0:3], a[168:171], v[0:3]
 ds_read_b64_tr_b16 a[28:29], v235 offset:21504
 v_mfma_f32_16x16x32_bf16 v[4:7], a[0:3], a[172:175], v[4:7]
 buffer_load_dwordx4 a[152:155], v231, s[24:27], s41 offen offset:2048 sc1
 v_mfma_f32_16x16x32_bf16 v[8:11], a[0:3], a[176:179], v[8:11]
 ds_read_b64_tr_b16 a[30:31], v235 offset:25088
 s_waitcnt vmcnt(60)
 v_mfma_f32_16x16x32_bf16 v[12:15], a[0:3], a[180:183], v[12:15]
 s_add_u32 s18, s18, s17
 s_waitcnt lgkmcnt(12)
 v_mfma_f32_16x16x32_bf16 v[28:31], a[4:7], a[180:183], v[28:31]
 ds_read_b64_tr_b16 a[32:33], v235 offset:21536
 v_mfma_f32_16x16x32_bf16 v[24:27], a[4:7], a[176:179], v[24:27]
 v_lshrrev_b32 v243, 4, v245
 v_mfma_f32_16x16x32_bf16 v[20:23], a[4:7], a[172:175], v[20:23]
 ds_read_b64_tr_b16 a[34:35], v235 offset:25120
 v_mfma_f32_16x16x32_bf16 v[16:19], a[4:7], a[168:171], v[16:19]
 buffer_load_dwordx4 a[156:159], v232, s[24:27], s41 offen offset:2048 sc1
 v_lshlrev_b32 v243, 1, v243
 s_waitcnt lgkmcnt(12)
 v_mfma_f32_16x16x32_bf16 v[32:35], a[8:11], a[168:171], v[32:35]
 ds_read_b64_tr_b16 a[36:37], v235 offset:21568
 v_mfma_f32_16x16x32_bf16 v[36:39], a[8:11], a[172:175], v[36:39]
 v_xor_b32 v243, v243, v245
 v_mfma_f32_16x16x32_bf16 v[40:43], a[8:11], a[176:179], v[40:43]
 ds_read_b64_tr_b16 a[38:39], v235 offset:25152
 v_mfma_f32_16x16x32_bf16 v[44:47], a[8:11], a[180:183], v[44:47]
 v_and_b32 v243, 15, v243
 s_waitcnt lgkmcnt(12)
 v_mfma_f32_16x16x32_bf16 v[60:63], a[12:15], a[180:183], v[60:63]
 ds_read_b64_tr_b16 a[40:41], v235 offset:21600
 v_mfma_f32_16x16x32_bf16 v[56:59], a[12:15], a[176:179], v[56:59]
 buffer_load_dwordx4 a[160:163], v233, s[24:27], s41 offen offset:2048 sc1
 v_lshlrev_b32 v243, 4, v243
 v_mfma_f32_16x16x32_bf16 v[52:55], a[12:15], a[172:175], v[52:55]
 ds_read_b64_tr_b16 a[42:43], v235 offset:25184
 v_mfma_f32_16x16x32_bf16 v[48:51], a[12:15], a[168:171], v[48:51]
 v_lshrrev_b32 v244, 4, v245
 s_waitcnt lgkmcnt(12)
 v_mfma_f32_16x16x32_bf16 v[64:67], a[16:19], a[168:171], v[64:67]
 ds_read_b64_tr_b16 a[44:45], v235 offset:21632
 v_mfma_f32_16x16x32_bf16 v[68:71], a[16:19], a[172:175], v[68:71]
 v_lshl_add_u32 v243, v244, 11, v243
 v_mfma_f32_16x16x32_bf16 v[72:75], a[16:19], a[176:179], v[72:75]
 ds_read_b64_tr_b16 a[46:47], v235 offset:25216
 v_mfma_f32_16x16x32_bf16 v[76:79], a[16:19], a[180:183], v[76:79]
 buffer_load_dwordx4 a[164:167], v234, s[24:27], s41 offen offset:2048 sc1
 v_add_u32 v243, s18, v243
 s_waitcnt lgkmcnt(12)
 v_mfma_f32_16x16x32_bf16 v[92:95], a[20:23], a[180:183], v[92:95]
 ds_read_b64_tr_b16 a[48:49], v235 offset:21664
 v_mfma_f32_16x16x32_bf16 v[88:91], a[20:23], a[176:179], v[88:91]
 v_add_u32 v239, 0, v243
 v_mfma_f32_16x16x32_bf16 v[84:87], a[20:23], a[172:175], v[84:87]
 ds_read_b64_tr_b16 a[50:51], v235 offset:25248
 v_mfma_f32_16x16x32_bf16 v[80:83], a[20:23], a[168:171], v[80:83]
 v_lshrrev_b32 v243, 4, v245
 s_waitcnt lgkmcnt(12)
 v_mfma_f32_16x16x32_bf16 v[96:99], a[24:27], a[168:171], v[96:99]
 ds_read_b64_tr_b16 a[52:53], v235 offset:21696
 v_mfma_f32_16x16x32_bf16 v[100:103], a[24:27], a[172:175], v[100:103]
 v_mfma_f32_16x16x32_bf16 v[104:107], a[24:27], a[176:179], v[104:107]
 ds_read_b64_tr_b16 a[54:55], v235 offset:25280
 v_mfma_f32_16x16x32_bf16 v[108:111], a[24:27], a[180:183], v[108:111]
 s_waitcnt lgkmcnt(0)
 s_waitcnt vmcnt(56)
 s_barrier
 v_mfma_f32_16x16x32_bf16 v[112:115], a[28:31], a[168:171], v[112:115]
 ds_read_b64_tr_b16 a[0:1], v235 offset:28672
 v_mfma_f32_16x16x32_bf16 v[116:119], a[28:31], a[172:175], v[116:119]
 v_mfma_f32_16x16x32_bf16 v[120:123], a[28:31], a[176:179], v[120:123]
 ds_read_b64_tr_b16 a[2:3], v235 offset:32256
 v_mfma_f32_16x16x32_bf16 v[124:127], a[28:31], a[180:183], v[124:127]
 v_or_b32 v243, 4, v243
 v_mfma_f32_16x16x32_bf16 v[140:143], a[32:35], a[180:183], v[140:143]
 ds_read_b64_tr_b16 a[4:5], v235 offset:28704
 v_mfma_f32_16x16x32_bf16 v[136:139], a[32:35], a[176:179], v[136:139]
 v_lshlrev_b32 v243, 1, v243
 v_mfma_f32_16x16x32_bf16 v[132:135], a[32:35], a[172:175], v[132:135]
 ds_read_b64_tr_b16 a[6:7], v235 offset:32288
 v_mfma_f32_16x16x32_bf16 v[128:131], a[32:35], a[168:171], v[128:131]
 v_xor_b32 v243, v243, v245
 v_mfma_f32_16x16x32_bf16 v[144:147], a[36:39], a[168:171], v[144:147]
 ds_read_b64_tr_b16 a[8:9], v235 offset:28736
 v_mfma_f32_16x16x32_bf16 v[148:151], a[36:39], a[172:175], v[148:151]
 v_and_b32 v243, 15, v243
 v_mfma_f32_16x16x32_bf16 v[152:155], a[36:39], a[176:179], v[152:155]
 ds_read_b64_tr_b16 a[10:11], v235 offset:32320
 v_mfma_f32_16x16x32_bf16 v[156:159], a[36:39], a[180:183], v[156:159]
 v_lshlrev_b32 v243, 4, v243
 v_mfma_f32_16x16x32_bf16 v[172:175], a[40:43], a[180:183], v[172:175]
 ds_read_b64_tr_b16 a[12:13], v235 offset:28768
 v_mfma_f32_16x16x32_bf16 v[168:171], a[40:43], a[176:179], v[168:171]
 v_lshrrev_b32 v244, 4, v245
 v_mfma_f32_16x16x32_bf16 v[164:167], a[40:43], a[172:175], v[164:167]
 ds_read_b64_tr_b16 a[14:15], v235 offset:32352
 v_mfma_f32_16x16x32_bf16 v[160:163], a[40:43], a[168:171], v[160:163]
 v_lshl_add_u32 v243, v244, 11, v243
 v_mfma_f32_16x16x32_bf16 v[176:179], a[44:47], a[168:171], v[176:179]
 ds_read_b64_tr_b16 a[16:17], v235 offset:28800
 v_mfma_f32_16x16x32_bf16 v[180:183], a[44:47], a[172:175], v[180:183]
 v_add_u32 v243, s18, v243
 v_mfma_f32_16x16x32_bf16 v[184:187], a[44:47], a[176:179], v[184:187]
 ds_read_b64_tr_b16 a[18:19], v235 offset:32384
 v_mfma_f32_16x16x32_bf16 v[188:191], a[44:47], a[180:183], v[188:191]
 v_add_u32 v240, 7168, v243
 v_mfma_f32_16x16x32_bf16 v[204:207], a[48:51], a[180:183], v[204:207]
 ds_read_b64_tr_b16 a[20:21], v235 offset:28832
 v_mfma_f32_16x16x32_bf16 v[200:203], a[48:51], a[176:179], v[200:203]
 v_lshrrev_b32 v243, 4, v245
 v_mfma_f32_16x16x32_bf16 v[196:199], a[48:51], a[172:175], v[196:199]
 ds_read_b64_tr_b16 a[22:23], v235 offset:32416
 v_mfma_f32_16x16x32_bf16 v[192:195], a[48:51], a[168:171], v[192:195]
 v_lshlrev_b32 v243, 1, v243
 v_mfma_f32_16x16x32_bf16 v[208:211], a[52:55], a[168:171], v[208:211]
 ds_read_b64_tr_b16 a[24:25], v235 offset:28864
 v_mfma_f32_16x16x32_bf16 v[212:215], a[52:55], a[172:175], v[212:215]
 v_mfma_f32_16x16x32_bf16 v[216:219], a[52:55], a[176:179], v[216:219]
 ds_read_b64_tr_b16 a[26:27], v235 offset:32448
 v_mfma_f32_16x16x32_bf16 v[220:223], a[52:55], a[180:183], v[220:223]
 s_waitcnt vmcnt(55) lgkmcnt(12)
 v_mfma_f32_16x16x32_bf16 v[0:3], a[0:3], a[56:59], v[0:3]
 ds_read_b64_tr_b16 a[28:29], v235 offset:43008
 s_waitcnt vmcnt(54)
 v_mfma_f32_16x16x32_bf16 v[4:7], a[0:3], a[60:63], v[4:7]
 buffer_load_dwordx4 a[168:171], v231, s[24:27], s41 offen offset:3072 sc1
 s_waitcnt vmcnt(54)
 v_mfma_f32_16x16x32_bf16 v[8:11], a[0:3], a[64:67], v[8:11]
 ds_read_b64_tr_b16 a[30:31], v235 offset:46592
 s_waitcnt vmcnt(53)
 v_mfma_f32_16x16x32_bf16 v[12:15], a[0:3], a[68:71], v[12:15]
 v_xor_b32 v243, v243, v245
 s_waitcnt lgkmcnt(12)
 v_mfma_f32_16x16x32_bf16 v[28:31], a[4:7], a[68:71], v[28:31]
 ds_read_b64_tr_b16 a[32:33], v235 offset:43040
 v_mfma_f32_16x16x32_bf16 v[24:27], a[4:7], a[64:67], v[24:27]
 v_and_b32 v243, 15, v243
 v_mfma_f32_16x16x32_bf16 v[20:23], a[4:7], a[60:63], v[20:23]
 ds_read_b64_tr_b16 a[34:35], v235 offset:46624
 v_mfma_f32_16x16x32_bf16 v[16:19], a[4:7], a[56:59], v[16:19]
 buffer_load_dwordx4 a[172:175], v232, s[24:27], s41 offen offset:3072 sc1
 v_lshlrev_b32 v243, 4, v243
 s_waitcnt lgkmcnt(12)
 v_mfma_f32_16x16x32_bf16 v[32:35], a[8:11], a[56:59], v[32:35]
 ds_read_b64_tr_b16 a[36:37], v235 offset:43072
 v_mfma_f32_16x16x32_bf16 v[36:39], a[8:11], a[60:63], v[36:39]
 v_lshrrev_b32 v244, 4, v245
 v_mfma_f32_16x16x32_bf16 v[40:43], a[8:11], a[64:67], v[40:43]
 ds_read_b64_tr_b16 a[38:39], v235 offset:46656
 v_mfma_f32_16x16x32_bf16 v[44:47], a[8:11], a[68:71], v[44:47]
 v_lshl_add_u32 v243, v244, 11, v243
 s_waitcnt lgkmcnt(12)
 v_mfma_f32_16x16x32_bf16 v[60:63], a[12:15], a[68:71], v[60:63]
 ds_read_b64_tr_b16 a[40:41], v235 offset:43104
 v_mfma_f32_16x16x32_bf16 v[56:59], a[12:15], a[64:67], v[56:59]
 buffer_load_dwordx4 a[176:179], v233, s[24:27], s41 offen offset:3072 sc1
 v_add_u32 v243, s18, v243
 v_mfma_f32_16x16x32_bf16 v[52:55], a[12:15], a[60:63], v[52:55]
 ds_read_b64_tr_b16 a[42:43], v235 offset:46688
 v_mfma_f32_16x16x32_bf16 v[48:51], a[12:15], a[56:59], v[48:51]
 v_add_u32 v241, 14336, v243
 s_waitcnt lgkmcnt(12)
 v_mfma_f32_16x16x32_bf16 v[64:67], a[16:19], a[56:59], v[64:67]
 ds_read_b64_tr_b16 a[44:45], v235 offset:43136
 v_mfma_f32_16x16x32_bf16 v[68:71], a[16:19], a[60:63], v[68:71]
 v_lshrrev_b32 v243, 4, v245
 v_mfma_f32_16x16x32_bf16 v[72:75], a[16:19], a[64:67], v[72:75]
 ds_read_b64_tr_b16 a[46:47], v235 offset:46720
 v_mfma_f32_16x16x32_bf16 v[76:79], a[16:19], a[68:71], v[76:79]
 buffer_load_dwordx4 a[180:183], v234, s[24:27], s41 offen offset:3072 sc1
 s_add_u32 s41, s41, 4096
 v_or_b32 v243, 4, v243
 s_waitcnt lgkmcnt(12)
 v_mfma_f32_16x16x32_bf16 v[92:95], a[20:23], a[68:71], v[92:95]
 ds_read_b64_tr_b16 a[48:49], v235 offset:43168
 v_mfma_f32_16x16x32_bf16 v[88:91], a[20:23], a[64:67], v[88:91]
 v_lshlrev_b32 v243, 1, v243
 v_mfma_f32_16x16x32_bf16 v[84:87], a[20:23], a[60:63], v[84:87]
 ds_read_b64_tr_b16 a[50:51], v235 offset:46752
 v_mfma_f32_16x16x32_bf16 v[80:83], a[20:23], a[56:59], v[80:83]
 v_xor_b32 v243, v243, v245
 s_waitcnt lgkmcnt(12)
 v_mfma_f32_16x16x32_bf16 v[96:99], a[24:27], a[56:59], v[96:99]
 ds_read_b64_tr_b16 a[52:53], v235 offset:43200
 v_mfma_f32_16x16x32_bf16 v[100:103], a[24:27], a[60:63], v[100:103]
 v_mfma_f32_16x16x32_bf16 v[104:107], a[24:27], a[64:67], v[104:107]
 ds_read_b64_tr_b16 a[54:55], v235 offset:46784
 v_mfma_f32_16x16x32_bf16 v[108:111], a[24:27], a[68:71], v[108:111]
 s_waitcnt lgkmcnt(12)
 v_mfma_f32_16x16x32_bf16 v[112:115], a[28:31], a[56:59], v[112:115]
 ds_read_b64_tr_b16 a[0:1], v235 offset:35840
 v_mfma_f32_16x16x32_bf16 v[116:119], a[28:31], a[60:63], v[116:119]
 v_mfma_f32_16x16x32_bf16 v[120:123], a[28:31], a[64:67], v[120:123]
 ds_read_b64_tr_b16 a[2:3], v235 offset:39424
 v_mfma_f32_16x16x32_bf16 v[124:127], a[28:31], a[68:71], v[124:127]
 v_and_b32 v243, 15, v243
 s_waitcnt lgkmcnt(12)
 v_mfma_f32_16x16x32_bf16 v[140:143], a[32:35], a[68:71], v[140:143]
 ds_read_b64_tr_b16 a[4:5], v235 offset:35872
 v_mfma_f32_16x16x32_bf16 v[136:139], a[32:35], a[64:67], v[136:139]
 v_lshlrev_b32 v243, 4, v243
 v_mfma_f32_16x16x32_bf16 v[132:135], a[32:35], a[60:63], v[132:135]
 ds_read_b64_tr_b16 a[6:7], v235 offset:39456
 v_mfma_f32_16x16x32_bf16 v[128:131], a[32:35], a[56:59], v[128:131]
 v_lshrrev_b32 v244, 4, v245
 s_waitcnt lgkmcnt(12)
 v_mfma_f32_16x16x32_bf16 v[144:147], a[36:39], a[56:59], v[144:147]
 ds_read_b64_tr_b16 a[8:9], v235 offset:35904
 v_mfma_f32_16x16x32_bf16 v[148:151], a[36:39], a[60:63], v[148:151]
 v_lshl_add_u32 v243, v244, 11, v243
 v_mfma_f32_16x16x32_bf16 v[152:155], a[36:39], a[64:67], v[152:155]
 ds_read_b64_tr_b16 a[10:11], v235 offset:39488
 v_mfma_f32_16x16x32_bf16 v[156:159], a[36:39], a[68:71], v[156:159]
 v_add_u32 v243, s18, v243
 s_waitcnt lgkmcnt(12)
 v_mfma_f32_16x16x32_bf16 v[172:175], a[40:43], a[68:71], v[172:175]
 ds_read_b64_tr_b16 a[12:13], v235 offset:35936
 v_mfma_f32_16x16x32_bf16 v[168:171], a[40:43], a[64:67], v[168:171]
 v_add_u32 v242, 21504, v243
 v_mfma_f32_16x16x32_bf16 v[164:167], a[40:43], a[60:63], v[164:167]
 ds_read_b64_tr_b16 a[14:15], v235 offset:39520
 v_mfma_f32_16x16x32_bf16 v[160:163], a[40:43], a[56:59], v[160:163]
 s_lshl_b32 s57, s3, 12
 s_waitcnt lgkmcnt(12)
 v_mfma_f32_16x16x32_bf16 v[176:179], a[44:47], a[56:59], v[176:179]
 ds_read_b64_tr_b16 a[16:17], v235 offset:35968
 v_mfma_f32_16x16x32_bf16 v[180:183], a[44:47], a[60:63], v[180:183]
 s_mov_b32 s56, 0
 v_mfma_f32_16x16x32_bf16 v[184:187], a[44:47], a[64:67], v[184:187]
 ds_read_b64_tr_b16 a[18:19], v235 offset:39552
 v_mfma_f32_16x16x32_bf16 v[188:191], a[44:47], a[68:71], v[188:191]
 v_readlane_b32 s56, v246, 0
 s_waitcnt lgkmcnt(12)
 v_mfma_f32_16x16x32_bf16 v[204:207], a[48:51], a[68:71], v[204:207]
 ds_read_b64_tr_b16 a[20:21], v235 offset:36000
 v_mfma_f32_16x16x32_bf16 v[200:203], a[48:51], a[64:67], v[200:203]
 v_mfma_f32_16x16x32_bf16 v[196:199], a[48:51], a[60:63], v[196:199]
 ds_read_b64_tr_b16 a[22:23], v235 offset:39584
 v_mfma_f32_16x16x32_bf16 v[192:195], a[48:51], a[56:59], v[192:195]
 s_waitcnt lgkmcnt(12)
 v_mfma_f32_16x16x32_bf16 v[208:211], a[52:55], a[56:59], v[208:211]
 ds_read_b64_tr_b16 a[24:25], v235 offset:36032
 v_mfma_f32_16x16x32_bf16 v[212:215], a[52:55], a[60:63], v[212:215]
 v_mfma_f32_16x16x32_bf16 v[216:219], a[52:55], a[64:67], v[216:219]
 ds_read_b64_tr_b16 a[26:27], v235 offset:39616
 v_mfma_f32_16x16x32_bf16 v[220:223], a[52:55], a[68:71], v[220:223]
 s_waitcnt vmcnt(55) lgkmcnt(12)
 v_mfma_f32_16x16x32_bf16 v[0:3], a[0:3], a[72:75], v[0:3]
 ds_read_b64_tr_b16 a[28:29], v235 offset:50176
 s_waitcnt vmcnt(54)
 v_mfma_f32_16x16x32_bf16 v[4:7], a[0:3], a[76:79], v[4:7]
 s_waitcnt vmcnt(53)
 v_mfma_f32_16x16x32_bf16 v[8:11], a[0:3], a[80:83], v[8:11]
 ds_read_b64_tr_b16 a[30:31], v235 offset:53760
 s_waitcnt vmcnt(52)
 v_mfma_f32_16x16x32_bf16 v[12:15], a[0:3], a[84:87], v[12:15]
 s_add_u32 s28, s8, 0x1400000
 s_waitcnt lgkmcnt(12)
 v_mfma_f32_16x16x32_bf16 v[28:31], a[4:7], a[84:87], v[28:31]
 ds_read_b64_tr_b16 a[32:33], v235 offset:50208
 v_mfma_f32_16x16x32_bf16 v[24:27], a[4:7], a[80:83], v[24:27]
 s_addc_u32 s29, s9, 0
 v_mfma_f32_16x16x32_bf16 v[20:23], a[4:7], a[76:79], v[20:23]
 ds_read_b64_tr_b16 a[34:35], v235 offset:53792
 v_mfma_f32_16x16x32_bf16 v[16:19], a[4:7], a[72:75], v[16:19]
 s_mov_b32 s30, 0xe00000
 s_waitcnt lgkmcnt(12)
 v_mfma_f32_16x16x32_bf16 v[32:35], a[8:11], a[72:75], v[32:35]
 ds_read_b64_tr_b16 a[36:37], v235 offset:50240
 v_mfma_f32_16x16x32_bf16 v[36:39], a[8:11], a[76:79], v[36:39]
 s_mov_b32 s31, 0x00020000
 v_mfma_f32_16x16x32_bf16 v[40:43], a[8:11], a[80:83], v[40:43]
 ds_read_b64_tr_b16 a[38:39], v235 offset:53824
 v_mfma_f32_16x16x32_bf16 v[44:47], a[8:11], a[84:87], v[44:47]
 s_mul_i32 s42, s94, 114688
 s_waitcnt lgkmcnt(12)
 v_mfma_f32_16x16x32_bf16 v[60:63], a[12:15], a[84:87], v[60:63]
 ds_read_b64_tr_b16 a[40:41], v235 offset:50272
 v_mfma_f32_16x16x32_bf16 v[56:59], a[12:15], a[80:83], v[56:59]
 s_lshl_b32 s44, s44, 9
 v_mfma_f32_16x16x32_bf16 v[52:55], a[12:15], a[76:79], v[52:55]
 ds_read_b64_tr_b16 a[42:43], v235 offset:53856
 v_mfma_f32_16x16x32_bf16 v[48:51], a[12:15], a[72:75], v[48:51]
 s_add_u32 s44, s44, s42
 s_waitcnt lgkmcnt(12)
 v_mfma_f32_16x16x32_bf16 v[64:67], a[16:19], a[72:75], v[64:67]
 ds_read_b64_tr_b16 a[44:45], v235 offset:50304
 v_mfma_f32_16x16x32_bf16 v[68:71], a[16:19], a[76:79], v[68:71]
 s_lshr_b32 s46, s46, 1
 v_mfma_f32_16x16x32_bf16 v[72:75], a[16:19], a[80:83], v[72:75]
 ds_read_b64_tr_b16 a[46:47], v235 offset:53888
 v_mfma_f32_16x16x32_bf16 v[76:79], a[16:19], a[84:87], v[76:79]
 s_lshl_b32 s46, s46, 10
 s_waitcnt lgkmcnt(12)
 v_mfma_f32_16x16x32_bf16 v[92:95], a[20:23], a[84:87], v[92:95]
 ds_read_b64_tr_b16 a[48:49], v235 offset:50336
 v_mfma_f32_16x16x32_bf16 v[88:91], a[20:23], a[80:83], v[88:91]
 s_add_u32 s46, s46, s42
 v_mfma_f32_16x16x32_bf16 v[84:87], a[20:23], a[76:79], v[84:87]
 ds_read_b64_tr_b16 a[50:51], v235 offset:53920
 v_mfma_f32_16x16x32_bf16 v[80:83], a[20:23], a[72:75], v[80:83]
 s_lshl_b32 s19, s19, 3
 s_waitcnt lgkmcnt(12)
 v_mfma_f32_16x16x32_bf16 v[96:99], a[24:27], a[72:75], v[96:99]
 ds_read_b64_tr_b16 a[52:53], v235 offset:50368
 v_mfma_f32_16x16x32_bf16 v[100:103], a[24:27], a[76:79], v[100:103]
 s_add_u32 s46, s46, s19
 v_mfma_f32_16x16x32_bf16 v[104:107], a[24:27], a[80:83], v[104:107]
 ds_read_b64_tr_b16 a[54:55], v235 offset:53952
 v_mfma_f32_16x16x32_bf16 v[108:111], a[24:27], a[84:87], v[108:111]
 s_waitcnt lgkmcnt(0)
 s_waitcnt vmcnt(8)
 s_barrier
 v_mfma_f32_16x16x32_bf16 v[112:115], a[28:31], a[72:75], v[112:115]
 ds_read_b64_tr_b16 a[0:1], v236 offset:192
 v_mfma_f32_16x16x32_bf16 v[116:119], a[28:31], a[76:79], v[116:119]
 v_mfma_f32_16x16x32_bf16 v[120:123], a[28:31], a[80:83], v[120:123]
 ds_read_b64_tr_b16 a[2:3], v236 offset:3776
 v_mfma_f32_16x16x32_bf16 v[124:127], a[28:31], a[84:87], v[124:127]
 v_and_b32 v224, 0x3f0, v231
 v_mfma_f32_16x16x32_bf16 v[140:143], a[32:35], a[84:87], v[140:143]
 ds_read_b64_tr_b16 a[4:5], v236 offset:14528
 v_mfma_f32_16x16x32_bf16 v[136:139], a[32:35], a[80:83], v[136:139]
 v_add_u32 v225, 114688, v224
 v_mfma_f32_16x16x32_bf16 v[132:135], a[32:35], a[76:79], v[132:135]
 ds_read_b64_tr_b16 a[6:7], v236 offset:18112
 v_mfma_f32_16x16x32_bf16 v[128:131], a[32:35], a[72:75], v[128:131]
 v_add_u32 v226, 229376, v224
 v_mfma_f32_16x16x32_bf16 v[144:147], a[36:39], a[72:75], v[144:147]
 ds_read_b64_tr_b16 a[8:9], v236 offset:7360
 v_mfma_f32_16x16x32_bf16 v[148:151], a[36:39], a[76:79], v[148:151]
 v_add_u32 v227, 344064, v224
 v_mfma_f32_16x16x32_bf16 v[152:155], a[36:39], a[80:83], v[152:155]
 ds_read_b64_tr_b16 a[10:11], v236 offset:10944
 v_mfma_f32_16x16x32_bf16 v[156:159], a[36:39], a[84:87], v[156:159]
 v_mfma_f32_16x16x32_bf16 v[172:175], a[40:43], a[84:87], v[172:175]
 ds_read_b64_tr_b16 a[12:13], v236 offset:21696
 v_mfma_f32_16x16x32_bf16 v[168:171], a[40:43], a[80:83], v[168:171]
 v_mfma_f32_16x16x32_bf16 v[164:167], a[40:43], a[76:79], v[164:167]
 ds_read_b64_tr_b16 a[14:15], v236 offset:25280
 v_mfma_f32_16x16x32_bf16 v[160:163], a[40:43], a[72:75], v[160:163]
 v_mfma_f32_16x16x32_bf16 v[176:179], a[44:47], a[72:75], v[176:179]
 ds_read_b64_tr_b16 a[16:17], v236 offset:28864
 v_mfma_f32_16x16x32_bf16 v[180:183], a[44:47], a[76:79], v[180:183]
 v_mfma_f32_16x16x32_bf16 v[184:187], a[44:47], a[80:83], v[184:187]
 ds_read_b64_tr_b16 a[18:19], v236 offset:32448
 v_mfma_f32_16x16x32_bf16 v[188:191], a[44:47], a[84:87], v[188:191]
 v_mfma_f32_16x16x32_bf16 v[204:207], a[48:51], a[84:87], v[204:207]
 ds_read_b64_tr_b16 a[20:21], v236 offset:43200
 v_mfma_f32_16x16x32_bf16 v[200:203], a[48:51], a[80:83], v[200:203]
 v_mfma_f32_16x16x32_bf16 v[196:199], a[48:51], a[76:79], v[196:199]
 ds_read_b64_tr_b16 a[22:23], v236 offset:46784
 v_mfma_f32_16x16x32_bf16 v[192:195], a[48:51], a[72:75], v[192:195]
 v_mfma_f32_16x16x32_bf16 v[208:211], a[52:55], a[72:75], v[208:211]
 ds_read_b64_tr_b16 a[24:25], v236 offset:36032
 v_mfma_f32_16x16x32_bf16 v[212:215], a[52:55], a[76:79], v[212:215]
 v_mfma_f32_16x16x32_bf16 v[216:219], a[52:55], a[80:83], v[216:219]
 ds_read_b64_tr_b16 a[26:27], v236 offset:39616
 v_mfma_f32_16x16x32_bf16 v[220:223], a[52:55], a[84:87], v[220:223]
 s_waitcnt lgkmcnt(12)
 v_mfma_f32_16x16x32_bf16 v[96:99], a[0:3], a[88:91], v[96:99]
 ds_read_b64_tr_b16 a[28:29], v236 offset:50368
 v_mfma_f32_16x16x32_bf16 v[100:103], a[0:3], a[92:95], v[100:103]
 s_mov_b32 m0, s57
 s_nop 0
 buffer_load_dwordx4 v239, s[52:55], s56 offen lds
 v_mfma_f32_16x16x32_bf16 v[104:107], a[0:3], a[96:99], v[104:107]
 ds_read_b64_tr_b16 a[30:31], v236 offset:53952
 v_mfma_f32_16x16x32_bf16 v[108:111], a[0:3], a[100:103], v[108:111]
 s_waitcnt lgkmcnt(12)
 v_mfma_f32_16x16x32_bf16 v[220:223], a[4:7], a[100:103], v[220:223]
 ds_read_b64_tr_b16 a[32:33], v237 offset:192
 v_mfma_f32_16x16x32_bf16 v[216:219], a[4:7], a[96:99], v[216:219]
 buffer_load_dwordx4 v240, s[52:55], s56 offen offset:1024 lds
 v_mfma_f32_16x16x32_bf16 v[212:215], a[4:7], a[92:95], v[212:215]
 ds_read_b64_tr_b16 a[34:35], v237 offset:3776
 v_mfma_f32_16x16x32_bf16 v[208:211], a[4:7], a[88:91], v[208:211]
 s_waitcnt lgkmcnt(12)
 v_mfma_f32_16x16x32_bf16 v[96:99], a[8:11], a[104:107], v[96:99]
 ds_read_b64_tr_b16 a[36:37], v237 offset:14528
 v_mfma_f32_16x16x32_bf16 v[100:103], a[8:11], a[108:111], v[100:103]
 buffer_load_dwordx4 v241, s[52:55], s56 offen offset:2048 lds
 v_mfma_f32_16x16x32_bf16 v[104:107], a[8:11], a[112:115], v[104:107]
 ds_read_b64_tr_b16 a[38:39], v237 offset:18112
 v_mfma_f32_16x16x32_bf16 v[108:111], a[8:11], a[116:119], v[108:111]
 s_waitcnt lgkmcnt(12)
 v_mfma_f32_16x16x32_bf16 v[220:223], a[12:15], a[116:119], v[220:223]
 ds_read_b64_tr_b16 a[40:41], v237 offset:7360
 v_mfma_f32_16x16x32_bf16 v[216:219], a[12:15], a[112:115], v[216:219]
 buffer_load_dwordx4 v242, s[52:55], s56 offen offset:3072 lds
 s_add_u32 m0, s57, 16384
 v_readlane_b32 s56, v246, 1
 v_mfma_f32_16x16x32_bf16 v[212:215], a[12:15], a[108:111], v[212:215]
 ds_read_b64_tr_b16 a[42:43], v237 offset:10944
 v_mfma_f32_16x16x32_bf16 v[208:211], a[12:15], a[104:107], v[208:211]
 s_waitcnt lgkmcnt(12)
 v_mfma_f32_16x16x32_bf16 v[96:99], a[16:19], a[120:123], v[96:99]
 ds_read_b64_tr_b16 a[44:45], v237 offset:21696
 v_mfma_f32_16x16x32_bf16 v[100:103], a[16:19], a[124:127], v[100:103]
 buffer_load_dwordx4 v239, s[52:55], s56 offen lds
 v_mfma_f32_16x16x32_bf16 v[104:107], a[16:19], a[128:131], v[104:107]
 ds_read_b64_tr_b16 a[46:47], v237 offset:25280
 v_mfma_f32_16x16x32_bf16 v[108:111], a[16:19], a[132:135], v[108:111]
 s_waitcnt lgkmcnt(12)
 v_mfma_f32_16x16x32_bf16 v[220:223], a[20:23], a[132:135], v[220:223]
 ds_read_b64_tr_b16 a[48:49], v236 offset:0
 v_mfma_f32_16x16x32_bf16 v[216:219], a[20:23], a[128:131], v[216:219]
 buffer_load_dwordx4 v240, s[52:55], s56 offen offset:1024 lds
 v_mfma_f32_16x16x32_bf16 v[212:215], a[20:23], a[124:127], v[212:215]
 ds_read_b64_tr_b16 a[50:51], v236 offset:3584
 v_mfma_f32_16x16x32_bf16 v[208:211], a[20:23], a[120:123], v[208:211]
 s_waitcnt lgkmcnt(12)
 v_mfma_f32_16x16x32_bf16 v[96:99], a[24:27], a[136:139], v[96:99]
 ds_read_b64_tr_b16 a[52:53], v236 offset:14336
 v_mfma_f32_16x16x32_bf16 v[100:103], a[24:27], a[140:143], v[100:103]
 buffer_load_dwordx4 v241, s[52:55], s56 offen offset:2048 lds
 v_mfma_f32_16x16x32_bf16 v[104:107], a[24:27], a[144:147], v[104:107]
 ds_read_b64_tr_b16 a[54:55], v236 offset:17920
 v_mfma_f32_16x16x32_bf16 v[108:111], a[24:27], a[148:151], v[108:111]
 s_waitcnt lgkmcnt(12)
 v_mfma_f32_16x16x32_bf16 v[220:223], a[28:31], a[148:151], v[220:223]
 ds_read_b64_tr_b16 a[0:1], v236 offset:7168
 v_mfma_f32_16x16x32_bf16 v[216:219], a[28:31], a[144:147], v[216:219]
 buffer_load_dwordx4 v242, s[52:55], s56 offen offset:3072 lds
 s_add_u32 m0, s57, 32768
 v_readlane_b32 s56, v246, 2
 v_mfma_f32_16x16x32_bf16 v[212:215], a[28:31], a[140:143], v[212:215]
 ds_read_b64_tr_b16 a[2:3], v236 offset:10752
 v_mfma_f32_16x16x32_bf16 v[208:211], a[28:31], a[136:139], v[208:211]
 s_waitcnt vmcnt(15) lgkmcnt(12)
 v_mfma_f32_16x16x32_bf16 v[96:99], a[32:35], a[152:155], v[96:99]
 ds_read_b64_tr_b16 a[4:5], v236 offset:21504
 s_waitcnt vmcnt(14)
 v_mfma_f32_16x16x32_bf16 v[100:103], a[32:35], a[156:159], v[100:103]
 s_waitcnt vmcnt(13)
 v_mfma_f32_16x16x32_bf16 v[104:107], a[32:35], a[160:163], v[104:107]
 ds_read_b64_tr_b16 a[6:7], v236 offset:25088
 s_waitcnt vmcnt(12)
 v_mfma_f32_16x16x32_bf16 v[108:111], a[32:35], a[164:167], v[108:111]
 s_waitcnt lgkmcnt(12)
 v_mfma_f32_16x16x32_bf16 v[220:223], a[36:39], a[164:167], v[220:223]
 ds_read_b64_tr_b16 a[8:9], v236 offset:28672
 v_mfma_f32_16x16x32_bf16 v[216:219], a[36:39], a[160:163], v[216:219]
 v_mfma_f32_16x16x32_bf16 v[212:215], a[36:39], a[156:159], v[212:215]
 ds_read_b64_tr_b16 a[10:11], v236 offset:32256
 v_mfma_f32_16x16x32_bf16 v[208:211], a[36:39], a[152:155], v[208:211]
 s_waitcnt vmcnt(11) lgkmcnt(12)
 v_mfma_f32_16x16x32_bf16 v[96:99], a[40:43], a[168:171], v[96:99]
 ds_read_b64_tr_b16 a[12:13], v236 offset:43008
 s_waitcnt vmcnt(10)
 v_mfma_f32_16x16x32_bf16 v[100:103], a[40:43], a[172:175], v[100:103]
 s_waitcnt vmcnt(9)
 v_mfma_f32_16x16x32_bf16 v[104:107], a[40:43], a[176:179], v[104:107]
 ds_read_b64_tr_b16 a[14:15], v236 offset:46592
 s_waitcnt vmcnt(8)
 v_mfma_f32_16x16x32_bf16 v[108:111], a[40:43], a[180:183], v[108:111]
 s_waitcnt lgkmcnt(12)
 v_mfma_f32_16x16x32_bf16 v[220:223], a[44:47], a[180:183], v[220:223]
 ds_read_b64_tr_b16 a[16:17], v236 offset:35840
 v_mfma_f32_16x16x32_bf16 v[216:219], a[44:47], a[176:179], v[216:219]
 v_mfma_f32_16x16x32_bf16 v[212:215], a[44:47], a[172:175], v[212:215]
 ds_read_b64_tr_b16 a[18:19], v236 offset:39424
 v_mfma_f32_16x16x32_bf16 v[208:211], a[44:47], a[168:171], v[208:211]
 v_mfma_f32_16x16x16_bf16 v[96:99], a[216:217], a[184:185], v[96:99]
 v_mfma_f32_16x16x16_bf16 v[100:103], a[216:217], a[186:187], v[100:103]
 v_mfma_f32_16x16x16_bf16 v[104:107], a[216:217], a[188:189], v[104:107]
 v_mfma_f32_16x16x16_bf16 v[108:111], a[216:217], a[190:191], v[108:111]
 s_nop 1
 v_mfma_f32_16x16x16_bf16 v[208:211], a[218:219], a[184:185], v[208:211]
 v_mfma_f32_16x16x16_bf16 v[212:215], a[218:219], a[186:187], v[212:215]
 v_mfma_f32_16x16x16_bf16 v[216:219], a[218:219], a[188:189], v[216:219]
 v_mfma_f32_16x16x16_bf16 v[220:223], a[218:219], a[190:191], v[220:223]
 s_waitcnt lgkmcnt(12)
 v_mfma_f32_16x16x32_bf16 v[0:3], a[48:51], a[88:91], v[0:3]
 ds_read_b64_tr_b16 a[20:21], v236 offset:50176
 v_mfma_f32_16x16x32_bf16 v[4:7], a[48:51], a[92:95], v[4:7]
 buffer_load_dwordx4 v239, s[52:55], s56 offen lds
 v_mfma_f32_16x16x32_bf16 v[8:11], a[48:51], a[96:99], v[8:11]
 ds_read_b64_tr_b16 a[22:23], v236 offset:53760
 v_mfma_f32_16x16x32_bf16 v[12:15], a[48:51], a[100:103], v[12:15]
 v_mul_f32 v96, v248, v96
 v_mul_f32 v97, v248, v97
 v_mul_f32 v98, v248, v98
 s_waitcnt lgkmcnt(12)
 v_mfma_f32_16x16x32_bf16 v[124:127], a[52:55], a[100:103], v[124:127]
 ds_read_b64_tr_b16 a[24:25], v237 offset:0
 v_mul_f32 v99, v248, v99
 v_mul_f32 v100, v249, v100
 v_mfma_f32_16x16x32_bf16 v[120:123], a[52:55], a[96:99], v[120:123]
 buffer_load_dwordx4 v240, s[52:55], s56 offen offset:1024 lds
 v_mul_f32 v101, v249, v101
 v_mul_f32 v102, v249, v102
 v_mfma_f32_16x16x32_bf16 v[116:119], a[52:55], a[92:95], v[116:119]
 ds_read_b64_tr_b16 a[26:27], v237 offset:3584
 v_mul_f32 v103, v249, v103
 v_exp_f32 v96, v96
 v_mfma_f32_16x16x32_bf16 v[112:115], a[52:55], a[88:91], v[112:115]
 v_mul_f32 v104, v250, v104
 v_exp_f32 v97, v97
 s_waitcnt lgkmcnt(12)
 v_mfma_f32_16x16x32_bf16 v[0:3], a[0:3], a[104:107], v[0:3]
 ds_read_b64_tr_b16 a[28:29], v237 offset:14336
 v_mul_f32 v105, v250, v105
 v_exp_f32 v98, v98
 v_mfma_f32_16x16x32_bf16 v[4:7], a[0:3], a[108:111], v[4:7]
 buffer_load_dwordx4 v241, s[52:55], s56 offen offset:2048 lds
 v_mul_f32 v106, v250, v106
 v_exp_f32 v99, v99
 v_mfma_f32_16x16x32_bf16 v[8:11], a[0:3], a[112:115], v[8:11]
 ds_read_b64_tr_b16 a[30:31], v237 offset:17920
 v_mul_f32 v107, v250, v107
 v_exp_f32 v100, v100
 v_mfma_f32_16x16x32_bf16 v[12:15], a[0:3], a[116:119], v[12:15]
 v_mul_f32 v108, v251, v108
 v_exp_f32 v101, v101
 s_waitcnt lgkmcnt(12)
 v_mfma_f32_16x16x32_bf16 v[124:127], a[4:7], a[116:119], v[124:127]
 ds_read_b64_tr_b16 a[32:33], v237 offset:7168
 v_mul_f32 v109, v251, v109
 v_exp_f32 v102, v102
 v_mfma_f32_16x16x32_bf16 v[120:123], a[4:7], a[112:115], v[120:123]
 buffer_load_dwordx4 v242, s[52:55], s56 offen offset:3072 lds
 s_add_u32 m0, s57, 114688
 v_readlane_b32 s56, v246, 3
 v_mul_f32 v110, v251, v110
 v_exp_f32 v103, v103
 v_mfma_f32_16x16x32_bf16 v[116:119], a[4:7], a[108:111], v[116:119]
 ds_read_b64_tr_b16 a[34:35], v237 offset:10752
 v_mul_f32 v111, v251, v111
 v_exp_f32 v104, v104
 v_mfma_f32_16x16x32_bf16 v[112:115], a[4:7], a[104:107], v[112:115]
 v_fma_f32 v96, v96, v252, v252
 v_exp_f32 v105, v105
 s_waitcnt lgkmcnt(12)
 v_mfma_f32_16x16x32_bf16 v[0:3], a[8:11], a[120:123], v[0:3]
 ds_read_b64_tr_b16 a[36:37], v237 offset:21504
 v_fma_f32 v97, v97, v252, v252
 v_exp_f32 v106, v106
 v_mfma_f32_16x16x32_bf16 v[4:7], a[8:11], a[124:127], v[4:7]
 buffer_load_dwordx4 v239, s[52:55], s56 offen lds
 v_fma_f32 v98, v98, v252, v252
 v_exp_f32 v107, v107
 v_mfma_f32_16x16x32_bf16 v[8:11], a[8:11], a[128:131], v[8:11]
 ds_read_b64_tr_b16 a[38:39], v237 offset:25088
 v_fma_f32 v99, v99, v252, v252
 v_exp_f32 v108, v108
 v_mfma_f32_16x16x32_bf16 v[12:15], a[8:11], a[132:135], v[12:15]
 v_fma_f32 v100, v100, v253, v253
 v_exp_f32 v109, v109
 s_waitcnt lgkmcnt(12)
 v_mfma_f32_16x16x32_bf16 v[124:127], a[12:15], a[132:135], v[124:127]
 ds_read_b64_tr_b16 a[40:41], v236 offset:32
 v_fma_f32 v101, v101, v253, v253
 v_exp_f32 v110, v110
 v_mfma_f32_16x16x32_bf16 v[120:123], a[12:15], a[128:131], v[120:123]
 buffer_load_dwordx4 v240, s[52:55], s56 offen offset:1024 lds
 v_fma_f32 v102, v102, v253, v253
 v_exp_f32 v111, v111
 v_mfma_f32_16x16x32_bf16 v[116:119], a[12:15], a[124:127], v[116:119]
 ds_read_b64_tr_b16 a[42:43], v236 offset:3616
 v_fma_f32 v103, v103, v253, v253
 v_rcp_f32 v96, v96
 v_mfma_f32_16x16x32_bf16 v[112:115], a[12:15], a[120:123], v[112:115]
 v_fma_f32 v104, v104, v254, v254
 v_rcp_f32 v97, v97
 s_waitcnt lgkmcnt(12)
 v_mfma_f32_16x16x32_bf16 v[0:3], a[16:19], a[136:139], v[0:3]
 ds_read_b64_tr_b16 a[44:45], v236 offset:14368
 v_fma_f32 v105, v105, v254, v254
 v_rcp_f32 v98, v98
 v_mfma_f32_16x16x32_bf16 v[4:7], a[16:19], a[140:143], v[4:7]
 buffer_load_dwordx4 v241, s[52:55], s56 offen offset:2048 lds
 v_fma_f32 v106, v106, v254, v254
 v_rcp_f32 v99, v99
 v_fma_f32 v107, v107, v254, v254
 v_mfma_f32_16x16x32_bf16 v[8:11], a[16:19], a[144:147], v[8:11]
 ds_read_b64_tr_b16 a[46:47], v236 offset:17952
 v_rcp_f32 v100, v100
 v_fma_f32 v108, v108, v255, v255
 v_mfma_f32_16x16x32_bf16 v[12:15], a[16:19], a[148:151], v[12:15]
 v_rcp_f32 v101, v101
 v_fma_f32 v109, v109, v255, v255
 s_waitcnt lgkmcnt(12)
 v_mfma_f32_16x16x32_bf16 v[124:127], a[20:23], a[148:151], v[124:127]
 ds_read_b64_tr_b16 a[48:49], v236 offset:7200
 v_rcp_f32 v102, v102
 v_fma_f32 v110, v110, v255, v255
 v_mfma_f32_16x16x32_bf16 v[120:123], a[20:23], a[144:147], v[120:123]
 buffer_load_dwordx4 v242, s[52:55], s56 offen offset:3072 lds
 s_add_u32 m0, s57, 49152
 v_readlane_b32 s56, v246, 4
 v_rcp_f32 v103, v103
 v_fma_f32 v111, v111, v255, v255
 v_mfma_f32_16x16x32_bf16 v[116:119], a[20:23], a[140:143], v[116:119]
 ds_read_b64_tr_b16 a[50:51], v236 offset:10784
 v_rcp_f32 v104, v104
 v_mul_f32 v96, v96, v208
 v_mfma_f32_16x16x32_bf16 v[112:115], a[20:23], a[136:139], v[112:115]
 v_rcp_f32 v105, v105
 v_mul_f32 v97, v97, v209
 s_waitcnt lgkmcnt(12)
 v_mfma_f32_16x16x32_bf16 v[0:3], a[24:27], a[152:155], v[0:3]
 ds_read_b64_tr_b16 a[52:53], v236 offset:21536
 v_rcp_f32 v106, v106
 v_mul_f32 v98, v98, v210
 v_mfma_f32_16x16x32_bf16 v[4:7], a[24:27], a[156:159], v[4:7]
 v_rcp_f32 v107, v107
 v_mul_f32 v99, v99, v211
 v_mfma_f32_16x16x32_bf16 v[8:11], a[24:27], a[160:163], v[8:11]
 ds_read_b64_tr_b16 a[54:55], v236 offset:25120
 v_rcp_f32 v108, v108
 v_mul_f32 v100, v100, v212
 v_mfma_f32_16x16x32_bf16 v[12:15], a[24:27], a[164:167], v[12:15]
 v_rcp_f32 v109, v109
 v_mul_f32 v101, v101, v213
 s_waitcnt lgkmcnt(12)
 v_mfma_f32_16x16x32_bf16 v[124:127], a[28:31], a[164:167], v[124:127]
 ds_read_b64_tr_b16 a[0:1], v236 offset:28704
 v_rcp_f32 v110, v110
 v_mul_f32 v102, v102, v214
 v_mfma_f32_16x16x32_bf16 v[120:123], a[28:31], a[160:163], v[120:123]
 v_rcp_f32 v111, v111
 v_mul_f32 v103, v103, v215
 v_mfma_f32_16x16x32_bf16 v[116:119], a[28:31], a[156:159], v[116:119]
 ds_read_b64_tr_b16 a[2:3], v236 offset:32288
 v_cvt_pk_bf16_f32 v208, v96, v97
 v_cvt_pk_bf16_f32 v209, v98, v99
 v_mfma_f32_16x16x32_bf16 v[112:115], a[28:31], a[152:155], v[112:115]
 buffer_store_dwordx2 v[208:209], v224, s[28:31], s46 offen sc1
 v_cvt_pk_bf16_f32 v212, v100, v101
 s_waitcnt lgkmcnt(12)
 v_mfma_f32_16x16x32_bf16 v[0:3], a[32:35], a[168:171], v[0:3]
 ds_read_b64_tr_b16 a[4:5], v236 offset:43040
 v_cvt_pk_bf16_f32 v213, v102, v103
 buffer_store_dwordx2 v[212:213], v225, s[28:31], s46 offen sc1
 v_mfma_f32_16x16x32_bf16 v[4:7], a[32:35], a[172:175], v[4:7]
 v_mul_f32 v104, v104, v216
 v_mul_f32 v105, v105, v217
 v_mfma_f32_16x16x32_bf16 v[8:11], a[32:35], a[176:179], v[8:11]
 ds_read_b64_tr_b16 a[6:7], v236 offset:46624
 v_mul_f32 v106, v106, v218
 v_mul_f32 v107, v107, v219
 v_mfma_f32_16x16x32_bf16 v[12:15], a[32:35], a[180:183], v[12:15]
 v_mul_f32 v108, v108, v220
 v_mul_f32 v109, v109, v221
 s_waitcnt lgkmcnt(12)
 v_mfma_f32_16x16x32_bf16 v[124:127], a[36:39], a[180:183], v[124:127]
 ds_read_b64_tr_b16 a[8:9], v236 offset:35872
 v_mul_f32 v110, v110, v222
 v_mul_f32 v111, v111, v223
 v_mfma_f32_16x16x32_bf16 v[120:123], a[36:39], a[176:179], v[120:123]
 v_cvt_pk_bf16_f32 v216, v104, v105
 v_cvt_pk_bf16_f32 v217, v106, v107
 v_mfma_f32_16x16x32_bf16 v[116:119], a[36:39], a[172:175], v[116:119]
 ds_read_b64_tr_b16 a[10:11], v236 offset:39456
 buffer_store_dwordx2 v[216:217], v226, s[28:31], s46 offen sc1
 v_cvt_pk_bf16_f32 v220, v108, v109
 v_mfma_f32_16x16x32_bf16 v[112:115], a[36:39], a[168:171], v[112:115]
 v_cvt_pk_bf16_f32 v221, v110, v111
 buffer_store_dwordx2 v[220:221], v227, s[28:31], s46 offen sc1
 v_mfma_f32_16x16x16_bf16 v[0:3], a[192:193], a[184:185], v[0:3]
 v_mfma_f32_16x16x16_bf16 v[4:7], a[192:193], a[186:187], v[4:7]
 v_mfma_f32_16x16x16_bf16 v[8:11], a[192:193], a[188:189], v[8:11]
 v_mfma_f32_16x16x16_bf16 v[12:15], a[192:193], a[190:191], v[12:15]
 v_mfma_f32_16x16x16_bf16 v[112:115], a[194:195], a[184:185], v[112:115]
 v_mfma_f32_16x16x16_bf16 v[116:119], a[194:195], a[186:187], v[116:119]
 v_mfma_f32_16x16x16_bf16 v[120:123], a[194:195], a[188:189], v[120:123]
 v_mfma_f32_16x16x16_bf16 v[124:127], a[194:195], a[190:191], v[124:127]
 s_waitcnt lgkmcnt(12)
 v_mfma_f32_16x16x32_bf16 v[16:19], a[40:43], a[88:91], v[16:19]
 ds_read_b64_tr_b16 a[12:13], v236 offset:50208
 v_mfma_f32_16x16x32_bf16 v[20:23], a[40:43], a[92:95], v[20:23]
 v_mfma_f32_16x16x32_bf16 v[24:27], a[40:43], a[96:99], v[24:27]
 ds_read_b64_tr_b16 a[14:15], v236 offset:53792
 v_mfma_f32_16x16x32_bf16 v[28:31], a[40:43], a[100:103], v[28:31]
 v_mul_f32 v0, v248, v0
 v_mul_f32 v1, v248, v1
 s_waitcnt lgkmcnt(12)
 v_mfma_f32_16x16x32_bf16 v[140:143], a[44:47], a[100:103], v[140:143]
 ds_read_b64_tr_b16 a[16:17], v237 offset:32
 v_mul_f32 v2, v248, v2
 v_mul_f32 v3, v248, v3
 v_mfma_f32_16x16x32_bf16 v[136:139], a[44:47], a[96:99], v[136:139]
 v_mul_f32 v4, v249, v4
 v_mul_f32 v5, v249, v5
 v_mfma_f32_16x16x32_bf16 v[132:135], a[44:47], a[92:95], v[132:135]
 ds_read_b64_tr_b16 a[18:19], v237 offset:3616
 v_mul_f32 v6, v249, v6
 v_mul_f32 v7, v249, v7
 v_mfma_f32_16x16x32_bf16 v[128:131], a[44:47], a[88:91], v[128:131]
 v_exp_f32 v0, v0
 v_mul_f32 v8, v250, v8
 s_waitcnt lgkmcnt(12)
 v_mfma_f32_16x16x32_bf16 v[16:19], a[48:51], a[104:107], v[16:19]
 ds_read_b64_tr_b16 a[20:21], v237 offset:14368
 v_exp_f32 v1, v1
 v_mul_f32 v9, v250, v9
 v_mfma_f32_16x16x32_bf16 v[20:23], a[48:51], a[108:111], v[20:23]
 v_exp_f32 v2, v2
 v_mul_f32 v10, v250, v10
 v_mfma_f32_16x16x32_bf16 v[24:27], a[48:51], a[112:115], v[24:27]
 ds_read_b64_tr_b16 a[22:23], v237 offset:17952
 v_exp_f32 v3, v3
 v_mul_f32 v11, v250, v11
 v_mfma_f32_16x16x32_bf16 v[28:31], a[48:51], a[116:119], v[28:31]
 v_exp_f32 v4, v4
 v_mul_f32 v12, v251, v12
 s_waitcnt lgkmcnt(12)
 v_mfma_f32_16x16x32_bf16 v[140:143], a[52:55], a[116:119], v[140:143]
 ds_read_b64_tr_b16 a[24:25], v237 offset:7200
 v_exp_f32 v5, v5
 v_mul_f32 v13, v251, v13
 v_mfma_f32_16x16x32_bf16 v[136:139], a[52:55], a[112:115], v[136:139]
 v_exp_f32 v6, v6
 v_mul_f32 v14, v251, v14
 v_mfma_f32_16x16x32_bf16 v[132:135], a[52:55], a[108:111], v[132:135]
 ds_read_b64_tr_b16 a[26:27], v237 offset:10784
 v_exp_f32 v7, v7
 v_mul_f32 v15, v251, v15
 v_mfma_f32_16x16x32_bf16 v[128:131], a[52:55], a[104:107], v[128:131]
 v_exp_f32 v8, v8
 v_fma_f32 v0, v0, v252, v252
 s_waitcnt lgkmcnt(12)
 v_mfma_f32_16x16x32_bf16 v[16:19], a[0:3], a[120:123], v[16:19]
 ds_read_b64_tr_b16 a[28:29], v237 offset:21536
 v_exp_f32 v9, v9
 v_fma_f32 v1, v1, v252, v252
 v_mfma_f32_16x16x32_bf16 v[20:23], a[0:3], a[124:127], v[20:23]
 v_exp_f32 v10, v10
 v_fma_f32 v2, v2, v252, v252
 v_mfma_f32_16x16x32_bf16 v[24:27], a[0:3], a[128:131], v[24:27]
 ds_read_b64_tr_b16 a[30:31], v237 offset:25120
 v_exp_f32 v11, v11
 v_fma_f32 v3, v3, v252, v252
 v_mfma_f32_16x16x32_bf16 v[28:31], a[0:3], a[132:135], v[28:31]
 v_exp_f32 v12, v12
 v_fma_f32 v4, v4, v253, v253
 s_waitcnt lgkmcnt(12)
 v_mfma_f32_16x16x32_bf16 v[140:143], a[4:7], a[132:135], v[140:143]
 ds_read_b64_tr_b16 a[32:33], v236 offset:64
 v_exp_f32 v13, v13
 v_fma_f32 v5, v5, v253, v253
 v_mfma_f32_16x16x32_bf16 v[136:139], a[4:7], a[128:131], v[136:139]
 v_exp_f32 v14, v14
 v_fma_f32 v6, v6, v253, v253
 v_mfma_f32_16x16x32_bf16 v[132:135], a[4:7], a[124:127], v[132:135]
 ds_read_b64_tr_b16 a[34:35], v236 offset:3648
 v_exp_f32 v15, v15
 v_fma_f32 v7, v7, v253, v253
 v_mfma_f32_16x16x32_bf16 v[128:131], a[4:7], a[120:123], v[128:131]
 v_rcp_f32 v0, v0
 v_fma_f32 v8, v8, v254, v254
 s_waitcnt lgkmcnt(12)
 v_mfma_f32_16x16x32_bf16 v[16:19], a[8:11], a[136:139], v[16:19]
 ds_read_b64_tr_b16 a[36:37], v236 offset:14400
 v_rcp_f32 v1, v1
 v_fma_f32 v9, v9, v254, v254
 v_mfma_f32_16x16x32_bf16 v[20:23], a[8:11], a[140:143], v[20:23]
 v_rcp_f32 v2, v2
 v_mfma_f32_16x16x32_bf16 v[24:27], a[8:11], a[144:147], v[24:27]
 ds_read_b64_tr_b16 a[38:39], v236 offset:17984
 v_fma_f32 v10, v10, v254, v254
 v_rcp_f32 v3, v3
 v_mfma_f32_16x16x32_bf16 v[28:31], a[8:11], a[148:151], v[28:31]
 v_fma_f32 v11, v11, v254, v254
 v_rcp_f32 v4, v4
 s_waitcnt lgkmcnt(12)
 v_mfma_f32_16x16x32_bf16 v[140:143], a[12:15], a[148:151], v[140:143]
 ds_read_b64_tr_b16 a[40:41], v236 offset:7232
 v_fma_f32 v12, v12, v255, v255
 v_rcp_f32 v5, v5
 v_mfma_f32_16x16x32_bf16 v[136:139], a[12:15], a[144:147], v[136:139]
 v_fma_f32 v13, v13, v255, v255
 v_rcp_f32 v6, v6
 v_mfma_f32_16x16x32_bf16 v[132:135], a[12:15], a[140:143], v[132:135]
 ds_read_b64_tr_b16 a[42:43], v236 offset:10816
 v_fma_f32 v14, v14, v255, v255
 v_rcp_f32 v7, v7
 v_mfma_f32_16x16x32_bf16 v[128:131], a[12:15], a[136:139], v[128:131]
 v_fma_f32 v15, v15, v255, v255
 v_rcp_f32 v8, v8
 s_waitcnt lgkmcnt(12)
 v_mfma_f32_16x16x32_bf16 v[16:19], a[16:19], a[152:155], v[16:19]
 ds_read_b64_tr_b16 a[44:45], v236 offset:21568
 v_mul_f32 v0, v0, v112
 v_rcp_f32 v9, v9
 v_mfma_f32_16x16x32_bf16 v[20:23], a[16:19], a[156:159], v[20:23]
 v_mul_f32 v1, v1, v113
 v_rcp_f32 v10, v10
 v_mfma_f32_16x16x32_bf16 v[24:27], a[16:19], a[160:163], v[24:27]
 ds_read_b64_tr_b16 a[46:47], v236 offset:25152
 v_mul_f32 v2, v2, v114
 v_rcp_f32 v11, v11
 v_mfma_f32_16x16x32_bf16 v[28:31], a[16:19], a[164:167], v[28:31]
 v_mul_f32 v3, v3, v115
 v_rcp_f32 v12, v12
 s_waitcnt lgkmcnt(12)
 v_mfma_f32_16x16x32_bf16 v[140:143], a[20:23], a[164:167], v[140:143]
 ds_read_b64_tr_b16 a[48:49], v236 offset:28736
 v_mul_f32 v4, v4, v116
 v_rcp_f32 v13, v13
 v_mfma_f32_16x16x32_bf16 v[136:139], a[20:23], a[160:163], v[136:139]
 v_mul_f32 v5, v5, v117
 v_rcp_f32 v14, v14
 v_mfma_f32_16x16x32_bf16 v[132:135], a[20:23], a[156:159], v[132:135]
 ds_read_b64_tr_b16 a[50:51], v236 offset:32320
 v_mul_f32 v6, v6, v118
 v_rcp_f32 v15, v15
 v_mfma_f32_16x16x32_bf16 v[128:131], a[20:23], a[152:155], v[128:131]
 v_mul_f32 v7, v7, v119
 v_cvt_pk_bf16_f32 v112, v0, v1
 s_waitcnt lgkmcnt(12)
 v_mfma_f32_16x16x32_bf16 v[16:19], a[24:27], a[168:171], v[16:19]
 ds_read_b64_tr_b16 a[52:53], v236 offset:43072
 v_cvt_pk_bf16_f32 v113, v2, v3
 v_cvt_pk_bf16_f32 v116, v4, v5
 v_mfma_f32_16x16x32_bf16 v[20:23], a[24:27], a[172:175], v[20:23]
 v_cvt_pk_bf16_f32 v117, v6, v7
 v_mul_f32 v8, v8, v120
 v_mfma_f32_16x16x32_bf16 v[24:27], a[24:27], a[176:179], v[24:27]
 ds_read_b64_tr_b16 a[54:55], v236 offset:46656
 v_mul_f32 v9, v9, v121
 v_mul_f32 v10, v10, v122
 v_mfma_f32_16x16x32_bf16 v[28:31], a[24:27], a[180:183], v[28:31]
 v_mul_f32 v11, v11, v123
 v_mul_f32 v12, v12, v124
 s_waitcnt lgkmcnt(12)
 v_mfma_f32_16x16x32_bf16 v[140:143], a[28:31], a[180:183], v[140:143]
 ds_read_b64_tr_b16 a[0:1], v236 offset:35904
 v_mul_f32 v13, v13, v125
 v_mul_f32 v14, v14, v126
 v_mfma_f32_16x16x32_bf16 v[136:139], a[28:31], a[176:179], v[136:139]
 v_mul_f32 v15, v15, v127
 v_cvt_pk_bf16_f32 v120, v8, v9
 v_mfma_f32_16x16x32_bf16 v[132:135], a[28:31], a[172:175], v[132:135]
 ds_read_b64_tr_b16 a[2:3], v236 offset:39488
 v_cvt_pk_bf16_f32 v121, v10, v11
 v_cvt_pk_bf16_f32 v124, v12, v13
 v_mfma_f32_16x16x32_bf16 v[128:131], a[28:31], a[168:171], v[128:131]
 v_cvt_pk_bf16_f32 v125, v14, v15
 v_mfma_f32_16x16x16_bf16 v[16:19], a[196:197], a[184:185], v[16:19]
 v_mfma_f32_16x16x16_bf16 v[20:23], a[196:197], a[186:187], v[20:23]
 v_mfma_f32_16x16x16_bf16 v[24:27], a[196:197], a[188:189], v[24:27]
 v_mfma_f32_16x16x16_bf16 v[28:31], a[196:197], a[190:191], v[28:31]
 s_nop 0
 v_mfma_f32_16x16x16_bf16 v[128:131], a[198:199], a[184:185], v[128:131]
 v_mfma_f32_16x16x16_bf16 v[132:135], a[198:199], a[186:187], v[132:135]
 v_mfma_f32_16x16x16_bf16 v[136:139], a[198:199], a[188:189], v[136:139]
 v_mfma_f32_16x16x16_bf16 v[140:143], a[198:199], a[190:191], v[140:143]
 s_waitcnt lgkmcnt(12)
 v_mfma_f32_16x16x32_bf16 v[32:35], a[32:35], a[88:91], v[32:35]
 ds_read_b64_tr_b16 a[4:5], v236 offset:50240
 v_mfma_f32_16x16x32_bf16 v[36:39], a[32:35], a[92:95], v[36:39]
 v_mfma_f32_16x16x32_bf16 v[40:43], a[32:35], a[96:99], v[40:43]
 ds_read_b64_tr_b16 a[6:7], v236 offset:53824
 v_mfma_f32_16x16x32_bf16 v[44:47], a[32:35], a[100:103], v[44:47]
 v_mul_f32 v16, v248, v16
 v_mul_f32 v17, v248, v17
 v_mul_f32 v18, v248, v18
 s_waitcnt lgkmcnt(12)
 v_mfma_f32_16x16x32_bf16 v[156:159], a[36:39], a[100:103], v[156:159]
 ds_read_b64_tr_b16 a[8:9], v237 offset:64
 v_mul_f32 v19, v248, v19
 v_mul_f32 v20, v249, v20
 v_mfma_f32_16x16x32_bf16 v[152:155], a[36:39], a[96:99], v[152:155]
 v_mul_f32 v21, v249, v21
 v_mul_f32 v22, v249, v22
 v_mfma_f32_16x16x32_bf16 v[148:151], a[36:39], a[92:95], v[148:151]
 ds_read_b64_tr_b16 a[10:11], v237 offset:3648
 v_mul_f32 v23, v249, v23
 v_exp_f32 v16, v16
 v_mfma_f32_16x16x32_bf16 v[144:147], a[36:39], a[88:91], v[144:147]
 v_mul_f32 v24, v250, v24
 v_exp_f32 v17, v17
 s_waitcnt lgkmcnt(12)
 v_mfma_f32_16x16x32_bf16 v[32:35], a[40:43], a[104:107], v[32:35]
 ds_read_b64_tr_b16 a[12:13], v237 offset:14400
 v_mul_f32 v25, v250, v25
 v_exp_f32 v18, v18
 v_mfma_f32_16x16x32_bf16 v[36:39], a[40:43], a[108:111], v[36:39]
 v_mul_f32 v26, v250, v26
 v_exp_f32 v19, v19
 v_mfma_f32_16x16x32_bf16 v[40:43], a[40:43], a[112:115], v[40:43]
 ds_read_b64_tr_b16 a[14:15], v237 offset:17984
 v_mul_f32 v27, v250, v27
 v_exp_f32 v20, v20
 v_mfma_f32_16x16x32_bf16 v[44:47], a[40:43], a[116:119], v[44:47]
 v_mul_f32 v28, v251, v28
 v_exp_f32 v21, v21
 s_waitcnt lgkmcnt(12)
 v_mfma_f32_16x16x32_bf16 v[156:159], a[44:47], a[116:119], v[156:159]
 ds_read_b64_tr_b16 a[16:17], v237 offset:7232
 v_mul_f32 v29, v251, v29
 v_exp_f32 v22, v22
 v_mfma_f32_16x16x32_bf16 v[152:155], a[44:47], a[112:115], v[152:155]
 v_mul_f32 v30, v251, v30
 v_exp_f32 v23, v23
 v_mfma_f32_16x16x32_bf16 v[148:151], a[44:47], a[108:111], v[148:151]
 ds_read_b64_tr_b16 a[18:19], v237 offset:10816
 v_mul_f32 v31, v251, v31
 v_exp_f32 v24, v24
 v_mfma_f32_16x16x32_bf16 v[144:147], a[44:47], a[104:107], v[144:147]
 v_fma_f32 v16, v16, v252, v252
 v_exp_f32 v25, v25
 s_waitcnt lgkmcnt(12)
 v_mfma_f32_16x16x32_bf16 v[32:35], a[48:51], a[120:123], v[32:35]
 ds_read_b64_tr_b16 a[20:21], v237 offset:21568
 v_fma_f32 v17, v17, v252, v252
 v_exp_f32 v26, v26
 v_mfma_f32_16x16x32_bf16 v[36:39], a[48:51], a[124:127], v[36:39]
 v_fma_f32 v18, v18, v252, v252
 v_exp_f32 v27, v27
 v_mfma_f32_16x16x32_bf16 v[40:43], a[48:51], a[128:131], v[40:43]
 ds_read_b64_tr_b16 a[22:23], v237 offset:25152
 v_fma_f32 v19, v19, v252, v252
 v_exp_f32 v28, v28
 v_mfma_f32_16x16x32_bf16 v[44:47], a[48:51], a[132:135], v[44:47]
 v_fma_f32 v20, v20, v253, v253
 v_exp_f32 v29, v29
 s_waitcnt lgkmcnt(12)
 v_mfma_f32_16x16x32_bf16 v[156:159], a[52:55], a[132:135], v[156:159]
 ds_read_b64_tr_b16 a[24:25], v236 offset:96
 v_fma_f32 v21, v21, v253, v253
 v_exp_f32 v30, v30
 v_mfma_f32_16x16x32_bf16 v[152:155], a[52:55], a[128:131], v[152:155]
 v_fma_f32 v22, v22, v253, v253
 v_exp_f32 v31, v31
 v_mfma_f32_16x16x32_bf16 v[148:151], a[52:55], a[124:127], v[148:151]
 ds_read_b64_tr_b16 a[26:27], v236 offset:3680
 v_fma_f32 v23, v23, v253, v253
 v_rcp_f32 v16, v16
 v_mfma_f32_16x16x32_bf16 v[144:147], a[52:55], a[120:123], v[144:147]
 v_fma_f32 v24, v24, v254, v254
 v_rcp_f32 v17, v17
 s_waitcnt lgkmcnt(12)
 v_mfma_f32_16x16x32_bf16 v[32:35], a[0:3], a[136:139], v[32:35]
 ds_read_b64_tr_b16 a[28:29], v236 offset:14432
 v_fma_f32 v25, v25, v254, v254
 v_rcp_f32 v18, v18
 v_mfma_f32_16x16x32_bf16 v[36:39], a[0:3], a[140:143], v[36:39]
 v_fma_f32 v26, v26, v254, v254
 v_rcp_f32 v19, v19
 v_fma_f32 v27, v27, v254, v254
 v_mfma_f32_16x16x32_bf16 v[40:43], a[0:3], a[144:147], v[40:43]
 ds_read_b64_tr_b16 a[30:31], v236 offset:18016
 v_rcp_f32 v20, v20
 v_fma_f32 v28, v28, v255, v255
 v_mfma_f32_16x16x32_bf16 v[44:47], a[0:3], a[148:151], v[44:47]
 v_rcp_f32 v21, v21
 v_fma_f32 v29, v29, v255, v255
 s_waitcnt lgkmcnt(12)
 v_mfma_f32_16x16x32_bf16 v[156:159], a[4:7], a[148:151], v[156:159]
 ds_read_b64_tr_b16 a[32:33], v236 offset:7264
 v_rcp_f32 v22, v22
 v_fma_f32 v30, v30, v255, v255
 v_mfma_f32_16x16x32_bf16 v[152:155], a[4:7], a[144:147], v[152:155]
 v_rcp_f32 v23, v23
 v_fma_f32 v31, v31, v255, v255
 v_mfma_f32_16x16x32_bf16 v[148:151], a[4:7], a[140:143], v[148:151]
 ds_read_b64_tr_b16 a[34:35], v236 offset:10848
 v_rcp_f32 v24, v24
 v_mul_f32 v16, v16, v128
 v_mfma_f32_16x16x32_bf16 v[144:147], a[4:7], a[136:139], v[144:147]
 v_rcp_f32 v25, v25
 v_mul_f32 v17, v17, v129
 s_waitcnt lgkmcnt(12)
 v_mfma_f32_16x16x32_bf16 v[32:35], a[8:11], a[152:155], v[32:35]
 ds_read_b64_tr_b16 a[36:37], v236 offset:21600
 v_rcp_f32 v26, v26
 v_mul_f32 v18, v18, v130
 v_mfma_f32_16x16x32_bf16 v[36:39], a[8:11], a[156:159], v[36:39]
 v_rcp_f32 v27, v27
 v_mul_f32 v19, v19, v131
 v_mfma_f32_16x16x32_bf16 v[40:43], a[8:11], a[160:163], v[40:43]
 ds_read_b64_tr_b16 a[38:39], v236 offset:25184
 v_rcp_f32 v28, v28
 v_mul_f32 v20, v20, v132
 v_mfma_f32_16x16x32_bf16 v[44:47], a[8:11], a[164:167], v[44:47]
 v_rcp_f32 v29, v29
 v_mul_f32 v21, v21, v133
 s_waitcnt lgkmcnt(12)
 v_mfma_f32_16x16x32_bf16 v[156:159], a[12:15], a[164:167], v[156:159]
 ds_read_b64_tr_b16 a[40:41], v236 offset:28768
 v_rcp_f32 v30, v30
 v_mul_f32 v22, v22, v134
 v_mfma_f32_16x16x32_bf16 v[152:155], a[12:15], a[160:163], v[152:155]
 v_rcp_f32 v31, v31
 v_mul_f32 v23, v23, v135
 v_mfma_f32_16x16x32_bf16 v[148:151], a[12:15], a[156:159], v[148:151]
 ds_read_b64_tr_b16 a[42:43], v236 offset:32352
 v_cvt_pk_bf16_f32 v114, v16, v17
 v_cvt_pk_bf16_f32 v115, v18, v19
 v_mfma_f32_16x16x32_bf16 v[144:147], a[12:15], a[152:155], v[144:147]
 buffer_store_dwordx4 v[112:115], v224, s[28:31], s44 offen offset:0 sc1
 v_cvt_pk_bf16_f32 v118, v20, v21
 s_waitcnt lgkmcnt(12)
 v_mfma_f32_16x16x32_bf16 v[32:35], a[16:19], a[168:171], v[32:35]
 ds_read_b64_tr_b16 a[44:45], v236 offset:43104
 v_cvt_pk_bf16_f32 v119, v22, v23
 buffer_store_dwordx4 v[116:119], v225, s[28:31], s44 offen offset:0 sc1
 v_mfma_f32_16x16x32_bf16 v[36:39], a[16:19], a[172:175], v[36:39]
 v_mul_f32 v24, v24, v136
 v_mul_f32 v25, v25, v137
 v_mfma_f32_16x16x32_bf16 v[40:43], a[16:19], a[176:179], v[40:43]
 ds_read_b64_tr_b16 a[46:47], v236 offset:46688
 v_mul_f32 v26, v26, v138
 v_mul_f32 v27, v27, v139
 v_mfma_f32_16x16x32_bf16 v[44:47], a[16:19], a[180:183], v[44:47]
 v_mul_f32 v28, v28, v140
 v_mul_f32 v29, v29, v141
 s_waitcnt lgkmcnt(12)
 v_mfma_f32_16x16x32_bf16 v[156:159], a[20:23], a[180:183], v[156:159]
 ds_read_b64_tr_b16 a[48:49], v236 offset:35936
 v_mul_f32 v30, v30, v142
 v_mul_f32 v31, v31, v143
 v_mfma_f32_16x16x32_bf16 v[152:155], a[20:23], a[176:179], v[152:155]
 v_cvt_pk_bf16_f32 v122, v24, v25
 v_cvt_pk_bf16_f32 v123, v26, v27
 v_mfma_f32_16x16x32_bf16 v[148:151], a[20:23], a[172:175], v[148:151]
 ds_read_b64_tr_b16 a[50:51], v236 offset:39520
 buffer_store_dwordx4 v[120:123], v226, s[28:31], s44 offen offset:0 sc1
 v_cvt_pk_bf16_f32 v126, v28, v29
 v_mfma_f32_16x16x32_bf16 v[144:147], a[20:23], a[168:171], v[144:147]
 v_cvt_pk_bf16_f32 v127, v30, v31
 buffer_store_dwordx4 v[124:127], v227, s[28:31], s44 offen offset:0 sc1
 v_mfma_f32_16x16x16_bf16 v[32:35], a[200:201], a[184:185], v[32:35]
 v_mfma_f32_16x16x16_bf16 v[36:39], a[200:201], a[186:187], v[36:39]
 v_mfma_f32_16x16x16_bf16 v[40:43], a[200:201], a[188:189], v[40:43]
 v_mfma_f32_16x16x16_bf16 v[44:47], a[200:201], a[190:191], v[44:47]
 v_mfma_f32_16x16x16_bf16 v[144:147], a[202:203], a[184:185], v[144:147]
 v_mfma_f32_16x16x16_bf16 v[148:151], a[202:203], a[186:187], v[148:151]
 v_mfma_f32_16x16x16_bf16 v[152:155], a[202:203], a[188:189], v[152:155]
 v_mfma_f32_16x16x16_bf16 v[156:159], a[202:203], a[190:191], v[156:159]
 s_waitcnt lgkmcnt(12)
 v_mfma_f32_16x16x32_bf16 v[48:51], a[24:27], a[88:91], v[48:51]
 ds_read_b64_tr_b16 a[52:53], v236 offset:50272
 v_mfma_f32_16x16x32_bf16 v[52:55], a[24:27], a[92:95], v[52:55]
 v_mfma_f32_16x16x32_bf16 v[56:59], a[24:27], a[96:99], v[56:59]
 ds_read_b64_tr_b16 a[54:55], v236 offset:53856
 v_mfma_f32_16x16x32_bf16 v[60:63], a[24:27], a[100:103], v[60:63]
 v_mul_f32 v32, v248, v32
 v_mul_f32 v33, v248, v33
 s_waitcnt lgkmcnt(12)
 v_mfma_f32_16x16x32_bf16 v[172:175], a[28:31], a[100:103], v[172:175]
 ds_read_b64_tr_b16 a[0:1], v237 offset:96
 v_mul_f32 v34, v248, v34
 v_mul_f32 v35, v248, v35
 v_mfma_f32_16x16x32_bf16 v[168:171], a[28:31], a[96:99], v[168:171]
 v_mul_f32 v36, v249, v36
 v_mul_f32 v37, v249, v37
 v_mfma_f32_16x16x32_bf16 v[164:167], a[28:31], a[92:95], v[164:167]
 ds_read_b64_tr_b16 a[2:3], v237 offset:3680
 v_mul_f32 v38, v249, v38
 v_mul_f32 v39, v249, v39
 v_mfma_f32_16x16x32_bf16 v[160:163], a[28:31], a[88:91], v[160:163]
 v_exp_f32 v32, v32
 v_mul_f32 v40, v250, v40
 s_waitcnt lgkmcnt(12)
 v_mfma_f32_16x16x32_bf16 v[48:51], a[32:35], a[104:107], v[48:51]
 ds_read_b64_tr_b16 a[4:5], v237 offset:14432
 v_exp_f32 v33, v33
 v_mul_f32 v41, v250, v41
 v_mfma_f32_16x16x32_bf16 v[52:55], a[32:35], a[108:111], v[52:55]
 v_exp_f32 v34, v34
 v_mul_f32 v42, v250, v42
 v_mfma_f32_16x16x32_bf16 v[56:59], a[32:35], a[112:115], v[56:59]
 ds_read_b64_tr_b16 a[6:7], v237 offset:18016
 v_exp_f32 v35, v35
 v_mul_f32 v43, v250, v43
 v_mfma_f32_16x16x32_bf16 v[60:63], a[32:35], a[116:119], v[60:63]
 v_exp_f32 v36, v36
 v_mul_f32 v44, v251, v44
 s_waitcnt lgkmcnt(12)
 v_mfma_f32_16x16x32_bf16 v[172:175], a[36:39], a[116:119], v[172:175]
 ds_read_b64_tr_b16 a[8:9], v237 offset:7264
 v_exp_f32 v37, v37
 v_mul_f32 v45, v251, v45
 v_mfma_f32_16x16x32_bf16 v[168:171], a[36:39], a[112:115], v[168:171]
 v_exp_f32 v38, v38
 v_mul_f32 v46, v251, v46
 v_mfma_f32_16x16x32_bf16 v[164:167], a[36:39], a[108:111], v[164:167]
 ds_read_b64_tr_b16 a[10:11], v237 offset:10848
 v_exp_f32 v39, v39
 v_mul_f32 v47, v251, v47
 v_mfma_f32_16x16x32_bf16 v[160:163], a[36:39], a[104:107], v[160:163]
 v_exp_f32 v40, v40
 v_fma_f32 v32, v32, v252, v252
 s_waitcnt lgkmcnt(12)
 v_mfma_f32_16x16x32_bf16 v[48:51], a[40:43], a[120:123], v[48:51]
 ds_read_b64_tr_b16 a[12:13], v237 offset:21600
 v_exp_f32 v41, v41
 v_fma_f32 v33, v33, v252, v252
 v_mfma_f32_16x16x32_bf16 v[52:55], a[40:43], a[124:127], v[52:55]
 v_exp_f32 v42, v42
 v_fma_f32 v34, v34, v252, v252
 v_mfma_f32_16x16x32_bf16 v[56:59], a[40:43], a[128:131], v[56:59]
 ds_read_b64_tr_b16 a[14:15], v237 offset:25184
 v_exp_f32 v43, v43
 v_fma_f32 v35, v35, v252, v252
 v_mfma_f32_16x16x32_bf16 v[60:63], a[40:43], a[132:135], v[60:63]
 v_exp_f32 v44, v44
 v_fma_f32 v36, v36, v253, v253
 s_waitcnt lgkmcnt(12)
 v_mfma_f32_16x16x32_bf16 v[172:175], a[44:47], a[132:135], v[172:175]
 ds_read_b64_tr_b16 a[16:17], v236 offset:128
 v_exp_f32 v45, v45
 v_fma_f32 v37, v37, v253, v253
 v_mfma_f32_16x16x32_bf16 v[168:171], a[44:47], a[128:131], v[168:171]
 v_exp_f32 v46, v46
 v_fma_f32 v38, v38, v253, v253
 v_mfma_f32_16x16x32_bf16 v[164:167], a[44:47], a[124:127], v[164:167]
 ds_read_b64_tr_b16 a[18:19], v236 offset:3712
 v_exp_f32 v47, v47
 v_fma_f32 v39, v39, v253, v253
 v_mfma_f32_16x16x32_bf16 v[160:163], a[44:47], a[120:123], v[160:163]
 v_rcp_f32 v32, v32
 v_fma_f32 v40, v40, v254, v254
 s_waitcnt lgkmcnt(12)
 v_mfma_f32_16x16x32_bf16 v[48:51], a[48:51], a[136:139], v[48:51]
 ds_read_b64_tr_b16 a[20:21], v236 offset:14464
 v_rcp_f32 v33, v33
 v_fma_f32 v41, v41, v254, v254
 v_mfma_f32_16x16x32_bf16 v[52:55], a[48:51], a[140:143], v[52:55]
 v_rcp_f32 v34, v34
 v_mfma_f32_16x16x32_bf16 v[56:59], a[48:51], a[144:147], v[56:59]
 ds_read_b64_tr_b16 a[22:23], v236 offset:18048
 v_fma_f32 v42, v42, v254, v254
 v_rcp_f32 v35, v35
 v_mfma_f32_16x16x32_bf16 v[60:63], a[48:51], a[148:151], v[60:63]
 v_fma_f32 v43, v43, v254, v254
 v_rcp_f32 v36, v36
 s_waitcnt lgkmcnt(12)
 v_mfma_f32_16x16x32_bf16 v[172:175], a[52:55], a[148:151], v[172:175]
 ds_read_b64_tr_b16 a[24:25], v236 offset:7296
 v_fma_f32 v44, v44, v255, v255
 v_rcp_f32 v37, v37
 v_mfma_f32_16x16x32_bf16 v[168:171], a[52:55], a[144:147], v[168:171]
 v_fma_f32 v45, v45, v255, v255
 v_rcp_f32 v38, v38
 v_mfma_f32_16x16x32_bf16 v[164:167], a[52:55], a[140:143], v[164:167]
 ds_read_b64_tr_b16 a[26:27], v236 offset:10880
 v_fma_f32 v46, v46, v255, v255
 v_rcp_f32 v39, v39
 v_mfma_f32_16x16x32_bf16 v[160:163], a[52:55], a[136:139], v[160:163]
 v_fma_f32 v47, v47, v255, v255
 v_rcp_f32 v40, v40
 s_waitcnt lgkmcnt(12)
 v_mfma_f32_16x16x32_bf16 v[48:51], a[0:3], a[152:155], v[48:51]
 ds_read_b64_tr_b16 a[28:29], v236 offset:21632
 v_mul_f32 v32, v32, v144
 v_rcp_f32 v41, v41
 v_mfma_f32_16x16x32_bf16 v[52:55], a[0:3], a[156:159], v[52:55]
 v_mul_f32 v33, v33, v145
 v_rcp_f32 v42, v42
 v_mfma_f32_16x16x32_bf16 v[56:59], a[0:3], a[160:163], v[56:59]
 ds_read_b64_tr_b16 a[30:31], v236 offset:25216
 v_mul_f32 v34, v34, v146
 v_rcp_f32 v43, v43
 v_mfma_f32_16x16x32_bf16 v[60:63], a[0:3], a[164:167], v[60:63]
 v_mul_f32 v35, v35, v147
 v_rcp_f32 v44, v44
 s_waitcnt lgkmcnt(12)
 v_mfma_f32_16x16x32_bf16 v[172:175], a[4:7], a[164:167], v[172:175]
 ds_read_b64_tr_b16 a[32:33], v236 offset:28800
 v_mul_f32 v36, v36, v148
 v_rcp_f32 v45, v45
 v_mfma_f32_16x16x32_bf16 v[168:171], a[4:7], a[160:163], v[168:171]
 v_mul_f32 v37, v37, v149
 v_rcp_f32 v46, v46
 v_mfma_f32_16x16x32_bf16 v[164:167], a[4:7], a[156:159], v[164:167]
 ds_read_b64_tr_b16 a[34:35], v236 offset:32384
 v_mul_f32 v38, v38, v150
 v_rcp_f32 v47, v47
 v_mfma_f32_16x16x32_bf16 v[160:163], a[4:7], a[152:155], v[160:163]
 v_mul_f32 v39, v39, v151
 v_cvt_pk_bf16_f32 v144, v32, v33
 s_waitcnt lgkmcnt(12)
 v_mfma_f32_16x16x32_bf16 v[48:51], a[8:11], a[168:171], v[48:51]
 ds_read_b64_tr_b16 a[36:37], v236 offset:43136
 v_cvt_pk_bf16_f32 v145, v34, v35
 v_cvt_pk_bf16_f32 v148, v36, v37
 v_mfma_f32_16x16x32_bf16 v[52:55], a[8:11], a[172:175], v[52:55]
 v_cvt_pk_bf16_f32 v149, v38, v39
 v_mul_f32 v40, v40, v152
 v_mfma_f32_16x16x32_bf16 v[56:59], a[8:11], a[176:179], v[56:59]
 ds_read_b64_tr_b16 a[38:39], v236 offset:46720
 v_mul_f32 v41, v41, v153
 v_mul_f32 v42, v42, v154
 v_mfma_f32_16x16x32_bf16 v[60:63], a[8:11], a[180:183], v[60:63]
 v_mul_f32 v43, v43, v155
 v_mul_f32 v44, v44, v156
 s_waitcnt lgkmcnt(12)
 v_mfma_f32_16x16x32_bf16 v[172:175], a[12:15], a[180:183], v[172:175]
 ds_read_b64_tr_b16 a[40:41], v236 offset:35968
 v_mul_f32 v45, v45, v157
 v_mul_f32 v46, v46, v158
 v_mfma_f32_16x16x32_bf16 v[168:171], a[12:15], a[176:179], v[168:171]
 v_mul_f32 v47, v47, v159
 v_cvt_pk_bf16_f32 v152, v40, v41
 v_mfma_f32_16x16x32_bf16 v[164:167], a[12:15], a[172:175], v[164:167]
 ds_read_b64_tr_b16 a[42:43], v236 offset:39552
 v_cvt_pk_bf16_f32 v153, v42, v43
 v_cvt_pk_bf16_f32 v156, v44, v45
 v_mfma_f32_16x16x32_bf16 v[160:163], a[12:15], a[168:171], v[160:163]
 v_cvt_pk_bf16_f32 v157, v46, v47
 v_mfma_f32_16x16x16_bf16 v[48:51], a[204:205], a[184:185], v[48:51]
 v_mfma_f32_16x16x16_bf16 v[52:55], a[204:205], a[186:187], v[52:55]
 v_mfma_f32_16x16x16_bf16 v[56:59], a[204:205], a[188:189], v[56:59]
 v_mfma_f32_16x16x16_bf16 v[60:63], a[204:205], a[190:191], v[60:63]
 s_nop 0
 v_mfma_f32_16x16x16_bf16 v[160:163], a[206:207], a[184:185], v[160:163]
 v_mfma_f32_16x16x16_bf16 v[164:167], a[206:207], a[186:187], v[164:167]
 v_mfma_f32_16x16x16_bf16 v[168:171], a[206:207], a[188:189], v[168:171]
 v_mfma_f32_16x16x16_bf16 v[172:175], a[206:207], a[190:191], v[172:175]
 s_waitcnt lgkmcnt(12)
 v_mfma_f32_16x16x32_bf16 v[64:67], a[16:19], a[88:91], v[64:67]
 ds_read_b64_tr_b16 a[44:45], v236 offset:50304
 v_mfma_f32_16x16x32_bf16 v[68:71], a[16:19], a[92:95], v[68:71]
 v_mfma_f32_16x16x32_bf16 v[72:75], a[16:19], a[96:99], v[72:75]
 ds_read_b64_tr_b16 a[46:47], v236 offset:53888
 v_mfma_f32_16x16x32_bf16 v[76:79], a[16:19], a[100:103], v[76:79]
 v_mul_f32 v48, v248, v48
 v_mul_f32 v49, v248, v49
 v_mul_f32 v50, v248, v50
 s_waitcnt lgkmcnt(12)
 v_mfma_f32_16x16x32_bf16 v[188:191], a[20:23], a[100:103], v[188:191]
 ds_read_b64_tr_b16 a[48:49], v237 offset:128
 v_mul_f32 v51, v248, v51
 v_mul_f32 v52, v249, v52
 v_mfma_f32_16x16x32_bf16 v[184:187], a[20:23], a[96:99], v[184:187]
 v_mul_f32 v53, v249, v53
 v_mul_f32 v54, v249, v54
 v_mfma_f32_16x16x32_bf16 v[180:183], a[20:23], a[92:95], v[180:183]
 ds_read_b64_tr_b16 a[50:51], v237 offset:3712
 v_mul_f32 v55, v249, v55
 v_exp_f32 v48, v48
 v_mfma_f32_16x16x32_bf16 v[176:179], a[20:23], a[88:91], v[176:179]
 v_mul_f32 v56, v250, v56
 v_exp_f32 v49, v49
 s_waitcnt lgkmcnt(12)
 v_mfma_f32_16x16x32_bf16 v[64:67], a[24:27], a[104:107], v[64:67]
 ds_read_b64_tr_b16 a[52:53], v237 offset:14464
 v_mul_f32 v57, v250, v57
 v_exp_f32 v50, v50
 v_mfma_f32_16x16x32_bf16 v[68:71], a[24:27], a[108:111], v[68:71]
 v_mul_f32 v58, v250, v58
 v_exp_f32 v51, v51
 v_mfma_f32_16x16x32_bf16 v[72:75], a[24:27], a[112:115], v[72:75]
 ds_read_b64_tr_b16 a[54:55], v237 offset:18048
 v_mul_f32 v59, v250, v59
 v_exp_f32 v52, v52
 v_mfma_f32_16x16x32_bf16 v[76:79], a[24:27], a[116:119], v[76:79]
 v_mul_f32 v60, v251, v60
 v_exp_f32 v53, v53
 s_waitcnt lgkmcnt(12)
 v_mfma_f32_16x16x32_bf16 v[188:191], a[28:31], a[116:119], v[188:191]
 ds_read_b64_tr_b16 a[0:1], v237 offset:7296
 v_mul_f32 v61, v251, v61
 v_exp_f32 v54, v54
 v_mfma_f32_16x16x32_bf16 v[184:187], a[28:31], a[112:115], v[184:187]
 v_mul_f32 v62, v251, v62
 v_exp_f32 v55, v55
 v_mfma_f32_16x16x32_bf16 v[180:183], a[28:31], a[108:111], v[180:183]
 ds_read_b64_tr_b16 a[2:3], v237 offset:10880
 v_mul_f32 v63, v251, v63
 v_exp_f32 v56, v56
 v_mfma_f32_16x16x32_bf16 v[176:179], a[28:31], a[104:107], v[176:179]
 v_fma_f32 v48, v48, v252, v252
 v_exp_f32 v57, v57
 s_waitcnt lgkmcnt(12)
 v_mfma_f32_16x16x32_bf16 v[64:67], a[32:35], a[120:123], v[64:67]
 ds_read_b64_tr_b16 a[4:5], v237 offset:21632
 v_fma_f32 v49, v49, v252, v252
 v_exp_f32 v58, v58
 v_mfma_f32_16x16x32_bf16 v[68:71], a[32:35], a[124:127], v[68:71]
 v_fma_f32 v50, v50, v252, v252
 v_exp_f32 v59, v59
 v_mfma_f32_16x16x32_bf16 v[72:75], a[32:35], a[128:131], v[72:75]
 ds_read_b64_tr_b16 a[6:7], v237 offset:25216
 v_fma_f32 v51, v51, v252, v252
 v_exp_f32 v60, v60
 v_mfma_f32_16x16x32_bf16 v[76:79], a[32:35], a[132:135], v[76:79]
 v_fma_f32 v52, v52, v253, v253
 v_exp_f32 v61, v61
 s_waitcnt lgkmcnt(12)
 v_mfma_f32_16x16x32_bf16 v[188:191], a[36:39], a[132:135], v[188:191]
 ds_read_b64_tr_b16 a[8:9], v236 offset:160
 v_fma_f32 v53, v53, v253, v253
 v_exp_f32 v62, v62
 v_mfma_f32_16x16x32_bf16 v[184:187], a[36:39], a[128:131], v[184:187]
 v_fma_f32 v54, v54, v253, v253
 v_exp_f32 v63, v63
 v_mfma_f32_16x16x32_bf16 v[180:183], a[36:39], a[124:127], v[180:183]
 ds_read_b64_tr_b16 a[10:11], v236 offset:3744
 v_fma_f32 v55, v55, v253, v253
 v_rcp_f32 v48, v48
 v_mfma_f32_16x16x32_bf16 v[176:179], a[36:39], a[120:123], v[176:179]
 v_fma_f32 v56, v56, v254, v254
 v_rcp_f32 v49, v49
 s_waitcnt lgkmcnt(12)
 v_mfma_f32_16x16x32_bf16 v[64:67], a[40:43], a[136:139], v[64:67]
 ds_read_b64_tr_b16 a[12:13], v236 offset:14496
 v_fma_f32 v57, v57, v254, v254
 v_rcp_f32 v50, v50
 v_mfma_f32_16x16x32_bf16 v[68:71], a[40:43], a[140:143], v[68:71]
 v_fma_f32 v58, v58, v254, v254
 v_rcp_f32 v51, v51
 v_fma_f32 v59, v59, v254, v254
 v_mfma_f32_16x16x32_bf16 v[72:75], a[40:43], a[144:147], v[72:75]
 ds_read_b64_tr_b16 a[14:15], v236 offset:18080
 v_rcp_f32 v52, v52
 v_fma_f32 v60, v60, v255, v255
 v_mfma_f32_16x16x32_bf16 v[76:79], a[40:43], a[148:151], v[76:79]
 v_rcp_f32 v53, v53
 v_fma_f32 v61, v61, v255, v255
 s_waitcnt lgkmcnt(12)
 v_mfma_f32_16x16x32_bf16 v[188:191], a[44:47], a[148:151], v[188:191]
 ds_read_b64_tr_b16 a[16:17], v236 offset:7328
 v_rcp_f32 v54, v54
 v_fma_f32 v62, v62, v255, v255
 v_mfma_f32_16x16x32_bf16 v[184:187], a[44:47], a[144:147], v[184:187]
 v_rcp_f32 v55, v55
 v_fma_f32 v63, v63, v255, v255
 v_mfma_f32_16x16x32_bf16 v[180:183], a[44:47], a[140:143], v[180:183]
 ds_read_b64_tr_b16 a[18:19], v236 offset:10912
 v_rcp_f32 v56, v56
 v_mul_f32 v48, v48, v160
 v_mfma_f32_16x16x32_bf16 v[176:179], a[44:47], a[136:139], v[176:179]
 v_rcp_f32 v57, v57
 v_mul_f32 v49, v49, v161
 s_waitcnt lgkmcnt(12)
 v_mfma_f32_16x16x32_bf16 v[64:67], a[48:51], a[152:155], v[64:67]
 ds_read_b64_tr_b16 a[20:21], v236 offset:21664
 v_rcp_f32 v58, v58
 v_mul_f32 v50, v50, v162
 v_mfma_f32_16x16x32_bf16 v[68:71], a[48:51], a[156:159], v[68:71]
 v_rcp_f32 v59, v59
 v_mul_f32 v51, v51, v163
 v_mfma_f32_16x16x32_bf16 v[72:75], a[48:51], a[160:163], v[72:75]
 ds_read_b64_tr_b16 a[22:23], v236 offset:25248
 v_rcp_f32 v60, v60
 v_mul_f32 v52, v52, v164
 v_mfma_f32_16x16x32_bf16 v[76:79], a[48:51], a[164:167], v[76:79]
 v_rcp_f32 v61, v61
 v_mul_f32 v53, v53, v165
 s_waitcnt lgkmcnt(12)
 v_mfma_f32_16x16x32_bf16 v[188:191], a[52:55], a[164:167], v[188:191]
 ds_read_b64_tr_b16 a[24:25], v236 offset:28832
 v_rcp_f32 v62, v62
 v_mul_f32 v54, v54, v166
 v_mfma_f32_16x16x32_bf16 v[184:187], a[52:55], a[160:163], v[184:187]
 v_rcp_f32 v63, v63
 v_mul_f32 v55, v55, v167
 v_mfma_f32_16x16x32_bf16 v[180:183], a[52:55], a[156:159], v[180:183]
 ds_read_b64_tr_b16 a[26:27], v236 offset:32416
 v_cvt_pk_bf16_f32 v146, v48, v49
 v_cvt_pk_bf16_f32 v147, v50, v51
 v_mfma_f32_16x16x32_bf16 v[176:179], a[52:55], a[152:155], v[176:179]
 buffer_store_dwordx4 v[144:147], v224, s[28:31], s44 offen offset:1024 sc1
 v_cvt_pk_bf16_f32 v150, v52, v53
 s_waitcnt lgkmcnt(12)
 v_mfma_f32_16x16x32_bf16 v[64:67], a[0:3], a[168:171], v[64:67]
 ds_read_b64_tr_b16 a[28:29], v236 offset:43168
 v_cvt_pk_bf16_f32 v151, v54, v55
 buffer_store_dwordx4 v[148:151], v225, s[28:31], s44 offen offset:1024 sc1
 v_mfma_f32_16x16x32_bf16 v[68:71], a[0:3], a[172:175], v[68:71]
 v_mul_f32 v56, v56, v168
 v_mul_f32 v57, v57, v169
 v_mfma_f32_16x16x32_bf16 v[72:75], a[0:3], a[176:179], v[72:75]
 ds_read_b64_tr_b16 a[30:31], v236 offset:46752
 v_mul_f32 v58, v58, v170
 v_mul_f32 v59, v59, v171
 v_mfma_f32_16x16x32_bf16 v[76:79], a[0:3], a[180:183], v[76:79]
 v_mul_f32 v60, v60, v172
 v_mul_f32 v61, v61, v173
 s_waitcnt lgkmcnt(12)
 v_mfma_f32_16x16x32_bf16 v[188:191], a[4:7], a[180:183], v[188:191]
 ds_read_b64_tr_b16 a[32:33], v236 offset:36000
 v_mul_f32 v62, v62, v174
 v_mul_f32 v63, v63, v175
 v_mfma_f32_16x16x32_bf16 v[184:187], a[4:7], a[176:179], v[184:187]
 v_cvt_pk_bf16_f32 v154, v56, v57
 v_cvt_pk_bf16_f32 v155, v58, v59
 v_mfma_f32_16x16x32_bf16 v[180:183], a[4:7], a[172:175], v[180:183]
 ds_read_b64_tr_b16 a[34:35], v236 offset:39584
 buffer_store_dwordx4 v[152:155], v226, s[28:31], s44 offen offset:1024 sc1
 v_cvt_pk_bf16_f32 v158, v60, v61
 v_mfma_f32_16x16x32_bf16 v[176:179], a[4:7], a[168:171], v[176:179]
 v_cvt_pk_bf16_f32 v159, v62, v63
 buffer_store_dwordx4 v[156:159], v227, s[28:31], s44 offen offset:1024 sc1
 v_mfma_f32_16x16x16_bf16 v[64:67], a[208:209], a[184:185], v[64:67]
 v_mfma_f32_16x16x16_bf16 v[68:71], a[208:209], a[186:187], v[68:71]
 v_mfma_f32_16x16x16_bf16 v[72:75], a[208:209], a[188:189], v[72:75]
 v_mfma_f32_16x16x16_bf16 v[76:79], a[208:209], a[190:191], v[76:79]
 v_mfma_f32_16x16x16_bf16 v[176:179], a[210:211], a[184:185], v[176:179]
 v_mfma_f32_16x16x16_bf16 v[180:183], a[210:211], a[186:187], v[180:183]
 v_mfma_f32_16x16x16_bf16 v[184:187], a[210:211], a[188:189], v[184:187]
 v_mfma_f32_16x16x16_bf16 v[188:191], a[210:211], a[190:191], v[188:191]
 s_waitcnt lgkmcnt(12)
 v_mfma_f32_16x16x32_bf16 v[80:83], a[8:11], a[88:91], v[80:83]
 ds_read_b64_tr_b16 a[36:37], v236 offset:50336
 v_mfma_f32_16x16x32_bf16 v[84:87], a[8:11], a[92:95], v[84:87]
 v_mfma_f32_16x16x32_bf16 v[88:91], a[8:11], a[96:99], v[88:91]
 ds_read_b64_tr_b16 a[38:39], v236 offset:53920
 v_mfma_f32_16x16x32_bf16 v[92:95], a[8:11], a[100:103], v[92:95]
 v_mul_f32 v64, v248, v64
 v_mul_f32 v65, v248, v65
 s_waitcnt lgkmcnt(12)
 v_mfma_f32_16x16x32_bf16 v[204:207], a[12:15], a[100:103], v[204:207]
 ds_read_b64_tr_b16 a[40:41], v237 offset:160
 v_mul_f32 v66, v248, v66
 v_mul_f32 v67, v248, v67
 v_mfma_f32_16x16x32_bf16 v[200:203], a[12:15], a[96:99], v[200:203]
 v_mul_f32 v68, v249, v68
 v_mul_f32 v69, v249, v69
 v_mfma_f32_16x16x32_bf16 v[196:199], a[12:15], a[92:95], v[196:199]
 ds_read_b64_tr_b16 a[42:43], v237 offset:3744
 v_mul_f32 v70, v249, v70
 v_mul_f32 v71, v249, v71
 v_mfma_f32_16x16x32_bf16 v[192:195], a[12:15], a[88:91], v[192:195]
 v_exp_f32 v64, v64
 v_mul_f32 v72, v250, v72
 s_waitcnt lgkmcnt(12)
 v_mfma_f32_16x16x32_bf16 v[80:83], a[16:19], a[104:107], v[80:83]
 ds_read_b64_tr_b16 a[44:45], v237 offset:14496
 v_exp_f32 v65, v65
 v_mul_f32 v73, v250, v73
 v_mfma_f32_16x16x32_bf16 v[84:87], a[16:19], a[108:111], v[84:87]
 v_exp_f32 v66, v66
 v_mul_f32 v74, v250, v74
 v_mfma_f32_16x16x32_bf16 v[88:91], a[16:19], a[112:115], v[88:91]
 ds_read_b64_tr_b16 a[46:47], v237 offset:18080
 v_exp_f32 v67, v67
 v_mul_f32 v75, v250, v75
 v_mfma_f32_16x16x32_bf16 v[92:95], a[16:19], a[116:119], v[92:95]
 v_exp_f32 v68, v68
 v_mul_f32 v76, v251, v76
 s_waitcnt lgkmcnt(12)
 v_mfma_f32_16x16x32_bf16 v[204:207], a[20:23], a[116:119], v[204:207]
 ds_read_b64_tr_b16 a[48:49], v237 offset:7328
 v_exp_f32 v69, v69
 v_mul_f32 v77, v251, v77
 v_mfma_f32_16x16x32_bf16 v[200:203], a[20:23], a[112:115], v[200:203]
 v_exp_f32 v70, v70
 v_mul_f32 v78, v251, v78
 v_mfma_f32_16x16x32_bf16 v[196:199], a[20:23], a[108:111], v[196:199]
 ds_read_b64_tr_b16 a[50:51], v237 offset:10912
 v_exp_f32 v71, v71
 v_mul_f32 v79, v251, v79
 v_mfma_f32_16x16x32_bf16 v[192:195], a[20:23], a[104:107], v[192:195]
 v_exp_f32 v72, v72
 v_fma_f32 v64, v64, v252, v252
 s_waitcnt lgkmcnt(12)
 v_mfma_f32_16x16x32_bf16 v[80:83], a[24:27], a[120:123], v[80:83]
 ds_read_b64_tr_b16 a[52:53], v237 offset:21664
 v_exp_f32 v73, v73
 v_fma_f32 v65, v65, v252, v252
 v_mfma_f32_16x16x32_bf16 v[84:87], a[24:27], a[124:127], v[84:87]
 v_exp_f32 v74, v74
 v_fma_f32 v66, v66, v252, v252
 v_mfma_f32_16x16x32_bf16 v[88:91], a[24:27], a[128:131], v[88:91]
 ds_read_b64_tr_b16 a[54:55], v237 offset:25248
 v_exp_f32 v75, v75
 v_fma_f32 v67, v67, v252, v252
 v_mfma_f32_16x16x32_bf16 v[92:95], a[24:27], a[132:135], v[92:95]
 v_exp_f32 v76, v76
 v_fma_f32 v68, v68, v253, v253
 s_waitcnt lgkmcnt(12)
 v_mfma_f32_16x16x32_bf16 v[204:207], a[28:31], a[132:135], v[204:207]
 v_exp_f32 v77, v77
 v_fma_f32 v69, v69, v253, v253
 v_mfma_f32_16x16x32_bf16 v[200:203], a[28:31], a[128:131], v[200:203]
 v_exp_f32 v78, v78
 v_fma_f32 v70, v70, v253, v253
 v_mfma_f32_16x16x32_bf16 v[196:199], a[28:31], a[124:127], v[196:199]
 v_exp_f32 v79, v79
 v_fma_f32 v71, v71, v253, v253
 v_mfma_f32_16x16x32_bf16 v[192:195], a[28:31], a[120:123], v[192:195]
 v_rcp_f32 v64, v64
 v_fma_f32 v72, v72, v254, v254
 s_waitcnt lgkmcnt(10)
 v_mfma_f32_16x16x32_bf16 v[80:83], a[32:35], a[136:139], v[80:83]
 v_rcp_f32 v65, v65
 v_fma_f32 v73, v73, v254, v254
 v_mfma_f32_16x16x32_bf16 v[84:87], a[32:35], a[140:143], v[84:87]
 v_rcp_f32 v66, v66
 v_mfma_f32_16x16x32_bf16 v[88:91], a[32:35], a[144:147], v[88:91]
 v_fma_f32 v74, v74, v254, v254
 v_rcp_f32 v67, v67
 v_mfma_f32_16x16x32_bf16 v[92:95], a[32:35], a[148:151], v[92:95]
 v_fma_f32 v75, v75, v254, v254
 v_rcp_f32 v68, v68
 s_waitcnt lgkmcnt(8)
 v_mfma_f32_16x16x32_bf16 v[204:207], a[36:39], a[148:151], v[204:207]
 v_fma_f32 v76, v76, v255, v255
 v_rcp_f32 v69, v69
 v_mfma_f32_16x16x32_bf16 v[200:203], a[36:39], a[144:147], v[200:203]
 v_fma_f32 v77, v77, v255, v255
 v_rcp_f32 v70, v70
 v_mfma_f32_16x16x32_bf16 v[196:199], a[36:39], a[140:143], v[196:199]
 v_fma_f32 v78, v78, v255, v255
 v_rcp_f32 v71, v71
 v_mfma_f32_16x16x32_bf16 v[192:195], a[36:39], a[136:139], v[192:195]
 v_fma_f32 v79, v79, v255, v255
 v_rcp_f32 v72, v72
 s_waitcnt lgkmcnt(6)
 v_mfma_f32_16x16x32_bf16 v[80:83], a[40:43], a[152:155], v[80:83]
 v_mul_f32 v64, v64, v176
 v_rcp_f32 v73, v73
 v_mfma_f32_16x16x32_bf16 v[84:87], a[40:43], a[156:159], v[84:87]
 v_mul_f32 v65, v65, v177
 v_rcp_f32 v74, v74
 v_mfma_f32_16x16x32_bf16 v[88:91], a[40:43], a[160:163], v[88:91]
 v_mul_f32 v66, v66, v178
 v_rcp_f32 v75, v75
 v_mfma_f32_16x16x32_bf16 v[92:95], a[40:43], a[164:167], v[92:95]
 v_mul_f32 v67, v67, v179
 v_rcp_f32 v76, v76
 s_waitcnt lgkmcnt(4)
 v_mfma_f32_16x16x32_bf16 v[204:207], a[44:47], a[164:167], v[204:207]
 v_mul_f32 v68, v68, v180
 v_rcp_f32 v77, v77
 v_mfma_f32_16x16x32_bf16 v[200:203], a[44:47], a[160:163], v[200:203]
 v_mul_f32 v69, v69, v181
 v_rcp_f32 v78, v78
 v_mfma_f32_16x16x32_bf16 v[196:199], a[44:47], a[156:159], v[196:199]
 v_mul_f32 v70, v70, v182
 v_rcp_f32 v79, v79
 v_mfma_f32_16x16x32_bf16 v[192:195], a[44:47], a[152:155], v[192:195]
 v_mul_f32 v71, v71, v183
 v_cvt_pk_bf16_f32 v176, v64, v65
 s_waitcnt lgkmcnt(2)
 v_mfma_f32_16x16x32_bf16 v[80:83], a[48:51], a[168:171], v[80:83]
 v_cvt_pk_bf16_f32 v177, v66, v67
 v_cvt_pk_bf16_f32 v180, v68, v69
 v_mfma_f32_16x16x32_bf16 v[84:87], a[48:51], a[172:175], v[84:87]
 v_cvt_pk_bf16_f32 v181, v70, v71
 v_mul_f32 v72, v72, v184
 v_mfma_f32_16x16x32_bf16 v[88:91], a[48:51], a[176:179], v[88:91]
 v_mul_f32 v73, v73, v185
 v_mul_f32 v74, v74, v186
 v_mfma_f32_16x16x32_bf16 v[92:95], a[48:51], a[180:183], v[92:95]
 v_mul_f32 v75, v75, v187
 v_mul_f32 v76, v76, v188
 s_waitcnt lgkmcnt(0)
 v_mfma_f32_16x16x32_bf16 v[204:207], a[52:55], a[180:183], v[204:207]
 v_mul_f32 v77, v77, v189
 v_mul_f32 v78, v78, v190
 v_mfma_f32_16x16x32_bf16 v[200:203], a[52:55], a[176:179], v[200:203]
 v_mul_f32 v79, v79, v191
 v_cvt_pk_bf16_f32 v184, v72, v73
 v_mfma_f32_16x16x32_bf16 v[196:199], a[52:55], a[172:175], v[196:199]
 v_cvt_pk_bf16_f32 v185, v74, v75
 v_cvt_pk_bf16_f32 v188, v76, v77
 v_mfma_f32_16x16x32_bf16 v[192:195], a[52:55], a[168:171], v[192:195]
 v_cvt_pk_bf16_f32 v189, v78, v79
 v_mfma_f32_16x16x16_bf16 v[80:83], a[212:213], a[184:185], v[80:83]
 v_mfma_f32_16x16x16_bf16 v[84:87], a[212:213], a[186:187], v[84:87]
 v_mfma_f32_16x16x16_bf16 v[88:91], a[212:213], a[188:189], v[88:91]
 v_mfma_f32_16x16x16_bf16 v[92:95], a[212:213], a[190:191], v[92:95]
 s_nop 0
 v_mfma_f32_16x16x16_bf16 v[192:195], a[214:215], a[184:185], v[192:195]
 v_mfma_f32_16x16x16_bf16 v[196:199], a[214:215], a[186:187], v[196:199]
 v_mfma_f32_16x16x16_bf16 v[200:203], a[214:215], a[188:189], v[200:203]
 v_mfma_f32_16x16x16_bf16 v[204:207], a[214:215], a[190:191], v[204:207]
 v_mul_f32 v80, v248, v80
 v_mul_f32 v81, v248, v81
 v_mul_f32 v82, v248, v82
 v_mul_f32 v83, v248, v83
 v_mul_f32 v84, v249, v84
 v_mul_f32 v85, v249, v85
 v_mul_f32 v86, v249, v86
 v_mul_f32 v87, v249, v87
 v_exp_f32 v80, v80
 v_mul_f32 v88, v250, v88
 v_exp_f32 v81, v81
 v_mul_f32 v89, v250, v89
 v_exp_f32 v82, v82
 v_mul_f32 v90, v250, v90
 v_exp_f32 v83, v83
 v_mul_f32 v91, v250, v91
 v_exp_f32 v84, v84
 v_mul_f32 v92, v251, v92
 v_exp_f32 v85, v85
 v_mul_f32 v93, v251, v93
 v_exp_f32 v86, v86
 v_mul_f32 v94, v251, v94
 v_exp_f32 v87, v87
 v_mul_f32 v95, v251, v95
 v_exp_f32 v88, v88
 v_fma_f32 v80, v80, v252, v252
 v_exp_f32 v89, v89
 v_fma_f32 v81, v81, v252, v252
 v_exp_f32 v90, v90
 v_fma_f32 v82, v82, v252, v252
 v_exp_f32 v91, v91
 v_fma_f32 v83, v83, v252, v252
 v_exp_f32 v92, v92
 v_fma_f32 v84, v84, v253, v253
 v_exp_f32 v93, v93
 v_fma_f32 v85, v85, v253, v253
 v_exp_f32 v94, v94
 v_fma_f32 v86, v86, v253, v253
 v_exp_f32 v95, v95
 v_fma_f32 v87, v87, v253, v253
 v_rcp_f32 v80, v80
 v_fma_f32 v88, v88, v254, v254
 v_rcp_f32 v81, v81
 v_fma_f32 v89, v89, v254, v254
 v_rcp_f32 v82, v82
 v_fma_f32 v90, v90, v254, v254
 v_rcp_f32 v83, v83
 v_fma_f32 v91, v91, v254, v254
 v_rcp_f32 v84, v84
 v_fma_f32 v92, v92, v255, v255
 v_rcp_f32 v85, v85
 v_fma_f32 v93, v93, v255, v255
 v_rcp_f32 v86, v86
 v_fma_f32 v94, v94, v255, v255
 v_rcp_f32 v87, v87
 v_fma_f32 v95, v95, v255, v255
 v_rcp_f32 v88, v88
 v_pk_mul_f32 v[80:81], v[80:81], v[192:193]
 v_rcp_f32 v89, v89
 v_pk_mul_f32 v[82:83], v[82:83], v[194:195]
 v_rcp_f32 v90, v90
 v_pk_mul_f32 v[84:85], v[84:85], v[196:197]
 v_rcp_f32 v91, v91
 v_pk_mul_f32 v[86:87], v[86:87], v[198:199]
 v_rcp_f32 v92, v92
 v_rcp_f32 v93, v93
 v_rcp_f32 v94, v94
 v_rcp_f32 v95, v95
 v_cvt_pk_bf16_f32 v178, v80, v81
 v_cvt_pk_bf16_f32 v179, v82, v83
 buffer_store_dwordx4 v[176:179], v224, s[28:31], s44 offen offset:2048 sc1
 v_cvt_pk_bf16_f32 v182, v84, v85
 v_cvt_pk_bf16_f32 v183, v86, v87
 buffer_store_dwordx4 v[180:183], v225, s[28:31], s44 offen offset:2048 sc1
 v_pk_mul_f32 v[88:89], v[88:89], v[200:201]
 v_pk_mul_f32 v[90:91], v[90:91], v[202:203]
 v_pk_mul_f32 v[92:93], v[92:93], v[204:205]
 v_pk_mul_f32 v[94:95], v[94:95], v[206:207]
 v_cvt_pk_bf16_f32 v186, v88, v89
 v_cvt_pk_bf16_f32 v187, v90, v91
 buffer_store_dwordx4 v[184:187], v226, s[28:31], s44 offen offset:2048 sc1
 v_cvt_pk_bf16_f32 v190, v92, v93
 v_cvt_pk_bf16_f32 v191, v94, v95
 buffer_store_dwordx4 v[188:191], v227, s[28:31], s44 offen offset:2048 sc1
 v_mov_b32 v0, v245
 s_add_u32 s32, s8, 0x20000
 s_addc_u32 s33, s9, 0
 s_mov_b32 s34, 0x30000
 s_mov_b32 s35, 0x00020000
 s_lshr_b32 s16, s94, 4
 s_lshl_b32 s16, s16, 12
 s_lshl_b32 s17, s95, 7
 s_add_u32 s16, s16, s17
 s_add_u32 s16, s16, 131072
 v_mov_b32 v228, s16
 s_lshr_b32 s16, s15, 4
 s_lshl_b32 s16, s16, 12
 s_add_u32 s16, s16, 131072
 v_and_b32 v1, 15, v0
 v_lshl_add_u32 v229, v1, 7, s16
 s_and_b32 s16, s14, 128
 s_lshl_b32 s16, s16, 4
 v_add_u32 v229, s16, v229
 s_load_dwordx2 s[6:7], s[0:1], 88
 s_add_u32 s24, s8, 0x1400000
 s_addc_u32 s25, s9, 0
 s_mov_b32 s26, 0xe00000
 s_mov_b32 s27, 0x00020000
 s_lshr_b32 s19, s14, 5
 s_and_b32 s19, s19, 4
 s_xor_b32 s19, s19, 4
 s_mul_i32 s18, s15, 114688
 v_lshl_add_u32 v70, v0, 4, s18
 v_add_u32 v71, 114688, v70
 s_mov_b32 s41, 0
 v_lshrrev_b32 v1, 4, v0
 v_lshlrev_b32 v1, 2, v1
 v_bfe_u32 v2, v0, 2, 2
 v_add_u32 v1, v1, v2
 v_lshlrev_b32 v1, 8, v1
 v_and_b32 v2, 3, v0
 v_lshl_add_u32 v1, v2, 3, v1
 v_bfe_u32 v2, v0, 2, 3
 v_xor_b32 v2, s19, v2
 v_xor_b32 v72, 0, v2
 v_lshl_add_u32 v72, v72, 5, v1
 v_add_u32 v80, 65536, v72
 v_xor_b32 v73, 1, v2
 v_lshl_add_u32 v73, v73, 5, v1
 v_add_u32 v81, 65536, v73
 v_xor_b32 v74, 2, v2
 v_lshl_add_u32 v74, v74, 5, v1
 v_add_u32 v82, 65536, v74
 v_xor_b32 v75, 3, v2
 v_lshl_add_u32 v75, v75, 5, v1
 v_add_u32 v83, 65536, v75
 v_xor_b32 v76, 4, v2
 v_lshl_add_u32 v76, v76, 5, v1
 v_add_u32 v84, 65536, v76
 v_xor_b32 v77, 5, v2
 v_lshl_add_u32 v77, v77, 5, v1
 v_add_u32 v85, 65536, v77
 v_xor_b32 v78, 6, v2
 v_lshl_add_u32 v78, v78, 5, v1
 v_add_u32 v86, 65536, v78
 v_xor_b32 v79, 7, v2
 v_lshl_add_u32 v79, v79, 5, v1
 v_add_u32 v87, 65536, v79
 v_readlane_b32 s41, v247, 0
 s_mov_b32 s36, s8
 s_mov_b32 s37, s9
 s_mov_b32 s38, 0x6000
 s_mov_b32 s39, 0x00020000
 v_and_b32 v1, 15, v0
 v_lshlrev_b32 v1, 11, v1
 v_bfe_u32 v2, v0, 4, 1
 v_lshl_add_u32 v1, v2, 5, v1
 v_lshrrev_b32 v2, 5, v0
 v_lshl_add_u32 v1, v2, 4, v1
 s_lshl_b32 s18, s15, 15
 s_add_u32 s18, s18, s14
 v_add_u32 v120, s18, v1
 s_mov_b32 s42, 32768
 v_lshrrev_b32 v2, 4, v0
 v_lshlrev_b32 v2, 4, v2
 s_lshl_b32 s19, s14, 1
 v_add_u32 v3, s19, v2
 s_mov_b32 s43, 20480
 s_waitcnt lgkmcnt(0)
 s_mov_b32 s20, s6
 s_mov_b32 s21, s7
 s_mov_b32 s22, 0x400000
 s_mov_b32 s23, 0x00020000
 s_waitcnt vmcnt(0)
 s_barrier
 s_cmp_lg_u32 s3, 0
 s_cbranch_scc1 m_kernel_pub9
 v_mov_b32 v230, s59
 s_mov_b64 exec, 1
 buffer_store_dword v230, v228, s[32:35], 0 offen sc1
 s_mov_b64 exec, -1
m_kernel_pub9:
 buffer_load_dwordx4 v[104:107], v3, s[36:39], s43 offen offset:0 sc1
 buffer_load_dwordx4 v[108:111], v3, s[36:39], s43 offen offset:64 sc1
 buffer_load_dwordx4 v[112:115], v3, s[36:39], s43 offen offset:128 sc1
 buffer_load_dwordx4 v[116:119], v3, s[36:39], s43 offen offset:192 sc1
 v_accvgpr_read_b32 v88, a236
 v_accvgpr_read_b32 v89, a237
 v_accvgpr_read_b32 v90, a238
 v_accvgpr_read_b32 v91, a239
 v_accvgpr_read_b32 v92, a240
 v_accvgpr_read_b32 v93, a241
 v_accvgpr_read_b32 v94, a242
 v_accvgpr_read_b32 v95, a243
 v_accvgpr_read_b32 v96, a244
 v_accvgpr_read_b32 v97, a245
 v_accvgpr_read_b32 v98, a246
 v_accvgpr_read_b32 v99, a247
 v_accvgpr_read_b32 v100, a248
 v_accvgpr_read_b32 v101, a249
 v_accvgpr_read_b32 v102, a250
 v_accvgpr_read_b32 v103, a251
 s_add_u32 s28, s8, 0x2400000
 s_addc_u32 s29, s9, 0
 s_mov_b32 s30, 0x820000
 s_mov_b32 s31, 0x00020000
 s_lshl_b32 s18, s15, 16
 s_lshl_b32 s19, s14, 6
 s_add_u32 s18, s18, s19
 v_lshl_add_u32 v160, v0, 4, s18
 v_xor_b32 v161, 8192, v160
 s_lshl_b32 s18, s15, 10
 s_add_u32 s18, s18, s14
 s_add_u32 s18, s18, 0x800000
 v_mov_b32 v162, s18
 v_xor_b32 v163, 128, v162
 s_movk_i32 s44, 0x1000
 s_mov_b32 s16, 0x8000
 s_cmp_lg_u32 s3, 1
 s_cbranch_scc1 m_kernel_poll10x
m_kernel_poll10:
 buffer_load_dword v230, v229, s[32:35], 0 offen sc1
 s_sub_u32 s16, s16, 1
 s_waitcnt vmcnt(0)
 v_cmp_ne_u32 vcc, s59, v230
 s_nop 0
 s_cselect_b64 vcc, 0, vcc
 s_cbranch_vccnz m_kernel_poll10
m_kernel_poll10x:
 s_barrier
 buffer_load_dwordx4 a[96:99], v70, s[24:27], s41 offen sc1
 buffer_load_dwordx4 a[100:103], v71, s[24:27], s41 offen sc1
 buffer_load_dwordx4 a[104:107], v70, s[24:27], s41 offen offset:1024 sc1
 buffer_load_dwordx4 a[108:111], v71, s[24:27], s41 offen offset:1024 sc1
 buffer_load_dwordx4 a[112:115], v70, s[24:27], s41 offen offset:2048 sc1
 buffer_load_dwordx4 a[116:119], v71, s[24:27], s41 offen offset:2048 sc1
 buffer_load_dwordx4 a[120:123], v70, s[24:27], s41 offen offset:3072 sc1
 buffer_load_dwordx4 a[124:127], v71, s[24:27], s41 offen offset:3072 sc1
 v_readlane_b32 s41, v247, 1
 s_nop 4
 buffer_load_dwordx4 a[128:131], v70, s[24:27], s41 offen sc1
 buffer_load_dwordx4 a[132:135], v71, s[24:27], s41 offen sc1
 buffer_load_dwordx4 a[136:139], v70, s[24:27], s41 offen offset:1024 sc1
 buffer_load_dwordx4 a[140:143], v71, s[24:27], s41 offen offset:1024 sc1
 buffer_load_dwordx4 a[144:147], v70, s[24:27], s41 offen offset:2048 sc1
 buffer_load_dwordx4 a[148:151], v71, s[24:27], s41 offen offset:2048 sc1
 buffer_load_dwordx4 a[152:155], v70, s[24:27], s41 offen offset:3072 sc1
 buffer_load_dwordx4 a[156:159], v71, s[24:27], s41 offen offset:3072 sc1
 v_readlane_b32 s41, v247, 2
 ds_read_b64_tr_b16 a[0:1], v72 offset:0
 ds_read_b64_tr_b16 a[2:3], v72 offset:4096
 ds_read_b64_tr_b16 a[4:5], v73 offset:0
 ds_read_b64_tr_b16 a[6:7], v73 offset:4096
 ds_read_b64_tr_b16 a[8:9], v74 offset:0
 ds_read_b64_tr_b16 a[10:11], v74 offset:4096
 ds_read_b64_tr_b16 a[12:13], v75 offset:0
 ds_read_b64_tr_b16 a[14:15], v75 offset:4096
 ds_read_b64_tr_b16 a[16:17], v76 offset:0
 ds_read_b64_tr_b16 a[18:19], v76 offset:4096
 ds_read_b64_tr_b16 a[20:21], v77 offset:0
 ds_read_b64_tr_b16 a[22:23], v77 offset:4096
 ds_read_b64_tr_b16 a[24:25], v78 offset:0
 ds_read_b64_tr_b16 a[26:27], v78 offset:4096
 ds_read_b64_tr_b16 a[28:29], v79 offset:0
 ds_read_b64_tr_b16 a[30:31], v79 offset:4096
 ds_read_b64_tr_b16 a[32:33], v72 offset:8192
 ds_read_b64_tr_b16 a[34:35], v72 offset:12288
 ds_read_b64_tr_b16 a[36:37], v73 offset:8192
 ds_read_b64_tr_b16 a[38:39], v73 offset:12288
 ds_read_b64_tr_b16 a[40:41], v74 offset:8192
 ds_read_b64_tr_b16 a[42:43], v74 offset:12288
 ds_read_b64_tr_b16 a[44:45], v75 offset:8192
 ds_read_b64_tr_b16 a[46:47], v75 offset:12288
 ds_read_b64_tr_b16 a[48:49], v76 offset:8192
 ds_read_b64_tr_b16 a[50:51], v76 offset:12288
 ds_read_b64_tr_b16 a[52:53], v77 offset:8192
 ds_read_b64_tr_b16 a[54:55], v77 offset:12288
 ds_read_b64_tr_b16 a[56:57], v78 offset:8192
 ds_read_b64_tr_b16 a[58:59], v78 offset:12288
 ds_read_b64_tr_b16 a[60:61], v79 offset:8192
 ds_read_b64_tr_b16 a[62:63], v79 offset:12288
 s_waitcnt vmcnt(14)
 s_waitcnt lgkmcnt(15)
 v_mfma_f32_16x16x32_bf16 v[4:7], a[0:3], a[96:99], 0
 v_mfma_f32_16x16x32_bf16 v[8:11], a[0:3], a[100:103], 0
 s_barrier
 v_mfma_f32_16x16x32_bf16 v[16:19], a[4:7], a[100:103], 0
 ds_read_b64_tr_b16 a[64:65], v72 offset:16384
 buffer_load_dwordx4 v239, s[52:55], s56 offen lds
 v_mfma_f32_16x16x32_bf16 v[12:15], a[4:7], a[96:99], 0
 ds_read_b64_tr_b16 a[66:67], v72 offset:20480
 v_mfma_f32_16x16x32_bf16 v[20:23], a[8:11], a[96:99], 0
 ds_read_b64_tr_b16 a[68:69], v73 offset:16384
 buffer_load_dwordx4 v240, s[52:55], s56 offen offset:1024 lds
 v_mfma_f32_16x16x32_bf16 v[24:27], a[8:11], a[100:103], 0
 ds_read_b64_tr_b16 a[70:71], v73 offset:20480
 v_mfma_f32_16x16x32_bf16 v[32:35], a[12:15], a[100:103], 0
 ds_read_b64_tr_b16 a[72:73], v74 offset:16384
 buffer_load_dwordx4 v241, s[52:55], s56 offen offset:2048 lds
 v_mfma_f32_16x16x32_bf16 v[28:31], a[12:15], a[96:99], 0
 ds_read_b64_tr_b16 a[74:75], v74 offset:20480
 s_waitcnt vmcnt(15) lgkmcnt(6)
 v_mfma_f32_16x16x32_bf16 v[36:39], a[16:19], a[96:99], 0
 ds_read_b64_tr_b16 a[76:77], v75 offset:16384
 v_mfma_f32_16x16x32_bf16 v[40:43], a[16:19], a[100:103], 0
 ds_read_b64_tr_b16 a[78:79], v75 offset:20480
 buffer_load_dwordx4 a[160:163], v70, s[24:27], s41 offen sc1
 v_mfma_f32_16x16x32_bf16 v[48:51], a[20:23], a[100:103], 0
 ds_read_b64_tr_b16 a[80:81], v76 offset:16384
 v_mfma_f32_16x16x32_bf16 v[44:47], a[20:23], a[96:99], 0
 ds_read_b64_tr_b16 a[82:83], v76 offset:20480
 buffer_load_dwordx4 a[164:167], v71, s[24:27], s41 offen sc1
 v_mfma_f32_16x16x32_bf16 v[52:55], a[24:27], a[96:99], 0
 ds_read_b64_tr_b16 a[84:85], v77 offset:16384
 v_mfma_f32_16x16x32_bf16 v[56:59], a[24:27], a[100:103], 0
 ds_read_b64_tr_b16 a[86:87], v77 offset:20480
 ds_read_b64_tr_b16 a[92:93], v79 offset:16384
 buffer_load_dwordx4 a[168:171], v70, s[24:27], s41 offen offset:1024 sc1
 v_mfma_f32_16x16x32_bf16 v[64:67], a[28:31], a[100:103], 0
 ds_read_b64_tr_b16 a[88:89], v78 offset:16384
 v_mfma_f32_16x16x32_bf16 v[60:63], a[28:31], a[96:99], 0
 ds_read_b64_tr_b16 a[90:91], v78 offset:20480
 ds_read_b64_tr_b16 a[94:95], v79 offset:20480
 v_mfma_f32_16x16x32_bf16 v[4:7], a[32:35], a[104:107], v[4:7]
 ds_read_b64_tr_b16 a[0:1], v72 offset:24576
 v_mfma_f32_16x16x32_bf16 v[8:11], a[32:35], a[108:111], v[8:11]
 ds_read_b64_tr_b16 a[2:3], v72 offset:28672
 v_mfma_f32_16x16x32_bf16 v[16:19], a[36:39], a[108:111], v[16:19]
 ds_read_b64_tr_b16 a[4:5], v73 offset:24576
 buffer_load_dwordx4 v242, s[52:55], s56 offen offset:3072 lds
 s_add_u32 m0, s57, 65536
 v_readlane_b32 s56, v246, 5
 v_mfma_f32_16x16x32_bf16 v[12:15], a[36:39], a[104:107], v[12:15]
 ds_read_b64_tr_b16 a[6:7], v73 offset:28672
 v_mfma_f32_16x16x32_bf16 v[20:23], a[40:43], a[104:107], v[20:23]
 ds_read_b64_tr_b16 a[8:9], v74 offset:24576
 v_mfma_f32_16x16x32_bf16 v[24:27], a[40:43], a[108:111], v[24:27]
 ds_read_b64_tr_b16 a[10:11], v74 offset:28672
 buffer_load_dwordx4 a[172:175], v71, s[24:27], s41 offen offset:1024 sc1
 v_mfma_f32_16x16x32_bf16 v[32:35], a[44:47], a[108:111], v[32:35]
 ds_read_b64_tr_b16 a[12:13], v75 offset:24576
 v_mfma_f32_16x16x32_bf16 v[28:31], a[44:47], a[104:107], v[28:31]
 ds_read_b64_tr_b16 a[14:15], v75 offset:28672
 s_waitcnt vmcnt(18) lgkmcnt(8)
 v_mfma_f32_16x16x32_bf16 v[36:39], a[48:51], a[104:107], v[36:39]
 ds_read_b64_tr_b16 a[16:17], v76 offset:24576
 v_mfma_f32_16x16x32_bf16 v[40:43], a[48:51], a[108:111], v[40:43]
 ds_read_b64_tr_b16 a[18:19], v76 offset:28672
 buffer_load_dwordx4 a[176:179], v70, s[24:27], s41 offen offset:2048 sc1
 v_mfma_f32_16x16x32_bf16 v[48:51], a[52:55], a[108:111], v[48:51]
 ds_read_b64_tr_b16 a[20:21], v77 offset:24576
 v_mfma_f32_16x16x32_bf16 v[44:47], a[52:55], a[104:107], v[44:47]
 ds_read_b64_tr_b16 a[22:23], v77 offset:28672
 v_mfma_f32_16x16x32_bf16 v[52:55], a[56:59], a[104:107], v[52:55]
 ds_read_b64_tr_b16 a[24:25], v78 offset:24576
 buffer_load_dwordx4 a[180:183], v71, s[24:27], s41 offen offset:2048 sc1
 v_mfma_f32_16x16x32_bf16 v[56:59], a[56:59], a[108:111], v[56:59]
 ds_read_b64_tr_b16 a[26:27], v78 offset:28672
 v_mfma_f32_16x16x32_bf16 v[64:67], a[60:63], a[108:111], v[64:67]
 ds_read_b64_tr_b16 a[28:29], v79 offset:24576
 v_mfma_f32_16x16x32_bf16 v[60:63], a[60:63], a[104:107], v[60:63]
 ds_read_b64_tr_b16 a[30:31], v79 offset:28672
 v_mfma_f32_16x16x32_bf16 v[4:7], a[64:67], a[112:115], v[4:7]
 v_mfma_f32_16x16x32_bf16 v[8:11], a[64:67], a[116:119], v[8:11]
 s_barrier
 v_mfma_f32_16x16x32_bf16 v[16:19], a[68:71], a[116:119], v[16:19]
 ds_read_b64_tr_b16 a[32:33], v72 offset:32768
 buffer_load_dwordx4 v239, s[52:55], s56 offen lds
 v_mfma_f32_16x16x32_bf16 v[12:15], a[68:71], a[112:115], v[12:15]
 ds_read_b64_tr_b16 a[34:35], v72 offset:36864
 v_mfma_f32_16x16x32_bf16 v[20:23], a[72:75], a[112:115], v[20:23]
 ds_read_b64_tr_b16 a[36:37], v73 offset:32768
 buffer_load_dwordx4 v240, s[52:55], s56 offen offset:1024 lds
 v_mfma_f32_16x16x32_bf16 v[24:27], a[72:75], a[116:119], v[24:27]
 ds_read_b64_tr_b16 a[38:39], v73 offset:36864
 v_mfma_f32_16x16x32_bf16 v[32:35], a[76:79], a[116:119], v[32:35]
 ds_read_b64_tr_b16 a[40:41], v74 offset:32768
 buffer_load_dwordx4 v241, s[52:55], s56 offen offset:2048 lds
 v_mfma_f32_16x16x32_bf16 v[28:31], a[76:79], a[112:115], v[28:31]
 ds_read_b64_tr_b16 a[42:43], v74 offset:36864
 s_waitcnt vmcnt(21) lgkmcnt(6)
 v_mfma_f32_16x16x32_bf16 v[36:39], a[80:83], a[112:115], v[36:39]
 ds_read_b64_tr_b16 a[44:45], v75 offset:32768
 v_mfma_f32_16x16x32_bf16 v[40:43], a[80:83], a[116:119], v[40:43]
 ds_read_b64_tr_b16 a[46:47], v75 offset:36864
 buffer_load_dwordx4 a[184:187], v70, s[24:27], s41 offen offset:3072 sc1
 v_mfma_f32_16x16x32_bf16 v[48:51], a[84:87], a[116:119], v[48:51]
 ds_read_b64_tr_b16 a[48:49], v76 offset:32768
 v_mfma_f32_16x16x32_bf16 v[44:47], a[84:87], a[112:115], v[44:47]
 ds_read_b64_tr_b16 a[50:51], v76 offset:36864
 buffer_load_dwordx4 a[188:191], v71, s[24:27], s41 offen offset:3072 sc1
 v_readlane_b32 s41, v247, 3
 v_mfma_f32_16x16x32_bf16 v[52:55], a[88:91], a[112:115], v[52:55]
 ds_read_b64_tr_b16 a[52:53], v77 offset:32768
 v_mfma_f32_16x16x32_bf16 v[56:59], a[88:91], a[116:119], v[56:59]
 ds_read_b64_tr_b16 a[54:55], v77 offset:36864
 ds_read_b64_tr_b16 a[60:61], v79 offset:32768
 buffer_load_dwordx4 a[192:195], v70, s[24:27], s41 offen sc1
 v_mfma_f32_16x16x32_bf16 v[64:67], a[92:95], a[116:119], v[64:67]
 ds_read_b64_tr_b16 a[56:57], v78 offset:32768
 v_mfma_f32_16x16x32_bf16 v[60:63], a[92:95], a[112:115], v[60:63]
 ds_read_b64_tr_b16 a[58:59], v78 offset:36864
 ds_read_b64_tr_b16 a[62:63], v79 offset:36864
 v_mfma_f32_16x16x32_bf16 v[4:7], a[0:3], a[120:123], v[4:7]
 ds_read_b64_tr_b16 a[64:65], v72 offset:40960
 v_mfma_f32_16x16x32_bf16 v[8:11], a[0:3], a[124:127], v[8:11]
 ds_read_b64_tr_b16 a[66:67], v72 offset:45056
 v_mfma_f32_16x16x32_bf16 v[16:19], a[4:7], a[124:127], v[16:19]
 ds_read_b64_tr_b16 a[68:69], v73 offset:40960
 buffer_load_dwordx4 v242, s[52:55], s56 offen offset:3072 lds
 s_add_u32 m0, s57, 81920
 v_readlane_b32 s56, v246, 6
 v_mfma_f32_16x16x32_bf16 v[12:15], a[4:7], a[120:123], v[12:15]
 ds_read_b64_tr_b16 a[70:71], v73 offset:45056
 v_mfma_f32_16x16x32_bf16 v[20:23], a[8:11], a[120:123], v[20:23]
 ds_read_b64_tr_b16 a[72:73], v74 offset:40960
 v_mfma_f32_16x16x32_bf16 v[24:27], a[8:11], a[124:127], v[24:27]
 ds_read_b64_tr_b16 a[74:75], v74 offset:45056
 buffer_load_dwordx4 a[196:199], v71, s[24:27], s41 offen sc1
 v_mfma_f32_16x16x32_bf16 v[32:35], a[12:15], a[124:127], v[32:35]
 ds_read_b64_tr_b16 a[76:77], v75 offset:40960
 v_mfma_f32_16x16x32_bf16 v[28:31], a[12:15], a[120:123], v[28:31]
 ds_read_b64_tr_b16 a[78:79], v75 offset:45056
 s_waitcnt vmcnt(24) lgkmcnt(8)
 v_mfma_f32_16x16x32_bf16 v[36:39], a[16:19], a[120:123], v[36:39]
 ds_read_b64_tr_b16 a[80:81], v76 offset:40960
 v_mfma_f32_16x16x32_bf16 v[40:43], a[16:19], a[124:127], v[40:43]
 ds_read_b64_tr_b16 a[82:83], v76 offset:45056
 buffer_load_dwordx4 a[200:203], v70, s[24:27], s41 offen offset:1024 sc1
 v_mfma_f32_16x16x32_bf16 v[48:51], a[20:23], a[124:127], v[48:51]
 ds_read_b64_tr_b16 a[84:85], v77 offset:40960
 v_mfma_f32_16x16x32_bf16 v[44:47], a[20:23], a[120:123], v[44:47]
 ds_read_b64_tr_b16 a[86:87], v77 offset:45056
 v_mfma_f32_16x16x32_bf16 v[52:55], a[24:27], a[120:123], v[52:55]
 ds_read_b64_tr_b16 a[88:89], v78 offset:40960
 buffer_load_dwordx4 a[204:207], v71, s[24:27], s41 offen offset:1024 sc1
 v_mfma_f32_16x16x32_bf16 v[56:59], a[24:27], a[124:127], v[56:59]
 ds_read_b64_tr_b16 a[90:91], v78 offset:45056
 v_mfma_f32_16x16x32_bf16 v[64:67], a[28:31], a[124:127], v[64:67]
 ds_read_b64_tr_b16 a[92:93], v79 offset:40960
 v_mfma_f32_16x16x32_bf16 v[60:63], a[28:31], a[120:123], v[60:63]
 ds_read_b64_tr_b16 a[94:95], v79 offset:45056
 v_mfma_f32_16x16x32_bf16 v[4:7], a[32:35], a[128:131], v[4:7]
 v_mfma_f32_16x16x32_bf16 v[8:11], a[32:35], a[132:135], v[8:11]
 s_barrier
 v_mfma_f32_16x16x32_bf16 v[16:19], a[36:39], a[132:135], v[16:19]
 ds_read_b64_tr_b16 a[0:1], v80 offset:49152
 buffer_load_dwordx4 v239, s[52:55], s56 offen lds
 v_mfma_f32_16x16x32_bf16 v[12:15], a[36:39], a[128:131], v[12:15]
 ds_read_b64_tr_b16 a[2:3], v80 offset:53248
 v_mfma_f32_16x16x32_bf16 v[20:23], a[40:43], a[128:131], v[20:23]
 ds_read_b64_tr_b16 a[4:5], v81 offset:49152
 buffer_load_dwordx4 v240, s[52:55], s56 offen offset:1024 lds
 v_mfma_f32_16x16x32_bf16 v[24:27], a[40:43], a[132:135], v[24:27]
 ds_read_b64_tr_b16 a[6:7], v81 offset:53248
 v_mfma_f32_16x16x32_bf16 v[32:35], a[44:47], a[132:135], v[32:35]
 ds_read_b64_tr_b16 a[8:9], v82 offset:49152
 buffer_load_dwordx4 v241, s[52:55], s56 offen offset:2048 lds
 v_mfma_f32_16x16x32_bf16 v[28:31], a[44:47], a[128:131], v[28:31]
 ds_read_b64_tr_b16 a[10:11], v82 offset:53248
 s_waitcnt vmcnt(27) lgkmcnt(6)
 v_mfma_f32_16x16x32_bf16 v[36:39], a[48:51], a[128:131], v[36:39]
 ds_read_b64_tr_b16 a[12:13], v83 offset:49152
 v_mfma_f32_16x16x32_bf16 v[40:43], a[48:51], a[132:135], v[40:43]
 ds_read_b64_tr_b16 a[14:15], v83 offset:53248
 buffer_load_dwordx4 a[208:211], v70, s[24:27], s41 offen offset:2048 sc1
 v_mfma_f32_16x16x32_bf16 v[48:51], a[52:55], a[132:135], v[48:51]
 ds_read_b64_tr_b16 a[16:17], v84 offset:49152
 v_mfma_f32_16x16x32_bf16 v[44:47], a[52:55], a[128:131], v[44:47]
 ds_read_b64_tr_b16 a[18:19], v84 offset:53248
 buffer_load_dwordx4 a[212:215], v71, s[24:27], s41 offen offset:2048 sc1
 v_mfma_f32_16x16x32_bf16 v[52:55], a[56:59], a[128:131], v[52:55]
 ds_read_b64_tr_b16 a[20:21], v85 offset:49152
 v_mfma_f32_16x16x32_bf16 v[56:59], a[56:59], a[132:135], v[56:59]
 ds_read_b64_tr_b16 a[22:23], v85 offset:53248
 ds_read_b64_tr_b16 a[28:29], v87 offset:49152
 buffer_load_dwordx4 a[216:219], v70, s[24:27], s41 offen offset:3072 sc1
 v_mfma_f32_16x16x32_bf16 v[64:67], a[60:63], a[132:135], v[64:67]
 ds_read_b64_tr_b16 a[24:25], v86 offset:49152
 v_mfma_f32_16x16x32_bf16 v[60:63], a[60:63], a[128:131], v[60:63]
 ds_read_b64_tr_b16 a[26:27], v86 offset:53248
 ds_read_b64_tr_b16 a[30:31], v87 offset:53248
 v_mfma_f32_16x16x32_bf16 v[4:7], a[64:67], a[136:139], v[4:7]
 ds_read_b64_tr_b16 a[32:33], v80 offset:57344
 v_mfma_f32_16x16x32_bf16 v[8:11], a[64:67], a[140:143], v[8:11]
 ds_read_b64_tr_b16 a[34:35], v80 offset:61440
 v_mfma_f32_16x16x32_bf16 v[16:19], a[68:71], a[140:143], v[16:19]
 ds_read_b64_tr_b16 a[36:37], v81 offset:57344
 buffer_load_dwordx4 v242, s[52:55], s56 offen offset:3072 lds
 s_add_u32 m0, s57, 98304
 v_readlane_b32 s56, v246, 7
 v_mfma_f32_16x16x32_bf16 v[12:15], a[68:71], a[136:139], v[12:15]
 ds_read_b64_tr_b16 a[38:39], v81 offset:61440
 v_mfma_f32_16x16x32_bf16 v[20:23], a[72:75], a[136:139], v[20:23]
 ds_read_b64_tr_b16 a[40:41], v82 offset:57344
 v_mfma_f32_16x16x32_bf16 v[24:27], a[72:75], a[140:143], v[24:27]
 ds_read_b64_tr_b16 a[42:43], v82 offset:61440
 buffer_load_dwordx4 a[220:223], v71, s[24:27], s41 offen offset:3072 sc1
 v_readlane_b32 s41, v247, 4
 v_mfma_f32_16x16x32_bf16 v[32:35], a[76:79], a[140:143], v[32:35]
 ds_read_b64_tr_b16 a[44:45], v83 offset:57344
 v_mfma_f32_16x16x32_bf16 v[28:31], a[76:79], a[136:139], v[28:31]
 ds_read_b64_tr_b16 a[46:47], v83 offset:61440
 s_waitcnt vmcnt(30) lgkmcnt(8)
 v_mfma_f32_16x16x32_bf16 v[36:39], a[80:83], a[136:139], v[36:39]
 ds_read_b64_tr_b16 a[48:49], v84 offset:57344
 v_mfma_f32_16x16x32_bf16 v[40:43], a[80:83], a[140:143], v[40:43]
 ds_read_b64_tr_b16 a[50:51], v84 offset:61440
 buffer_load_dwordx4 a[96:99], v70, s[24:27], s41 offen sc1
 v_mfma_f32_16x16x32_bf16 v[48:51], a[84:87], a[140:143], v[48:51]
 ds_read_b64_tr_b16 a[52:53], v85 offset:57344
 v_mfma_f32_16x16x32_bf16 v[44:47], a[84:87], a[136:139], v[44:47]
 ds_read_b64_tr_b16 a[54:55], v85 offset:61440
 v_mfma_f32_16x16x32_bf16 v[52:55], a[88:91], a[136:139], v[52:55]
 ds_read_b64_tr_b16 a[56:57], v86 offset:57344
 buffer_load_dwordx4 a[100:103], v71, s[24:27], s41 offen sc1
 v_mfma_f32_16x16x32_bf16 v[56:59], a[88:91], a[140:143], v[56:59]
 ds_read_b64_tr_b16 a[58:59], v86 offset:61440
 v_mfma_f32_16x16x32_bf16 v[64:67], a[92:95], a[140:143], v[64:67]
 ds_read_b64_tr_b16 a[60:61], v87 offset:57344
 v_mfma_f32_16x16x32_bf16 v[60:63], a[92:95], a[136:139], v[60:63]
 ds_read_b64_tr_b16 a[62:63], v87 offset:61440
 v_mfma_f32_16x16x32_bf16 v[4:7], a[0:3], a[144:147], v[4:7]
 s_waitcnt vmcnt(23)
 v_mfma_f32_16x16x32_bf16 v[8:11], a[0:3], a[148:151], v[8:11]
 s_barrier
 v_mfma_f32_16x16x32_bf16 v[16:19], a[4:7], a[148:151], v[16:19]
 ds_read_b64_tr_b16 a[64:65], v72 offset:49152
 buffer_load_dwordx4 v239, s[52:55], s56 offen lds
 v_mfma_f32_16x16x32_bf16 v[12:15], a[4:7], a[144:147], v[12:15]
 ds_read_b64_tr_b16 a[66:67], v72 offset:53248
 v_mfma_f32_16x16x32_bf16 v[20:23], a[8:11], a[144:147], v[20:23]
 ds_read_b64_tr_b16 a[68:69], v73 offset:49152
 buffer_load_dwordx4 v240, s[52:55], s56 offen offset:1024 lds
 v_mfma_f32_16x16x32_bf16 v[24:27], a[8:11], a[148:151], v[24:27]
 ds_read_b64_tr_b16 a[70:71], v73 offset:53248
 v_mfma_f32_16x16x32_bf16 v[32:35], a[12:15], a[148:151], v[32:35]
 ds_read_b64_tr_b16 a[72:73], v74 offset:49152
 buffer_load_dwordx4 v241, s[52:55], s56 offen offset:2048 lds
 v_mfma_f32_16x16x32_bf16 v[28:31], a[12:15], a[144:147], v[28:31]
 ds_read_b64_tr_b16 a[74:75], v74 offset:53248
 s_waitcnt lgkmcnt(6)
 v_mfma_f32_16x16x32_bf16 v[36:39], a[16:19], a[144:147], v[36:39]
 ds_read_b64_tr_b16 a[76:77], v75 offset:49152
 v_mfma_f32_16x16x32_bf16 v[40:43], a[16:19], a[148:151], v[40:43]
 ds_read_b64_tr_b16 a[78:79], v75 offset:53248
 buffer_load_dwordx4 a[104:107], v70, s[24:27], s41 offen offset:1024 sc1
 v_mfma_f32_16x16x32_bf16 v[48:51], a[20:23], a[148:151], v[48:51]
 ds_read_b64_tr_b16 a[80:81], v76 offset:49152
 v_mfma_f32_16x16x32_bf16 v[44:47], a[20:23], a[144:147], v[44:47]
 ds_read_b64_tr_b16 a[82:83], v76 offset:53248
 buffer_load_dwordx4 a[108:111], v71, s[24:27], s41 offen offset:1024 sc1
 v_mfma_f32_16x16x32_bf16 v[52:55], a[24:27], a[144:147], v[52:55]
 ds_read_b64_tr_b16 a[84:85], v77 offset:49152
 v_mfma_f32_16x16x32_bf16 v[56:59], a[24:27], a[148:151], v[56:59]
 ds_read_b64_tr_b16 a[86:87], v77 offset:53248
 ds_read_b64_tr_b16 a[92:93], v79 offset:49152
 buffer_load_dwordx4 a[112:115], v70, s[24:27], s41 offen offset:2048 sc1
 v_mfma_f32_16x16x32_bf16 v[64:67], a[28:31], a[148:151], v[64:67]
 ds_read_b64_tr_b16 a[88:89], v78 offset:49152
 v_mfma_f32_16x16x32_bf16 v[60:63], a[28:31], a[144:147], v[60:63]
 ds_read_b64_tr_b16 a[90:91], v78 offset:53248
 ds_read_b64_tr_b16 a[94:95], v79 offset:53248
 v_mfma_f32_16x16x32_bf16 v[4:7], a[32:35], a[152:155], v[4:7]
 ds_read_b64_tr_b16 a[0:1], v72 offset:57344
 v_mfma_f32_16x16x32_bf16 v[8:11], a[32:35], a[156:159], v[8:11]
 ds_read_b64_tr_b16 a[2:3], v72 offset:61440
 v_mfma_f32_16x16x32_bf16 v[16:19], a[36:39], a[156:159], v[16:19]
 ds_read_b64_tr_b16 a[4:5], v73 offset:57344
 buffer_load_dwordx4 v242, s[52:55], s56 offen offset:3072 lds
 s_add_u32 m0, s57, 0
 v_readlane_b32 s56, v246, 8
 v_mfma_f32_16x16x32_bf16 v[12:15], a[36:39], a[152:155], v[12:15]
 ds_read_b64_tr_b16 a[6:7], v73 offset:61440
 v_mfma_f32_16x16x32_bf16 v[20:23], a[40:43], a[152:155], v[20:23]
 ds_read_b64_tr_b16 a[8:9], v74 offset:57344
 v_mfma_f32_16x16x32_bf16 v[24:27], a[40:43], a[156:159], v[24:27]
 ds_read_b64_tr_b16 a[10:11], v74 offset:61440
 buffer_load_dwordx4 a[116:119], v71, s[24:27], s41 offen offset:2048 sc1
 v_mfma_f32_16x16x32_bf16 v[32:35], a[44:47], a[156:159], v[32:35]
 ds_read_b64_tr_b16 a[12:13], v75 offset:57344
 v_mfma_f32_16x16x32_bf16 v[28:31], a[44:47], a[152:155], v[28:31]
 ds_read_b64_tr_b16 a[14:15], v75 offset:61440
 s_waitcnt lgkmcnt(8)
 v_mfma_f32_16x16x32_bf16 v[36:39], a[48:51], a[152:155], v[36:39]
 ds_read_b64_tr_b16 a[16:17], v76 offset:57344
 v_mfma_f32_16x16x32_bf16 v[40:43], a[48:51], a[156:159], v[40:43]
 ds_read_b64_tr_b16 a[18:19], v76 offset:61440
 buffer_load_dwordx4 a[120:123], v70, s[24:27], s41 offen offset:3072 sc1
 v_mfma_f32_16x16x32_bf16 v[48:51], a[52:55], a[156:159], v[48:51]
 ds_read_b64_tr_b16 a[20:21], v77 offset:57344
 v_mfma_f32_16x16x32_bf16 v[44:47], a[52:55], a[152:155], v[44:47]
 ds_read_b64_tr_b16 a[22:23], v77 offset:61440
 v_mfma_f32_16x16x32_bf16 v[52:55], a[56:59], a[152:155], v[52:55]
 ds_read_b64_tr_b16 a[24:25], v78 offset:57344
 buffer_load_dwordx4 a[124:127], v71, s[24:27], s41 offen offset:3072 sc1
 v_readlane_b32 s41, v247, 5
 v_mfma_f32_16x16x32_bf16 v[56:59], a[56:59], a[156:159], v[56:59]
 ds_read_b64_tr_b16 a[26:27], v78 offset:61440
 v_mfma_f32_16x16x32_bf16 v[64:67], a[60:63], a[156:159], v[64:67]
 ds_read_b64_tr_b16 a[28:29], v79 offset:57344
 v_mfma_f32_16x16x32_bf16 v[60:63], a[60:63], a[152:155], v[60:63]
 ds_read_b64_tr_b16 a[30:31], v79 offset:61440
 v_mfma_f32_16x16x32_bf16 v[4:7], a[64:67], a[160:163], v[4:7]
 s_waitcnt vmcnt(23)
 v_mfma_f32_16x16x32_bf16 v[8:11], a[64:67], a[164:167], v[8:11]
 s_barrier
 v_mfma_f32_16x16x32_bf16 v[16:19], a[68:71], a[164:167], v[16:19]
 ds_read_b64_tr_b16 a[32:33], v80 offset:0
 buffer_load_dwordx4 v239, s[52:55], s56 offen lds
 v_mfma_f32_16x16x32_bf16 v[12:15], a[68:71], a[160:163], v[12:15]
 ds_read_b64_tr_b16 a[34:35], v80 offset:4096
 v_mfma_f32_16x16x32_bf16 v[20:23], a[72:75], a[160:163], v[20:23]
 ds_read_b64_tr_b16 a[36:37], v81 offset:0
 buffer_load_dwordx4 v240, s[52:55], s56 offen offset:1024 lds
 v_mfma_f32_16x16x32_bf16 v[24:27], a[72:75], a[164:167], v[24:27]
 ds_read_b64_tr_b16 a[38:39], v81 offset:4096
 v_mfma_f32_16x16x32_bf16 v[32:35], a[76:79], a[164:167], v[32:35]
 ds_read_b64_tr_b16 a[40:41], v82 offset:0
 buffer_load_dwordx4 v241, s[52:55], s56 offen offset:2048 lds
 v_mfma_f32_16x16x32_bf16 v[28:31], a[76:79], a[160:163], v[28:31]
 ds_read_b64_tr_b16 a[42:43], v82 offset:4096
 s_waitcnt lgkmcnt(6)
 v_mfma_f32_16x16x32_bf16 v[36:39], a[80:83], a[160:163], v[36:39]
 ds_read_b64_tr_b16 a[44:45], v83 offset:0
 v_mfma_f32_16x16x32_bf16 v[40:43], a[80:83], a[164:167], v[40:43]
 ds_read_b64_tr_b16 a[46:47], v83 offset:4096
 buffer_load_dwordx4 a[128:131], v70, s[24:27], s41 offen sc1
 v_mfma_f32_16x16x32_bf16 v[48:51], a[84:87], a[164:167], v[48:51]
 ds_read_b64_tr_b16 a[48:49], v84 offset:0
 v_mfma_f32_16x16x32_bf16 v[44:47], a[84:87], a[160:163], v[44:47]
 ds_read_b64_tr_b16 a[50:51], v84 offset:4096
 buffer_load_dwordx4 a[132:135], v71, s[24:27], s41 offen sc1
 v_mfma_f32_16x16x32_bf16 v[52:55], a[88:91], a[160:163], v[52:55]
 ds_read_b64_tr_b16 a[52:53], v85 offset:0
 v_mfma_f32_16x16x32_bf16 v[56:59], a[88:91], a[164:167], v[56:59]
 ds_read_b64_tr_b16 a[54:55], v85 offset:4096
 ds_read_b64_tr_b16 a[60:61], v87 offset:0
 buffer_load_dwordx4 a[136:139], v70, s[24:27], s41 offen offset:1024 sc1
 v_mfma_f32_16x16x32_bf16 v[64:67], a[92:95], a[164:167], v[64:67]
 ds_read_b64_tr_b16 a[56:57], v86 offset:0
 v_mfma_f32_16x16x32_bf16 v[60:63], a[92:95], a[160:163], v[60:63]
 ds_read_b64_tr_b16 a[58:59], v86 offset:4096
 ds_read_b64_tr_b16 a[62:63], v87 offset:4096
 v_mfma_f32_16x16x32_bf16 v[4:7], a[0:3], a[168:171], v[4:7]
 ds_read_b64_tr_b16 a[64:65], v80 offset:8192
 v_mfma_f32_16x16x32_bf16 v[8:11], a[0:3], a[172:175], v[8:11]
 ds_read_b64_tr_b16 a[66:67], v80 offset:12288
 v_mfma_f32_16x16x32_bf16 v[16:19], a[4:7], a[172:175], v[16:19]
 ds_read_b64_tr_b16 a[68:69], v81 offset:8192
 buffer_load_dwordx4 v242, s[52:55], s56 offen offset:3072 lds
 s_add_u32 m0, s57, 16384
 v_readlane_b32 s56, v246, 9
 v_mfma_f32_16x16x32_bf16 v[12:15], a[4:7], a[168:171], v[12:15]
 ds_read_b64_tr_b16 a[70:71], v81 offset:12288
 v_mfma_f32_16x16x32_bf16 v[20:23], a[8:11], a[168:171], v[20:23]
 ds_read_b64_tr_b16 a[72:73], v82 offset:8192
 v_mfma_f32_16x16x32_bf16 v[24:27], a[8:11], a[172:175], v[24:27]
 ds_read_b64_tr_b16 a[74:75], v82 offset:12288
 buffer_load_dwordx4 a[140:143], v71, s[24:27], s41 offen offset:1024 sc1
 v_mfma_f32_16x16x32_bf16 v[32:35], a[12:15], a[172:175], v[32:35]
 ds_read_b64_tr_b16 a[76:77], v83 offset:8192
 v_mfma_f32_16x16x32_bf16 v[28:31], a[12:15], a[168:171], v[28:31]
 ds_read_b64_tr_b16 a[78:79], v83 offset:12288
 s_waitcnt lgkmcnt(8)
 v_mfma_f32_16x16x32_bf16 v[36:39], a[16:19], a[168:171], v[36:39]
 ds_read_b64_tr_b16 a[80:81], v84 offset:8192
 v_mfma_f32_16x16x32_bf16 v[40:43], a[16:19], a[172:175], v[40:43]
 ds_read_b64_tr_b16 a[82:83], v84 offset:12288
 buffer_load_dwordx4 a[144:147], v70, s[24:27], s41 offen offset:2048 sc1
 v_mfma_f32_16x16x32_bf16 v[48:51], a[20:23], a[172:175], v[48:51]
 ds_read_b64_tr_b16 a[84:85], v85 offset:8192
 v_mfma_f32_16x16x32_bf16 v[44:47], a[20:23], a[168:171], v[44:47]
 ds_read_b64_tr_b16 a[86:87], v85 offset:12288
 v_mfma_f32_16x16x32_bf16 v[52:55], a[24:27], a[168:171], v[52:55]
 ds_read_b64_tr_b16 a[88:89], v86 offset:8192
 buffer_load_dwordx4 a[148:151], v71, s[24:27], s41 offen offset:2048 sc1
 v_mfma_f32_16x16x32_bf16 v[56:59], a[24:27], a[172:175], v[56:59]
 ds_read_b64_tr_b16 a[90:91], v86 offset:12288
 v_mfma_f32_16x16x32_bf16 v[64:67], a[28:31], a[172:175], v[64:67]
 ds_read_b64_tr_b16 a[92:93], v87 offset:8192
 v_mfma_f32_16x16x32_bf16 v[60:63], a[28:31], a[168:171], v[60:63]
 ds_read_b64_tr_b16 a[94:95], v87 offset:12288
 v_mfma_f32_16x16x32_bf16 v[4:7], a[32:35], a[176:179], v[4:7]
 s_waitcnt vmcnt(23)
 v_mfma_f32_16x16x32_bf16 v[8:11], a[32:35], a[180:183], v[8:11]
 s_barrier
 v_mfma_f32_16x16x32_bf16 v[16:19], a[36:39], a[180:183], v[16:19]
 ds_read_b64_tr_b16 a[0:1], v80 offset:16384
 buffer_load_dwordx4 v239, s[52:55], s56 offen lds
 v_mfma_f32_16x16x32_bf16 v[12:15], a[36:39], a[176:179], v[12:15]
 ds_read_b64_tr_b16 a[2:3], v80 offset:20480
 v_mfma_f32_16x16x32_bf16 v[20:23], a[40:43], a[176:179], v[20:23]
 ds_read_b64_tr_b16 a[4:5], v81 offset:16384
 buffer_load_dwordx4 v240, s[52:55], s56 offen offset:1024 lds
 v_mfma_f32_16x16x32_bf16 v[24:27], a[40:43], a[180:183], v[24:27]
 ds_read_b64_tr_b16 a[6:7], v81 offset:20480
 v_mfma_f32_16x16x32_bf16 v[32:35], a[44:47], a[180:183], v[32:35]
 ds_read_b64_tr_b16 a[8:9], v82 offset:16384
 buffer_load_dwordx4 v241, s[52:55], s56 offen offset:2048 lds
 v_mfma_f32_16x16x32_bf16 v[28:31], a[44:47], a[176:179], v[28:31]
 ds_read_b64_tr_b16 a[10:11], v82 offset:20480
 s_waitcnt lgkmcnt(6)
 v_mfma_f32_16x16x32_bf16 v[36:39], a[48:51], a[176:179], v[36:39]
 ds_read_b64_tr_b16 a[12:13], v83 offset:16384
 v_mfma_f32_16x16x32_bf16 v[40:43], a[48:51], a[180:183], v[40:43]
 ds_read_b64_tr_b16 a[14:15], v83 offset:20480
 buffer_load_dwordx4 a[152:155], v70, s[24:27], s41 offen offset:3072 sc1
 v_mfma_f32_16x16x32_bf16 v[48:51], a[52:55], a[180:183], v[48:51]
 ds_read_b64_tr_b16 a[16:17], v84 offset:16384
 v_mfma_f32_16x16x32_bf16 v[44:47], a[52:55], a[176:179], v[44:47]
 ds_read_b64_tr_b16 a[18:19], v84 offset:20480
 buffer_load_dwordx4 a[156:159], v71, s[24:27], s41 offen offset:3072 sc1
 v_readlane_b32 s41, v247, 6
 v_mfma_f32_16x16x32_bf16 v[52:55], a[56:59], a[176:179], v[52:55]
 ds_read_b64_tr_b16 a[20:21], v85 offset:16384
 v_mfma_f32_16x16x32_bf16 v[56:59], a[56:59], a[180:183], v[56:59]
 ds_read_b64_tr_b16 a[22:23], v85 offset:20480
 ds_read_b64_tr_b16 a[28:29], v87 offset:16384
 buffer_load_dwordx4 a[160:163], v70, s[24:27], s41 offen sc1
 v_mfma_f32_16x16x32_bf16 v[64:67], a[60:63], a[180:183], v[64:67]
 ds_read_b64_tr_b16 a[24:25], v86 offset:16384
 v_mfma_f32_16x16x32_bf16 v[60:63], a[60:63], a[176:179], v[60:63]
 ds_read_b64_tr_b16 a[26:27], v86 offset:20480
 ds_read_b64_tr_b16 a[30:31], v87 offset:20480
 v_mfma_f32_16x16x32_bf16 v[4:7], a[64:67], a[184:187], v[4:7]
 ds_read_b64_tr_b16 a[32:33], v80 offset:24576
 v_mfma_f32_16x16x32_bf16 v[8:11], a[64:67], a[188:191], v[8:11]
 ds_read_b64_tr_b16 a[34:35], v80 offset:28672
 v_mfma_f32_16x16x32_bf16 v[16:19], a[68:71], a[188:191], v[16:19]
 ds_read_b64_tr_b16 a[36:37], v81 offset:24576
 buffer_load_dwordx4 v242, s[52:55], s56 offen offset:3072 lds
 s_add_u32 m0, s57, 32768
 v_readlane_b32 s56, v246, 10
 v_mfma_f32_16x16x32_bf16 v[12:15], a[68:71], a[184:187], v[12:15]
 ds_read_b64_tr_b16 a[38:39], v81 offset:28672
 v_mfma_f32_16x16x32_bf16 v[20:23], a[72:75], a[184:187], v[20:23]
 ds_read_b64_tr_b16 a[40:41], v82 offset:24576
 v_mfma_f32_16x16x32_bf16 v[24:27], a[72:75], a[188:191], v[24:27]
 ds_read_b64_tr_b16 a[42:43], v82 offset:28672
 buffer_load_dwordx4 a[164:167], v71, s[24:27], s41 offen sc1
 v_mfma_f32_16x16x32_bf16 v[32:35], a[76:79], a[188:191], v[32:35]
 ds_read_b64_tr_b16 a[44:45], v83 offset:24576
 v_mfma_f32_16x16x32_bf16 v[28:31], a[76:79], a[184:187], v[28:31]
 ds_read_b64_tr_b16 a[46:47], v83 offset:28672
 s_waitcnt lgkmcnt(8)
 v_mfma_f32_16x16x32_bf16 v[36:39], a[80:83], a[184:187], v[36:39]
 ds_read_b64_tr_b16 a[48:49], v84 offset:24576
 v_mfma_f32_16x16x32_bf16 v[40:43], a[80:83], a[188:191], v[40:43]
 ds_read_b64_tr_b16 a[50:51], v84 offset:28672
 buffer_load_dwordx4 a[168:171], v70, s[24:27], s41 offen offset:1024 sc1
 v_mfma_f32_16x16x32_bf16 v[48:51], a[84:87], a[188:191], v[48:51]
 ds_read_b64_tr_b16 a[52:53], v85 offset:24576
 v_mfma_f32_16x16x32_bf16 v[44:47], a[84:87], a[184:187], v[44:47]
 ds_read_b64_tr_b16 a[54:55], v85 offset:28672
 v_mfma_f32_16x16x32_bf16 v[52:55], a[88:91], a[184:187], v[52:55]
 ds_read_b64_tr_b16 a[56:57], v86 offset:24576
 buffer_load_dwordx4 a[172:175], v71, s[24:27], s41 offen offset:1024 sc1
 v_mfma_f32_16x16x32_bf16 v[56:59], a[88:91], a[188:191], v[56:59]
 ds_read_b64_tr_b16 a[58:59], v86 offset:28672
 v_mfma_f32_16x16x32_bf16 v[64:67], a[92:95], a[188:191], v[64:67]
 ds_read_b64_tr_b16 a[60:61], v87 offset:24576
 v_mfma_f32_16x16x32_bf16 v[60:63], a[92:95], a[184:187], v[60:63]
 ds_read_b64_tr_b16 a[62:63], v87 offset:28672
 v_mfma_f32_16x16x32_bf16 v[4:7], a[0:3], a[192:195], v[4:7]
 s_waitcnt vmcnt(23)
 v_mfma_f32_16x16x32_bf16 v[8:11], a[0:3], a[196:199], v[8:11]
 s_barrier
 v_mfma_f32_16x16x32_bf16 v[16:19], a[4:7], a[196:199], v[16:19]
 ds_read_b64_tr_b16 a[64:65], v80 offset:32768
 buffer_load_dwordx4 v239, s[52:55], s56 offen lds
 v_mfma_f32_16x16x32_bf16 v[12:15], a[4:7], a[192:195], v[12:15]
 ds_read_b64_tr_b16 a[66:67], v80 offset:36864
 v_mfma_f32_16x16x32_bf16 v[20:23], a[8:11], a[192:195], v[20:23]
 ds_read_b64_tr_b16 a[68:69], v81 offset:32768
 buffer_load_dwordx4 v240, s[52:55], s56 offen offset:1024 lds
 v_mfma_f32_16x16x32_bf16 v[24:27], a[8:11], a[196:199], v[24:27]
 ds_read_b64_tr_b16 a[70:71], v81 offset:36864
 v_mfma_f32_16x16x32_bf16 v[32:35], a[12:15], a[196:199], v[32:35]
 ds_read_b64_tr_b16 a[72:73], v82 offset:32768
 buffer_load_dwordx4 v241, s[52:55], s56 offen offset:2048 lds
 v_mfma_f32_16x16x32_bf16 v[28:31], a[12:15], a[192:195], v[28:31]
 ds_read_b64_tr_b16 a[74:75], v82 offset:36864
 s_waitcnt lgkmcnt(6)
 v_mfma_f32_16x16x32_bf16 v[36:39], a[16:19], a[192:195], v[36:39]
 ds_read_b64_tr_b16 a[76:77], v83 offset:32768
 v_mfma_f32_16x16x32_bf16 v[40:43], a[16:19], a[196:199], v[40:43]
 ds_read_b64_tr_b16 a[78:79], v83 offset:36864
 buffer_load_dwordx4 a[176:179], v70, s[24:27], s41 offen offset:2048 sc1
 v_mfma_f32_16x16x32_bf16 v[48:51], a[20:23], a[196:199], v[48:51]
 ds_read_b64_tr_b16 a[80:81], v84 offset:32768
 v_mfma_f32_16x16x32_bf16 v[44:47], a[20:23], a[192:195], v[44:47]
 ds_read_b64_tr_b16 a[82:83], v84 offset:36864
 buffer_load_dwordx4 a[180:183], v71, s[24:27], s41 offen offset:2048 sc1
 v_mfma_f32_16x16x32_bf16 v[52:55], a[24:27], a[192:195], v[52:55]
 ds_read_b64_tr_b16 a[84:85], v85 offset:32768
 v_mfma_f32_16x16x32_bf16 v[56:59], a[24:27], a[196:199], v[56:59]
 ds_read_b64_tr_b16 a[86:87], v85 offset:36864
 ds_read_b64_tr_b16 a[92:93], v87 offset:32768
 buffer_load_dwordx4 a[184:187], v70, s[24:27], s41 offen offset:3072 sc1
 v_mfma_f32_16x16x32_bf16 v[64:67], a[28:31], a[196:199], v[64:67]
 ds_read_b64_tr_b16 a[88:89], v86 offset:32768
 v_mfma_f32_16x16x32_bf16 v[60:63], a[28:31], a[192:195], v[60:63]
 ds_read_b64_tr_b16 a[90:91], v86 offset:36864
 ds_read_b64_tr_b16 a[94:95], v87 offset:36864
 v_mfma_f32_16x16x32_bf16 v[4:7], a[32:35], a[200:203], v[4:7]
 ds_read_b64_tr_b16 a[0:1], v80 offset:40960
 v_mfma_f32_16x16x32_bf16 v[8:11], a[32:35], a[204:207], v[8:11]
 ds_read_b64_tr_b16 a[2:3], v80 offset:45056
 v_mfma_f32_16x16x32_bf16 v[16:19], a[36:39], a[204:207], v[16:19]
 ds_read_b64_tr_b16 a[4:5], v81 offset:40960
 buffer_load_dwordx4 v242, s[52:55], s56 offen offset:3072 lds
 s_add_u32 m0, s57, 114688
 v_readlane_b32 s56, v246, 11
 v_mfma_f32_16x16x32_bf16 v[12:15], a[36:39], a[200:203], v[12:15]
 ds_read_b64_tr_b16 a[6:7], v81 offset:45056
 v_mfma_f32_16x16x32_bf16 v[20:23], a[40:43], a[200:203], v[20:23]
 ds_read_b64_tr_b16 a[8:9], v82 offset:40960
 v_mfma_f32_16x16x32_bf16 v[24:27], a[40:43], a[204:207], v[24:27]
 ds_read_b64_tr_b16 a[10:11], v82 offset:45056
 buffer_load_dwordx4 a[188:191], v71, s[24:27], s41 offen offset:3072 sc1
 v_readlane_b32 s41, v247, 7
 v_mfma_f32_16x16x32_bf16 v[32:35], a[44:47], a[204:207], v[32:35]
 ds_read_b64_tr_b16 a[12:13], v83 offset:40960
 v_mfma_f32_16x16x32_bf16 v[28:31], a[44:47], a[200:203], v[28:31]
 ds_read_b64_tr_b16 a[14:15], v83 offset:45056
 s_waitcnt lgkmcnt(8)
 v_mfma_f32_16x16x32_bf16 v[36:39], a[48:51], a[200:203], v[36:39]
 ds_read_b64_tr_b16 a[16:17], v84 offset:40960
 v_mfma_f32_16x16x32_bf16 v[40:43], a[48:51], a[204:207], v[40:43]
 ds_read_b64_tr_b16 a[18:19], v84 offset:45056
 buffer_load_dwordx4 a[192:195], v70, s[24:27], s41 offen sc1
 v_mfma_f32_16x16x32_bf16 v[48:51], a[52:55], a[204:207], v[48:51]
 ds_read_b64_tr_b16 a[20:21], v85 offset:40960
 v_mfma_f32_16x16x32_bf16 v[44:47], a[52:55], a[200:203], v[44:47]
 ds_read_b64_tr_b16 a[22:23], v85 offset:45056
 v_mfma_f32_16x16x32_bf16 v[52:55], a[56:59], a[200:203], v[52:55]
 ds_read_b64_tr_b16 a[24:25], v86 offset:40960
 buffer_load_dwordx4 a[196:199], v71, s[24:27], s41 offen sc1
 v_mfma_f32_16x16x32_bf16 v[56:59], a[56:59], a[204:207], v[56:59]
 ds_read_b64_tr_b16 a[26:27], v86 offset:45056
 v_mfma_f32_16x16x32_bf16 v[64:67], a[60:63], a[204:207], v[64:67]
 ds_read_b64_tr_b16 a[28:29], v87 offset:40960
 v_mfma_f32_16x16x32_bf16 v[60:63], a[60:63], a[200:203], v[60:63]
 ds_read_b64_tr_b16 a[30:31], v87 offset:45056
 v_mfma_f32_16x16x32_bf16 v[4:7], a[64:67], a[208:211], v[4:7]
 s_waitcnt vmcnt(23)
 v_mfma_f32_16x16x32_bf16 v[8:11], a[64:67], a[212:215], v[8:11]
 s_barrier
 v_mfma_f32_16x16x32_bf16 v[16:19], a[68:71], a[212:215], v[16:19]
 ds_read_b64_tr_b16 a[32:33], v72 offset:0
 buffer_load_dwordx4 v239, s[52:55], s56 offen lds
 v_mfma_f32_16x16x32_bf16 v[12:15], a[68:71], a[208:211], v[12:15]
 ds_read_b64_tr_b16 a[34:35], v72 offset:4096
 v_mfma_f32_16x16x32_bf16 v[20:23], a[72:75], a[208:211], v[20:23]
 ds_read_b64_tr_b16 a[36:37], v73 offset:0
 buffer_load_dwordx4 v240, s[52:55], s56 offen offset:1024 lds
 v_mfma_f32_16x16x32_bf16 v[24:27], a[72:75], a[212:215], v[24:27]
 ds_read_b64_tr_b16 a[38:39], v73 offset:4096
 v_mfma_f32_16x16x32_bf16 v[32:35], a[76:79], a[212:215], v[32:35]
 ds_read_b64_tr_b16 a[40:41], v74 offset:0
 buffer_load_dwordx4 v241, s[52:55], s56 offen offset:2048 lds
 v_mfma_f32_16x16x32_bf16 v[28:31], a[76:79], a[208:211], v[28:31]
 ds_read_b64_tr_b16 a[42:43], v74 offset:4096
 s_waitcnt lgkmcnt(6)
 v_mfma_f32_16x16x32_bf16 v[36:39], a[80:83], a[208:211], v[36:39]
 ds_read_b64_tr_b16 a[44:45], v75 offset:0
 v_mfma_f32_16x16x32_bf16 v[40:43], a[80:83], a[212:215], v[40:43]
 ds_read_b64_tr_b16 a[46:47], v75 offset:4096
 buffer_load_dwordx4 a[200:203], v70, s[24:27], s41 offen offset:1024 sc1
 v_mfma_f32_16x16x32_bf16 v[48:51], a[84:87], a[212:215], v[48:51]
 ds_read_b64_tr_b16 a[48:49], v76 offset:0
 v_mfma_f32_16x16x32_bf16 v[44:47], a[84:87], a[208:211], v[44:47]
 ds_read_b64_tr_b16 a[50:51], v76 offset:4096
 buffer_load_dwordx4 a[204:207], v71, s[24:27], s41 offen offset:1024 sc1
 v_mfma_f32_16x16x32_bf16 v[52:55], a[88:91], a[208:211], v[52:55]
 ds_read_b64_tr_b16 a[52:53], v77 offset:0
 v_mfma_f32_16x16x32_bf16 v[56:59], a[88:91], a[212:215], v[56:59]
 ds_read_b64_tr_b16 a[54:55], v77 offset:4096
 ds_read_b64_tr_b16 a[60:61], v79 offset:0
 v_mfma_f32_16x16x32_bf16 v[64:67], a[92:95], a[212:215], v[64:67]
 ds_read_b64_tr_b16 a[56:57], v78 offset:0
 v_mfma_f32_16x16x32_bf16 v[60:63], a[92:95], a[208:211], v[60:63]
 ds_read_b64_tr_b16 a[58:59], v78 offset:4096
 ds_read_b64_tr_b16 a[62:63], v79 offset:4096
 v_mfma_f32_16x16x32_bf16 v[4:7], a[0:3], a[216:219], v[4:7]
 ds_read_b64_tr_b16 a[64:65], v72 offset:8192
 v_mfma_f32_16x16x32_bf16 v[8:11], a[0:3], a[220:223], v[8:11]
 ds_read_b64_tr_b16 a[66:67], v72 offset:12288
 v_mfma_f32_16x16x32_bf16 v[16:19], a[4:7], a[220:223], v[16:19]
 ds_read_b64_tr_b16 a[68:69], v73 offset:8192
 buffer_load_dwordx4 v242, s[52:55], s56 offen offset:3072 lds
 s_add_u32 m0, s57, 49152
 v_readlane_b32 s56, v246, 12
 v_mfma_f32_16x16x32_bf16 v[12:15], a[4:7], a[216:219], v[12:15]
 ds_read_b64_tr_b16 a[70:71], v73 offset:12288
 v_mfma_f32_16x16x32_bf16 v[20:23], a[8:11], a[216:219], v[20:23]
 ds_read_b64_tr_b16 a[72:73], v74 offset:8192
 v_mfma_f32_16x16x32_bf16 v[24:27], a[8:11], a[220:223], v[24:27]
 ds_read_b64_tr_b16 a[74:75], v74 offset:12288
 v_mfma_f32_16x16x32_bf16 v[32:35], a[12:15], a[220:223], v[32:35]
 ds_read_b64_tr_b16 a[76:77], v75 offset:8192
 buffer_load_dwordx4 a[208:211], v70, s[24:27], s41 offen offset:2048 sc1
 v_mfma_f32_16x16x32_bf16 v[28:31], a[12:15], a[216:219], v[28:31]
 ds_read_b64_tr_b16 a[78:79], v75 offset:12288
 s_waitcnt lgkmcnt(8)
 v_mfma_f32_16x16x32_bf16 v[36:39], a[16:19], a[216:219], v[36:39]
 ds_read_b64_tr_b16 a[80:81], v76 offset:8192
 v_mfma_f32_16x16x32_bf16 v[40:43], a[16:19], a[220:223], v[40:43]
 ds_read_b64_tr_b16 a[82:83], v76 offset:12288
 v_mfma_f32_16x16x32_bf16 v[48:51], a[20:23], a[220:223], v[48:51]
 ds_read_b64_tr_b16 a[84:85], v77 offset:8192
 v_mfma_f32_16x16x32_bf16 v[44:47], a[20:23], a[216:219], v[44:47]
 ds_read_b64_tr_b16 a[86:87], v77 offset:12288
 buffer_load_dwordx4 a[212:215], v71, s[24:27], s41 offen offset:2048 sc1
 v_mfma_f32_16x16x32_bf16 v[52:55], a[24:27], a[216:219], v[52:55]
 ds_read_b64_tr_b16 a[88:89], v78 offset:8192
 v_mfma_f32_16x16x32_bf16 v[56:59], a[24:27], a[220:223], v[56:59]
 ds_read_b64_tr_b16 a[90:91], v78 offset:12288
 v_mfma_f32_16x16x32_bf16 v[64:67], a[28:31], a[220:223], v[64:67]
 ds_read_b64_tr_b16 a[92:93], v79 offset:8192
 v_mfma_f32_16x16x32_bf16 v[60:63], a[28:31], a[216:219], v[60:63]
 ds_read_b64_tr_b16 a[94:95], v79 offset:12288
 v_mfma_f32_16x16x32_bf16 v[4:7], a[32:35], a[96:99], v[4:7]
 s_waitcnt vmcnt(21)
 v_mfma_f32_16x16x32_bf16 v[8:11], a[32:35], a[100:103], v[8:11]
 s_barrier
 v_mfma_f32_16x16x32_bf16 v[16:19], a[36:39], a[100:103], v[16:19]
 ds_read_b64_tr_b16 a[0:1], v72 offset:16384
 buffer_load_dwordx4 v239, s[52:55], s56 offen lds
 v_mfma_f32_16x16x32_bf16 v[12:15], a[36:39], a[96:99], v[12:15]
 ds_read_b64_tr_b16 a[2:3], v72 offset:20480
 v_mfma_f32_16x16x32_bf16 v[20:23], a[40:43], a[96:99], v[20:23]
 ds_read_b64_tr_b16 a[4:5], v73 offset:16384
 buffer_load_dwordx4 v240, s[52:55], s56 offen offset:1024 lds
 v_mfma_f32_16x16x32_bf16 v[24:27], a[40:43], a[100:103], v[24:27]
 ds_read_b64_tr_b16 a[6:7], v73 offset:20480
 v_mfma_f32_16x16x32_bf16 v[32:35], a[44:47], a[100:103], v[32:35]
 ds_read_b64_tr_b16 a[8:9], v74 offset:16384
 buffer_load_dwordx4 v241, s[52:55], s56 offen offset:2048 lds
 v_mfma_f32_16x16x32_bf16 v[28:31], a[44:47], a[96:99], v[28:31]
 ds_read_b64_tr_b16 a[10:11], v74 offset:20480
 s_waitcnt lgkmcnt(6)
 v_mfma_f32_16x16x32_bf16 v[36:39], a[48:51], a[96:99], v[36:39]
 ds_read_b64_tr_b16 a[12:13], v75 offset:16384
 v_mfma_f32_16x16x32_bf16 v[40:43], a[48:51], a[100:103], v[40:43]
 ds_read_b64_tr_b16 a[14:15], v75 offset:20480
 buffer_load_dwordx4 a[216:219], v70, s[24:27], s41 offen offset:3072 sc1
 v_mfma_f32_16x16x32_bf16 v[48:51], a[52:55], a[100:103], v[48:51]
 ds_read_b64_tr_b16 a[16:17], v76 offset:16384
 v_mfma_f32_16x16x32_bf16 v[44:47], a[52:55], a[96:99], v[44:47]
 ds_read_b64_tr_b16 a[18:19], v76 offset:20480
 buffer_load_dwordx4 a[220:223], v71, s[24:27], s41 offen offset:3072 sc1
 v_readlane_b32 s41, v247, 8
 v_mfma_f32_16x16x32_bf16 v[52:55], a[56:59], a[96:99], v[52:55]
 ds_read_b64_tr_b16 a[20:21], v77 offset:16384
 v_mfma_f32_16x16x32_bf16 v[56:59], a[56:59], a[100:103], v[56:59]
 ds_read_b64_tr_b16 a[22:23], v77 offset:20480
 ds_read_b64_tr_b16 a[28:29], v79 offset:16384
 v_mfma_f32_16x16x32_bf16 v[64:67], a[60:63], a[100:103], v[64:67]
 ds_read_b64_tr_b16 a[24:25], v78 offset:16384
 v_mfma_f32_16x16x32_bf16 v[60:63], a[60:63], a[96:99], v[60:63]
 ds_read_b64_tr_b16 a[26:27], v78 offset:20480
 ds_read_b64_tr_b16 a[30:31], v79 offset:20480
 v_mfma_f32_16x16x32_bf16 v[4:7], a[64:67], a[104:107], v[4:7]
 ds_read_b64_tr_b16 a[32:33], v72 offset:24576
 v_mfma_f32_16x16x32_bf16 v[8:11], a[64:67], a[108:111], v[8:11]
 ds_read_b64_tr_b16 a[34:35], v72 offset:28672
 v_mfma_f32_16x16x32_bf16 v[16:19], a[68:71], a[108:111], v[16:19]
 ds_read_b64_tr_b16 a[36:37], v73 offset:24576
 buffer_load_dwordx4 v242, s[52:55], s56 offen offset:3072 lds
 s_add_u32 m0, s57, 65536
 v_readlane_b32 s56, v246, 13
 v_mfma_f32_16x16x32_bf16 v[12:15], a[68:71], a[104:107], v[12:15]
 ds_read_b64_tr_b16 a[38:39], v73 offset:28672
 v_mfma_f32_16x16x32_bf16 v[20:23], a[72:75], a[104:107], v[20:23]
 ds_read_b64_tr_b16 a[40:41], v74 offset:24576
 v_mfma_f32_16x16x32_bf16 v[24:27], a[72:75], a[108:111], v[24:27]
 ds_read_b64_tr_b16 a[42:43], v74 offset:28672
 v_mfma_f32_16x16x32_bf16 v[32:35], a[76:79], a[108:111], v[32:35]
 ds_read_b64_tr_b16 a[44:45], v75 offset:24576
 buffer_load_dwordx4 a[96:99], v70, s[24:27], s41 offen sc1
 v_mfma_f32_16x16x32_bf16 v[28:31], a[76:79], a[104:107], v[28:31]
 ds_read_b64_tr_b16 a[46:47], v75 offset:28672
 s_waitcnt lgkmcnt(8)
 v_mfma_f32_16x16x32_bf16 v[36:39], a[80:83], a[104:107], v[36:39]
 ds_read_b64_tr_b16 a[48:49], v76 offset:24576
 v_mfma_f32_16x16x32_bf16 v[40:43], a[80:83], a[108:111], v[40:43]
 ds_read_b64_tr_b16 a[50:51], v76 offset:28672
 v_mfma_f32_16x16x32_bf16 v[48:51], a[84:87], a[108:111], v[48:51]
 ds_read_b64_tr_b16 a[52:53], v77 offset:24576
 v_mfma_f32_16x16x32_bf16 v[44:47], a[84:87], a[104:107], v[44:47]
 ds_read_b64_tr_b16 a[54:55], v77 offset:28672
 buffer_load_dwordx4 a[100:103], v71, s[24:27], s41 offen sc1
 v_mfma_f32_16x16x32_bf16 v[52:55], a[88:91], a[104:107], v[52:55]
 ds_read_b64_tr_b16 a[56:57], v78 offset:24576
 v_mfma_f32_16x16x32_bf16 v[56:59], a[88:91], a[108:111], v[56:59]
 ds_read_b64_tr_b16 a[58:59], v78 offset:28672
 v_mfma_f32_16x16x32_bf16 v[64:67], a[92:95], a[108:111], v[64:67]
 ds_read_b64_tr_b16 a[60:61], v79 offset:24576
 v_mfma_f32_16x16x32_bf16 v[60:63], a[92:95], a[104:107], v[60:63]
 ds_read_b64_tr_b16 a[62:63], v79 offset:28672
 v_mfma_f32_16x16x32_bf16 v[4:7], a[0:3], a[112:115], v[4:7]
 s_waitcnt vmcnt(19)
 v_mfma_f32_16x16x32_bf16 v[8:11], a[0:3], a[116:119], v[8:11]
 s_barrier
 v_mfma_f32_16x16x32_bf16 v[16:19], a[4:7], a[116:119], v[16:19]
 ds_read_b64_tr_b16 a[64:65], v72 offset:32768
 buffer_load_dwordx4 v239, s[52:55], s56 offen lds
 v_mfma_f32_16x16x32_bf16 v[12:15], a[4:7], a[112:115], v[12:15]
 ds_read_b64_tr_b16 a[66:67], v72 offset:36864
 v_mfma_f32_16x16x32_bf16 v[20:23], a[8:11], a[112:115], v[20:23]
 ds_read_b64_tr_b16 a[68:69], v73 offset:32768
 buffer_load_dwordx4 v240, s[52:55], s56 offen offset:1024 lds
 v_mfma_f32_16x16x32_bf16 v[24:27], a[8:11], a[116:119], v[24:27]
 ds_read_b64_tr_b16 a[70:71], v73 offset:36864
 v_mfma_f32_16x16x32_bf16 v[32:35], a[12:15], a[116:119], v[32:35]
 ds_read_b64_tr_b16 a[72:73], v74 offset:32768
 buffer_load_dwordx4 v241, s[52:55], s56 offen offset:2048 lds
 v_mfma_f32_16x16x32_bf16 v[28:31], a[12:15], a[112:115], v[28:31]
 ds_read_b64_tr_b16 a[74:75], v74 offset:36864
 s_waitcnt lgkmcnt(6)
 v_mfma_f32_16x16x32_bf16 v[36:39], a[16:19], a[112:115], v[36:39]
 ds_read_b64_tr_b16 a[76:77], v75 offset:32768
 v_mfma_f32_16x16x32_bf16 v[40:43], a[16:19], a[116:119], v[40:43]
 ds_read_b64_tr_b16 a[78:79], v75 offset:36864
 buffer_load_dwordx4 a[104:107], v70, s[24:27], s41 offen offset:1024 sc1
 v_mfma_f32_16x16x32_bf16 v[48:51], a[20:23], a[116:119], v[48:51]
 ds_read_b64_tr_b16 a[80:81], v76 offset:32768
 v_mfma_f32_16x16x32_bf16 v[44:47], a[20:23], a[112:115], v[44:47]
 ds_read_b64_tr_b16 a[82:83], v76 offset:36864
 buffer_load_dwordx4 a[108:111], v71, s[24:27], s41 offen offset:1024 sc1
 v_mfma_f32_16x16x32_bf16 v[52:55], a[24:27], a[112:115], v[52:55]
 ds_read_b64_tr_b16 a[84:85], v77 offset:32768
 v_mfma_f32_16x16x32_bf16 v[56:59], a[24:27], a[116:119], v[56:59]
 ds_read_b64_tr_b16 a[86:87], v77 offset:36864
 ds_read_b64_tr_b16 a[92:93], v79 offset:32768
 v_mfma_f32_16x16x32_bf16 v[64:67], a[28:31], a[116:119], v[64:67]
 ds_read_b64_tr_b16 a[88:89], v78 offset:32768
 v_mfma_f32_16x16x32_bf16 v[60:63], a[28:31], a[112:115], v[60:63]
 ds_read_b64_tr_b16 a[90:91], v78 offset:36864
 ds_read_b64_tr_b16 a[94:95], v79 offset:36864
 v_mfma_f32_16x16x32_bf16 v[4:7], a[32:35], a[120:123], v[4:7]
 ds_read_b64_tr_b16 a[0:1], v72 offset:40960
 v_mfma_f32_16x16x32_bf16 v[8:11], a[32:35], a[124:127], v[8:11]
 ds_read_b64_tr_b16 a[2:3], v72 offset:45056
 v_mfma_f32_16x16x32_bf16 v[16:19], a[36:39], a[124:127], v[16:19]
 ds_read_b64_tr_b16 a[4:5], v73 offset:40960
 buffer_load_dwordx4 v242, s[52:55], s56 offen offset:3072 lds
 s_add_u32 m0, s57, 81920
 v_readlane_b32 s56, v246, 14
 v_mfma_f32_16x16x32_bf16 v[12:15], a[36:39], a[120:123], v[12:15]
 ds_read_b64_tr_b16 a[6:7], v73 offset:45056
 v_mfma_f32_16x16x32_bf16 v[20:23], a[40:43], a[120:123], v[20:23]
 ds_read_b64_tr_b16 a[8:9], v74 offset:40960
 v_mfma_f32_16x16x32_bf16 v[24:27], a[40:43], a[124:127], v[24:27]
 ds_read_b64_tr_b16 a[10:11], v74 offset:45056
 v_mfma_f32_16x16x32_bf16 v[32:35], a[44:47], a[124:127], v[32:35]
 ds_read_b64_tr_b16 a[12:13], v75 offset:40960
 buffer_load_dwordx4 a[112:115], v70, s[24:27], s41 offen offset:2048 sc1
 v_mfma_f32_16x16x32_bf16 v[28:31], a[44:47], a[120:123], v[28:31]
 ds_read_b64_tr_b16 a[14:15], v75 offset:45056
 s_waitcnt lgkmcnt(8)
 v_mfma_f32_16x16x32_bf16 v[36:39], a[48:51], a[120:123], v[36:39]
 ds_read_b64_tr_b16 a[16:17], v76 offset:40960
 v_mfma_f32_16x16x32_bf16 v[40:43], a[48:51], a[124:127], v[40:43]
 ds_read_b64_tr_b16 a[18:19], v76 offset:45056
 v_mfma_f32_16x16x32_bf16 v[48:51], a[52:55], a[124:127], v[48:51]
 ds_read_b64_tr_b16 a[20:21], v77 offset:40960
 v_mfma_f32_16x16x32_bf16 v[44:47], a[52:55], a[120:123], v[44:47]
 ds_read_b64_tr_b16 a[22:23], v77 offset:45056
 buffer_load_dwordx4 a[116:119], v71, s[24:27], s41 offen offset:2048 sc1
 v_mfma_f32_16x16x32_bf16 v[52:55], a[56:59], a[120:123], v[52:55]
 ds_read_b64_tr_b16 a[24:25], v78 offset:40960
 v_mfma_f32_16x16x32_bf16 v[56:59], a[56:59], a[124:127], v[56:59]
 ds_read_b64_tr_b16 a[26:27], v78 offset:45056
 v_mfma_f32_16x16x32_bf16 v[64:67], a[60:63], a[124:127], v[64:67]
 ds_read_b64_tr_b16 a[28:29], v79 offset:40960
 v_mfma_f32_16x16x32_bf16 v[60:63], a[60:63], a[120:123], v[60:63]
 ds_read_b64_tr_b16 a[30:31], v79 offset:45056
 v_mfma_f32_16x16x32_bf16 v[4:7], a[64:67], a[128:131], v[4:7]
 s_waitcnt vmcnt(18)
 v_mfma_f32_16x16x32_bf16 v[8:11], a[64:67], a[132:135], v[8:11]
 s_barrier
 v_mfma_f32_16x16x32_bf16 v[16:19], a[68:71], a[132:135], v[16:19]
 ds_read_b64_tr_b16 a[32:33], v80 offset:49152
 buffer_load_dwordx4 v239, s[52:55], s56 offen lds
 v_mfma_f32_16x16x32_bf16 v[12:15], a[68:71], a[128:131], v[12:15]
 ds_read_b64_tr_b16 a[34:35], v80 offset:53248
 v_mfma_f32_16x16x32_bf16 v[20:23], a[72:75], a[128:131], v[20:23]
 ds_read_b64_tr_b16 a[36:37], v81 offset:49152
 buffer_load_dwordx4 v240, s[52:55], s56 offen offset:1024 lds
 v_mfma_f32_16x16x32_bf16 v[24:27], a[72:75], a[132:135], v[24:27]
 ds_read_b64_tr_b16 a[38:39], v81 offset:53248
 v_mfma_f32_16x16x32_bf16 v[32:35], a[76:79], a[132:135], v[32:35]
 ds_read_b64_tr_b16 a[40:41], v82 offset:49152
 buffer_load_dwordx4 v241, s[52:55], s56 offen offset:2048 lds
 v_mfma_f32_16x16x32_bf16 v[28:31], a[76:79], a[128:131], v[28:31]
 ds_read_b64_tr_b16 a[42:43], v82 offset:53248
 s_waitcnt lgkmcnt(6)
 v_mfma_f32_16x16x32_bf16 v[36:39], a[80:83], a[128:131], v[36:39]
 ds_read_b64_tr_b16 a[44:45], v83 offset:49152
 v_mfma_f32_16x16x32_bf16 v[40:43], a[80:83], a[132:135], v[40:43]
 ds_read_b64_tr_b16 a[46:47], v83 offset:53248
 buffer_load_dwordx4 a[120:123], v70, s[24:27], s41 offen offset:3072 sc1
 v_mfma_f32_16x16x32_bf16 v[48:51], a[84:87], a[132:135], v[48:51]
 ds_read_b64_tr_b16 a[48:49], v84 offset:49152
 v_mfma_f32_16x16x32_bf16 v[44:47], a[84:87], a[128:131], v[44:47]
 ds_read_b64_tr_b16 a[50:51], v84 offset:53248
 buffer_load_dwordx4 a[124:127], v71, s[24:27], s41 offen offset:3072 sc1
 v_readlane_b32 s41, v247, 9
 v_mfma_f32_16x16x32_bf16 v[52:55], a[88:91], a[128:131], v[52:55]
 ds_read_b64_tr_b16 a[52:53], v85 offset:49152
 v_mfma_f32_16x16x32_bf16 v[56:59], a[88:91], a[132:135], v[56:59]
 ds_read_b64_tr_b16 a[54:55], v85 offset:53248
 ds_read_b64_tr_b16 a[60:61], v87 offset:49152
 v_mfma_f32_16x16x32_bf16 v[64:67], a[92:95], a[132:135], v[64:67]
 ds_read_b64_tr_b16 a[56:57], v86 offset:49152
 v_mfma_f32_16x16x32_bf16 v[60:63], a[92:95], a[128:131], v[60:63]
 ds_read_b64_tr_b16 a[58:59], v86 offset:53248
 ds_read_b64_tr_b16 a[62:63], v87 offset:53248
 v_mfma_f32_16x16x32_bf16 v[4:7], a[0:3], a[136:139], v[4:7]
 ds_read_b64_tr_b16 a[64:65], v80 offset:57344
 v_mfma_f32_16x16x32_bf16 v[8:11], a[0:3], a[140:143], v[8:11]
 ds_read_b64_tr_b16 a[66:67], v80 offset:61440
 v_mfma_f32_16x16x32_bf16 v[16:19], a[4:7], a[140:143], v[16:19]
 ds_read_b64_tr_b16 a[68:69], v81 offset:57344
 buffer_load_dwordx4 v242, s[52:55], s56 offen offset:3072 lds
 s_add_u32 m0, s57, 98304
 v_readlane_b32 s56, v246, 15
 v_mfma_f32_16x16x32_bf16 v[12:15], a[4:7], a[136:139], v[12:15]
 ds_read_b64_tr_b16 a[70:71], v81 offset:61440
 v_mfma_f32_16x16x32_bf16 v[20:23], a[8:11], a[136:139], v[20:23]
 ds_read_b64_tr_b16 a[72:73], v82 offset:57344
 v_mfma_f32_16x16x32_bf16 v[24:27], a[8:11], a[140:143], v[24:27]
 ds_read_b64_tr_b16 a[74:75], v82 offset:61440
 v_mfma_f32_16x16x32_bf16 v[32:35], a[12:15], a[140:143], v[32:35]
 ds_read_b64_tr_b16 a[76:77], v83 offset:57344
 buffer_load_dwordx4 a[128:131], v70, s[24:27], s41 offen sc1
 v_mfma_f32_16x16x32_bf16 v[28:31], a[12:15], a[136:139], v[28:31]
 ds_read_b64_tr_b16 a[78:79], v83 offset:61440
 s_waitcnt lgkmcnt(8)
 v_mfma_f32_16x16x32_bf16 v[36:39], a[16:19], a[136:139], v[36:39]
 ds_read_b64_tr_b16 a[80:81], v84 offset:57344
 v_mfma_f32_16x16x32_bf16 v[40:43], a[16:19], a[140:143], v[40:43]
 ds_read_b64_tr_b16 a[82:83], v84 offset:61440
 v_mfma_f32_16x16x32_bf16 v[48:51], a[20:23], a[140:143], v[48:51]
 ds_read_b64_tr_b16 a[84:85], v85 offset:57344
 v_mfma_f32_16x16x32_bf16 v[44:47], a[20:23], a[136:139], v[44:47]
 ds_read_b64_tr_b16 a[86:87], v85 offset:61440
 buffer_load_dwordx4 a[132:135], v71, s[24:27], s41 offen sc1
 v_mfma_f32_16x16x32_bf16 v[52:55], a[24:27], a[136:139], v[52:55]
 ds_read_b64_tr_b16 a[88:89], v86 offset:57344
 v_mfma_f32_16x16x32_bf16 v[56:59], a[24:27], a[140:143], v[56:59]
 ds_read_b64_tr_b16 a[90:91], v86 offset:61440
 v_mfma_f32_16x16x32_bf16 v[64:67], a[28:31], a[140:143], v[64:67]
 ds_read_b64_tr_b16 a[92:93], v87 offset:57344
 v_mfma_f32_16x16x32_bf16 v[60:63], a[28:31], a[136:139], v[60:63]
 ds_read_b64_tr_b16 a[94:95], v87 offset:61440
 v_mfma_f32_16x16x32_bf16 v[4:7], a[32:35], a[144:147], v[4:7]
 s_waitcnt vmcnt(18)
 v_mfma_f32_16x16x32_bf16 v[8:11], a[32:35], a[148:151], v[8:11]
 s_barrier
 v_mfma_f32_16x16x32_bf16 v[16:19], a[36:39], a[148:151], v[16:19]
 ds_read_b64_tr_b16 a[0:1], v72 offset:49152
 buffer_load_dwordx4 v239, s[52:55], s56 offen lds
 v_mfma_f32_16x16x32_bf16 v[12:15], a[36:39], a[144:147], v[12:15]
 ds_read_b64_tr_b16 a[2:3], v72 offset:53248
 v_mfma_f32_16x16x32_bf16 v[20:23], a[40:43], a[144:147], v[20:23]
 ds_read_b64_tr_b16 a[4:5], v73 offset:49152
 buffer_load_dwordx4 v240, s[52:55], s56 offen offset:1024 lds
 v_mfma_f32_16x16x32_bf16 v[24:27], a[40:43], a[148:151], v[24:27]
 ds_read_b64_tr_b16 a[6:7], v73 offset:53248
 v_mfma_f32_16x16x32_bf16 v[32:35], a[44:47], a[148:151], v[32:35]
 ds_read_b64_tr_b16 a[8:9], v74 offset:49152
 buffer_load_dwordx4 v241, s[52:55], s56 offen offset:2048 lds
 v_mfma_f32_16x16x32_bf16 v[28:31], a[44:47], a[144:147], v[28:31]
 ds_read_b64_tr_b16 a[10:11], v74 offset:53248
 s_waitcnt lgkmcnt(6)
 v_mfma_f32_16x16x32_bf16 v[36:39], a[48:51], a[144:147], v[36:39]
 ds_read_b64_tr_b16 a[12:13], v75 offset:49152
 v_mfma_f32_16x16x32_bf16 v[40:43], a[48:51], a[148:151], v[40:43]
 ds_read_b64_tr_b16 a[14:15], v75 offset:53248
 buffer_load_dwordx4 a[136:139], v70, s[24:27], s41 offen offset:1024 sc1
 v_mfma_f32_16x16x32_bf16 v[48:51], a[52:55], a[148:151], v[48:51]
 ds_read_b64_tr_b16 a[16:17], v76 offset:49152
 v_mfma_f32_16x16x32_bf16 v[44:47], a[52:55], a[144:147], v[44:47]
 ds_read_b64_tr_b16 a[18:19], v76 offset:53248
 buffer_load_dwordx4 a[140:143], v71, s[24:27], s41 offen offset:1024 sc1
 v_mfma_f32_16x16x32_bf16 v[52:55], a[56:59], a[144:147], v[52:55]
 ds_read_b64_tr_b16 a[20:21], v77 offset:49152
 v_mfma_f32_16x16x32_bf16 v[56:59], a[56:59], a[148:151], v[56:59]
 ds_read_b64_tr_b16 a[22:23], v77 offset:53248
 ds_read_b64_tr_b16 a[28:29], v79 offset:49152
 v_mfma_f32_16x16x32_bf16 v[64:67], a[60:63], a[148:151], v[64:67]
 ds_read_b64_tr_b16 a[24:25], v78 offset:49152
 v_mfma_f32_16x16x32_bf16 v[60:63], a[60:63], a[144:147], v[60:63]
 ds_read_b64_tr_b16 a[26:27], v78 offset:53248
 ds_read_b64_tr_b16 a[30:31], v79 offset:53248
 v_mfma_f32_16x16x32_bf16 v[4:7], a[64:67], a[152:155], v[4:7]
 ds_read_b64_tr_b16 a[32:33], v72 offset:57344
 v_mfma_f32_16x16x32_bf16 v[8:11], a[64:67], a[156:159], v[8:11]
 ds_read_b64_tr_b16 a[34:35], v72 offset:61440
 v_mfma_f32_16x16x32_bf16 v[16:19], a[68:71], a[156:159], v[16:19]
 ds_read_b64_tr_b16 a[36:37], v73 offset:57344
 buffer_load_dwordx4 v242, s[52:55], s56 offen offset:3072 lds
 s_add_u32 m0, s57, 0
 v_readlane_b32 s56, v246, 16
 v_mfma_f32_16x16x32_bf16 v[12:15], a[68:71], a[152:155], v[12:15]
 ds_read_b64_tr_b16 a[38:39], v73 offset:61440
 v_mfma_f32_16x16x32_bf16 v[20:23], a[72:75], a[152:155], v[20:23]
 ds_read_b64_tr_b16 a[40:41], v74 offset:57344
 v_mfma_f32_16x16x32_bf16 v[24:27], a[72:75], a[156:159], v[24:27]
 ds_read_b64_tr_b16 a[42:43], v74 offset:61440
 v_mfma_f32_16x16x32_bf16 v[32:35], a[76:79], a[156:159], v[32:35]
 ds_read_b64_tr_b16 a[44:45], v75 offset:57344
 buffer_load_dwordx4 a[144:147], v70, s[24:27], s41 offen offset:2048 sc1
 v_mfma_f32_16x16x32_bf16 v[28:31], a[76:79], a[152:155], v[28:31]
 ds_read_b64_tr_b16 a[46:47], v75 offset:61440
 s_waitcnt lgkmcnt(8)
 v_mfma_f32_16x16x32_bf16 v[36:39], a[80:83], a[152:155], v[36:39]
 ds_read_b64_tr_b16 a[48:49], v76 offset:57344
 v_mfma_f32_16x16x32_bf16 v[40:43], a[80:83], a[156:159], v[40:43]
 ds_read_b64_tr_b16 a[50:51], v76 offset:61440
 v_mfma_f32_16x16x32_bf16 v[48:51], a[84:87], a[156:159], v[48:51]
 ds_read_b64_tr_b16 a[52:53], v77 offset:57344
 v_mfma_f32_16x16x32_bf16 v[44:47], a[84:87], a[152:155], v[44:47]
 ds_read_b64_tr_b16 a[54:55], v77 offset:61440
 buffer_load_dwordx4 a[148:151], v71, s[24:27], s41 offen offset:2048 sc1
 v_mfma_f32_16x16x32_bf16 v[52:55], a[88:91], a[152:155], v[52:55]
 ds_read_b64_tr_b16 a[56:57], v78 offset:57344
 v_mfma_f32_16x16x32_bf16 v[56:59], a[88:91], a[156:159], v[56:59]
 ds_read_b64_tr_b16 a[58:59], v78 offset:61440
 v_mfma_f32_16x16x32_bf16 v[64:67], a[92:95], a[156:159], v[64:67]
 ds_read_b64_tr_b16 a[60:61], v79 offset:57344
 v_mfma_f32_16x16x32_bf16 v[60:63], a[92:95], a[152:155], v[60:63]
 ds_read_b64_tr_b16 a[62:63], v79 offset:61440
 v_mfma_f32_16x16x32_bf16 v[4:7], a[0:3], a[160:163], v[4:7]
 s_waitcnt vmcnt(18)
 v_mfma_f32_16x16x32_bf16 v[8:11], a[0:3], a[164:167], v[8:11]
 s_barrier
 v_mfma_f32_16x16x32_bf16 v[16:19], a[4:7], a[164:167], v[16:19]
 ds_read_b64_tr_b16 a[64:65], v80 offset:0
 buffer_load_dwordx4 v239, s[52:55], s56 offen lds
 v_mfma_f32_16x16x32_bf16 v[12:15], a[4:7], a[160:163], v[12:15]
 ds_read_b64_tr_b16 a[66:67], v80 offset:4096
 v_mfma_f32_16x16x32_bf16 v[20:23], a[8:11], a[160:163], v[20:23]
 ds_read_b64_tr_b16 a[68:69], v81 offset:0
 buffer_load_dwordx4 v240, s[52:55], s56 offen offset:1024 lds
 v_mfma_f32_16x16x32_bf16 v[24:27], a[8:11], a[164:167], v[24:27]
 ds_read_b64_tr_b16 a[70:71], v81 offset:4096
 v_mfma_f32_16x16x32_bf16 v[32:35], a[12:15], a[164:167], v[32:35]
 ds_read_b64_tr_b16 a[72:73], v82 offset:0
 buffer_load_dwordx4 v241, s[52:55], s56 offen offset:2048 lds
 v_mfma_f32_16x16x32_bf16 v[28:31], a[12:15], a[160:163], v[28:31]
 ds_read_b64_tr_b16 a[74:75], v82 offset:4096
 s_waitcnt lgkmcnt(6)
 v_mfma_f32_16x16x32_bf16 v[36:39], a[16:19], a[160:163], v[36:39]
 ds_read_b64_tr_b16 a[76:77], v83 offset:0
 v_mfma_f32_16x16x32_bf16 v[40:43], a[16:19], a[164:167], v[40:43]
 ds_read_b64_tr_b16 a[78:79], v83 offset:4096
 buffer_load_dwordx4 a[152:155], v70, s[24:27], s41 offen offset:3072 sc1
 v_mfma_f32_16x16x32_bf16 v[48:51], a[20:23], a[164:167], v[48:51]
 ds_read_b64_tr_b16 a[80:81], v84 offset:0
 v_mfma_f32_16x16x32_bf16 v[44:47], a[20:23], a[160:163], v[44:47]
 ds_read_b64_tr_b16 a[82:83], v84 offset:4096
 buffer_load_dwordx4 a[156:159], v71, s[24:27], s41 offen offset:3072 sc1
 v_readlane_b32 s41, v247, 10
 v_mfma_f32_16x16x32_bf16 v[52:55], a[24:27], a[160:163], v[52:55]
 ds_read_b64_tr_b16 a[84:85], v85 offset:0
 v_mfma_f32_16x16x32_bf16 v[56:59], a[24:27], a[164:167], v[56:59]
 ds_read_b64_tr_b16 a[86:87], v85 offset:4096
 ds_read_b64_tr_b16 a[92:93], v87 offset:0
 v_mfma_f32_16x16x32_bf16 v[64:67], a[28:31], a[164:167], v[64:67]
 ds_read_b64_tr_b16 a[88:89], v86 offset:0
 v_mfma_f32_16x16x32_bf16 v[60:63], a[28:31], a[160:163], v[60:63]
 ds_read_b64_tr_b16 a[90:91], v86 offset:4096
 ds_read_b64_tr_b16 a[94:95], v87 offset:4096
 v_mfma_f32_16x16x32_bf16 v[4:7], a[32:35], a[168:171], v[4:7]
 ds_read_b64_tr_b16 a[0:1], v80 offset:8192
 v_mfma_f32_16x16x32_bf16 v[8:11], a[32:35], a[172:175], v[8:11]
 ds_read_b64_tr_b16 a[2:3], v80 offset:12288
 v_mfma_f32_16x16x32_bf16 v[16:19], a[36:39], a[172:175], v[16:19]
 ds_read_b64_tr_b16 a[4:5], v81 offset:8192
 buffer_load_dwordx4 v242, s[52:55], s56 offen offset:3072 lds
 s_add_u32 m0, s57, 16384
 v_readlane_b32 s56, v246, 17
 v_mfma_f32_16x16x32_bf16 v[12:15], a[36:39], a[168:171], v[12:15]
 ds_read_b64_tr_b16 a[6:7], v81 offset:12288
 v_mfma_f32_16x16x32_bf16 v[20:23], a[40:43], a[168:171], v[20:23]
 ds_read_b64_tr_b16 a[8:9], v82 offset:8192
 v_mfma_f32_16x16x32_bf16 v[24:27], a[40:43], a[172:175], v[24:27]
 ds_read_b64_tr_b16 a[10:11], v82 offset:12288
 v_mfma_f32_16x16x32_bf16 v[32:35], a[44:47], a[172:175], v[32:35]
 ds_read_b64_tr_b16 a[12:13], v83 offset:8192
 buffer_load_dwordx4 a[160:163], v70, s[24:27], s41 offen sc1
 v_mfma_f32_16x16x32_bf16 v[28:31], a[44:47], a[168:171], v[28:31]
 ds_read_b64_tr_b16 a[14:15], v83 offset:12288
 s_waitcnt lgkmcnt(8)
 v_mfma_f32_16x16x32_bf16 v[36:39], a[48:51], a[168:171], v[36:39]
 ds_read_b64_tr_b16 a[16:17], v84 offset:8192
 v_mfma_f32_16x16x32_bf16 v[40:43], a[48:51], a[172:175], v[40:43]
 ds_read_b64_tr_b16 a[18:19], v84 offset:12288
 v_mfma_f32_16x16x32_bf16 v[48:51], a[52:55], a[172:175], v[48:51]
 ds_read_b64_tr_b16 a[20:21], v85 offset:8192
 v_mfma_f32_16x16x32_bf16 v[44:47], a[52:55], a[168:171], v[44:47]
 ds_read_b64_tr_b16 a[22:23], v85 offset:12288
 buffer_load_dwordx4 a[164:167], v71, s[24:27], s41 offen sc1
 v_mfma_f32_16x16x32_bf16 v[52:55], a[56:59], a[168:171], v[52:55]
 ds_read_b64_tr_b16 a[24:25], v86 offset:8192
 v_mfma_f32_16x16x32_bf16 v[56:59], a[56:59], a[172:175], v[56:59]
 ds_read_b64_tr_b16 a[26:27], v86 offset:12288
 v_mfma_f32_16x16x32_bf16 v[64:67], a[60:63], a[172:175], v[64:67]
 ds_read_b64_tr_b16 a[28:29], v87 offset:8192
 v_mfma_f32_16x16x32_bf16 v[60:63], a[60:63], a[168:171], v[60:63]
 ds_read_b64_tr_b16 a[30:31], v87 offset:12288
 v_mfma_f32_16x16x32_bf16 v[4:7], a[64:67], a[176:179], v[4:7]
 s_waitcnt vmcnt(18)
 v_mfma_f32_16x16x32_bf16 v[8:11], a[64:67], a[180:183], v[8:11]
 s_barrier
 v_mfma_f32_16x16x32_bf16 v[16:19], a[68:71], a[180:183], v[16:19]
 ds_read_b64_tr_b16 a[32:33], v80 offset:16384
 buffer_load_dwordx4 v239, s[52:55], s56 offen lds
 v_mfma_f32_16x16x32_bf16 v[12:15], a[68:71], a[176:179], v[12:15]
 ds_read_b64_tr_b16 a[34:35], v80 offset:20480
 v_mfma_f32_16x16x32_bf16 v[20:23], a[72:75], a[176:179], v[20:23]
 ds_read_b64_tr_b16 a[36:37], v81 offset:16384
 buffer_load_dwordx4 v240, s[52:55], s56 offen offset:1024 lds
 v_mfma_f32_16x16x32_bf16 v[24:27], a[72:75], a[180:183], v[24:27]
 ds_read_b64_tr_b16 a[38:39], v81 offset:20480
 v_mfma_f32_16x16x32_bf16 v[32:35], a[76:79], a[180:183], v[32:35]
 ds_read_b64_tr_b16 a[40:41], v82 offset:16384
 buffer_load_dwordx4 v241, s[52:55], s56 offen offset:2048 lds
 v_mfma_f32_16x16x32_bf16 v[28:31], a[76:79], a[176:179], v[28:31]
 ds_read_b64_tr_b16 a[42:43], v82 offset:20480
 s_waitcnt lgkmcnt(6)
 v_mfma_f32_16x16x32_bf16 v[36:39], a[80:83], a[176:179], v[36:39]
 ds_read_b64_tr_b16 a[44:45], v83 offset:16384
 v_mfma_f32_16x16x32_bf16 v[40:43], a[80:83], a[180:183], v[40:43]
 ds_read_b64_tr_b16 a[46:47], v83 offset:20480
 buffer_load_dwordx4 a[168:171], v70, s[24:27], s41 offen offset:1024 sc1
 v_mfma_f32_16x16x32_bf16 v[48:51], a[84:87], a[180:183], v[48:51]
 ds_read_b64_tr_b16 a[48:49], v84 offset:16384
 v_mfma_f32_16x16x32_bf16 v[44:47], a[84:87], a[176:179], v[44:47]
 ds_read_b64_tr_b16 a[50:51], v84 offset:20480
 buffer_load_dwordx4 a[172:175], v71, s[24:27], s41 offen offset:1024 sc1
 v_mfma_f32_16x16x32_bf16 v[52:55], a[88:91], a[176:179], v[52:55]
 ds_read_b64_tr_b16 a[52:53], v85 offset:16384
 v_mfma_f32_16x16x32_bf16 v[56:59], a[88:91], a[180:183], v[56:59]
 ds_read_b64_tr_b16 a[54:55], v85 offset:20480
 ds_read_b64_tr_b16 a[60:61], v87 offset:16384
 v_mfma_f32_16x16x32_bf16 v[64:67], a[92:95], a[180:183], v[64:67]
 ds_read_b64_tr_b16 a[56:57], v86 offset:16384
 v_mfma_f32_16x16x32_bf16 v[60:63], a[92:95], a[176:179], v[60:63]
 ds_read_b64_tr_b16 a[58:59], v86 offset:20480
 ds_read_b64_tr_b16 a[62:63], v87 offset:20480
 v_mfma_f32_16x16x32_bf16 v[4:7], a[0:3], a[184:187], v[4:7]
 ds_read_b64_tr_b16 a[64:65], v80 offset:24576
 v_mfma_f32_16x16x32_bf16 v[8:11], a[0:3], a[188:191], v[8:11]
 ds_read_b64_tr_b16 a[66:67], v80 offset:28672
 v_mfma_f32_16x16x32_bf16 v[16:19], a[4:7], a[188:191], v[16:19]
 ds_read_b64_tr_b16 a[68:69], v81 offset:24576
 buffer_load_dwordx4 v242, s[52:55], s56 offen offset:3072 lds
 s_add_u32 m0, s57, 32768
 v_readlane_b32 s56, v246, 18
 v_mfma_f32_16x16x32_bf16 v[12:15], a[4:7], a[184:187], v[12:15]
 ds_read_b64_tr_b16 a[70:71], v81 offset:28672
 v_mfma_f32_16x16x32_bf16 v[20:23], a[8:11], a[184:187], v[20:23]
 ds_read_b64_tr_b16 a[72:73], v82 offset:24576
 v_mfma_f32_16x16x32_bf16 v[24:27], a[8:11], a[188:191], v[24:27]
 ds_read_b64_tr_b16 a[74:75], v82 offset:28672
 v_mfma_f32_16x16x32_bf16 v[32:35], a[12:15], a[188:191], v[32:35]
 ds_read_b64_tr_b16 a[76:77], v83 offset:24576
 buffer_load_dwordx4 a[176:179], v70, s[24:27], s41 offen offset:2048 sc1
 v_mfma_f32_16x16x32_bf16 v[28:31], a[12:15], a[184:187], v[28:31]
 ds_read_b64_tr_b16 a[78:79], v83 offset:28672
 s_waitcnt lgkmcnt(8)
 v_mfma_f32_16x16x32_bf16 v[36:39], a[16:19], a[184:187], v[36:39]
 ds_read_b64_tr_b16 a[80:81], v84 offset:24576
 v_mfma_f32_16x16x32_bf16 v[40:43], a[16:19], a[188:191], v[40:43]
 ds_read_b64_tr_b16 a[82:83], v84 offset:28672
 v_mfma_f32_16x16x32_bf16 v[48:51], a[20:23], a[188:191], v[48:51]
 ds_read_b64_tr_b16 a[84:85], v85 offset:24576
 v_mfma_f32_16x16x32_bf16 v[44:47], a[20:23], a[184:187], v[44:47]
 ds_read_b64_tr_b16 a[86:87], v85 offset:28672
 buffer_load_dwordx4 a[180:183], v71, s[24:27], s41 offen offset:2048 sc1
 v_mfma_f32_16x16x32_bf16 v[52:55], a[24:27], a[184:187], v[52:55]
 ds_read_b64_tr_b16 a[88:89], v86 offset:24576
 v_mfma_f32_16x16x32_bf16 v[56:59], a[24:27], a[188:191], v[56:59]
 ds_read_b64_tr_b16 a[90:91], v86 offset:28672
 v_mfma_f32_16x16x32_bf16 v[64:67], a[28:31], a[188:191], v[64:67]
 ds_read_b64_tr_b16 a[92:93], v87 offset:24576
 v_mfma_f32_16x16x32_bf16 v[60:63], a[28:31], a[184:187], v[60:63]
 ds_read_b64_tr_b16 a[94:95], v87 offset:28672
 v_mfma_f32_16x16x32_bf16 v[4:7], a[32:35], a[192:195], v[4:7]
 s_waitcnt vmcnt(18)
 v_mfma_f32_16x16x32_bf16 v[8:11], a[32:35], a[196:199], v[8:11]
 s_barrier
 v_mfma_f32_16x16x32_bf16 v[16:19], a[36:39], a[196:199], v[16:19]
 ds_read_b64_tr_b16 a[0:1], v80 offset:32768
 buffer_load_dwordx4 v239, s[52:55], s56 offen lds
 v_mfma_f32_16x16x32_bf16 v[12:15], a[36:39], a[192:195], v[12:15]
 ds_read_b64_tr_b16 a[2:3], v80 offset:36864
 v_mfma_f32_16x16x32_bf16 v[20:23], a[40:43], a[192:195], v[20:23]
 ds_read_b64_tr_b16 a[4:5], v81 offset:32768
 buffer_load_dwordx4 v240, s[52:55], s56 offen offset:1024 lds
 v_mfma_f32_16x16x32_bf16 v[24:27], a[40:43], a[196:199], v[24:27]
 ds_read_b64_tr_b16 a[6:7], v81 offset:36864
 v_mfma_f32_16x16x32_bf16 v[32:35], a[44:47], a[196:199], v[32:35]
 ds_read_b64_tr_b16 a[8:9], v82 offset:32768
 buffer_load_dwordx4 v241, s[52:55], s56 offen offset:2048 lds
 v_mfma_f32_16x16x32_bf16 v[28:31], a[44:47], a[192:195], v[28:31]
 ds_read_b64_tr_b16 a[10:11], v82 offset:36864
 s_waitcnt lgkmcnt(6)
 v_mfma_f32_16x16x32_bf16 v[36:39], a[48:51], a[192:195], v[36:39]
 ds_read_b64_tr_b16 a[12:13], v83 offset:32768
 v_mfma_f32_16x16x32_bf16 v[40:43], a[48:51], a[196:199], v[40:43]
 ds_read_b64_tr_b16 a[14:15], v83 offset:36864
 buffer_load_dwordx4 a[184:187], v70, s[24:27], s41 offen offset:3072 sc1
 v_mfma_f32_16x16x32_bf16 v[48:51], a[52:55], a[196:199], v[48:51]
 ds_read_b64_tr_b16 a[16:17], v84 offset:32768
 v_mfma_f32_16x16x32_bf16 v[44:47], a[52:55], a[192:195], v[44:47]
 ds_read_b64_tr_b16 a[18:19], v84 offset:36864
 buffer_load_dwordx4 a[188:191], v71, s[24:27], s41 offen offset:3072 sc1
 v_readlane_b32 s41, v247, 11
 v_mfma_f32_16x16x32_bf16 v[52:55], a[56:59], a[192:195], v[52:55]
 ds_read_b64_tr_b16 a[20:21], v85 offset:32768
 v_mfma_f32_16x16x32_bf16 v[56:59], a[56:59], a[196:199], v[56:59]
 ds_read_b64_tr_b16 a[22:23], v85 offset:36864
 ds_read_b64_tr_b16 a[28:29], v87 offset:32768
 v_mfma_f32_16x16x32_bf16 v[64:67], a[60:63], a[196:199], v[64:67]
 ds_read_b64_tr_b16 a[24:25], v86 offset:32768
 v_mfma_f32_16x16x32_bf16 v[60:63], a[60:63], a[192:195], v[60:63]
 ds_read_b64_tr_b16 a[26:27], v86 offset:36864
 ds_read_b64_tr_b16 a[30:31], v87 offset:36864
 v_mfma_f32_16x16x32_bf16 v[4:7], a[64:67], a[200:203], v[4:7]
 ds_read_b64_tr_b16 a[32:33], v80 offset:40960
 v_mfma_f32_16x16x32_bf16 v[8:11], a[64:67], a[204:207], v[8:11]
 ds_read_b64_tr_b16 a[34:35], v80 offset:45056
 v_mfma_f32_16x16x32_bf16 v[16:19], a[68:71], a[204:207], v[16:19]
 ds_read_b64_tr_b16 a[36:37], v81 offset:40960
 buffer_load_dwordx4 v242, s[52:55], s56 offen offset:3072 lds
 s_add_u32 m0, s57, 114688
 v_readlane_b32 s56, v246, 19
 v_mfma_f32_16x16x32_bf16 v[12:15], a[68:71], a[200:203], v[12:15]
 ds_read_b64_tr_b16 a[38:39], v81 offset:45056
 v_mfma_f32_16x16x32_bf16 v[20:23], a[72:75], a[200:203], v[20:23]
 ds_read_b64_tr_b16 a[40:41], v82 offset:40960
 v_mfma_f32_16x16x32_bf16 v[24:27], a[72:75], a[204:207], v[24:27]
 ds_read_b64_tr_b16 a[42:43], v82 offset:45056
 v_mfma_f32_16x16x32_bf16 v[32:35], a[76:79], a[204:207], v[32:35]
 ds_read_b64_tr_b16 a[44:45], v83 offset:40960
 buffer_load_dwordx4 a[192:195], v70, s[24:27], s41 offen sc1
 v_mfma_f32_16x16x32_bf16 v[28:31], a[76:79], a[200:203], v[28:31]
 ds_read_b64_tr_b16 a[46:47], v83 offset:45056
 s_waitcnt lgkmcnt(8)
 v_mfma_f32_16x16x32_bf16 v[36:39], a[80:83], a[200:203], v[36:39]
 ds_read_b64_tr_b16 a[48:49], v84 offset:40960
 v_mfma_f32_16x16x32_bf16 v[40:43], a[80:83], a[204:207], v[40:43]
 ds_read_b64_tr_b16 a[50:51], v84 offset:45056
 v_mfma_f32_16x16x32_bf16 v[48:51], a[84:87], a[204:207], v[48:51]
 ds_read_b64_tr_b16 a[52:53], v85 offset:40960
 v_mfma_f32_16x16x32_bf16 v[44:47], a[84:87], a[200:203], v[44:47]
 ds_read_b64_tr_b16 a[54:55], v85 offset:45056
 buffer_load_dwordx4 a[196:199], v71, s[24:27], s41 offen sc1
 v_mfma_f32_16x16x32_bf16 v[52:55], a[88:91], a[200:203], v[52:55]
 ds_read_b64_tr_b16 a[56:57], v86 offset:40960
 v_mfma_f32_16x16x32_bf16 v[56:59], a[88:91], a[204:207], v[56:59]
 ds_read_b64_tr_b16 a[58:59], v86 offset:45056
 v_mfma_f32_16x16x32_bf16 v[64:67], a[92:95], a[204:207], v[64:67]
 ds_read_b64_tr_b16 a[60:61], v87 offset:40960
 v_mfma_f32_16x16x32_bf16 v[60:63], a[92:95], a[200:203], v[60:63]
 ds_read_b64_tr_b16 a[62:63], v87 offset:45056
 v_mfma_f32_16x16x32_bf16 v[4:7], a[0:3], a[208:211], v[4:7]
 s_waitcnt vmcnt(18)
 v_mfma_f32_16x16x32_bf16 v[8:11], a[0:3], a[212:215], v[8:11]
 s_barrier
 v_mfma_f32_16x16x32_bf16 v[16:19], a[4:7], a[212:215], v[16:19]
 ds_read_b64_tr_b16 a[64:65], v72 offset:0
 buffer_load_dwordx4 v239, s[52:55], s56 offen lds
 v_mfma_f32_16x16x32_bf16 v[12:15], a[4:7], a[208:211], v[12:15]
 ds_read_b64_tr_b16 a[66:67], v72 offset:4096
 v_mfma_f32_16x16x32_bf16 v[20:23], a[8:11], a[208:211], v[20:23]
 ds_read_b64_tr_b16 a[68:69], v73 offset:0
 buffer_load_dwordx4 v240, s[52:55], s56 offen offset:1024 lds
 v_mfma_f32_16x16x32_bf16 v[24:27], a[8:11], a[212:215], v[24:27]
 ds_read_b64_tr_b16 a[70:71], v73 offset:4096
 v_mfma_f32_16x16x32_bf16 v[32:35], a[12:15], a[212:215], v[32:35]
 ds_read_b64_tr_b16 a[72:73], v74 offset:0
 buffer_load_dwordx4 v241, s[52:55], s56 offen offset:2048 lds
 v_mfma_f32_16x16x32_bf16 v[28:31], a[12:15], a[208:211], v[28:31]
 ds_read_b64_tr_b16 a[74:75], v74 offset:4096
 s_waitcnt lgkmcnt(6)
 v_mfma_f32_16x16x32_bf16 v[36:39], a[16:19], a[208:211], v[36:39]
 ds_read_b64_tr_b16 a[76:77], v75 offset:0
 v_mfma_f32_16x16x32_bf16 v[40:43], a[16:19], a[212:215], v[40:43]
 ds_read_b64_tr_b16 a[78:79], v75 offset:4096
 buffer_load_dwordx4 a[200:203], v70, s[24:27], s41 offen offset:1024 sc1
 v_mfma_f32_16x16x32_bf16 v[48:51], a[20:23], a[212:215], v[48:51]
 ds_read_b64_tr_b16 a[80:81], v76 offset:0
 v_mfma_f32_16x16x32_bf16 v[44:47], a[20:23], a[208:211], v[44:47]
 ds_read_b64_tr_b16 a[82:83], v76 offset:4096
 buffer_load_dwordx4 a[204:207], v71, s[24:27], s41 offen offset:1024 sc1
 v_mfma_f32_16x16x32_bf16 v[52:55], a[24:27], a[208:211], v[52:55]
 ds_read_b64_tr_b16 a[84:85], v77 offset:0
 v_mfma_f32_16x16x32_bf16 v[56:59], a[24:27], a[212:215], v[56:59]
 ds_read_b64_tr_b16 a[86:87], v77 offset:4096
 ds_read_b64_tr_b16 a[92:93], v79 offset:0
 v_mfma_f32_16x16x32_bf16 v[64:67], a[28:31], a[212:215], v[64:67]
 ds_read_b64_tr_b16 a[88:89], v78 offset:0
 v_mfma_f32_16x16x32_bf16 v[60:63], a[28:31], a[208:211], v[60:63]
 ds_read_b64_tr_b16 a[90:91], v78 offset:4096
 ds_read_b64_tr_b16 a[94:95], v79 offset:4096
 v_mfma_f32_16x16x32_bf16 v[4:7], a[32:35], a[216:219], v[4:7]
 ds_read_b64_tr_b16 a[0:1], v72 offset:8192
 v_mfma_f32_16x16x32_bf16 v[8:11], a[32:35], a[220:223], v[8:11]
 ds_read_b64_tr_b16 a[2:3], v72 offset:12288
 v_mfma_f32_16x16x32_bf16 v[16:19], a[36:39], a[220:223], v[16:19]
 ds_read_b64_tr_b16 a[4:5], v73 offset:8192
 buffer_load_dwordx4 v242, s[52:55], s56 offen offset:3072 lds
 s_add_u32 m0, s57, 49152
 v_readlane_b32 s56, v246, 20
 v_mfma_f32_16x16x32_bf16 v[12:15], a[36:39], a[216:219], v[12:15]
 ds_read_b64_tr_b16 a[6:7], v73 offset:12288
 v_mfma_f32_16x16x32_bf16 v[20:23], a[40:43], a[216:219], v[20:23]
 ds_read_b64_tr_b16 a[8:9], v74 offset:8192
 v_mfma_f32_16x16x32_bf16 v[24:27], a[40:43], a[220:223], v[24:27]
 ds_read_b64_tr_b16 a[10:11], v74 offset:12288
 v_mfma_f32_16x16x32_bf16 v[32:35], a[44:47], a[220:223], v[32:35]
 ds_read_b64_tr_b16 a[12:13], v75 offset:8192
 buffer_load_dwordx4 a[208:211], v70, s[24:27], s41 offen offset:2048 sc1
 v_mfma_f32_16x16x32_bf16 v[28:31], a[44:47], a[216:219], v[28:31]
 ds_read_b64_tr_b16 a[14:15], v75 offset:12288
 s_waitcnt lgkmcnt(8)
 v_mfma_f32_16x16x32_bf16 v[36:39], a[48:51], a[216:219], v[36:39]
 ds_read_b64_tr_b16 a[16:17], v76 offset:8192
 v_mfma_f32_16x16x32_bf16 v[40:43], a[48:51], a[220:223], v[40:43]
 ds_read_b64_tr_b16 a[18:19], v76 offset:12288
 v_mfma_f32_16x16x32_bf16 v[48:51], a[52:55], a[220:223], v[48:51]
 ds_read_b64_tr_b16 a[20:21], v77 offset:8192
 v_mfma_f32_16x16x32_bf16 v[44:47], a[52:55], a[216:219], v[44:47]
 ds_read_b64_tr_b16 a[22:23], v77 offset:12288
 buffer_load_dwordx4 a[212:215], v71, s[24:27], s41 offen offset:2048 sc1
 v_mfma_f32_16x16x32_bf16 v[52:55], a[56:59], a[216:219], v[52:55]
 ds_read_b64_tr_b16 a[24:25], v78 offset:8192
 v_mfma_f32_16x16x32_bf16 v[56:59], a[56:59], a[220:223], v[56:59]
 ds_read_b64_tr_b16 a[26:27], v78 offset:12288
 v_mfma_f32_16x16x32_bf16 v[64:67], a[60:63], a[220:223], v[64:67]
 ds_read_b64_tr_b16 a[28:29], v79 offset:8192
 v_mfma_f32_16x16x32_bf16 v[60:63], a[60:63], a[216:219], v[60:63]
 ds_read_b64_tr_b16 a[30:31], v79 offset:12288
 v_mfma_f32_16x16x32_bf16 v[4:7], a[64:67], a[96:99], v[4:7]
 s_waitcnt vmcnt(18)
 v_mfma_f32_16x16x32_bf16 v[8:11], a[64:67], a[100:103], v[8:11]
 s_barrier
 v_mfma_f32_16x16x32_bf16 v[16:19], a[68:71], a[100:103], v[16:19]
 ds_read_b64_tr_b16 a[32:33], v72 offset:16384
 buffer_load_dwordx4 v239, s[52:55], s56 offen lds
 v_mfma_f32_16x16x32_bf16 v[12:15], a[68:71], a[96:99], v[12:15]
 ds_read_b64_tr_b16 a[34:35], v72 offset:20480
 v_mfma_f32_16x16x32_bf16 v[20:23], a[72:75], a[96:99], v[20:23]
 ds_read_b64_tr_b16 a[36:37], v73 offset:16384
 buffer_load_dwordx4 v240, s[52:55], s56 offen offset:1024 lds
 v_mfma_f32_16x16x32_bf16 v[24:27], a[72:75], a[100:103], v[24:27]
 ds_read_b64_tr_b16 a[38:39], v73 offset:20480
 v_mfma_f32_16x16x32_bf16 v[32:35], a[76:79], a[100:103], v[32:35]
 ds_read_b64_tr_b16 a[40:41], v74 offset:16384
 buffer_load_dwordx4 v241, s[52:55], s56 offen offset:2048 lds
 v_mfma_f32_16x16x32_bf16 v[28:31], a[76:79], a[96:99], v[28:31]
 ds_read_b64_tr_b16 a[42:43], v74 offset:20480
 s_waitcnt lgkmcnt(6)
 v_mfma_f32_16x16x32_bf16 v[36:39], a[80:83], a[96:99], v[36:39]
 ds_read_b64_tr_b16 a[44:45], v75 offset:16384
 v_mfma_f32_16x16x32_bf16 v[40:43], a[80:83], a[100:103], v[40:43]
 ds_read_b64_tr_b16 a[46:47], v75 offset:20480
 buffer_load_dwordx4 v242, s[52:55], s56 offen offset:3072 lds
 s_add_u32 m0, s57, 65536
 v_readlane_b32 s56, v246, 21
 v_mfma_f32_16x16x32_bf16 v[48:51], a[84:87], a[100:103], v[48:51]
 ds_read_b64_tr_b16 a[48:49], v76 offset:16384
 v_mfma_f32_16x16x32_bf16 v[44:47], a[84:87], a[96:99], v[44:47]
 ds_read_b64_tr_b16 a[50:51], v76 offset:20480
 buffer_load_dwordx4 a[216:219], v70, s[24:27], s41 offen offset:3072 sc1
 v_mfma_f32_16x16x32_bf16 v[52:55], a[88:91], a[96:99], v[52:55]
 ds_read_b64_tr_b16 a[52:53], v77 offset:16384
 v_mfma_f32_16x16x32_bf16 v[56:59], a[88:91], a[100:103], v[56:59]
 ds_read_b64_tr_b16 a[54:55], v77 offset:20480
 ds_read_b64_tr_b16 a[60:61], v79 offset:16384
 buffer_load_dwordx4 a[220:223], v71, s[24:27], s41 offen offset:3072 sc1
 v_readlane_b32 s41, v247, 12
 v_mfma_f32_16x16x32_bf16 v[64:67], a[92:95], a[100:103], v[64:67]
 ds_read_b64_tr_b16 a[56:57], v78 offset:16384
 v_mfma_f32_16x16x32_bf16 v[60:63], a[92:95], a[96:99], v[60:63]
 ds_read_b64_tr_b16 a[58:59], v78 offset:20480
 ds_read_b64_tr_b16 a[62:63], v79 offset:20480
 v_mfma_f32_16x16x32_bf16 v[4:7], a[0:3], a[104:107], v[4:7]
 ds_read_b64_tr_b16 a[64:65], v72 offset:24576
 v_mfma_f32_16x16x32_bf16 v[8:11], a[0:3], a[108:111], v[8:11]
 ds_read_b64_tr_b16 a[66:67], v72 offset:28672
 v_mfma_f32_16x16x32_bf16 v[16:19], a[4:7], a[108:111], v[16:19]
 ds_read_b64_tr_b16 a[68:69], v73 offset:24576
 buffer_load_dwordx4 v239, s[52:55], s56 offen lds
 v_mfma_f32_16x16x32_bf16 v[12:15], a[4:7], a[104:107], v[12:15]
 ds_read_b64_tr_b16 a[70:71], v73 offset:28672
 v_mfma_f32_16x16x32_bf16 v[20:23], a[8:11], a[104:107], v[20:23]
 ds_read_b64_tr_b16 a[72:73], v74 offset:24576
 buffer_load_dwordx4 v240, s[52:55], s56 offen offset:1024 lds
 v_mfma_f32_16x16x32_bf16 v[24:27], a[8:11], a[108:111], v[24:27]
 ds_read_b64_tr_b16 a[74:75], v74 offset:28672
 v_mfma_f32_16x16x32_bf16 v[32:35], a[12:15], a[108:111], v[32:35]
 ds_read_b64_tr_b16 a[76:77], v75 offset:24576
 buffer_load_dwordx4 v241, s[52:55], s56 offen offset:2048 lds
 v_mfma_f32_16x16x32_bf16 v[28:31], a[12:15], a[104:107], v[28:31]
 ds_read_b64_tr_b16 a[78:79], v75 offset:28672
 s_waitcnt lgkmcnt(8)
 v_mfma_f32_16x16x32_bf16 v[36:39], a[16:19], a[104:107], v[36:39]
 ds_read_b64_tr_b16 a[80:81], v76 offset:24576
 v_mfma_f32_16x16x32_bf16 v[40:43], a[16:19], a[108:111], v[40:43]
 ds_read_b64_tr_b16 a[82:83], v76 offset:28672
 buffer_load_dwordx4 v242, s[52:55], s56 offen offset:3072 lds
 s_add_u32 m0, s57, 81920
 v_readlane_b32 s56, v246, 22
 v_mfma_f32_16x16x32_bf16 v[48:51], a[20:23], a[108:111], v[48:51]
 ds_read_b64_tr_b16 a[84:85], v77 offset:24576
 v_mfma_f32_16x16x32_bf16 v[44:47], a[20:23], a[104:107], v[44:47]
 ds_read_b64_tr_b16 a[86:87], v77 offset:28672
 buffer_load_dwordx4 a[96:99], v70, s[24:27], s41 offen sc1
 v_mfma_f32_16x16x32_bf16 v[52:55], a[24:27], a[104:107], v[52:55]
 ds_read_b64_tr_b16 a[88:89], v78 offset:24576
 v_mfma_f32_16x16x32_bf16 v[56:59], a[24:27], a[108:111], v[56:59]
 ds_read_b64_tr_b16 a[90:91], v78 offset:28672
 buffer_load_dwordx4 a[100:103], v71, s[24:27], s41 offen sc1
 v_mfma_f32_16x16x32_bf16 v[64:67], a[28:31], a[108:111], v[64:67]
 ds_read_b64_tr_b16 a[92:93], v79 offset:24576
 v_mfma_f32_16x16x32_bf16 v[60:63], a[28:31], a[104:107], v[60:63]
 ds_read_b64_tr_b16 a[94:95], v79 offset:28672
 v_mfma_f32_16x16x32_bf16 v[4:7], a[32:35], a[112:115], v[4:7]
 s_waitcnt vmcnt(22)
 v_mfma_f32_16x16x32_bf16 v[8:11], a[32:35], a[116:119], v[8:11]
 s_barrier
 v_mfma_f32_16x16x32_bf16 v[16:19], a[36:39], a[116:119], v[16:19]
 ds_read_b64_tr_b16 a[0:1], v72 offset:32768
 buffer_load_dwordx4 v239, s[52:55], s56 offen lds
 v_mfma_f32_16x16x32_bf16 v[12:15], a[36:39], a[112:115], v[12:15]
 ds_read_b64_tr_b16 a[2:3], v72 offset:36864
 v_mfma_f32_16x16x32_bf16 v[20:23], a[40:43], a[112:115], v[20:23]
 ds_read_b64_tr_b16 a[4:5], v73 offset:32768
 buffer_load_dwordx4 v240, s[52:55], s56 offen offset:1024 lds
 v_mfma_f32_16x16x32_bf16 v[24:27], a[40:43], a[116:119], v[24:27]
 ds_read_b64_tr_b16 a[6:7], v73 offset:36864
 v_mfma_f32_16x16x32_bf16 v[32:35], a[44:47], a[116:119], v[32:35]
 ds_read_b64_tr_b16 a[8:9], v74 offset:32768
 buffer_load_dwordx4 v241, s[52:55], s56 offen offset:2048 lds
 v_mfma_f32_16x16x32_bf16 v[28:31], a[44:47], a[112:115], v[28:31]
 ds_read_b64_tr_b16 a[10:11], v74 offset:36864
 s_waitcnt lgkmcnt(6)
 v_mfma_f32_16x16x32_bf16 v[36:39], a[48:51], a[112:115], v[36:39]
 ds_read_b64_tr_b16 a[12:13], v75 offset:32768
 v_mfma_f32_16x16x32_bf16 v[40:43], a[48:51], a[116:119], v[40:43]
 ds_read_b64_tr_b16 a[14:15], v75 offset:36864
 buffer_load_dwordx4 v242, s[52:55], s56 offen offset:3072 lds
 s_add_u32 m0, s57, 98304
 v_readlane_b32 s56, v246, 23
 v_mfma_f32_16x16x32_bf16 v[48:51], a[52:55], a[116:119], v[48:51]
 ds_read_b64_tr_b16 a[16:17], v76 offset:32768
 v_mfma_f32_16x16x32_bf16 v[44:47], a[52:55], a[112:115], v[44:47]
 ds_read_b64_tr_b16 a[18:19], v76 offset:36864
 buffer_load_dwordx4 a[104:107], v70, s[24:27], s41 offen offset:1024 sc1
 v_mfma_f32_16x16x32_bf16 v[52:55], a[56:59], a[112:115], v[52:55]
 ds_read_b64_tr_b16 a[20:21], v77 offset:32768
 v_mfma_f32_16x16x32_bf16 v[56:59], a[56:59], a[116:119], v[56:59]
 ds_read_b64_tr_b16 a[22:23], v77 offset:36864
 ds_read_b64_tr_b16 a[28:29], v79 offset:32768
 buffer_load_dwordx4 a[108:111], v71, s[24:27], s41 offen offset:1024 sc1
 v_mfma_f32_16x16x32_bf16 v[64:67], a[60:63], a[116:119], v[64:67]
 ds_read_b64_tr_b16 a[24:25], v78 offset:32768
 v_mfma_f32_16x16x32_bf16 v[60:63], a[60:63], a[112:115], v[60:63]
 ds_read_b64_tr_b16 a[26:27], v78 offset:36864
 ds_read_b64_tr_b16 a[30:31], v79 offset:36864
 v_mfma_f32_16x16x32_bf16 v[4:7], a[64:67], a[120:123], v[4:7]
 ds_read_b64_tr_b16 a[32:33], v72 offset:40960
 v_mfma_f32_16x16x32_bf16 v[8:11], a[64:67], a[124:127], v[8:11]
 ds_read_b64_tr_b16 a[34:35], v72 offset:45056
 v_mfma_f32_16x16x32_bf16 v[16:19], a[68:71], a[124:127], v[16:19]
 ds_read_b64_tr_b16 a[36:37], v73 offset:40960
 buffer_load_dwordx4 v239, s[52:55], s56 offen lds
 v_mfma_f32_16x16x32_bf16 v[12:15], a[68:71], a[120:123], v[12:15]
 ds_read_b64_tr_b16 a[38:39], v73 offset:45056
 v_mfma_f32_16x16x32_bf16 v[20:23], a[72:75], a[120:123], v[20:23]
 ds_read_b64_tr_b16 a[40:41], v74 offset:40960
 buffer_load_dwordx4 v240, s[52:55], s56 offen offset:1024 lds
 v_mfma_f32_16x16x32_bf16 v[24:27], a[72:75], a[124:127], v[24:27]
 ds_read_b64_tr_b16 a[42:43], v74 offset:45056
 v_mfma_f32_16x16x32_bf16 v[32:35], a[76:79], a[124:127], v[32:35]
 ds_read_b64_tr_b16 a[44:45], v75 offset:40960
 buffer_load_dwordx4 v241, s[52:55], s56 offen offset:2048 lds
 v_mfma_f32_16x16x32_bf16 v[28:31], a[76:79], a[120:123], v[28:31]
 ds_read_b64_tr_b16 a[46:47], v75 offset:45056
 s_waitcnt lgkmcnt(8)
 v_mfma_f32_16x16x32_bf16 v[36:39], a[80:83], a[120:123], v[36:39]
 ds_read_b64_tr_b16 a[48:49], v76 offset:40960
 v_mfma_f32_16x16x32_bf16 v[40:43], a[80:83], a[124:127], v[40:43]
 ds_read_b64_tr_b16 a[50:51], v76 offset:45056
 buffer_load_dwordx4 v242, s[52:55], s56 offen offset:3072 lds
 s_add_u32 m0, s57, 0
 v_readlane_b32 s56, v246, 24
 v_mfma_f32_16x16x32_bf16 v[48:51], a[84:87], a[124:127], v[48:51]
 ds_read_b64_tr_b16 a[52:53], v77 offset:40960
 v_mfma_f32_16x16x32_bf16 v[44:47], a[84:87], a[120:123], v[44:47]
 ds_read_b64_tr_b16 a[54:55], v77 offset:45056
 buffer_load_dwordx4 a[112:115], v70, s[24:27], s41 offen offset:2048 sc1
 v_mfma_f32_16x16x32_bf16 v[52:55], a[88:91], a[120:123], v[52:55]
 ds_read_b64_tr_b16 a[56:57], v78 offset:40960
 v_mfma_f32_16x16x32_bf16 v[56:59], a[88:91], a[124:127], v[56:59]
 ds_read_b64_tr_b16 a[58:59], v78 offset:45056
 buffer_load_dwordx4 a[116:119], v71, s[24:27], s41 offen offset:2048 sc1
 v_mfma_f32_16x16x32_bf16 v[64:67], a[92:95], a[124:127], v[64:67]
 ds_read_b64_tr_b16 a[60:61], v79 offset:40960
 v_mfma_f32_16x16x32_bf16 v[60:63], a[92:95], a[120:123], v[60:63]
 ds_read_b64_tr_b16 a[62:63], v79 offset:45056
 v_mfma_f32_16x16x32_bf16 v[4:7], a[0:3], a[128:131], v[4:7]
 s_waitcnt vmcnt(26)
 v_mfma_f32_16x16x32_bf16 v[8:11], a[0:3], a[132:135], v[8:11]
 s_barrier
 v_mfma_f32_16x16x32_bf16 v[16:19], a[4:7], a[132:135], v[16:19]
 ds_read_b64_tr_b16 a[64:65], v80 offset:49152
 buffer_load_dwordx4 v239, s[52:55], s56 offen lds
 v_mfma_f32_16x16x32_bf16 v[12:15], a[4:7], a[128:131], v[12:15]
 ds_read_b64_tr_b16 a[66:67], v80 offset:53248
 v_mfma_f32_16x16x32_bf16 v[20:23], a[8:11], a[128:131], v[20:23]
 ds_read_b64_tr_b16 a[68:69], v81 offset:49152
 buffer_load_dwordx4 v240, s[52:55], s56 offen offset:1024 lds
 v_mfma_f32_16x16x32_bf16 v[24:27], a[8:11], a[132:135], v[24:27]
 ds_read_b64_tr_b16 a[70:71], v81 offset:53248
 v_mfma_f32_16x16x32_bf16 v[32:35], a[12:15], a[132:135], v[32:35]
 ds_read_b64_tr_b16 a[72:73], v82 offset:49152
 buffer_load_dwordx4 v241, s[52:55], s56 offen offset:2048 lds
 v_mfma_f32_16x16x32_bf16 v[28:31], a[12:15], a[128:131], v[28:31]
 ds_read_b64_tr_b16 a[74:75], v82 offset:53248
 s_waitcnt lgkmcnt(6)
 v_mfma_f32_16x16x32_bf16 v[36:39], a[16:19], a[128:131], v[36:39]
 ds_read_b64_tr_b16 a[76:77], v83 offset:49152
 v_mfma_f32_16x16x32_bf16 v[40:43], a[16:19], a[132:135], v[40:43]
 ds_read_b64_tr_b16 a[78:79], v83 offset:53248
 buffer_load_dwordx4 v242, s[52:55], s56 offen offset:3072 lds
 s_add_u32 m0, s57, 16384
 v_readlane_b32 s56, v246, 25
 v_mfma_f32_16x16x32_bf16 v[48:51], a[20:23], a[132:135], v[48:51]
 ds_read_b64_tr_b16 a[80:81], v84 offset:49152
 v_mfma_f32_16x16x32_bf16 v[44:47], a[20:23], a[128:131], v[44:47]
 ds_read_b64_tr_b16 a[82:83], v84 offset:53248
 buffer_load_dwordx4 a[120:123], v70, s[24:27], s41 offen offset:3072 sc1
 v_mfma_f32_16x16x32_bf16 v[52:55], a[24:27], a[128:131], v[52:55]
 ds_read_b64_tr_b16 a[84:85], v85 offset:49152
 v_mfma_f32_16x16x32_bf16 v[56:59], a[24:27], a[132:135], v[56:59]
 ds_read_b64_tr_b16 a[86:87], v85 offset:53248
 ds_read_b64_tr_b16 a[92:93], v87 offset:49152
 buffer_load_dwordx4 a[124:127], v71, s[24:27], s41 offen offset:3072 sc1
 v_readlane_b32 s41, v247, 13
 v_mfma_f32_16x16x32_bf16 v[64:67], a[28:31], a[132:135], v[64:67]
 ds_read_b64_tr_b16 a[88:89], v86 offset:49152
 v_mfma_f32_16x16x32_bf16 v[60:63], a[28:31], a[128:131], v[60:63]
 ds_read_b64_tr_b16 a[90:91], v86 offset:53248
 ds_read_b64_tr_b16 a[94:95], v87 offset:53248
 v_mfma_f32_16x16x32_bf16 v[4:7], a[32:35], a[136:139], v[4:7]
 ds_read_b64_tr_b16 a[0:1], v80 offset:57344
 v_mfma_f32_16x16x32_bf16 v[8:11], a[32:35], a[140:143], v[8:11]
 ds_read_b64_tr_b16 a[2:3], v80 offset:61440
 v_mfma_f32_16x16x32_bf16 v[16:19], a[36:39], a[140:143], v[16:19]
 ds_read_b64_tr_b16 a[4:5], v81 offset:57344
 buffer_load_dwordx4 v239, s[52:55], s56 offen lds
 v_mfma_f32_16x16x32_bf16 v[12:15], a[36:39], a[136:139], v[12:15]
 ds_read_b64_tr_b16 a[6:7], v81 offset:61440
 v_mfma_f32_16x16x32_bf16 v[20:23], a[40:43], a[136:139], v[20:23]
 ds_read_b64_tr_b16 a[8:9], v82 offset:57344
 buffer_load_dwordx4 v240, s[52:55], s56 offen offset:1024 lds
 v_mfma_f32_16x16x32_bf16 v[24:27], a[40:43], a[140:143], v[24:27]
 ds_read_b64_tr_b16 a[10:11], v82 offset:61440
 v_mfma_f32_16x16x32_bf16 v[32:35], a[44:47], a[140:143], v[32:35]
 ds_read_b64_tr_b16 a[12:13], v83 offset:57344
 buffer_load_dwordx4 v241, s[52:55], s56 offen offset:2048 lds
 v_mfma_f32_16x16x32_bf16 v[28:31], a[44:47], a[136:139], v[28:31]
 ds_read_b64_tr_b16 a[14:15], v83 offset:61440
 s_waitcnt lgkmcnt(8)
 v_mfma_f32_16x16x32_bf16 v[36:39], a[48:51], a[136:139], v[36:39]
 ds_read_b64_tr_b16 a[16:17], v84 offset:57344
 v_mfma_f32_16x16x32_bf16 v[40:43], a[48:51], a[140:143], v[40:43]
 ds_read_b64_tr_b16 a[18:19], v84 offset:61440
 buffer_load_dwordx4 v242, s[52:55], s56 offen offset:3072 lds
 s_add_u32 m0, s57, 32768
 v_readlane_b32 s56, v246, 26
 v_mfma_f32_16x16x32_bf16 v[48:51], a[52:55], a[140:143], v[48:51]
 ds_read_b64_tr_b16 a[20:21], v85 offset:57344
 v_mfma_f32_16x16x32_bf16 v[44:47], a[52:55], a[136:139], v[44:47]
 ds_read_b64_tr_b16 a[22:23], v85 offset:61440
 buffer_load_dwordx4 a[128:131], v70, s[24:27], s41 offen sc1
 v_mfma_f32_16x16x32_bf16 v[52:55], a[56:59], a[136:139], v[52:55]
 ds_read_b64_tr_b16 a[24:25], v86 offset:57344
 v_mfma_f32_16x16x32_bf16 v[56:59], a[56:59], a[140:143], v[56:59]
 ds_read_b64_tr_b16 a[26:27], v86 offset:61440
 buffer_load_dwordx4 a[132:135], v71, s[24:27], s41 offen sc1
 v_mfma_f32_16x16x32_bf16 v[64:67], a[60:63], a[140:143], v[64:67]
 ds_read_b64_tr_b16 a[28:29], v87 offset:57344
 v_mfma_f32_16x16x32_bf16 v[60:63], a[60:63], a[136:139], v[60:63]
 ds_read_b64_tr_b16 a[30:31], v87 offset:61440
 v_mfma_f32_16x16x32_bf16 v[4:7], a[64:67], a[144:147], v[4:7]
 s_waitcnt vmcnt(32)
 v_mfma_f32_16x16x32_bf16 v[8:11], a[64:67], a[148:151], v[8:11]
 s_barrier
 v_mfma_f32_16x16x32_bf16 v[16:19], a[68:71], a[148:151], v[16:19]
 ds_read_b64_tr_b16 a[32:33], v72 offset:49152
 buffer_load_dwordx4 v239, s[52:55], s56 offen lds
 v_mfma_f32_16x16x32_bf16 v[12:15], a[68:71], a[144:147], v[12:15]
 ds_read_b64_tr_b16 a[34:35], v72 offset:53248
 v_mfma_f32_16x16x32_bf16 v[20:23], a[72:75], a[144:147], v[20:23]
 ds_read_b64_tr_b16 a[36:37], v73 offset:49152
 buffer_load_dwordx4 v240, s[52:55], s56 offen offset:1024 lds
 v_mfma_f32_16x16x32_bf16 v[24:27], a[72:75], a[148:151], v[24:27]
 ds_read_b64_tr_b16 a[38:39], v73 offset:53248
 v_mfma_f32_16x16x32_bf16 v[32:35], a[76:79], a[148:151], v[32:35]
 ds_read_b64_tr_b16 a[40:41], v74 offset:49152
 buffer_load_dwordx4 v241, s[52:55], s56 offen offset:2048 lds
 v_mfma_f32_16x16x32_bf16 v[28:31], a[76:79], a[144:147], v[28:31]
 ds_read_b64_tr_b16 a[42:43], v74 offset:53248
 s_waitcnt lgkmcnt(6)
 v_mfma_f32_16x16x32_bf16 v[36:39], a[80:83], a[144:147], v[36:39]
 ds_read_b64_tr_b16 a[44:45], v75 offset:49152
 v_mfma_f32_16x16x32_bf16 v[40:43], a[80:83], a[148:151], v[40:43]
 ds_read_b64_tr_b16 a[46:47], v75 offset:53248
 buffer_load_dwordx4 v242, s[52:55], s56 offen offset:3072 lds
 s_add_u32 m0, s57, 114688
 v_readlane_b32 s56, v246, 27
 v_mfma_f32_16x16x32_bf16 v[48:51], a[84:87], a[148:151], v[48:51]
 ds_read_b64_tr_b16 a[48:49], v72 offset:57344
 v_mfma_f32_16x16x32_bf16 v[44:47], a[84:87], a[144:147], v[44:47]
 ds_read_b64_tr_b16 a[50:51], v72 offset:61440
 buffer_load_dwordx4 a[136:139], v70, s[24:27], s41 offen offset:1024 sc1
 v_mfma_f32_16x16x32_bf16 v[52:55], a[88:91], a[144:147], v[52:55]
 ds_read_b64_tr_b16 a[52:53], v73 offset:57344
 v_mfma_f32_16x16x32_bf16 v[56:59], a[88:91], a[148:151], v[56:59]
 ds_read_b64_tr_b16 a[54:55], v73 offset:61440
 ds_read_b64_tr_b16 a[60:61], v75 offset:57344
 buffer_load_dwordx4 a[140:143], v71, s[24:27], s41 offen offset:1024 sc1
 v_mfma_f32_16x16x32_bf16 v[64:67], a[92:95], a[148:151], v[64:67]
 ds_read_b64_tr_b16 a[56:57], v74 offset:57344
 v_mfma_f32_16x16x32_bf16 v[60:63], a[92:95], a[144:147], v[60:63]
 ds_read_b64_tr_b16 a[58:59], v74 offset:61440
 ds_read_b64_tr_b16 a[62:63], v75 offset:61440
 v_mfma_f32_16x16x32_bf16 v[4:7], a[0:3], a[152:155], v[4:7]
 s_waitcnt vmcnt(32)
 v_mfma_f32_16x16x32_bf16 v[8:11], a[0:3], a[156:159], v[8:11]
 s_barrier
 v_mfma_f32_16x16x32_bf16 v[16:19], a[4:7], a[156:159], v[16:19]
 ds_read_b64_tr_b16 a[64:65], v80 offset:0
 buffer_load_dwordx4 v239, s[52:55], s56 offen lds
 v_mfma_f32_16x16x32_bf16 v[12:15], a[4:7], a[152:155], v[12:15]
 ds_read_b64_tr_b16 a[66:67], v80 offset:4096
 v_mfma_f32_16x16x32_bf16 v[20:23], a[8:11], a[152:155], v[20:23]
 ds_read_b64_tr_b16 a[68:69], v81 offset:0
 buffer_load_dwordx4 v240, s[52:55], s56 offen offset:1024 lds
 v_mfma_f32_16x16x32_bf16 v[24:27], a[8:11], a[156:159], v[24:27]
 ds_read_b64_tr_b16 a[70:71], v81 offset:4096
 v_mfma_f32_16x16x32_bf16 v[32:35], a[12:15], a[156:159], v[32:35]
 ds_read_b64_tr_b16 a[72:73], v82 offset:0
 buffer_load_dwordx4 v241, s[52:55], s56 offen offset:2048 lds
 v_mfma_f32_16x16x32_bf16 v[28:31], a[12:15], a[152:155], v[28:31]
 ds_read_b64_tr_b16 a[74:75], v82 offset:4096
 s_waitcnt lgkmcnt(6)
 v_mfma_f32_16x16x32_bf16 v[36:39], a[16:19], a[152:155], v[36:39]
 ds_read_b64_tr_b16 a[76:77], v83 offset:0
 v_mfma_f32_16x16x32_bf16 v[40:43], a[16:19], a[156:159], v[40:43]
 ds_read_b64_tr_b16 a[78:79], v83 offset:4096
 buffer_load_dwordx4 v242, s[52:55], s56 offen offset:3072 lds
 v_mfma_f32_16x16x32_bf16 v[48:51], a[20:23], a[156:159], v[48:51]
 ds_read_b64_tr_b16 a[80:81], v80 offset:8192
 v_mfma_f32_16x16x32_bf16 v[44:47], a[20:23], a[152:155], v[44:47]
 ds_read_b64_tr_b16 a[82:83], v80 offset:12288
 buffer_load_dwordx4 a[144:147], v70, s[24:27], s41 offen offset:2048 sc1
 v_mfma_f32_16x16x32_bf16 v[52:55], a[24:27], a[152:155], v[52:55]
 ds_read_b64_tr_b16 a[84:85], v81 offset:8192
 v_mfma_f32_16x16x32_bf16 v[56:59], a[24:27], a[156:159], v[56:59]
 ds_read_b64_tr_b16 a[86:87], v81 offset:12288
 ds_read_b64_tr_b16 a[92:93], v83 offset:8192
 buffer_load_dwordx4 a[148:151], v71, s[24:27], s41 offen offset:2048 sc1
 v_mfma_f32_16x16x32_bf16 v[64:67], a[28:31], a[156:159], v[64:67]
 ds_read_b64_tr_b16 a[88:89], v82 offset:8192
 v_mfma_f32_16x16x32_bf16 v[60:63], a[28:31], a[152:155], v[60:63]
 ds_read_b64_tr_b16 a[90:91], v82 offset:12288
 ds_read_b64_tr_b16 a[94:95], v83 offset:12288
 v_mfma_f32_16x16x32_bf16 v[4:7], a[32:35], a[160:163], v[4:7]
 s_waitcnt vmcnt(32)
 v_mfma_f32_16x16x32_bf16 v[8:11], a[32:35], a[164:167], v[8:11]
 s_barrier
 v_mfma_f32_16x16x32_bf16 v[16:19], a[36:39], a[164:167], v[16:19]
 ds_read_b64_tr_b16 a[0:1], v80 offset:16384
 buffer_load_dwordx4 a[152:155], v70, s[24:27], s41 offen offset:3072 sc1
 v_mfma_f32_16x16x32_bf16 v[12:15], a[36:39], a[160:163], v[12:15]
 ds_read_b64_tr_b16 a[2:3], v80 offset:20480
 v_mfma_f32_16x16x32_bf16 v[20:23], a[40:43], a[160:163], v[20:23]
 ds_read_b64_tr_b16 a[4:5], v81 offset:16384
 v_mfma_f32_16x16x32_bf16 v[24:27], a[40:43], a[164:167], v[24:27]
 ds_read_b64_tr_b16 a[6:7], v81 offset:20480
 v_mfma_f32_16x16x32_bf16 v[32:35], a[44:47], a[164:167], v[32:35]
 ds_read_b64_tr_b16 a[8:9], v82 offset:16384
 v_mfma_f32_16x16x32_bf16 v[28:31], a[44:47], a[160:163], v[28:31]
 ds_read_b64_tr_b16 a[10:11], v82 offset:20480
 s_waitcnt lgkmcnt(6)
 v_mfma_f32_16x16x32_bf16 v[4:7], a[48:51], a[168:171], v[4:7]
 ds_read_b64_tr_b16 a[12:13], v83 offset:16384
 v_mfma_f32_16x16x32_bf16 v[8:11], a[48:51], a[172:175], v[8:11]
 ds_read_b64_tr_b16 a[14:15], v83 offset:20480
 buffer_load_dwordx4 a[156:159], v71, s[24:27], s41 offen offset:3072 sc1
 v_mfma_f32_16x16x32_bf16 v[16:19], a[52:55], a[172:175], v[16:19]
 ds_read_b64_tr_b16 a[16:17], v80 offset:24576
 v_mfma_f32_16x16x32_bf16 v[12:15], a[52:55], a[168:171], v[12:15]
 ds_read_b64_tr_b16 a[18:19], v80 offset:28672
 v_mfma_f32_16x16x32_bf16 v[20:23], a[56:59], a[168:171], v[20:23]
 ds_read_b64_tr_b16 a[20:21], v81 offset:24576
 v_mfma_f32_16x16x32_bf16 v[24:27], a[56:59], a[172:175], v[24:27]
 ds_read_b64_tr_b16 a[22:23], v81 offset:28672
 ds_read_b64_tr_b16 a[28:29], v83 offset:24576
 v_mfma_f32_16x16x32_bf16 v[32:35], a[60:63], a[172:175], v[32:35]
 ds_read_b64_tr_b16 a[24:25], v82 offset:24576
 v_mfma_f32_16x16x32_bf16 v[28:31], a[60:63], a[168:171], v[28:31]
 ds_read_b64_tr_b16 a[26:27], v82 offset:28672
 ds_read_b64_tr_b16 a[30:31], v83 offset:28672
 v_mfma_f32_16x16x32_bf16 v[4:7], a[64:67], a[176:179], v[4:7]
 s_waitcnt vmcnt(28)
 v_mfma_f32_16x16x32_bf16 v[8:11], a[64:67], a[180:183], v[8:11]
 s_barrier
 v_mfma_f32_16x16x32_bf16 v[16:19], a[68:71], a[180:183], v[16:19]
 ds_read_b64_tr_b16 a[32:33], v80 offset:32768
 v_mfma_f32_16x16x32_bf16 v[12:15], a[68:71], a[176:179], v[12:15]
 ds_read_b64_tr_b16 a[34:35], v80 offset:36864
 v_mfma_f32_16x16x32_bf16 v[20:23], a[72:75], a[176:179], v[20:23]
 ds_read_b64_tr_b16 a[36:37], v81 offset:32768
 v_mfma_f32_16x16x32_bf16 v[24:27], a[72:75], a[180:183], v[24:27]
 ds_read_b64_tr_b16 a[38:39], v81 offset:36864
 v_mfma_f32_16x16x32_bf16 v[32:35], a[76:79], a[180:183], v[32:35]
 ds_read_b64_tr_b16 a[40:41], v82 offset:32768
 v_mfma_f32_16x16x32_bf16 v[28:31], a[76:79], a[176:179], v[28:31]
 ds_read_b64_tr_b16 a[42:43], v82 offset:36864
 s_waitcnt lgkmcnt(6)
 v_mfma_f32_16x16x32_bf16 v[4:7], a[80:83], a[184:187], v[4:7]
 ds_read_b64_tr_b16 a[44:45], v83 offset:32768
 v_mfma_f32_16x16x32_bf16 v[8:11], a[80:83], a[188:191], v[8:11]
 ds_read_b64_tr_b16 a[46:47], v83 offset:36864
 v_mfma_f32_16x16x32_bf16 v[16:19], a[84:87], a[188:191], v[16:19]
 ds_read_b64_tr_b16 a[48:49], v80 offset:40960
 v_mfma_f32_16x16x32_bf16 v[12:15], a[84:87], a[184:187], v[12:15]
 ds_read_b64_tr_b16 a[50:51], v80 offset:45056
 v_mfma_f32_16x16x32_bf16 v[20:23], a[88:91], a[184:187], v[20:23]
 ds_read_b64_tr_b16 a[52:53], v81 offset:40960
 v_mfma_f32_16x16x32_bf16 v[24:27], a[88:91], a[188:191], v[24:27]
 ds_read_b64_tr_b16 a[54:55], v81 offset:45056
 ds_read_b64_tr_b16 a[60:61], v83 offset:40960
 v_mfma_f32_16x16x32_bf16 v[32:35], a[92:95], a[188:191], v[32:35]
 ds_read_b64_tr_b16 a[56:57], v82 offset:40960
 v_mfma_f32_16x16x32_bf16 v[28:31], a[92:95], a[184:187], v[28:31]
 ds_read_b64_tr_b16 a[58:59], v82 offset:45056
 ds_read_b64_tr_b16 a[62:63], v83 offset:45056
 v_mfma_f32_16x16x32_bf16 v[4:7], a[0:3], a[192:195], v[4:7]
 s_waitcnt vmcnt(22)
 v_mfma_f32_16x16x32_bf16 v[8:11], a[0:3], a[196:199], v[8:11]
 s_barrier
 v_mfma_f32_16x16x32_bf16 v[16:19], a[4:7], a[196:199], v[16:19]
 ds_read_b64_tr_b16 a[64:65], v72 offset:0
 v_mfma_f32_16x16x32_bf16 v[12:15], a[4:7], a[192:195], v[12:15]
 ds_read_b64_tr_b16 a[66:67], v72 offset:4096
 v_mfma_f32_16x16x32_bf16 v[20:23], a[8:11], a[192:195], v[20:23]
 ds_read_b64_tr_b16 a[68:69], v73 offset:0
 v_mfma_f32_16x16x32_bf16 v[24:27], a[8:11], a[196:199], v[24:27]
 ds_read_b64_tr_b16 a[70:71], v73 offset:4096
 v_mfma_f32_16x16x32_bf16 v[32:35], a[12:15], a[196:199], v[32:35]
 ds_read_b64_tr_b16 a[72:73], v74 offset:0
 v_mfma_f32_16x16x32_bf16 v[28:31], a[12:15], a[192:195], v[28:31]
 ds_read_b64_tr_b16 a[74:75], v74 offset:4096
 s_waitcnt lgkmcnt(6)
 v_mfma_f32_16x16x32_bf16 v[4:7], a[16:19], a[200:203], v[4:7]
 ds_read_b64_tr_b16 a[76:77], v75 offset:0
 v_mfma_f32_16x16x32_bf16 v[8:11], a[16:19], a[204:207], v[8:11]
 ds_read_b64_tr_b16 a[78:79], v75 offset:4096
 v_mfma_f32_16x16x32_bf16 v[16:19], a[20:23], a[204:207], v[16:19]
 ds_read_b64_tr_b16 a[80:81], v72 offset:8192
 v_mfma_f32_16x16x32_bf16 v[12:15], a[20:23], a[200:203], v[12:15]
 ds_read_b64_tr_b16 a[82:83], v72 offset:12288
 v_mfma_f32_16x16x32_bf16 v[20:23], a[24:27], a[200:203], v[20:23]
 ds_read_b64_tr_b16 a[84:85], v73 offset:8192
 v_mfma_f32_16x16x32_bf16 v[24:27], a[24:27], a[204:207], v[24:27]
 ds_read_b64_tr_b16 a[86:87], v73 offset:12288
 ds_read_b64_tr_b16 a[92:93], v75 offset:8192
 v_mfma_f32_16x16x32_bf16 v[32:35], a[28:31], a[204:207], v[32:35]
 ds_read_b64_tr_b16 a[88:89], v74 offset:8192
 v_mfma_f32_16x16x32_bf16 v[28:31], a[28:31], a[200:203], v[28:31]
 ds_read_b64_tr_b16 a[90:91], v74 offset:12288
 ds_read_b64_tr_b16 a[94:95], v75 offset:12288
 v_mfma_f32_16x16x32_bf16 v[4:7], a[32:35], a[208:211], v[4:7]
 s_waitcnt vmcnt(16)
 v_mfma_f32_16x16x32_bf16 v[8:11], a[32:35], a[212:215], v[8:11]
 s_barrier
 v_mfma_f32_16x16x32_bf16 v[16:19], a[36:39], a[212:215], v[16:19]
 ds_read_b64_tr_b16 a[0:1], v72 offset:16384
 v_mfma_f32_16x16x32_bf16 v[12:15], a[36:39], a[208:211], v[12:15]
 ds_read_b64_tr_b16 a[2:3], v72 offset:20480
 v_mfma_f32_16x16x32_bf16 v[20:23], a[40:43], a[208:211], v[20:23]
 ds_read_b64_tr_b16 a[4:5], v73 offset:16384
 v_mfma_f32_16x16x32_bf16 v[24:27], a[40:43], a[212:215], v[24:27]
 ds_read_b64_tr_b16 a[6:7], v73 offset:20480
 v_mfma_f32_16x16x32_bf16 v[32:35], a[44:47], a[212:215], v[32:35]
 ds_read_b64_tr_b16 a[8:9], v74 offset:16384
 v_mfma_f32_16x16x32_bf16 v[28:31], a[44:47], a[208:211], v[28:31]
 ds_read_b64_tr_b16 a[10:11], v74 offset:20480
 s_waitcnt lgkmcnt(6)
 v_mfma_f32_16x16x32_bf16 v[4:7], a[48:51], a[216:219], v[4:7]
 ds_read_b64_tr_b16 a[12:13], v75 offset:16384
 v_mfma_f32_16x16x32_bf16 v[8:11], a[48:51], a[220:223], v[8:11]
 ds_read_b64_tr_b16 a[14:15], v75 offset:20480
 v_mfma_f32_16x16x32_bf16 v[16:19], a[52:55], a[220:223], v[16:19]
 ds_read_b64_tr_b16 a[16:17], v72 offset:24576
 v_mfma_f32_16x16x32_bf16 v[12:15], a[52:55], a[216:219], v[12:15]
 ds_read_b64_tr_b16 a[18:19], v72 offset:28672
 v_mfma_f32_16x16x32_bf16 v[20:23], a[56:59], a[216:219], v[20:23]
 ds_read_b64_tr_b16 a[20:21], v73 offset:24576
 v_mfma_f32_16x16x32_bf16 v[24:27], a[56:59], a[220:223], v[24:27]
 ds_read_b64_tr_b16 a[22:23], v73 offset:28672
 ds_read_b64_tr_b16 a[28:29], v75 offset:24576
 v_mfma_f32_16x16x32_bf16 v[32:35], a[60:63], a[220:223], v[32:35]
 ds_read_b64_tr_b16 a[24:25], v74 offset:24576
 v_mfma_f32_16x16x32_bf16 v[28:31], a[60:63], a[216:219], v[28:31]
 ds_read_b64_tr_b16 a[26:27], v74 offset:28672
 ds_read_b64_tr_b16 a[30:31], v75 offset:28672
 v_mfma_f32_16x16x32_bf16 v[4:7], a[64:67], a[96:99], v[4:7]
 s_waitcnt vmcnt(10)
 v_mfma_f32_16x16x32_bf16 v[8:11], a[64:67], a[100:103], v[8:11]
 s_barrier
 v_mfma_f32_16x16x32_bf16 v[16:19], a[68:71], a[100:103], v[16:19]
 ds_read_b64_tr_b16 a[32:33], v72 offset:32768
 v_mfma_f32_16x16x32_bf16 v[12:15], a[68:71], a[96:99], v[12:15]
 ds_read_b64_tr_b16 a[34:35], v72 offset:36864
 v_mfma_f32_16x16x32_bf16 v[20:23], a[72:75], a[96:99], v[20:23]
 ds_read_b64_tr_b16 a[36:37], v73 offset:32768
 v_mfma_f32_16x16x32_bf16 v[24:27], a[72:75], a[100:103], v[24:27]
 ds_read_b64_tr_b16 a[38:39], v73 offset:36864
 v_mfma_f32_16x16x32_bf16 v[32:35], a[76:79], a[100:103], v[32:35]
 ds_read_b64_tr_b16 a[40:41], v74 offset:32768
 v_mfma_f32_16x16x32_bf16 v[28:31], a[76:79], a[96:99], v[28:31]
 ds_read_b64_tr_b16 a[42:43], v74 offset:36864
 s_waitcnt lgkmcnt(6)
 v_mfma_f32_16x16x32_bf16 v[4:7], a[80:83], a[104:107], v[4:7]
 ds_read_b64_tr_b16 a[44:45], v75 offset:32768
 v_mfma_f32_16x16x32_bf16 v[8:11], a[80:83], a[108:111], v[8:11]
 ds_read_b64_tr_b16 a[46:47], v75 offset:36864
 v_mfma_f32_16x16x32_bf16 v[16:19], a[84:87], a[108:111], v[16:19]
 ds_read_b64_tr_b16 a[48:49], v72 offset:40960
 v_mfma_f32_16x16x32_bf16 v[12:15], a[84:87], a[104:107], v[12:15]
 ds_read_b64_tr_b16 a[50:51], v72 offset:45056
 v_mfma_f32_16x16x32_bf16 v[20:23], a[88:91], a[104:107], v[20:23]
 ds_read_b64_tr_b16 a[52:53], v73 offset:40960
 v_mfma_f32_16x16x32_bf16 v[24:27], a[88:91], a[108:111], v[24:27]
 ds_read_b64_tr_b16 a[54:55], v73 offset:45056
 ds_read_b64_tr_b16 a[60:61], v75 offset:40960
 v_mfma_f32_16x16x32_bf16 v[32:35], a[92:95], a[108:111], v[32:35]
 ds_read_b64_tr_b16 a[56:57], v74 offset:40960
 v_mfma_f32_16x16x32_bf16 v[28:31], a[92:95], a[104:107], v[28:31]
 ds_read_b64_tr_b16 a[58:59], v74 offset:45056
 ds_read_b64_tr_b16 a[62:63], v75 offset:45056
 v_mfma_f32_16x16x32_bf16 v[4:7], a[0:3], a[112:115], v[4:7]
 s_waitcnt vmcnt(4)
 v_mfma_f32_16x16x32_bf16 v[8:11], a[0:3], a[116:119], v[8:11]
 s_barrier
 v_mfma_f32_16x16x32_bf16 v[16:19], a[4:7], a[116:119], v[16:19]
 ds_read_b64_tr_b16 a[64:65], v80 offset:49152
 v_mfma_f32_16x16x32_bf16 v[12:15], a[4:7], a[112:115], v[12:15]
 ds_read_b64_tr_b16 a[66:67], v80 offset:53248
 v_mfma_f32_16x16x32_bf16 v[20:23], a[8:11], a[112:115], v[20:23]
 ds_read_b64_tr_b16 a[68:69], v81 offset:49152
 v_mfma_f32_16x16x32_bf16 v[24:27], a[8:11], a[116:119], v[24:27]
 ds_read_b64_tr_b16 a[70:71], v81 offset:53248
 v_mfma_f32_16x16x32_bf16 v[32:35], a[12:15], a[116:119], v[32:35]
 ds_read_b64_tr_b16 a[72:73], v82 offset:49152
 v_mfma_f32_16x16x32_bf16 v[28:31], a[12:15], a[112:115], v[28:31]
 ds_read_b64_tr_b16 a[74:75], v82 offset:53248
 s_waitcnt lgkmcnt(6)
 v_mfma_f32_16x16x32_bf16 v[4:7], a[16:19], a[120:123], v[4:7]
 ds_read_b64_tr_b16 a[76:77], v83 offset:49152
 v_mfma_f32_16x16x32_bf16 v[8:11], a[16:19], a[124:127], v[8:11]
 ds_read_b64_tr_b16 a[78:79], v83 offset:53248
 v_mfma_f32_16x16x32_bf16 v[16:19], a[20:23], a[124:127], v[16:19]
 ds_read_b64_tr_b16 a[80:81], v80 offset:57344
 v_mfma_f32_16x16x32_bf16 v[12:15], a[20:23], a[120:123], v[12:15]
 ds_read_b64_tr_b16 a[82:83], v80 offset:61440
 v_mfma_f32_16x16x32_bf16 v[20:23], a[24:27], a[120:123], v[20:23]
 ds_read_b64_tr_b16 a[84:85], v81 offset:57344
 v_mfma_f32_16x16x32_bf16 v[24:27], a[24:27], a[124:127], v[24:27]
 ds_read_b64_tr_b16 a[86:87], v81 offset:61440
 ds_read_b64_tr_b16 a[92:93], v83 offset:57344
 v_mfma_f32_16x16x32_bf16 v[32:35], a[28:31], a[124:127], v[32:35]
 ds_read_b64_tr_b16 a[88:89], v82 offset:57344
 v_mfma_f32_16x16x32_bf16 v[28:31], a[28:31], a[120:123], v[28:31]
 ds_read_b64_tr_b16 a[90:91], v82 offset:61440
 ds_read_b64_tr_b16 a[94:95], v83 offset:61440
 v_mfma_f32_16x16x32_bf16 v[4:7], a[32:35], a[128:131], v[4:7]
 ds_read_b64_tr_b16 a[0:1], v76 offset:49152
 v_mfma_f32_16x16x32_bf16 v[8:11], a[32:35], a[132:135], v[8:11]
 ds_read_b64_tr_b16 a[2:3], v76 offset:53248
 v_mfma_f32_16x16x32_bf16 v[16:19], a[36:39], a[132:135], v[16:19]
 ds_read_b64_tr_b16 a[4:5], v77 offset:49152
 v_mfma_f32_16x16x32_bf16 v[12:15], a[36:39], a[128:131], v[12:15]
 ds_read_b64_tr_b16 a[6:7], v77 offset:53248
 v_mfma_f32_16x16x32_bf16 v[20:23], a[40:43], a[128:131], v[20:23]
 ds_read_b64_tr_b16 a[8:9], v78 offset:49152
 v_mfma_f32_16x16x32_bf16 v[24:27], a[40:43], a[132:135], v[24:27]
 ds_read_b64_tr_b16 a[10:11], v78 offset:53248
 v_mfma_f32_16x16x32_bf16 v[32:35], a[44:47], a[132:135], v[32:35]
 ds_read_b64_tr_b16 a[12:13], v79 offset:49152
 v_mfma_f32_16x16x32_bf16 v[28:31], a[44:47], a[128:131], v[28:31]
 ds_read_b64_tr_b16 a[14:15], v79 offset:53248
 s_waitcnt vmcnt(0) lgkmcnt(8)
 v_mfma_f32_16x16x32_bf16 v[4:7], a[48:51], a[136:139], v[4:7]
 ds_read_b64_tr_b16 a[16:17], v76 offset:57344
 v_mfma_f32_16x16x32_bf16 v[8:11], a[48:51], a[140:143], v[8:11]
 ds_read_b64_tr_b16 a[18:19], v76 offset:61440
 v_mfma_f32_16x16x32_bf16 v[16:19], a[52:55], a[140:143], v[16:19]
 ds_read_b64_tr_b16 a[20:21], v77 offset:57344
 v_mfma_f32_16x16x32_bf16 v[12:15], a[52:55], a[136:139], v[12:15]
 ds_read_b64_tr_b16 a[22:23], v77 offset:61440
 v_mfma_f32_16x16x32_bf16 v[20:23], a[56:59], a[136:139], v[20:23]
 ds_read_b64_tr_b16 a[24:25], v78 offset:57344
 v_mfma_f32_16x16x32_bf16 v[24:27], a[56:59], a[140:143], v[24:27]
 ds_read_b64_tr_b16 a[26:27], v78 offset:61440
 v_mfma_f32_16x16x32_bf16 v[32:35], a[60:63], a[140:143], v[32:35]
 ds_read_b64_tr_b16 a[28:29], v79 offset:57344
 v_mfma_f32_16x16x32_bf16 v[28:31], a[60:63], a[136:139], v[28:31]
 ds_read_b64_tr_b16 a[30:31], v79 offset:61440
 v_mfma_f32_16x16x32_bf16 v[4:7], a[64:67], a[144:147], v[4:7]
 ds_read_b64_tr_b16 a[32:33], v84 offset:0
 v_mfma_f32_16x16x32_bf16 v[8:11], a[64:67], a[148:151], v[8:11]
 ds_read_b64_tr_b16 a[34:35], v84 offset:4096
 v_mfma_f32_16x16x32_bf16 v[16:19], a[68:71], a[148:151], v[16:19]
 ds_read_b64_tr_b16 a[36:37], v85 offset:0
 v_mfma_f32_16x16x32_bf16 v[12:15], a[68:71], a[144:147], v[12:15]
 ds_read_b64_tr_b16 a[38:39], v85 offset:4096
 v_mfma_f32_16x16x32_bf16 v[20:23], a[72:75], a[144:147], v[20:23]
 ds_read_b64_tr_b16 a[40:41], v86 offset:0
 v_mfma_f32_16x16x32_bf16 v[24:27], a[72:75], a[148:151], v[24:27]
 ds_read_b64_tr_b16 a[42:43], v86 offset:4096
 v_mfma_f32_16x16x32_bf16 v[32:35], a[76:79], a[148:151], v[32:35]
 ds_read_b64_tr_b16 a[44:45], v87 offset:0
 v_mfma_f32_16x16x32_bf16 v[28:31], a[76:79], a[144:147], v[28:31]
 ds_read_b64_tr_b16 a[46:47], v87 offset:4096
 s_waitcnt lgkmcnt(8)
 v_mfma_f32_16x16x32_bf16 v[4:7], a[80:83], a[152:155], v[4:7]
 ds_read_b64_tr_b16 a[48:49], v84 offset:8192
 v_mfma_f32_16x16x32_bf16 v[8:11], a[80:83], a[156:159], v[8:11]
 ds_read_b64_tr_b16 a[50:51], v84 offset:12288
 v_mfma_f32_16x16x32_bf16 v[16:19], a[84:87], a[156:159], v[16:19]
 ds_read_b64_tr_b16 a[52:53], v85 offset:8192
 v_mfma_f32_16x16x32_bf16 v[12:15], a[84:87], a[152:155], v[12:15]
 ds_read_b64_tr_b16 a[54:55], v85 offset:12288
 v_mfma_f32_16x16x32_bf16 v[20:23], a[88:91], a[152:155], v[20:23]
 ds_read_b64_tr_b16 a[56:57], v86 offset:8192
 v_mfma_f32_16x16x32_bf16 v[24:27], a[88:91], a[156:159], v[24:27]
 ds_read_b64_tr_b16 a[58:59], v86 offset:12288
 v_mfma_f32_16x16x32_bf16 v[32:35], a[92:95], a[156:159], v[32:35]
 ds_read_b64_tr_b16 a[60:61], v87 offset:8192
 v_mfma_f32_16x16x32_bf16 v[28:31], a[92:95], a[152:155], v[28:31]
 ds_read_b64_tr_b16 a[62:63], v87 offset:12288
 v_mfma_f32_16x16x32_bf16 v[36:39], a[0:3], a[160:163], v[36:39]
 ds_read_b64_tr_b16 a[64:65], v84 offset:16384
 v_mfma_f32_16x16x32_bf16 v[40:43], a[0:3], a[164:167], v[40:43]
 ds_read_b64_tr_b16 a[66:67], v84 offset:20480
 v_mfma_f32_16x16x32_bf16 v[48:51], a[4:7], a[164:167], v[48:51]
 ds_read_b64_tr_b16 a[68:69], v85 offset:16384
 v_mfma_f32_16x16x32_bf16 v[44:47], a[4:7], a[160:163], v[44:47]
 ds_read_b64_tr_b16 a[70:71], v85 offset:20480
 v_mfma_f32_16x16x32_bf16 v[52:55], a[8:11], a[160:163], v[52:55]
 ds_read_b64_tr_b16 a[72:73], v86 offset:16384
 v_cvt_pk_bf16_f32 v164, v4, v5
 v_mfma_f32_16x16x32_bf16 v[56:59], a[8:11], a[164:167], v[56:59]
 ds_read_b64_tr_b16 a[74:75], v86 offset:20480
 v_cvt_pk_bf16_f32 v165, v6, v7
 v_mfma_f32_16x16x32_bf16 v[64:67], a[12:15], a[164:167], v[64:67]
 ds_read_b64_tr_b16 a[76:77], v87 offset:16384
 v_cvt_pk_bf16_f32 v166, v8, v9
 v_mfma_f32_16x16x32_bf16 v[60:63], a[12:15], a[160:163], v[60:63]
 ds_read_b64_tr_b16 a[78:79], v87 offset:20480
 s_waitcnt lgkmcnt(8)
 v_cvt_pk_bf16_f32 v167, v10, v11
 v_mfma_f32_16x16x32_bf16 v[36:39], a[16:19], a[168:171], v[36:39]
 ds_read_b64_tr_b16 a[80:81], v84 offset:24576
 buffer_store_dwordx4 v[164:167], v160, s[28:31], 0 offen sc1
 v_mfma_f32_16x16x32_bf16 v[40:43], a[16:19], a[172:175], v[40:43]
 ds_read_b64_tr_b16 a[82:83], v84 offset:28672
 v_cvt_pk_bf16_f32 v168, v12, v13
 v_mfma_f32_16x16x32_bf16 v[48:51], a[20:23], a[172:175], v[48:51]
 ds_read_b64_tr_b16 a[84:85], v85 offset:24576
 v_cvt_pk_bf16_f32 v169, v14, v15
 v_mfma_f32_16x16x32_bf16 v[44:47], a[20:23], a[168:171], v[44:47]
 ds_read_b64_tr_b16 a[86:87], v85 offset:28672
 v_cvt_pk_bf16_f32 v170, v16, v17
 v_mfma_f32_16x16x32_bf16 v[52:55], a[24:27], a[168:171], v[52:55]
 ds_read_b64_tr_b16 a[88:89], v86 offset:24576
 v_cvt_pk_bf16_f32 v171, v18, v19
 v_mfma_f32_16x16x32_bf16 v[56:59], a[24:27], a[172:175], v[56:59]
 ds_read_b64_tr_b16 a[90:91], v86 offset:28672
 buffer_store_dwordx4 v[168:171], v160, s[28:31], 0 offen offset:1024 sc1
 v_mfma_f32_16x16x32_bf16 v[64:67], a[28:31], a[172:175], v[64:67]
 ds_read_b64_tr_b16 a[92:93], v87 offset:24576
 v_mfma_f32_16x16x32_bf16 v[60:63], a[28:31], a[168:171], v[60:63]
 ds_read_b64_tr_b16 a[94:95], v87 offset:28672
 v_mfma_f32_16x16x32_bf16 v[36:39], a[32:35], a[176:179], v[36:39]
 ds_read_b64_tr_b16 a[0:1], v84 offset:32768
 v_cvt_pk_bf16_f32 v172, v20, v21
 v_mfma_f32_16x16x32_bf16 v[40:43], a[32:35], a[180:183], v[40:43]
 ds_read_b64_tr_b16 a[2:3], v84 offset:36864
 v_cvt_pk_bf16_f32 v173, v22, v23
 v_mfma_f32_16x16x32_bf16 v[48:51], a[36:39], a[180:183], v[48:51]
 ds_read_b64_tr_b16 a[4:5], v85 offset:32768
 v_cvt_pk_bf16_f32 v174, v24, v25
 v_mfma_f32_16x16x32_bf16 v[44:47], a[36:39], a[176:179], v[44:47]
 ds_read_b64_tr_b16 a[6:7], v85 offset:36864
 v_cvt_pk_bf16_f32 v175, v26, v27
 v_mfma_f32_16x16x32_bf16 v[52:55], a[40:43], a[176:179], v[52:55]
 ds_read_b64_tr_b16 a[8:9], v86 offset:32768
 buffer_store_dwordx4 v[172:175], v160, s[28:31], 0 offen offset:2048 sc1
 v_mfma_f32_16x16x32_bf16 v[56:59], a[40:43], a[180:183], v[56:59]
 ds_read_b64_tr_b16 a[10:11], v86 offset:36864
 v_cvt_pk_bf16_f32 v176, v28, v29
 v_mfma_f32_16x16x32_bf16 v[64:67], a[44:47], a[180:183], v[64:67]
 ds_read_b64_tr_b16 a[12:13], v87 offset:32768
 v_cvt_pk_bf16_f32 v177, v30, v31
 v_mfma_f32_16x16x32_bf16 v[60:63], a[44:47], a[176:179], v[60:63]
 ds_read_b64_tr_b16 a[14:15], v87 offset:36864
 s_waitcnt lgkmcnt(8)
 v_cvt_pk_bf16_f32 v178, v32, v33
 v_mfma_f32_16x16x32_bf16 v[36:39], a[48:51], a[184:187], v[36:39]
 ds_read_b64_tr_b16 a[16:17], v84 offset:40960
 v_cvt_pk_bf16_f32 v179, v34, v35
 v_mfma_f32_16x16x32_bf16 v[40:43], a[48:51], a[188:191], v[40:43]
 ds_read_b64_tr_b16 a[18:19], v84 offset:45056
 buffer_store_dwordx4 v[176:179], v160, s[28:31], 0 offen offset:3072 sc1
 v_mfma_f32_16x16x32_bf16 v[48:51], a[52:55], a[188:191], v[48:51]
 ds_read_b64_tr_b16 a[20:21], v85 offset:40960
 v_mfma_f32_16x16x32_bf16 v[44:47], a[52:55], a[184:187], v[44:47]
 ds_read_b64_tr_b16 a[22:23], v85 offset:45056
 v_mfma_f32_16x16x32_bf16 v[52:55], a[56:59], a[184:187], v[52:55]
 ds_read_b64_tr_b16 a[24:25], v86 offset:40960
 v_mfma_f32_16x16x32_bf16 v[56:59], a[56:59], a[188:191], v[56:59]
 ds_read_b64_tr_b16 a[26:27], v86 offset:45056
 v_mfma_f32_16x16x32_bf16 v[64:67], a[60:63], a[188:191], v[64:67]
 ds_read_b64_tr_b16 a[28:29], v87 offset:40960
 v_mfma_f32_16x16x32_bf16 v[60:63], a[60:63], a[184:187], v[60:63]
 ds_read_b64_tr_b16 a[30:31], v87 offset:45056
 v_mfma_f32_16x16x32_bf16 v[36:39], a[64:67], a[192:195], v[36:39]
 ds_read_b64_tr_b16 a[32:33], v76 offset:0
 v_mfma_f32_16x16x32_bf16 v[40:43], a[64:67], a[196:199], v[40:43]
 ds_read_b64_tr_b16 a[34:35], v76 offset:4096
 v_mfma_f32_16x16x32_bf16 v[48:51], a[68:71], a[196:199], v[48:51]
 ds_read_b64_tr_b16 a[36:37], v77 offset:0
 v_mfma_f32_16x16x32_bf16 v[44:47], a[68:71], a[192:195], v[44:47]
 ds_read_b64_tr_b16 a[38:39], v77 offset:4096
 v_mfma_f32_16x16x32_bf16 v[52:55], a[72:75], a[192:195], v[52:55]
 ds_read_b64_tr_b16 a[40:41], v78 offset:0
 v_mfma_f32_16x16x32_bf16 v[56:59], a[72:75], a[196:199], v[56:59]
 ds_read_b64_tr_b16 a[42:43], v78 offset:4096
 v_mfma_f32_16x16x32_bf16 v[64:67], a[76:79], a[196:199], v[64:67]
 ds_read_b64_tr_b16 a[44:45], v79 offset:0
 v_mfma_f32_16x16x32_bf16 v[60:63], a[76:79], a[192:195], v[60:63]
 ds_read_b64_tr_b16 a[46:47], v79 offset:4096
 s_waitcnt lgkmcnt(8)
 v_mfma_f32_16x16x32_bf16 v[36:39], a[80:83], a[200:203], v[36:39]
 ds_read_b64_tr_b16 a[48:49], v76 offset:8192
 v_mfma_f32_16x16x32_bf16 v[40:43], a[80:83], a[204:207], v[40:43]
 ds_read_b64_tr_b16 a[50:51], v76 offset:12288
 v_mfma_f32_16x16x32_bf16 v[48:51], a[84:87], a[204:207], v[48:51]
 ds_read_b64_tr_b16 a[52:53], v77 offset:8192
 v_mfma_f32_16x16x32_bf16 v[44:47], a[84:87], a[200:203], v[44:47]
 ds_read_b64_tr_b16 a[54:55], v77 offset:12288
 v_mfma_f32_16x16x32_bf16 v[52:55], a[88:91], a[200:203], v[52:55]
 ds_read_b64_tr_b16 a[56:57], v78 offset:8192
 v_mfma_f32_16x16x32_bf16 v[56:59], a[88:91], a[204:207], v[56:59]
 ds_read_b64_tr_b16 a[58:59], v78 offset:12288
 v_mfma_f32_16x16x32_bf16 v[64:67], a[92:95], a[204:207], v[64:67]
 ds_read_b64_tr_b16 a[60:61], v79 offset:8192
 v_mfma_f32_16x16x32_bf16 v[60:63], a[92:95], a[200:203], v[60:63]
 ds_read_b64_tr_b16 a[62:63], v79 offset:12288
 v_mfma_f32_16x16x32_bf16 v[36:39], a[0:3], a[208:211], v[36:39]
 ds_read_b64_tr_b16 a[64:65], v76 offset:16384
 v_mfma_f32_16x16x32_bf16 v[40:43], a[0:3], a[212:215], v[40:43]
 ds_read_b64_tr_b16 a[66:67], v76 offset:20480
 v_mfma_f32_16x16x32_bf16 v[48:51], a[4:7], a[212:215], v[48:51]
 ds_read_b64_tr_b16 a[68:69], v77 offset:16384
 v_mfma_f32_16x16x32_bf16 v[44:47], a[4:7], a[208:211], v[44:47]
 ds_read_b64_tr_b16 a[70:71], v77 offset:20480
 v_mfma_f32_16x16x32_bf16 v[52:55], a[8:11], a[208:211], v[52:55]
 ds_read_b64_tr_b16 a[72:73], v78 offset:16384
 v_mfma_f32_16x16x32_bf16 v[56:59], a[8:11], a[212:215], v[56:59]
 ds_read_b64_tr_b16 a[74:75], v78 offset:20480
 v_mfma_f32_16x16x32_bf16 v[64:67], a[12:15], a[212:215], v[64:67]
 ds_read_b64_tr_b16 a[76:77], v79 offset:16384
 v_mfma_f32_16x16x32_bf16 v[60:63], a[12:15], a[208:211], v[60:63]
 ds_read_b64_tr_b16 a[78:79], v79 offset:20480
 s_waitcnt lgkmcnt(8)
 v_mfma_f32_16x16x32_bf16 v[36:39], a[16:19], a[216:219], v[36:39]
 ds_read_b64_tr_b16 a[80:81], v76 offset:24576
 v_mfma_f32_16x16x32_bf16 v[40:43], a[16:19], a[220:223], v[40:43]
 ds_read_b64_tr_b16 a[82:83], v76 offset:28672
 v_mfma_f32_16x16x32_bf16 v[48:51], a[20:23], a[220:223], v[48:51]
 ds_read_b64_tr_b16 a[84:85], v77 offset:24576
 v_mfma_f32_16x16x32_bf16 v[44:47], a[20:23], a[216:219], v[44:47]
 ds_read_b64_tr_b16 a[86:87], v77 offset:28672
 v_mfma_f32_16x16x32_bf16 v[52:55], a[24:27], a[216:219], v[52:55]
 ds_read_b64_tr_b16 a[88:89], v78 offset:24576
 v_mfma_f32_16x16x32_bf16 v[56:59], a[24:27], a[220:223], v[56:59]
 ds_read_b64_tr_b16 a[90:91], v78 offset:28672
 v_mfma_f32_16x16x32_bf16 v[64:67], a[28:31], a[220:223], v[64:67]
 ds_read_b64_tr_b16 a[92:93], v79 offset:24576
 v_mfma_f32_16x16x32_bf16 v[60:63], a[28:31], a[216:219], v[60:63]
 ds_read_b64_tr_b16 a[94:95], v79 offset:28672
 v_mfma_f32_16x16x32_bf16 v[36:39], a[32:35], a[96:99], v[36:39]
 ds_read_b64_tr_b16 a[0:1], v76 offset:32768
 v_mfma_f32_16x16x32_bf16 v[40:43], a[32:35], a[100:103], v[40:43]
 ds_read_b64_tr_b16 a[2:3], v76 offset:36864
 v_mfma_f32_16x16x32_bf16 v[48:51], a[36:39], a[100:103], v[48:51]
 ds_read_b64_tr_b16 a[4:5], v77 offset:32768
 v_mfma_f32_16x16x32_bf16 v[44:47], a[36:39], a[96:99], v[44:47]
 ds_read_b64_tr_b16 a[6:7], v77 offset:36864
 v_mfma_f32_16x16x32_bf16 v[52:55], a[40:43], a[96:99], v[52:55]
 ds_read_b64_tr_b16 a[8:9], v78 offset:32768
 v_mfma_f32_16x16x32_bf16 v[56:59], a[40:43], a[100:103], v[56:59]
 ds_read_b64_tr_b16 a[10:11], v78 offset:36864
 v_mfma_f32_16x16x32_bf16 v[64:67], a[44:47], a[100:103], v[64:67]
 ds_read_b64_tr_b16 a[12:13], v79 offset:32768
 v_mfma_f32_16x16x32_bf16 v[60:63], a[44:47], a[96:99], v[60:63]
 ds_read_b64_tr_b16 a[14:15], v79 offset:36864
 s_waitcnt lgkmcnt(8)
 v_mfma_f32_16x16x32_bf16 v[36:39], a[48:51], a[104:107], v[36:39]
 ds_read_b64_tr_b16 a[16:17], v76 offset:40960
 v_mov_b32 v230, s59
 s_waitcnt vmcnt(0)
 buffer_store_dword v230, v162, s[28:31], 0 offen sc1
 v_mfma_f32_16x16x32_bf16 v[40:43], a[48:51], a[108:111], v[40:43]
 ds_read_b64_tr_b16 a[18:19], v76 offset:45056
 v_mfma_f32_16x16x32_bf16 v[48:51], a[52:55], a[108:111], v[48:51]
 ds_read_b64_tr_b16 a[20:21], v77 offset:40960
 v_mfma_f32_16x16x32_bf16 v[44:47], a[52:55], a[104:107], v[44:47]
 ds_read_b64_tr_b16 a[22:23], v77 offset:45056
 v_mfma_f32_16x16x32_bf16 v[52:55], a[56:59], a[104:107], v[52:55]
 ds_read_b64_tr_b16 a[24:25], v78 offset:40960
 v_mfma_f32_16x16x32_bf16 v[56:59], a[56:59], a[108:111], v[56:59]
 ds_read_b64_tr_b16 a[26:27], v78 offset:45056
 v_mfma_f32_16x16x32_bf16 v[64:67], a[60:63], a[108:111], v[64:67]
 ds_read_b64_tr_b16 a[28:29], v79 offset:40960
 v_mfma_f32_16x16x32_bf16 v[60:63], a[60:63], a[104:107], v[60:63]
 ds_read_b64_tr_b16 a[30:31], v79 offset:45056
 v_mfma_f32_16x16x32_bf16 v[36:39], a[64:67], a[112:115], v[36:39]
 ds_read_b64_tr_b16 a[32:33], v84 offset:49152
 v_mfma_f32_16x16x32_bf16 v[40:43], a[64:67], a[116:119], v[40:43]
 ds_read_b64_tr_b16 a[34:35], v84 offset:53248
 v_mfma_f32_16x16x32_bf16 v[48:51], a[68:71], a[116:119], v[48:51]
 ds_read_b64_tr_b16 a[36:37], v85 offset:49152
 v_mfma_f32_16x16x32_bf16 v[44:47], a[68:71], a[112:115], v[44:47]
 ds_read_b64_tr_b16 a[38:39], v85 offset:53248
 v_mfma_f32_16x16x32_bf16 v[52:55], a[72:75], a[112:115], v[52:55]
 ds_read_b64_tr_b16 a[40:41], v86 offset:49152
 v_mfma_f32_16x16x32_bf16 v[56:59], a[72:75], a[116:119], v[56:59]
 ds_read_b64_tr_b16 a[42:43], v86 offset:53248
 v_mfma_f32_16x16x32_bf16 v[64:67], a[76:79], a[116:119], v[64:67]
 ds_read_b64_tr_b16 a[44:45], v87 offset:49152
 v_mfma_f32_16x16x32_bf16 v[60:63], a[76:79], a[112:115], v[60:63]
 ds_read_b64_tr_b16 a[46:47], v87 offset:53248
 s_waitcnt lgkmcnt(8)
 v_mfma_f32_16x16x32_bf16 v[36:39], a[80:83], a[120:123], v[36:39]
 ds_read_b64_tr_b16 a[48:49], v84 offset:57344
 v_mfma_f32_16x16x32_bf16 v[40:43], a[80:83], a[124:127], v[40:43]
 ds_read_b64_tr_b16 a[50:51], v84 offset:61440
 v_mfma_f32_16x16x32_bf16 v[48:51], a[84:87], a[124:127], v[48:51]
 ds_read_b64_tr_b16 a[52:53], v85 offset:57344
 v_mfma_f32_16x16x32_bf16 v[44:47], a[84:87], a[120:123], v[44:47]
 ds_read_b64_tr_b16 a[54:55], v85 offset:61440
 v_mfma_f32_16x16x32_bf16 v[52:55], a[88:91], a[120:123], v[52:55]
 ds_read_b64_tr_b16 a[56:57], v86 offset:57344
 v_mfma_f32_16x16x32_bf16 v[56:59], a[88:91], a[124:127], v[56:59]
 ds_read_b64_tr_b16 a[58:59], v86 offset:61440
 v_mfma_f32_16x16x32_bf16 v[64:67], a[92:95], a[124:127], v[64:67]
 ds_read_b64_tr_b16 a[60:61], v87 offset:57344
 v_mfma_f32_16x16x32_bf16 v[60:63], a[92:95], a[120:123], v[60:63]
 ds_read_b64_tr_b16 a[62:63], v87 offset:61440
 v_mfma_f32_16x16x32_bf16 v[36:39], a[0:3], a[128:131], v[36:39]
 v_mfma_f32_16x16x32_bf16 v[40:43], a[0:3], a[132:135], v[40:43]
 v_mfma_f32_16x16x32_bf16 v[48:51], a[4:7], a[132:135], v[48:51]
 v_mfma_f32_16x16x32_bf16 v[44:47], a[4:7], a[128:131], v[44:47]
 v_mfma_f32_16x16x32_bf16 v[52:55], a[8:11], a[128:131], v[52:55]
 v_mfma_f32_16x16x32_bf16 v[56:59], a[8:11], a[132:135], v[56:59]
 v_mfma_f32_16x16x32_bf16 v[64:67], a[12:15], a[132:135], v[64:67]
 v_mfma_f32_16x16x32_bf16 v[60:63], a[12:15], a[128:131], v[60:63]
 s_waitcnt lgkmcnt(0)
 v_mfma_f32_16x16x32_bf16 v[36:39], a[16:19], a[136:139], v[36:39]
 v_mfma_f32_16x16x32_bf16 v[40:43], a[16:19], a[140:143], v[40:43]
 v_mfma_f32_16x16x32_bf16 v[48:51], a[20:23], a[140:143], v[48:51]
 v_mfma_f32_16x16x32_bf16 v[44:47], a[20:23], a[136:139], v[44:47]
 v_mfma_f32_16x16x32_bf16 v[52:55], a[24:27], a[136:139], v[52:55]
 v_mfma_f32_16x16x32_bf16 v[56:59], a[24:27], a[140:143], v[56:59]
 v_mfma_f32_16x16x32_bf16 v[64:67], a[28:31], a[140:143], v[64:67]
 v_mfma_f32_16x16x32_bf16 v[60:63], a[28:31], a[136:139], v[60:63]
 v_mfma_f32_16x16x32_bf16 v[36:39], a[32:35], a[144:147], v[36:39]
 v_mfma_f32_16x16x32_bf16 v[40:43], a[32:35], a[148:151], v[40:43]
 v_mfma_f32_16x16x32_bf16 v[48:51], a[36:39], a[148:151], v[48:51]
 v_mfma_f32_16x16x32_bf16 v[44:47], a[36:39], a[144:147], v[44:47]
 v_mfma_f32_16x16x32_bf16 v[52:55], a[40:43], a[144:147], v[52:55]
 v_mfma_f32_16x16x32_bf16 v[56:59], a[40:43], a[148:151], v[56:59]
 v_mfma_f32_16x16x32_bf16 v[64:67], a[44:47], a[148:151], v[64:67]
 v_mfma_f32_16x16x32_bf16 v[60:63], a[44:47], a[144:147], v[60:63]
 v_mfma_f32_16x16x32_bf16 v[36:39], a[48:51], a[152:155], v[36:39]
 v_mfma_f32_16x16x32_bf16 v[40:43], a[48:51], a[156:159], v[40:43]
 v_mfma_f32_16x16x32_bf16 v[48:51], a[52:55], a[156:159], v[48:51]
 v_mfma_f32_16x16x32_bf16 v[44:47], a[52:55], a[152:155], v[44:47]
 v_mfma_f32_16x16x32_bf16 v[52:55], a[56:59], a[152:155], v[52:55]
 v_mfma_f32_16x16x32_bf16 v[56:59], a[56:59], a[156:159], v[56:59]
 v_mfma_f32_16x16x32_bf16 v[64:67], a[60:63], a[156:159], v[64:67]
 v_mfma_f32_16x16x32_bf16 v[60:63], a[60:63], a[152:155], v[60:63]
 v_lshlrev_b32 v124, 16, v88
 v_and_b32 v125, 0xffff0000, v88
 v_lshlrev_b32 v126, 16, v89
 v_and_b32 v127, 0xffff0000, v89
 v_pk_fma_f32 v[36:37], v[36:37], v[104:105], v[124:125]
 v_pk_fma_f32 v[38:39], v[38:39], v[106:107], v[126:127]
 v_lshlrev_b32 v124, 16, v90
 v_and_b32 v125, 0xffff0000, v90
 v_lshlrev_b32 v126, 16, v91
 v_and_b32 v127, 0xffff0000, v91
 v_pk_fma_f32 v[44:45], v[44:45], v[108:109], v[124:125]
 v_pk_fma_f32 v[46:47], v[46:47], v[110:111], v[126:127]
 v_lshlrev_b32 v124, 16, v92
 v_and_b32 v125, 0xffff0000, v92
 v_lshlrev_b32 v126, 16, v93
 v_and_b32 v127, 0xffff0000, v93
 v_pk_fma_f32 v[52:53], v[52:53], v[112:113], v[124:125]
 v_pk_fma_f32 v[54:55], v[54:55], v[114:115], v[126:127]
 v_lshlrev_b32 v124, 16, v94
 v_and_b32 v125, 0xffff0000, v94
 v_lshlrev_b32 v126, 16, v95
 v_and_b32 v127, 0xffff0000, v95
 v_pk_fma_f32 v[60:61], v[60:61], v[116:117], v[124:125]
 v_pk_fma_f32 v[62:63], v[62:63], v[118:119], v[126:127]
 v_lshlrev_b32 v124, 16, v96
 v_and_b32 v125, 0xffff0000, v96
 v_lshlrev_b32 v126, 16, v97
 v_and_b32 v127, 0xffff0000, v97
 v_pk_fma_f32 v[40:41], v[40:41], v[104:105], v[124:125]
 v_pk_fma_f32 v[42:43], v[42:43], v[106:107], v[126:127]
 v_lshlrev_b32 v124, 16, v98
 v_and_b32 v125, 0xffff0000, v98
 v_lshlrev_b32 v126, 16, v99
 v_and_b32 v127, 0xffff0000, v99
 v_pk_fma_f32 v[48:49], v[48:49], v[108:109], v[124:125]
 v_pk_fma_f32 v[50:51], v[50:51], v[110:111], v[126:127]
 v_lshlrev_b32 v124, 16, v100
 v_and_b32 v125, 0xffff0000, v100
 v_lshlrev_b32 v126, 16, v101
 v_and_b32 v127, 0xffff0000, v101
 v_pk_fma_f32 v[56:57], v[56:57], v[112:113], v[124:125]
 v_pk_fma_f32 v[58:59], v[58:59], v[114:115], v[126:127]
 v_lshlrev_b32 v124, 16, v102
 v_and_b32 v125, 0xffff0000, v102
 v_lshlrev_b32 v126, 16, v103
 v_and_b32 v127, 0xffff0000, v103
 v_pk_fma_f32 v[64:65], v[64:65], v[116:117], v[124:125]
 v_pk_fma_f32 v[66:67], v[66:67], v[118:119], v[126:127]
 s_mov_b32 s16, 0x8000
m_kernel_poll11:
 buffer_load_dword v230, v163, s[28:31], 0 offen sc1
 s_sub_u32 s16, s16, 1
 s_waitcnt vmcnt(0)
 v_cmp_ne_u32 vcc, s59, v230
 s_nop 0
 s_cselect_b64 vcc, 0, vcc
 s_cbranch_vccnz m_kernel_poll11
 buffer_load_dwordx4 v[128:131], v161, s[28:31], 0 offen sc1
 buffer_load_dwordx4 v[132:135], v161, s[28:31], 0 offen offset:1024 sc1
 buffer_load_dwordx4 v[136:139], v161, s[28:31], 0 offen offset:2048 sc1
 buffer_load_dwordx4 v[140:143], v161, s[28:31], 0 offen offset:3072 sc1
 s_waitcnt vmcnt(3)
 v_lshlrev_b32 v124, 16, v128
 v_and_b32 v125, 0xffff0000, v128
 v_lshlrev_b32 v126, 16, v129
 v_and_b32 v127, 0xffff0000, v129
 v_pk_fma_f32 v[36:37], v[124:125], v[104:105], v[36:37]
 v_pk_fma_f32 v[38:39], v[126:127], v[106:107], v[38:39]
 v_cvt_pk_bf16_f32 v88, v36, v37
 v_cvt_pk_bf16_f32 v89, v38, v39
 s_waitcnt vmcnt(2)
 v_lshlrev_b32 v124, 16, v132
 v_and_b32 v125, 0xffff0000, v132
 v_lshlrev_b32 v126, 16, v133
 v_and_b32 v127, 0xffff0000, v133
 v_pk_fma_f32 v[44:45], v[124:125], v[108:109], v[44:45]
 v_pk_fma_f32 v[46:47], v[126:127], v[110:111], v[46:47]
 v_cvt_pk_bf16_f32 v90, v44, v45
 v_cvt_pk_bf16_f32 v91, v46, v47
 s_nop 0
 v_permlane16_swap_b32 v88, v90
 v_permlane16_swap_b32 v89, v91
 buffer_store_dwordx4 v[88:91], v120, s[20:23], 0 offen offset:0
 s_waitcnt vmcnt(2)
 v_lshlrev_b32 v124, 16, v136
 v_and_b32 v125, 0xffff0000, v136
 v_lshlrev_b32 v126, 16, v137
 v_and_b32 v127, 0xffff0000, v137
 v_pk_fma_f32 v[52:53], v[124:125], v[112:113], v[52:53]
 v_pk_fma_f32 v[54:55], v[126:127], v[114:115], v[54:55]
 v_cvt_pk_bf16_f32 v92, v52, v53
 v_cvt_pk_bf16_f32 v93, v54, v55
 s_waitcnt vmcnt(1)
 v_lshlrev_b32 v124, 16, v140
 v_and_b32 v125, 0xffff0000, v140
 v_lshlrev_b32 v126, 16, v141
 v_and_b32 v127, 0xffff0000, v141
 v_pk_fma_f32 v[60:61], v[124:125], v[116:117], v[60:61]
 v_pk_fma_f32 v[62:63], v[126:127], v[118:119], v[62:63]
 v_cvt_pk_bf16_f32 v94, v60, v61
 v_cvt_pk_bf16_f32 v95, v62, v63
 s_nop 0
 v_permlane16_swap_b32 v92, v94
 v_permlane16_swap_b32 v93, v95
 buffer_store_dwordx4 v[92:95], v120, s[20:23], 0 offen offset:64
 v_lshlrev_b32 v124, 16, v130
 v_and_b32 v125, 0xffff0000, v130
 v_lshlrev_b32 v126, 16, v131
 v_and_b32 v127, 0xffff0000, v131
 v_pk_fma_f32 v[40:41], v[124:125], v[104:105], v[40:41]
 v_pk_fma_f32 v[42:43], v[126:127], v[106:107], v[42:43]
 v_cvt_pk_bf16_f32 v96, v40, v41
 v_cvt_pk_bf16_f32 v97, v42, v43
 v_lshlrev_b32 v124, 16, v134
 v_and_b32 v125, 0xffff0000, v134
 v_lshlrev_b32 v126, 16, v135
 v_and_b32 v127, 0xffff0000, v135
 v_pk_fma_f32 v[48:49], v[124:125], v[108:109], v[48:49]
 v_pk_fma_f32 v[50:51], v[126:127], v[110:111], v[50:51]
 v_cvt_pk_bf16_f32 v98, v48, v49
 v_cvt_pk_bf16_f32 v99, v50, v51
 s_nop 0
 v_permlane16_swap_b32 v96, v98
 v_permlane16_swap_b32 v97, v99
 buffer_store_dwordx4 v[96:99], v120, s[20:23], s42 offen offset:0
 v_lshlrev_b32 v124, 16, v138
 v_and_b32 v125, 0xffff0000, v138
 v_lshlrev_b32 v126, 16, v139
 v_and_b32 v127, 0xffff0000, v139
 v_pk_fma_f32 v[56:57], v[124:125], v[112:113], v[56:57]
 v_pk_fma_f32 v[58:59], v[126:127], v[114:115], v[58:59]
 v_cvt_pk_bf16_f32 v100, v56, v57
 v_cvt_pk_bf16_f32 v101, v58, v59
 v_lshlrev_b32 v124, 16, v142
 v_and_b32 v125, 0xffff0000, v142
 v_lshlrev_b32 v126, 16, v143
 v_and_b32 v127, 0xffff0000, v143
 v_pk_fma_f32 v[64:65], v[124:125], v[116:117], v[64:65]
 v_pk_fma_f32 v[66:67], v[126:127], v[118:119], v[66:67]
 v_cvt_pk_bf16_f32 v102, v64, v65
 v_cvt_pk_bf16_f32 v103, v66, v67
 s_nop 0
 v_permlane16_swap_b32 v100, v102
 v_permlane16_swap_b32 v101, v103
 buffer_store_dwordx4 v[100:103], v120, s[20:23], s42 offen offset:64
 s_endpgm
m_kernel_fb:
 s_waitcnt vmcnt(0) lgkmcnt(0)
 s_add_u32 s28, s8, 0x300000
 s_addc_u32 s29, s9, 0
 s_mov_b32 s30, 0x40000
 s_mov_b32 s31, 0x00020000
 s_mov_b32 s12, 1
 s_mov_b32 s18, 0
 v_mov_b32 v1, 0xff800000
 v_mov_b32 v2, 0xff800000
m_kernel_fbl:
 buffer_load_dwordx4 v[212:215], v221, s[28:31], s18 offen offset:0 sc1
 buffer_load_dwordx4 v[216:219], v221, s[28:31], s18 offen offset:1024 sc1
 s_waitcnt vmcnt(1)
 v_mfma_f32_32x32x16_bf16 v[48:63], v[212:215], v[168:171], 0
 v_mfma_f32_32x32x16_bf16 v[64:79], v[212:215], v[176:179], 0
 s_waitcnt vmcnt(0)
 v_mfma_f32_32x32x16_bf16 v[48:63], v[216:219], v[172:175], v[48:63]
 v_mfma_f32_32x32x16_bf16 v[64:79], v[216:219], v[180:183], v[64:79]
 s_nop 10
 v_max3_f32 v1, v48, v49, v1
 v_max3_f32 v1, v50, v51, v1
 v_max3_f32 v1, v52, v53, v1
 v_max3_f32 v1, v54, v55, v1
 v_max3_f32 v1, v56, v57, v1
 v_max3_f32 v1, v58, v59, v1
 v_max3_f32 v1, v60, v61, v1
 v_max3_f32 v1, v62, v63, v1
 v_max3_f32 v2, v64, v65, v2
 v_max3_f32 v2, v66, v67, v2
 v_max3_f32 v2, v68, v69, v2
 v_max3_f32 v2, v70, v71, v2
 v_max3_f32 v2, v72, v73, v2
 v_max3_f32 v2, v74, v75, v2
 v_max3_f32 v2, v76, v77, v2
 v_max3_f32 v2, v78, v79, v2
 s_add_u32 s18, s18, 4096
 s_cmp_lt_u32 s18, 0x40000
 s_cbranch_scc1 m_kernel_fbl
 v_mov_b32 v3, v1
 s_nop 1
 v_permlane32_swap_b32 v1, v3
 v_max_f32 v1, v1, v3
 v_sub_f32 v80, 0x80000000, v1
 v_mov_b32 v81, v80
 v_mov_b32 v82, v80
 v_mov_b32 v83, v80
 v_mov_b32 v84, v80
 v_mov_b32 v85, v80
 v_mov_b32 v86, v80
 v_mov_b32 v87, v80
 v_mov_b32 v88, v80
 v_mov_b32 v89, v80
 v_mov_b32 v90, v80
 v_mov_b32 v91, v80
 v_mov_b32 v92, v80
 v_mov_b32 v93, v80
 v_mov_b32 v94, v80
 v_mov_b32 v95, v80
 v_mov_b32 v3, v2
 s_nop 1
 v_permlane32_swap_b32 v2, v3
 v_max_f32 v2, v2, v3
 v_sub_f32 v96, 0x80000000, v2
 v_mov_b32 v97, v96
 v_mov_b32 v98, v96
 v_mov_b32 v99, v96
 v_mov_b32 v100, v96
 v_mov_b32 v101, v96
 v_mov_b32 v102, v96
 v_mov_b32 v103, v96
 v_mov_b32 v104, v96
 v_mov_b32 v105, v96
 v_mov_b32 v106, v96
 v_mov_b32 v107, v96
 v_mov_b32 v108, v96
 v_mov_b32 v109, v96
 v_mov_b32 v110, v96
 v_mov_b32 v111, v96
 buffer_load_dwordx4 v[212:215], v221, s[28:31], 0 offen offset:0 sc1
 buffer_load_dwordx4 v[216:219], v221, s[28:31], 0 offen offset:1024 sc1
 s_add_u32 m0, s56, 0
 s_mov_b32 s42, s6
 buffer_load_dwordx4 v221, s[28:31], s42 offen offset:0 sc1 lds
 buffer_load_dwordx4 v221, s[28:31], s42 offen offset:1024 sc1 lds
 buffer_load_dwordx4 v221, s[28:31], s42 offen offset:2048 sc1 lds
 buffer_load_dwordx4 v221, s[28:31], s42 offen offset:3072 sc1 lds
 s_add_u32 m0, s56, 16384
 s_add_u32 s42, s42, 16384
 buffer_load_dwordx4 v221, s[28:31], s42 offen offset:0 sc1 lds
 buffer_load_dwordx4 v221, s[28:31], s42 offen offset:1024 sc1 lds
 buffer_load_dwordx4 v221, s[28:31], s42 offen offset:2048 sc1 lds
 buffer_load_dwordx4 v221, s[28:31], s42 offen offset:3072 sc1 lds
 s_add_u32 m0, s56, 32768
 s_add_u32 s42, s42, 16384
 buffer_load_dwordx4 v221, s[28:31], s42 offen offset:0 sc1 lds
 buffer_load_dwordx4 v221, s[28:31], s42 offen offset:1024 sc1 lds
 buffer_load_dwordx4 v221, s[28:31], s42 offen offset:2048 sc1 lds
 buffer_load_dwordx4 v221, s[28:31], s42 offen offset:3072 sc1 lds
 s_add_u32 m0, s56, 49152
 s_add_u32 s42, s42, 16384
 buffer_load_dwordx4 v221, s[28:31], s42 offen offset:0 sc1 lds
 buffer_load_dwordx4 v221, s[28:31], s42 offen offset:1024 sc1 lds
 buffer_load_dwordx4 v221, s[28:31], s42 offen offset:2048 sc1 lds
 buffer_load_dwordx4 v221, s[28:31], s42 offen offset:3072 sc1 lds
 s_waitcnt vmcnt(0)
 s_nop 1
 s_branch m_kernel_att
m_kernel_end:
 s_endpgm
.section .rodata,"a"
.p2align 6
.amdhsa_kernel m_kernel
  .amdhsa_next_free_vgpr 512
  .amdhsa_next_free_sgpr 102
  .amdhsa_accum_offset 256
  .amdhsa_group_segment_fixed_size 0
  .amdhsa_kernarg_size 112
  .amdhsa_user_sgpr_count 2
  .amdhsa_user_sgpr_kernarg_segment_ptr 1
  .amdhsa_system_sgpr_workgroup_id_x 1
.end_amdhsa_kernel
```
